```python
import torch

def _softmax(x, axis=-1):
    return torch.softmax(x, dim=axis)

def _gelu(x):
    return torch.nn.functional.gelu(x, approximate='tanh')

def _silu(x):
    return torch.nn.functional.silu(x)

def _sigmoid(x):
    return torch.sigmoid(x)

def _layernorm(x, axis=-1, eps=1e-05):
    m = x.mean(dim=axis, keepdim=True)
    v = x.var(dim=axis, keepdim=True, unbiased=False)
    return (x - m) / torch.sqrt(v + eps)

def _scatter_add(tgt, idx, src, axis=0):
    return tgt.clone().index_add_(axis, idx, src)

def _segment_sum(src, seg, n):
    out = torch.zeros((n,) + src.shape[1:], dtype=src.dtype)
    return out.index_add_(0, seg, src)

def _pad(x, pw):
    flat = tuple((v for pair in reversed(pw) for v in pair))
    return torch.nn.functional.pad(x, flat)
kernel_name = 'parallel_sum__memory_aug_recurrent_mem_tr__mixer_token_mlp__prompt'

def setup_inputs():

    _w = lambda a: (lambda t: t.to(torch.bfloat16) if t.is_floating_point() else t)(torch.as_tensor(a))

    def _A_setup():
        B, S, Dm = (1, 2048, 512)
        H, Dh = (32, 128)
        M, seg = (8, 32)
        seg = min(seg, S)
        S = S // seg * seg
        return {'x': _w((lambda *s: torch.randn(*s, dtype=torch.bfloat16) * 0.05)(B, S, Dm)), 'mem0': _w((lambda *s: torch.randn(*s, dtype=torch.bfloat16) * 0.2)(B, M, Dm)), 'Wq': _w((lambda *s: torch.randn(*s, dtype=torch.bfloat16) * 1.6)(Dm, H, Dh) * Dm ** (-0.5)), 'Wk': _w((lambda *s: torch.randn(*s, dtype=torch.bfloat16) * 1.6)(Dm, H, Dh) * Dm ** (-0.5)), 'Wv': _w((lambda *s: torch.randn(*s, dtype=torch.bfloat16) * 0.2)(Dm, H, Dh) * Dm ** (-0.5)), 'Wo': _w((lambda *s: torch.randn(*s, dtype=torch.bfloat16) * 0.2)(H, Dh, Dm) * (H * Dh) ** (-0.5)), 'seg_len': seg}
    _A_in = _A_setup()

    def _B_setup():
        B, S, D, F = (1, 2048, 512, 1792)
        return {'x': _w((lambda *s: torch.randn(*s, dtype=torch.bfloat16) * 0.05)(B, S, D)), 'w1': _w((lambda *s: torch.randn(*s, dtype=torch.bfloat16) * 0.4)(S, F) * S ** (-0.5)), 'b1': _w((lambda *s: torch.randn(*s, dtype=torch.bfloat16) * 3.2)(F) * 0.02), 'w2': _w((lambda *s: torch.randn(*s, dtype=torch.bfloat16) * 0.2)(F, S) * F ** (-0.5)), 'b2': _w((lambda *s: torch.randn(*s, dtype=torch.bfloat16) * 0.4)(S) * 0.02)}
    _B_in = _B_setup()
    return {'A_x': _A_in['x'], 'A_mem0': _A_in['mem0'], 'A_Wq': _A_in['Wq'], 'A_Wk': _A_in['Wk'], 'A_Wv': _A_in['Wv'], 'A_Wo': _A_in['Wo'], 'A_seg_len': _A_in['seg_len'], 'B_x': _B_in['x'], 'B_w1': _B_in['w1'], 'B_b1': _B_in['b1'], 'B_w2': _B_in['w2'], 'B_b2': _B_in['b2']}

def reference(A_x, A_mem0, A_Wq, A_Wk, A_Wv, A_Wo, A_seg_len, B_x, B_w1, B_b1, B_w2, B_b2):

    def _A_ref(x, mem0, Wq, Wk, Wv, Wo, seg_len):
        B, S, Dm = x.shape
        H, Dh = (Wq.shape[1], Wq.shape[2])
        M = mem0.shape[1]
        scale = Dh ** (-0.5)
        n_seg = S // seg_len
        L = M + seg_len
        idx = torch.arange(L)
        mask = (idx[:, None] < M) | (idx[:, None] >= idx[None, :])
        mem = mem0
        outs = []
        for s in range(n_seg):
            xs = x[:, s * seg_len:(s + 1) * seg_len, :].clone()
            h = torch.concatenate([mem, xs], axis=1)
            q = torch.einsum('btd,dhe->bhte', h, Wq)
            k = torch.einsum('btd,dhe->bhte', h, Wk)
            v = torch.einsum('btd,dhe->bhte', h, Wv)
            scores = torch.einsum('bhqe,bhke->bhqk', q, k) * scale
            scores = torch.where(mask[None, None], scores, -1000000000.0)
            p = _softmax(scores, axis=-1)
            o = torch.einsum('bhqk,bhke->bhqe', p, v)
            o = torch.einsum('bhte,hed->btd', o, Wo)
            mem = o[:, :M, :].clone()
            outs.append(o[:, M:, :])
        return torch.concatenate(outs, axis=1)

    def _B_ref(x, w1, b1, w2, b2):
        B, S, D = x.shape
        h = _layernorm(x, axis=-1)
        u = torch.einsum('bsd,sf->bdf', h, w1) + b1
        u = _gelu(u)
        y = torch.einsum('bdf,fs->bds', u, w2) + b2
        return (lambda x, *d: x.permute(*d))(y, 0, 2, 1)
    x = A_x
    xn = _layernorm(x, axis=-1)
    return x + _A_ref(xn, A_mem0, A_Wq, A_Wk, A_Wv, A_Wo, A_seg_len) + _B_ref(xn, B_w1, B_b1, B_w2, B_b2)
```

```asm
; @launch grid=(256,1,1) block=(256,1,1) lds=163840
.amdgcn_target "amdgcn-amd-amdhsa--gfx950"
.text
.globl parallel_sum__memory_aug_recurrent_mem_tr__mixer_token_mlp__prompt_kernel
.p2align 8
.type parallel_sum__memory_aug_recurrent_mem_tr__mixer_token_mlp__prompt_kernel,@function
parallel_sum__memory_aug_recurrent_mem_tr__mixer_token_mlp__prompt_kernel:
    s_cmp_ge_u32 s2, 256
    s_cbranch_scc1 L_exit
    s_load_dwordx16 s[64:79], s[0:1], 0
    s_load_dwordx8 s[80:87], s[0:1], 64
    s_load_dwordx4 s[88:91], s[0:1], 96
    s_load_dwordx2 s[92:93], s[0:1], 112
    s_mov_b32 s100, 0
    s_getreg_b32 s3, hwreg(HW_REG_XCC_ID)
    s_and_b32 s3, s3, 15
    v_lshrrev_b32 v1, 6, v0
    v_and_b32 v0, 63, v0
    v_readfirstlane_b32 s28, v1
    s_waitcnt lgkmcnt(0)
    s_mov_b32 s4, s92
    s_mov_b32 s5, s93
    s_mov_b32 s6, 0x10000000
    s_mov_b32 s7, 0x20000
    s_mov_b32 s8, s90
    s_mov_b32 s9, s91
    s_mov_b32 s10, 0x100
    s_mov_b32 s11, 0x20000
    s_mov_b32 s12, s64
    s_mov_b32 s13, s65
    s_mov_b32 s14, 0x200000
    s_mov_b32 s15, 0x20000
    v_lshrrev_b32 v1, 5, v0
    s_lshl_b32 s52, s28, 1
    v_add_u32 v1, s52, v1
    v_and_b32 v12, 31, v0
    v_lshlrev_b32 v13, 10, v1
    v_lshl_add_u32 v13, v12, 5, v13
    s_lshl_b32 s52, s2, 13
    buffer_load_dwordx4 v[4:7], v13, s[12:15], s52 offen
    buffer_load_dwordx4 v[8:11], v13, s[12:15], s52 offen offset:16
    s_mov_b32 s60, 0x05040100
    s_mov_b32 s61, 0x07060302
    s_mov_b32 s62, 0xffff0000
    s_cmp_lg_u32 s28, 0
    s_cbranch_scc1 L_role_wait0
    s_cmp_lg_u32 s3, 0
    s_cbranch_scc1 L_role_worker
    v_mov_b32 v2, 1
    v_mov_b32 v3, 0
    s_mov_b64 exec, 1
    buffer_atomic_add v2, v3, s[8:11], 0 offen sc0
    s_mov_b64 exec, -1
    s_waitcnt vmcnt(0)
    v_readfirstlane_b32 s29, v2
    s_cmp_lt_u32 s29, 32
    s_cbranch_scc1 L_role_done
L_role_worker:
    v_mov_b32 v2, 1
    v_mov_b32 v3, 128
    s_mov_b64 exec, 1
    buffer_atomic_add v2, v3, s[8:11], 0 offen sc0
    s_mov_b64 exec, -1
    s_waitcnt vmcnt(0)
    v_readfirstlane_b32 s29, v2
    s_add_u32 s29, s29, 32
    s_cmp_lt_u32 s29, 256
    s_cbranch_scc1 L_role_done
    v_mov_b32 v2, 1
    v_mov_b32 v3, 0
    s_mov_b64 exec, 1
    buffer_atomic_add v2, v3, s[8:11], 0 offen sc0
    s_mov_b64 exec, -1
    s_waitcnt vmcnt(0)
    v_readfirstlane_b32 s29, v2
    s_cmp_lt_u32 s29, 32
    s_cselect_b32 s29, s29, 256
L_role_done:
    v_mov_b32 v2, s29
    v_mov_b32 v3, 163832
    ds_write_b32 v3, v2
    s_waitcnt lgkmcnt(0)
L_role_wait0:
    s_waitcnt vmcnt(0)
L_role_wait:
    s_barrier
    v_mov_b32 v3, 163832
    ds_read_b32 v2, v3
    s_waitcnt lgkmcnt(0)
    v_readfirstlane_b32 s29, v2
    s_cmp_ge_u32 s29, 256
    s_cbranch_scc1 L_exit
    s_cmp_ge_u32 s29, 32
    s_cbranch_scc0 L_chain
    s_branch L_worker
L_exit:
    s_endpgm
L_chain:
    s_mov_b32 s12, s68
    s_mov_b32 s13, s69
    s_mov_b32 s14, 0x400000
    s_mov_b32 s15, 0x20000
    s_mov_b32 s16, s70
    s_mov_b32 s17, s71
    s_mov_b32 s18, 0x400000
    s_mov_b32 s19, 0x20000
    s_mov_b32 s20, s72
    s_mov_b32 s21, s73
    s_mov_b32 s22, 0x400000
    s_mov_b32 s23, 0x20000
    s_mov_b32 s24, s66
    s_mov_b32 s25, s67
    s_mov_b32 s26, 0x2000
    s_mov_b32 s27, 0x20000
    v_and_b32 v2, 15, v0
    v_lshrrev_b32 v3, 4, v0
    v_lshrrev_b32 v14, 2, v0
    v_xor_b32 v14, s28, v14
    v_and_b32 v15, 1, v14
    v_and_b32 v14, 14, v14
    v_lshlrev_b32 v14, 5, v14
    v_lshl_add_u32 v14, v15, 3, v14
    v_and_b32 v15, 3, v0
    v_lshl_add_u32 v14, v15, 10, v14
    s_and_b32 s45, s28, 1
    s_lshl_b32 s45, s45, 12
    v_lshrrev_b32 v12, 5, v0
    v_lshlrev_b32 v12, 2, v12
    v_bfe_u32 v13, v0, 4, 1
    v_lshl_add_u32 v12, v13, 1, v12
    v_bfe_u32 v13, v0, 3, 1
    v_add_u32 v12, v13, v12
    v_bfe_u32 v13, v0, 2, 1
    v_lshl_add_u32 v12, v13, 4, v12
    v_lshlrev_b32 v12, 13, v12
    v_and_b32 v13, 3, v0
    v_lshl_add_u32 v12, v13, 4, v12
    s_lshl_b32 s46, s29, 8
    s_lshl_b32 s30, s28, 6
    s_add_u32 s46, s46, s30
    v_add_u32 v57, s46, v12
    s_lshl_b32 s55, s28, 15
    buffer_load_dwordx2 v[88:89], v14, s[24:27], s45 offen offset:0
    buffer_load_dwordx2 v[90:91], v14, s[24:27], s45 offen offset:16
    buffer_load_dwordx2 v[92:93], v14, s[24:27], s45 offen offset:32
    buffer_load_dwordx2 v[94:95], v14, s[24:27], s45 offen offset:48
    buffer_load_dwordx2 v[96:97], v14, s[24:27], s45 offen offset:512
    buffer_load_dwordx2 v[98:99], v14, s[24:27], s45 offen offset:528
    buffer_load_dwordx2 v[100:101], v14, s[24:27], s45 offen offset:544
    buffer_load_dwordx2 v[102:103], v14, s[24:27], s45 offen offset:560
    s_mov_b32 s24, s74
    s_mov_b32 s25, s75
    s_mov_b32 s26, 0x400000
    s_mov_b32 s27, 0x20000
    s_cmp_lg_u32 s28, 0
    s_cbranch_scc1 L_ci_1
    s_cmp_lg_u32 s3, 0
    s_cselect_b32 s56, 0x10001, 1
    v_mov_b32 v20, s56
    v_mov_b32 v21, 4
    s_mov_b64 exec, 1
    buffer_atomic_add v20, v21, s[8:11], 0 offen
    s_mov_b64 exec, -1
    s_add_u32 s56, s2, 1
    s_lshl_b32 s57, s29, 1
    s_add_u32 s57, s57, 192
    v_mov_b32 v22, s56
    v_mov_b32 v23, s57
    s_mov_b64 exec, 1
    buffer_store_short v22, v23, s[8:11], 0 offen sc1
    s_mov_b64 exec, -1
L_ci_1:
    s_add_u32 m0, s55, 0
    s_mov_b32 s45, 0x0
    buffer_load_dwordx4 v57, s[12:15], s45 offen lds
    s_add_u32 m0, s55, 1024
    s_mov_b32 s45, 0x10000
    buffer_load_dwordx4 v57, s[12:15], s45 offen lds
    s_add_u32 m0, s55, 2048
    s_mov_b32 s45, 0x40000
    buffer_load_dwordx4 v57, s[12:15], s45 offen lds
    s_add_u32 m0, s55, 3072
    s_mov_b32 s45, 0x50000
    buffer_load_dwordx4 v57, s[12:15], s45 offen lds
    s_add_u32 m0, s55, 4096
    s_mov_b32 s45, 0x80000
    buffer_load_dwordx4 v57, s[12:15], s45 offen lds
    s_add_u32 m0, s55, 5120
    s_mov_b32 s45, 0x90000
    buffer_load_dwordx4 v57, s[12:15], s45 offen lds
    s_add_u32 m0, s55, 6144
    s_mov_b32 s45, 0xc0000
    buffer_load_dwordx4 v57, s[12:15], s45 offen lds
    s_add_u32 m0, s55, 7168
    s_mov_b32 s45, 0xd0000
    buffer_load_dwordx4 v57, s[12:15], s45 offen lds
    s_add_u32 m0, s55, 8192
    s_mov_b32 s45, 0x100000
    buffer_load_dwordx4 v57, s[12:15], s45 offen lds
    s_add_u32 m0, s55, 9216
    s_mov_b32 s45, 0x110000
    buffer_load_dwordx4 v57, s[12:15], s45 offen lds
    s_add_u32 m0, s55, 10240
    s_mov_b32 s45, 0x140000
    buffer_load_dwordx4 v57, s[12:15], s45 offen lds
    s_add_u32 m0, s55, 11264
    s_mov_b32 s45, 0x150000
    buffer_load_dwordx4 v57, s[12:15], s45 offen lds
    s_add_u32 m0, s55, 12288
    s_mov_b32 s45, 0x180000
    buffer_load_dwordx4 v57, s[12:15], s45 offen lds
    s_add_u32 m0, s55, 13312
    s_mov_b32 s45, 0x190000
    buffer_load_dwordx4 v57, s[12:15], s45 offen lds
    s_add_u32 m0, s55, 14336
    s_mov_b32 s45, 0x1c0000
    buffer_load_dwordx4 v57, s[12:15], s45 offen lds
    s_add_u32 m0, s55, 15360
    s_mov_b32 s45, 0x1d0000
    buffer_load_dwordx4 v57, s[12:15], s45 offen lds
    s_add_u32 m0, s55, 16384
    s_mov_b32 s45, 0x200000
    buffer_load_dwordx4 v57, s[12:15], s45 offen lds
    s_add_u32 m0, s55, 17408
    s_mov_b32 s45, 0x210000
    buffer_load_dwordx4 v57, s[12:15], s45 offen lds
    s_add_u32 m0, s55, 18432
    s_mov_b32 s45, 0x240000
    buffer_load_dwordx4 v57, s[12:15], s45 offen lds
    s_add_u32 m0, s55, 19456
    s_mov_b32 s45, 0x250000
    buffer_load_dwordx4 v57, s[12:15], s45 offen lds
    s_add_u32 m0, s55, 20480
    s_mov_b32 s45, 0x280000
    buffer_load_dwordx4 v57, s[12:15], s45 offen lds
    s_add_u32 m0, s55, 21504
    s_mov_b32 s45, 0x290000
    buffer_load_dwordx4 v57, s[12:15], s45 offen lds
    s_add_u32 m0, s55, 22528
    s_mov_b32 s45, 0x2c0000
    buffer_load_dwordx4 v57, s[12:15], s45 offen lds
    s_add_u32 m0, s55, 23552
    s_mov_b32 s45, 0x2d0000
    buffer_load_dwordx4 v57, s[12:15], s45 offen lds
    s_add_u32 m0, s55, 24576
    s_mov_b32 s45, 0x300000
    buffer_load_dwordx4 v57, s[12:15], s45 offen lds
    s_add_u32 m0, s55, 25600
    s_mov_b32 s45, 0x310000
    buffer_load_dwordx4 v57, s[12:15], s45 offen lds
    s_add_u32 m0, s55, 26624
    s_mov_b32 s45, 0x340000
    buffer_load_dwordx4 v57, s[12:15], s45 offen lds
    s_add_u32 m0, s55, 27648
    s_mov_b32 s45, 0x350000
    buffer_load_dwordx4 v57, s[12:15], s45 offen lds
    s_add_u32 m0, s55, 28672
    s_mov_b32 s45, 0x380000
    buffer_load_dwordx4 v57, s[12:15], s45 offen lds
    s_add_u32 m0, s55, 29696
    s_mov_b32 s45, 0x390000
    buffer_load_dwordx4 v57, s[12:15], s45 offen lds
    s_add_u32 m0, s55, 30720
    s_mov_b32 s45, 0x3c0000
    buffer_load_dwordx4 v57, s[12:15], s45 offen lds
    s_add_u32 m0, s55, 31744
    s_mov_b32 s45, 0x3d0000
    buffer_load_dwordx4 v57, s[12:15], s45 offen lds
    v_lshlrev_b32 v1, 4, v0
    v_add_u32 v104, 131072, v1
    s_lshl_b32 s45, s28, 11
    v_add_u32 v56, s45, v104
    s_lshl_b32 s45, s28, 15
    v_add_u32 v106, s45, v1
    v_mov_b32 v12, 0x8888
    v_mov_b32 v13, 0xdddd
    v_cmp_gt_u32 vcc, 8, v2
    s_nop 1
    v_cndmask_b32 v107, v13, v12, vcc
    v_lshrrev_b32 v12, 2, v2
    v_lshlrev_b32 v12, 1, v12
    s_lshl_b32 s45, s28, 3
    v_add_u32 v12, s45, v12
    v_add_u32 v13, s29, v12
    v_and_b32 v13, 31, v13
    v_lshlrev_b32 v13, 6, v13
    v_lshl_add_u32 v13, v12, 13, v13
    v_and_b32 v12, 3, v2
    v_lshl_add_u32 v13, v12, 4, v13
    v_lshl_add_u32 v108, v3, 11, v13
    v_lshlrev_b32 v13, 2, v12
    v_lshl_add_u32 v13, v3, 4, v13
    s_xor_b32 s45, s29, s28
    s_lshl_b32 s45, s45, 6
    s_lshl_b32 s46, s28, 11
    s_add_u32 s45, s45, s46
    v_add_u32 v109, s45, v13
    v_mov_b32 v12, 0x7f000000
    v_cmp_gt_u32 vcc, 4, v2
    s_nop 1
    v_cndmask_b32 v109, v12, v109, vcc
    v_and_b32 v12, 7, v2
    v_lshlrev_b32 v12, 4, v12
    v_lshl_add_u32 v12, v3, 7, v12
    v_add_u32 v105, 131072, v12
    v_bfe_u32 v12, v2, 2, 1
    v_and_b32 v13, 1, v3
    v_lshl_add_u32 v14, v13, 1, v12
    v_lshlrev_b32 v14, 11, v14
    v_lshrrev_b32 v15, 1, v3
    v_xor_b32 v15, v15, v12
    v_lshl_add_u32 v14, v15, 6, v14
    v_and_b32 v15, 3, v2
    v_lshl_add_u32 v14, v15, 4, v14
    v_add_u32 v14, 131072, v14
    v_lshlrev_b32 v13, 7, v13
    v_add_u32 v118, v14, v13
    v_sub_u32 v119, v14, v13
    v_mov_b32 v116, v104
    v_lshlrev_b32 v117, 5, v0
    v_add_u32 v117, 393216, v117
    v_lshrrev_b32 v12, 1, v3
    v_lshlrev_b32 v13, 8, v12
    v_lshl_add_u32 v13, v2, 4, v13
    v_and_b32 v12, 1, v3
    v_lshl_add_u32 v13, v12, 3, v13
    s_lshl_b32 s45, s28, 9
    s_add_u32 s45, s45, 155648
    v_add_u32 v110, s45, v13
    v_lshrrev_b32 v12, 2, v2
    v_lshl_add_u32 v12, v3, 2, v12
    v_lshlrev_b32 v12, 4, v12
    v_and_b32 v13, 1, v2
    v_lshl_add_u32 v12, v13, 3, v12
    v_add_u32 v111, 155648, v12
    v_mov_b32 v125, 0
    v_mov_b32 v126, 0
    s_mov_b32 s34, 0x3e0293ee
    s_mov_b32 s35, s34
    s_mov_b32 s48, 0
    s_mov_b32 s49, -1
    s_mov_b32 s31, 0
    s_mov_b32 s32, 0x900000
    s_lshl_b32 s45, s29, 13
    s_add_u32 s47, s45, 0x8e0000
    s_mov_b32 s98, 0x3f803f80
    s_mov_b32 s99, 0x3f803f80
    s_lshl_b32 s46, s28, 11
    s_add_u32 s45, s45, s46
    s_add_u32 s39, s45, 0x1fe0000
    s_add_u32 s40, s45, 0x2fe0000
    s_lshl_b32 s45, s29, 12
    s_lshl_b32 s46, s28, 10
    s_add_u32 s45, s45, s46
    s_add_u32 s41, s45, 0xfe0000
    s_lshl_b32 s45, s28, 11
    s_add_u32 s43, s45, 139264
    s_lshl_b32 s45, s29, 7
    s_add_u32 s50, s45, 0x8b0000
    s_mov_b32 s42, 0
    s_mov_b32 s101, 1
    s_mov_b32 s44, 6
    v_lshrrev_b32 v18, 1, v3
    v_lshlrev_b32 v18, 3, v18
    v_and_b32 v19, 1, v3
    v_add_u32 v18, v18, v19
    v_lshlrev_b32 v18, 10, v18
    v_lshl_add_u32 v18, v2, 4, v18
    s_lshl_b32 s45, s29, 17
    s_lshl_b32 s46, s28, 8
    s_add_u32 s45, s45, s46
    v_add_u32 v58, s45, v18
    v_lshlrev_b32 v18, 2, v0
    v_add_u32 v59, s55, v18
    v_and_b32 v2, 15, v0
    v_lshrrev_b32 v3, 4, v0
    s_waitcnt vmcnt(31)
    ds_read2st64_b32 a[128:129], v59 offset0:0 offset1:1
    ds_read2st64_b32 a[132:133], v59 offset0:2 offset1:3
    s_waitcnt lgkmcnt(0)
    s_add_u32 m0, s55, 0
    s_mov_b32 s45, 0x0
    buffer_load_dwordx4 v57, s[16:19], s45 offen lds
    s_waitcnt vmcnt(31)
    ds_read2st64_b32 a[130:131], v59 offset0:4 offset1:5
    ds_read2st64_b32 a[134:135], v59 offset0:6 offset1:7
    s_waitcnt lgkmcnt(0)
    s_add_u32 m0, s55, 1024
    s_mov_b32 s45, 0x10000
    buffer_load_dwordx4 v57, s[16:19], s45 offen lds
    s_waitcnt vmcnt(31)
    ds_read2st64_b32 a[136:137], v59 offset0:8 offset1:9
    ds_read2st64_b32 a[140:141], v59 offset0:10 offset1:11
    s_waitcnt lgkmcnt(0)
    s_add_u32 m0, s55, 2048
    s_mov_b32 s45, 0x40000
    buffer_load_dwordx4 v57, s[16:19], s45 offen lds
    s_waitcnt vmcnt(31)
    ds_read2st64_b32 a[138:139], v59 offset0:12 offset1:13
    ds_read2st64_b32 a[142:143], v59 offset0:14 offset1:15
    s_waitcnt lgkmcnt(0)
    s_add_u32 m0, s55, 3072
    s_mov_b32 s45, 0x50000
    buffer_load_dwordx4 v57, s[16:19], s45 offen lds
    s_waitcnt vmcnt(31)
    ds_read2st64_b32 a[144:145], v59 offset0:16 offset1:17
    ds_read2st64_b32 a[148:149], v59 offset0:18 offset1:19
    s_waitcnt lgkmcnt(0)
    s_add_u32 m0, s55, 4096
    s_mov_b32 s45, 0x80000
    buffer_load_dwordx4 v57, s[16:19], s45 offen lds
    s_waitcnt vmcnt(31)
    ds_read2st64_b32 a[146:147], v59 offset0:20 offset1:21
    ds_read2st64_b32 a[150:151], v59 offset0:22 offset1:23
    s_waitcnt lgkmcnt(0)
    s_add_u32 m0, s55, 5120
    s_mov_b32 s45, 0x90000
    buffer_load_dwordx4 v57, s[16:19], s45 offen lds
    s_waitcnt vmcnt(31)
    ds_read2st64_b32 a[152:153], v59 offset0:24 offset1:25
    ds_read2st64_b32 a[156:157], v59 offset0:26 offset1:27
    s_waitcnt lgkmcnt(0)
    s_add_u32 m0, s55, 6144
    s_mov_b32 s45, 0xc0000
    buffer_load_dwordx4 v57, s[16:19], s45 offen lds
    s_waitcnt vmcnt(31)
    ds_read2st64_b32 a[154:155], v59 offset0:28 offset1:29
    ds_read2st64_b32 a[158:159], v59 offset0:30 offset1:31
    s_waitcnt lgkmcnt(0)
    s_add_u32 m0, s55, 7168
    s_mov_b32 s45, 0xd0000
    buffer_load_dwordx4 v57, s[16:19], s45 offen lds
    s_waitcnt vmcnt(31)
    ds_read2st64_b32 a[160:161], v59 offset0:32 offset1:33
    ds_read2st64_b32 a[164:165], v59 offset0:34 offset1:35
    s_waitcnt lgkmcnt(0)
    s_add_u32 m0, s55, 8192
    s_mov_b32 s45, 0x100000
    buffer_load_dwordx4 v57, s[16:19], s45 offen lds
    s_waitcnt vmcnt(31)
    ds_read2st64_b32 a[162:163], v59 offset0:36 offset1:37
    ds_read2st64_b32 a[166:167], v59 offset0:38 offset1:39
    s_waitcnt lgkmcnt(0)
    s_add_u32 m0, s55, 9216
    s_mov_b32 s45, 0x110000
    buffer_load_dwordx4 v57, s[16:19], s45 offen lds
    s_waitcnt vmcnt(31)
    ds_read2st64_b32 a[168:169], v59 offset0:40 offset1:41
    ds_read2st64_b32 a[172:173], v59 offset0:42 offset1:43
    s_waitcnt lgkmcnt(0)
    s_add_u32 m0, s55, 10240
    s_mov_b32 s45, 0x140000
    buffer_load_dwordx4 v57, s[16:19], s45 offen lds
    s_waitcnt vmcnt(31)
    ds_read2st64_b32 a[170:171], v59 offset0:44 offset1:45
    ds_read2st64_b32 a[174:175], v59 offset0:46 offset1:47
    s_waitcnt lgkmcnt(0)
    s_add_u32 m0, s55, 11264
    s_mov_b32 s45, 0x150000
    buffer_load_dwordx4 v57, s[16:19], s45 offen lds
    s_waitcnt vmcnt(31)
    ds_read2st64_b32 a[176:177], v59 offset0:48 offset1:49
    ds_read2st64_b32 a[180:181], v59 offset0:50 offset1:51
    s_waitcnt lgkmcnt(0)
    s_add_u32 m0, s55, 12288
    s_mov_b32 s45, 0x180000
    buffer_load_dwordx4 v57, s[16:19], s45 offen lds
    s_waitcnt vmcnt(31)
    ds_read2st64_b32 a[178:179], v59 offset0:52 offset1:53
    ds_read2st64_b32 a[182:183], v59 offset0:54 offset1:55
    s_waitcnt lgkmcnt(0)
    s_add_u32 m0, s55, 13312
    s_mov_b32 s45, 0x190000
    buffer_load_dwordx4 v57, s[16:19], s45 offen lds
    s_waitcnt vmcnt(31)
    ds_read2st64_b32 a[184:185], v59 offset0:56 offset1:57
    ds_read2st64_b32 a[188:189], v59 offset0:58 offset1:59
    s_waitcnt lgkmcnt(0)
    s_add_u32 m0, s55, 14336
    s_mov_b32 s45, 0x1c0000
    buffer_load_dwordx4 v57, s[16:19], s45 offen lds
    s_waitcnt vmcnt(31)
    ds_read2st64_b32 a[186:187], v59 offset0:60 offset1:61
    ds_read2st64_b32 a[190:191], v59 offset0:62 offset1:63
    s_waitcnt lgkmcnt(0)
    s_add_u32 m0, s55, 15360
    s_mov_b32 s45, 0x1d0000
    buffer_load_dwordx4 v57, s[16:19], s45 offen lds
    s_waitcnt vmcnt(31)
    ds_read2st64_b32 a[192:193], v59 offset0:64 offset1:65
    ds_read2st64_b32 a[196:197], v59 offset0:66 offset1:67
    s_waitcnt lgkmcnt(0)
    s_add_u32 m0, s55, 16384
    s_mov_b32 s45, 0x200000
    buffer_load_dwordx4 v57, s[16:19], s45 offen lds
    s_waitcnt vmcnt(31)
    ds_read2st64_b32 a[194:195], v59 offset0:68 offset1:69
    ds_read2st64_b32 a[198:199], v59 offset0:70 offset1:71
    s_waitcnt lgkmcnt(0)
    s_add_u32 m0, s55, 17408
    s_mov_b32 s45, 0x210000
    buffer_load_dwordx4 v57, s[16:19], s45 offen lds
    s_waitcnt vmcnt(31)
    ds_read2st64_b32 a[200:201], v59 offset0:72 offset1:73
    ds_read2st64_b32 a[204:205], v59 offset0:74 offset1:75
    s_waitcnt lgkmcnt(0)
    s_add_u32 m0, s55, 18432
    s_mov_b32 s45, 0x240000
    buffer_load_dwordx4 v57, s[16:19], s45 offen lds
    s_waitcnt vmcnt(31)
    ds_read2st64_b32 a[202:203], v59 offset0:76 offset1:77
    ds_read2st64_b32 a[206:207], v59 offset0:78 offset1:79
    s_waitcnt lgkmcnt(0)
    s_add_u32 m0, s55, 19456
    s_mov_b32 s45, 0x250000
    buffer_load_dwordx4 v57, s[16:19], s45 offen lds
    s_waitcnt vmcnt(31)
    ds_read2st64_b32 a[208:209], v59 offset0:80 offset1:81
    ds_read2st64_b32 a[212:213], v59 offset0:82 offset1:83
    s_waitcnt lgkmcnt(0)
    s_add_u32 m0, s55, 20480
    s_mov_b32 s45, 0x280000
    buffer_load_dwordx4 v57, s[16:19], s45 offen lds
    s_waitcnt vmcnt(31)
    ds_read2st64_b32 a[210:211], v59 offset0:84 offset1:85
    ds_read2st64_b32 a[214:215], v59 offset0:86 offset1:87
    s_waitcnt lgkmcnt(0)
    s_add_u32 m0, s55, 21504
    s_mov_b32 s45, 0x290000
    buffer_load_dwordx4 v57, s[16:19], s45 offen lds
    s_waitcnt vmcnt(31)
    ds_read2st64_b32 a[216:217], v59 offset0:88 offset1:89
    ds_read2st64_b32 a[220:221], v59 offset0:90 offset1:91
    s_waitcnt lgkmcnt(0)
    s_add_u32 m0, s55, 22528
    s_mov_b32 s45, 0x2c0000
    buffer_load_dwordx4 v57, s[16:19], s45 offen lds
    s_waitcnt vmcnt(31)
    ds_read2st64_b32 a[218:219], v59 offset0:92 offset1:93
    ds_read2st64_b32 a[222:223], v59 offset0:94 offset1:95
    s_waitcnt lgkmcnt(0)
    s_add_u32 m0, s55, 23552
    s_mov_b32 s45, 0x2d0000
    buffer_load_dwordx4 v57, s[16:19], s45 offen lds
    s_waitcnt vmcnt(31)
    ds_read2st64_b32 a[224:225], v59 offset0:96 offset1:97
    ds_read2st64_b32 a[228:229], v59 offset0:98 offset1:99
    s_waitcnt lgkmcnt(0)
    s_add_u32 m0, s55, 24576
    s_mov_b32 s45, 0x300000
    buffer_load_dwordx4 v57, s[16:19], s45 offen lds
    s_waitcnt vmcnt(31)
    ds_read2st64_b32 a[226:227], v59 offset0:100 offset1:101
    ds_read2st64_b32 a[230:231], v59 offset0:102 offset1:103
    s_waitcnt lgkmcnt(0)
    s_add_u32 m0, s55, 25600
    s_mov_b32 s45, 0x310000
    buffer_load_dwordx4 v57, s[16:19], s45 offen lds
    s_waitcnt vmcnt(31)
    ds_read2st64_b32 a[232:233], v59 offset0:104 offset1:105
    ds_read2st64_b32 a[236:237], v59 offset0:106 offset1:107
    s_waitcnt lgkmcnt(0)
    s_add_u32 m0, s55, 26624
    s_mov_b32 s45, 0x340000
    buffer_load_dwordx4 v57, s[16:19], s45 offen lds
    s_waitcnt vmcnt(31)
    ds_read2st64_b32 a[234:235], v59 offset0:108 offset1:109
    ds_read2st64_b32 a[238:239], v59 offset0:110 offset1:111
    s_waitcnt lgkmcnt(0)
    s_add_u32 m0, s55, 27648
    s_mov_b32 s45, 0x350000
    buffer_load_dwordx4 v57, s[16:19], s45 offen lds
    s_waitcnt vmcnt(31)
    ds_read2st64_b32 a[240:241], v59 offset0:112 offset1:113
    ds_read2st64_b32 a[244:245], v59 offset0:114 offset1:115
    s_waitcnt lgkmcnt(0)
    s_add_u32 m0, s55, 28672
    s_mov_b32 s45, 0x380000
    buffer_load_dwordx4 v57, s[16:19], s45 offen lds
    s_waitcnt vmcnt(31)
    ds_read2st64_b32 a[242:243], v59 offset0:116 offset1:117
    ds_read2st64_b32 a[246:247], v59 offset0:118 offset1:119
    s_waitcnt lgkmcnt(0)
    s_add_u32 m0, s55, 29696
    s_mov_b32 s45, 0x390000
    buffer_load_dwordx4 v57, s[16:19], s45 offen lds
    s_waitcnt vmcnt(31)
    ds_read2st64_b32 a[248:249], v59 offset0:120 offset1:121
    ds_read2st64_b32 a[252:253], v59 offset0:122 offset1:123
    s_waitcnt lgkmcnt(0)
    s_add_u32 m0, s55, 30720
    s_mov_b32 s45, 0x3c0000
    buffer_load_dwordx4 v57, s[16:19], s45 offen lds
    s_waitcnt vmcnt(31)
    ds_read2st64_b32 a[250:251], v59 offset0:124 offset1:125
    ds_read2st64_b32 a[254:255], v59 offset0:126 offset1:127
    s_waitcnt lgkmcnt(0)
    s_add_u32 m0, s55, 31744
    s_mov_b32 s45, 0x3d0000
    buffer_load_dwordx4 v57, s[16:19], s45 offen lds
    s_waitcnt vmcnt(31)
    s_and_b32 s45, s29, 3
    s_cmp_eq_u32 s29, 31
    s_cselect_b32 s45, 1, s45
    s_cselect_b32 s57, 32, s29
    s_cselect_b32 s46, 32, s29
    s_cmp_lg_u32 s45, 1
    s_cbranch_scc1 L_vc_2
    s_and_b32 s46, s46, 60
    s_add_u32 s46, s46, 64
    s_lshl_b32 s56, s28, 3
L_vcp_3:
    s_load_dword s45, s[90:91], s46 glc
    s_waitcnt lgkmcnt(0)
    s_lshr_b32 s45, s45, s56
    s_and_b32 s45, s45, 0xff
    s_cbranch_scc1 L_vcp_3_ok
    s_sleep 4
    s_add_u32 s100, s100, 1
    s_bitcmp1_b32 s100, 15
    s_cbranch_scc1 L_exit
    s_branch L_vcp_3
L_vcp_3_ok:
    s_add_u32 s20, s92, 0x7000000
    s_addc_u32 s21, s93, 0
    s_lshr_b32 s45, s57, 2
    s_lshl_b32 s45, s45, 12
    s_lshl_b32 s46, s28, 10
    s_add_u32 s45, s45, s46
    v_lshlrev_b32 v57, 4, v0
    v_add_u32 v57, s45, v57
L_vc_2:
    ds_read2st64_b32 a[0:1], v59 offset0:0 offset1:1
    ds_read2st64_b32 a[4:5], v59 offset0:2 offset1:3
    s_waitcnt lgkmcnt(0)
    s_add_u32 m0, s55, 0
    s_mov_b32 s45, 0x0
    buffer_load_dwordx4 v57, s[20:23], s45 offen sc1 lds
    s_waitcnt vmcnt(31)
    ds_read2st64_b32 a[2:3], v59 offset0:4 offset1:5
    ds_read2st64_b32 a[6:7], v59 offset0:6 offset1:7
    s_waitcnt lgkmcnt(0)
    s_add_u32 m0, s55, 1024
    s_mov_b32 s45, 0x10000
    buffer_load_dwordx4 v57, s[20:23], s45 offen sc1 lds
    s_waitcnt vmcnt(31)
    ds_read2st64_b32 a[8:9], v59 offset0:8 offset1:9
    ds_read2st64_b32 a[12:13], v59 offset0:10 offset1:11
    s_waitcnt lgkmcnt(0)
    s_add_u32 m0, s55, 2048
    s_mov_b32 s45, 0x40000
    buffer_load_dwordx4 v57, s[20:23], s45 offen sc1 lds
    s_waitcnt vmcnt(31)
    ds_read2st64_b32 a[10:11], v59 offset0:12 offset1:13
    ds_read2st64_b32 a[14:15], v59 offset0:14 offset1:15
    s_waitcnt lgkmcnt(0)
    s_add_u32 m0, s55, 3072
    s_mov_b32 s45, 0x50000
    buffer_load_dwordx4 v57, s[20:23], s45 offen sc1 lds
    s_waitcnt vmcnt(31)
    ds_read2st64_b32 a[16:17], v59 offset0:16 offset1:17
    ds_read2st64_b32 a[20:21], v59 offset0:18 offset1:19
    s_waitcnt lgkmcnt(0)
    s_add_u32 m0, s55, 4096
    s_mov_b32 s45, 0x80000
    buffer_load_dwordx4 v57, s[20:23], s45 offen sc1 lds
    s_waitcnt vmcnt(31)
    ds_read2st64_b32 a[18:19], v59 offset0:20 offset1:21
    ds_read2st64_b32 a[22:23], v59 offset0:22 offset1:23
    s_waitcnt lgkmcnt(0)
    s_add_u32 m0, s55, 5120
    s_mov_b32 s45, 0x90000
    buffer_load_dwordx4 v57, s[20:23], s45 offen sc1 lds
    s_waitcnt vmcnt(31)
    ds_read2st64_b32 a[24:25], v59 offset0:24 offset1:25
    ds_read2st64_b32 a[28:29], v59 offset0:26 offset1:27
    s_waitcnt lgkmcnt(0)
    s_add_u32 m0, s55, 6144
    s_mov_b32 s45, 0xc0000
    buffer_load_dwordx4 v57, s[20:23], s45 offen sc1 lds
    s_waitcnt vmcnt(31)
    ds_read2st64_b32 a[26:27], v59 offset0:28 offset1:29
    ds_read2st64_b32 a[30:31], v59 offset0:30 offset1:31
    s_waitcnt lgkmcnt(0)
    s_add_u32 m0, s55, 7168
    s_mov_b32 s45, 0xd0000
    buffer_load_dwordx4 v57, s[20:23], s45 offen sc1 lds
    s_waitcnt vmcnt(31)
    ds_read2st64_b32 a[32:33], v59 offset0:32 offset1:33
    ds_read2st64_b32 a[36:37], v59 offset0:34 offset1:35
    s_waitcnt lgkmcnt(0)
    s_add_u32 m0, s55, 8192
    s_mov_b32 s45, 0x100000
    buffer_load_dwordx4 v57, s[20:23], s45 offen sc1 lds
    s_waitcnt vmcnt(31)
    ds_read2st64_b32 a[34:35], v59 offset0:36 offset1:37
    ds_read2st64_b32 a[38:39], v59 offset0:38 offset1:39
    s_waitcnt lgkmcnt(0)
    s_add_u32 m0, s55, 9216
    s_mov_b32 s45, 0x110000
    buffer_load_dwordx4 v57, s[20:23], s45 offen sc1 lds
    s_waitcnt vmcnt(31)
    ds_read2st64_b32 a[40:41], v59 offset0:40 offset1:41
    ds_read2st64_b32 a[44:45], v59 offset0:42 offset1:43
    s_waitcnt lgkmcnt(0)
    s_add_u32 m0, s55, 10240
    s_mov_b32 s45, 0x140000
    buffer_load_dwordx4 v57, s[20:23], s45 offen sc1 lds
    s_waitcnt vmcnt(31)
    ds_read2st64_b32 a[42:43], v59 offset0:44 offset1:45
    ds_read2st64_b32 a[46:47], v59 offset0:46 offset1:47
    s_waitcnt lgkmcnt(0)
    s_add_u32 m0, s55, 11264
    s_mov_b32 s45, 0x150000
    buffer_load_dwordx4 v57, s[20:23], s45 offen sc1 lds
    s_waitcnt vmcnt(31)
    ds_read2st64_b32 a[48:49], v59 offset0:48 offset1:49
    ds_read2st64_b32 a[52:53], v59 offset0:50 offset1:51
    s_waitcnt lgkmcnt(0)
    s_add_u32 m0, s55, 12288
    s_mov_b32 s45, 0x180000
    buffer_load_dwordx4 v57, s[20:23], s45 offen sc1 lds
    s_waitcnt vmcnt(31)
    ds_read2st64_b32 a[50:51], v59 offset0:52 offset1:53
    ds_read2st64_b32 a[54:55], v59 offset0:54 offset1:55
    s_waitcnt lgkmcnt(0)
    s_add_u32 m0, s55, 13312
    s_mov_b32 s45, 0x190000
    buffer_load_dwordx4 v57, s[20:23], s45 offen sc1 lds
    s_waitcnt vmcnt(31)
    ds_read2st64_b32 a[56:57], v59 offset0:56 offset1:57
    ds_read2st64_b32 a[60:61], v59 offset0:58 offset1:59
    s_waitcnt lgkmcnt(0)
    s_add_u32 m0, s55, 14336
    s_mov_b32 s45, 0x1c0000
    buffer_load_dwordx4 v57, s[20:23], s45 offen sc1 lds
    s_waitcnt vmcnt(31)
    ds_read2st64_b32 a[58:59], v59 offset0:60 offset1:61
    ds_read2st64_b32 a[62:63], v59 offset0:62 offset1:63
    s_waitcnt lgkmcnt(0)
    s_add_u32 m0, s55, 15360
    s_mov_b32 s45, 0x1d0000
    buffer_load_dwordx4 v57, s[20:23], s45 offen sc1 lds
    s_waitcnt vmcnt(31)
    ds_read2st64_b32 a[64:65], v59 offset0:64 offset1:65
    ds_read2st64_b32 a[68:69], v59 offset0:66 offset1:67
    s_waitcnt lgkmcnt(0)
    s_add_u32 m0, s55, 16384
    s_mov_b32 s45, 0x200000
    buffer_load_dwordx4 v57, s[20:23], s45 offen sc1 lds
    s_waitcnt vmcnt(31)
    ds_read2st64_b32 a[66:67], v59 offset0:68 offset1:69
    ds_read2st64_b32 a[70:71], v59 offset0:70 offset1:71
    s_waitcnt lgkmcnt(0)
    s_add_u32 m0, s55, 17408
    s_mov_b32 s45, 0x210000
    buffer_load_dwordx4 v57, s[20:23], s45 offen sc1 lds
    s_waitcnt vmcnt(31)
    ds_read2st64_b32 a[72:73], v59 offset0:72 offset1:73
    ds_read2st64_b32 a[76:77], v59 offset0:74 offset1:75
    s_waitcnt lgkmcnt(0)
    s_add_u32 m0, s55, 18432
    s_mov_b32 s45, 0x240000
    buffer_load_dwordx4 v57, s[20:23], s45 offen sc1 lds
    s_waitcnt vmcnt(31)
    ds_read2st64_b32 a[74:75], v59 offset0:76 offset1:77
    ds_read2st64_b32 a[78:79], v59 offset0:78 offset1:79
    s_waitcnt lgkmcnt(0)
    s_add_u32 m0, s55, 19456
    s_mov_b32 s45, 0x250000
    buffer_load_dwordx4 v57, s[20:23], s45 offen sc1 lds
    s_waitcnt vmcnt(31)
    ds_read2st64_b32 a[80:81], v59 offset0:80 offset1:81
    ds_read2st64_b32 a[84:85], v59 offset0:82 offset1:83
    s_waitcnt lgkmcnt(0)
    s_add_u32 m0, s55, 20480
    s_mov_b32 s45, 0x280000
    buffer_load_dwordx4 v57, s[20:23], s45 offen sc1 lds
    s_waitcnt vmcnt(31)
    ds_read2st64_b32 a[82:83], v59 offset0:84 offset1:85
    ds_read2st64_b32 a[86:87], v59 offset0:86 offset1:87
    s_waitcnt lgkmcnt(0)
    s_add_u32 m0, s55, 21504
    s_mov_b32 s45, 0x290000
    buffer_load_dwordx4 v57, s[20:23], s45 offen sc1 lds
    s_waitcnt vmcnt(31)
    ds_read2st64_b32 a[88:89], v59 offset0:88 offset1:89
    ds_read2st64_b32 a[92:93], v59 offset0:90 offset1:91
    s_waitcnt lgkmcnt(0)
    s_add_u32 m0, s55, 22528
    s_mov_b32 s45, 0x2c0000
    buffer_load_dwordx4 v57, s[20:23], s45 offen sc1 lds
    s_waitcnt vmcnt(31)
    ds_read2st64_b32 a[90:91], v59 offset0:92 offset1:93
    ds_read2st64_b32 a[94:95], v59 offset0:94 offset1:95
    s_waitcnt lgkmcnt(0)
    s_add_u32 m0, s55, 23552
    s_mov_b32 s45, 0x2d0000
    buffer_load_dwordx4 v57, s[20:23], s45 offen sc1 lds
    s_waitcnt vmcnt(31)
    ds_read2st64_b32 a[96:97], v59 offset0:96 offset1:97
    ds_read2st64_b32 a[100:101], v59 offset0:98 offset1:99
    s_waitcnt lgkmcnt(0)
    s_add_u32 m0, s55, 24576
    s_mov_b32 s45, 0x300000
    buffer_load_dwordx4 v57, s[20:23], s45 offen sc1 lds
    s_waitcnt vmcnt(31)
    ds_read2st64_b32 a[98:99], v59 offset0:100 offset1:101
    ds_read2st64_b32 a[102:103], v59 offset0:102 offset1:103
    s_waitcnt lgkmcnt(0)
    s_add_u32 m0, s55, 25600
    s_mov_b32 s45, 0x310000
    buffer_load_dwordx4 v57, s[20:23], s45 offen sc1 lds
    s_waitcnt vmcnt(31)
    ds_read2st64_b32 a[104:105], v59 offset0:104 offset1:105
    ds_read2st64_b32 a[108:109], v59 offset0:106 offset1:107
    s_waitcnt lgkmcnt(0)
    s_add_u32 m0, s55, 26624
    s_mov_b32 s45, 0x340000
    buffer_load_dwordx4 v57, s[20:23], s45 offen sc1 lds
    s_waitcnt vmcnt(31)
    ds_read2st64_b32 a[106:107], v59 offset0:108 offset1:109
    ds_read2st64_b32 a[110:111], v59 offset0:110 offset1:111
    s_waitcnt lgkmcnt(0)
    s_add_u32 m0, s55, 27648
    s_mov_b32 s45, 0x350000
    buffer_load_dwordx4 v57, s[20:23], s45 offen sc1 lds
    s_waitcnt vmcnt(31)
    ds_read2st64_b32 a[112:113], v59 offset0:112 offset1:113
    ds_read2st64_b32 a[116:117], v59 offset0:114 offset1:115
    s_waitcnt lgkmcnt(0)
    s_add_u32 m0, s55, 28672
    s_mov_b32 s45, 0x380000
    buffer_load_dwordx4 v57, s[20:23], s45 offen sc1 lds
    s_waitcnt vmcnt(31)
    ds_read2st64_b32 a[114:115], v59 offset0:116 offset1:117
    ds_read2st64_b32 a[118:119], v59 offset0:118 offset1:119
    s_waitcnt lgkmcnt(0)
    s_add_u32 m0, s55, 29696
    s_mov_b32 s45, 0x390000
    buffer_load_dwordx4 v57, s[20:23], s45 offen sc1 lds
    s_waitcnt vmcnt(31)
    ds_read2st64_b32 a[120:121], v59 offset0:120 offset1:121
    ds_read2st64_b32 a[124:125], v59 offset0:122 offset1:123
    s_waitcnt lgkmcnt(0)
    s_add_u32 m0, s55, 30720
    s_mov_b32 s45, 0x3c0000
    buffer_load_dwordx4 v57, s[20:23], s45 offen sc1 lds
    s_waitcnt vmcnt(31)
    ds_read2st64_b32 a[122:123], v59 offset0:124 offset1:125
    ds_read2st64_b32 a[126:127], v59 offset0:126 offset1:127
    s_waitcnt lgkmcnt(0)
    s_add_u32 m0, s55, 31744
    s_mov_b32 s45, 0x3d0000
    buffer_load_dwordx4 v57, s[20:23], s45 offen sc1 lds
    s_waitcnt vmcnt(31)
    ds_read2st64_b32 v[128:129], v59 offset0:0 offset1:1
    ds_read2st64_b32 v[132:133], v59 offset0:2 offset1:3
    s_waitcnt lgkmcnt(0)
    s_add_u32 m0, s55, 0
    s_xor_b32 s45, s28, 0
    s_lshl_b32 s45, s45, 15
    s_add_u32 s45, s45, 0
    buffer_load_dwordx4 v58, s[24:27], s45 offen lds
    s_waitcnt vmcnt(31)
    ds_read2st64_b32 v[130:131], v59 offset0:4 offset1:5
    ds_read2st64_b32 v[134:135], v59 offset0:6 offset1:7
    s_waitcnt lgkmcnt(0)
    s_add_u32 m0, s55, 1024
    s_xor_b32 s45, s28, 0
    s_lshl_b32 s45, s45, 15
    s_add_u32 s45, s45, 2048
    buffer_load_dwordx4 v58, s[24:27], s45 offen lds
    s_waitcnt vmcnt(31)
    ds_read2st64_b32 v[136:137], v59 offset0:8 offset1:9
    ds_read2st64_b32 v[140:141], v59 offset0:10 offset1:11
    s_waitcnt lgkmcnt(0)
    s_add_u32 m0, s55, 2048
    s_xor_b32 s45, s28, 0
    s_lshl_b32 s45, s45, 15
    s_add_u32 s45, s45, 4096
    buffer_load_dwordx4 v58, s[24:27], s45 offen lds
    s_waitcnt vmcnt(31)
    ds_read2st64_b32 v[138:139], v59 offset0:12 offset1:13
    ds_read2st64_b32 v[142:143], v59 offset0:14 offset1:15
    s_waitcnt lgkmcnt(0)
    s_add_u32 m0, s55, 3072
    s_xor_b32 s45, s28, 0
    s_lshl_b32 s45, s45, 15
    s_add_u32 s45, s45, 6144
    buffer_load_dwordx4 v58, s[24:27], s45 offen lds
    s_waitcnt vmcnt(31)
    ds_read2st64_b32 v[144:145], v59 offset0:16 offset1:17
    ds_read2st64_b32 v[148:149], v59 offset0:18 offset1:19
    s_waitcnt lgkmcnt(0)
    s_add_u32 m0, s55, 4096
    s_xor_b32 s45, s28, 0
    s_lshl_b32 s45, s45, 15
    s_add_u32 s45, s45, 16384
    buffer_load_dwordx4 v58, s[24:27], s45 offen lds
    s_waitcnt vmcnt(31)
    ds_read2st64_b32 v[146:147], v59 offset0:20 offset1:21
    ds_read2st64_b32 v[150:151], v59 offset0:22 offset1:23
    s_waitcnt lgkmcnt(0)
    s_add_u32 m0, s55, 5120
    s_xor_b32 s45, s28, 0
    s_lshl_b32 s45, s45, 15
    s_add_u32 s45, s45, 18432
    buffer_load_dwordx4 v58, s[24:27], s45 offen lds
    s_waitcnt vmcnt(31)
    ds_read2st64_b32 v[152:153], v59 offset0:24 offset1:25
    ds_read2st64_b32 v[156:157], v59 offset0:26 offset1:27
    s_waitcnt lgkmcnt(0)
    s_add_u32 m0, s55, 6144
    s_xor_b32 s45, s28, 0
    s_lshl_b32 s45, s45, 15
    s_add_u32 s45, s45, 20480
    buffer_load_dwordx4 v58, s[24:27], s45 offen lds
    s_waitcnt vmcnt(31)
    ds_read2st64_b32 v[154:155], v59 offset0:28 offset1:29
    ds_read2st64_b32 v[158:159], v59 offset0:30 offset1:31
    s_waitcnt lgkmcnt(0)
    s_add_u32 m0, s55, 7168
    s_xor_b32 s45, s28, 0
    s_lshl_b32 s45, s45, 15
    s_add_u32 s45, s45, 22528
    buffer_load_dwordx4 v58, s[24:27], s45 offen lds
    s_waitcnt vmcnt(31)
    ds_read2st64_b32 v[160:161], v59 offset0:32 offset1:33
    ds_read2st64_b32 v[164:165], v59 offset0:34 offset1:35
    s_waitcnt lgkmcnt(0)
    s_add_u32 m0, s55, 8192
    s_xor_b32 s45, s28, 1
    s_lshl_b32 s45, s45, 15
    s_add_u32 s45, s45, 0
    buffer_load_dwordx4 v58, s[24:27], s45 offen lds
    s_waitcnt vmcnt(31)
    ds_read2st64_b32 v[162:163], v59 offset0:36 offset1:37
    ds_read2st64_b32 v[166:167], v59 offset0:38 offset1:39
    s_waitcnt lgkmcnt(0)
    s_add_u32 m0, s55, 9216
    s_xor_b32 s45, s28, 1
    s_lshl_b32 s45, s45, 15
    s_add_u32 s45, s45, 2048
    buffer_load_dwordx4 v58, s[24:27], s45 offen lds
    s_waitcnt vmcnt(31)
    ds_read2st64_b32 v[168:169], v59 offset0:40 offset1:41
    ds_read2st64_b32 v[172:173], v59 offset0:42 offset1:43
    s_waitcnt lgkmcnt(0)
    s_add_u32 m0, s55, 10240
    s_xor_b32 s45, s28, 1
    s_lshl_b32 s45, s45, 15
    s_add_u32 s45, s45, 4096
    buffer_load_dwordx4 v58, s[24:27], s45 offen lds
    s_waitcnt vmcnt(31)
    ds_read2st64_b32 v[170:171], v59 offset0:44 offset1:45
    ds_read2st64_b32 v[174:175], v59 offset0:46 offset1:47
    s_waitcnt lgkmcnt(0)
    s_add_u32 m0, s55, 11264
    s_xor_b32 s45, s28, 1
    s_lshl_b32 s45, s45, 15
    s_add_u32 s45, s45, 6144
    buffer_load_dwordx4 v58, s[24:27], s45 offen lds
    s_waitcnt vmcnt(31)
    ds_read2st64_b32 v[176:177], v59 offset0:48 offset1:49
    ds_read2st64_b32 v[180:181], v59 offset0:50 offset1:51
    s_waitcnt lgkmcnt(0)
    s_add_u32 m0, s55, 12288
    s_xor_b32 s45, s28, 1
    s_lshl_b32 s45, s45, 15
    s_add_u32 s45, s45, 16384
    buffer_load_dwordx4 v58, s[24:27], s45 offen lds
    s_waitcnt vmcnt(31)
    ds_read2st64_b32 v[178:179], v59 offset0:52 offset1:53
    ds_read2st64_b32 v[182:183], v59 offset0:54 offset1:55
    s_waitcnt lgkmcnt(0)
    s_add_u32 m0, s55, 13312
    s_xor_b32 s45, s28, 1
    s_lshl_b32 s45, s45, 15
    s_add_u32 s45, s45, 18432
    buffer_load_dwordx4 v58, s[24:27], s45 offen lds
    s_waitcnt vmcnt(31)
    ds_read2st64_b32 v[184:185], v59 offset0:56 offset1:57
    ds_read2st64_b32 v[188:189], v59 offset0:58 offset1:59
    s_waitcnt lgkmcnt(0)
    s_add_u32 m0, s55, 14336
    s_xor_b32 s45, s28, 1
    s_lshl_b32 s45, s45, 15
    s_add_u32 s45, s45, 20480
    buffer_load_dwordx4 v58, s[24:27], s45 offen lds
    s_waitcnt vmcnt(31)
    ds_read2st64_b32 v[186:187], v59 offset0:60 offset1:61
    ds_read2st64_b32 v[190:191], v59 offset0:62 offset1:63
    s_waitcnt lgkmcnt(0)
    s_add_u32 m0, s55, 15360
    s_xor_b32 s45, s28, 1
    s_lshl_b32 s45, s45, 15
    s_add_u32 s45, s45, 22528
    buffer_load_dwordx4 v58, s[24:27], s45 offen lds
    s_waitcnt vmcnt(31)
    ds_read2st64_b32 v[192:193], v59 offset0:64 offset1:65
    ds_read2st64_b32 v[196:197], v59 offset0:66 offset1:67
    s_waitcnt lgkmcnt(0)
    s_add_u32 m0, s55, 16384
    s_xor_b32 s45, s28, 2
    s_lshl_b32 s45, s45, 15
    s_add_u32 s45, s45, 0
    buffer_load_dwordx4 v58, s[24:27], s45 offen lds
    s_waitcnt vmcnt(31)
    ds_read2st64_b32 v[194:195], v59 offset0:68 offset1:69
    ds_read2st64_b32 v[198:199], v59 offset0:70 offset1:71
    s_waitcnt lgkmcnt(0)
    s_add_u32 m0, s55, 17408
    s_xor_b32 s45, s28, 2
    s_lshl_b32 s45, s45, 15
    s_add_u32 s45, s45, 2048
    buffer_load_dwordx4 v58, s[24:27], s45 offen lds
    s_waitcnt vmcnt(31)
    ds_read2st64_b32 v[200:201], v59 offset0:72 offset1:73
    ds_read2st64_b32 v[204:205], v59 offset0:74 offset1:75
    s_waitcnt lgkmcnt(0)
    s_add_u32 m0, s55, 18432
    s_xor_b32 s45, s28, 2
    s_lshl_b32 s45, s45, 15
    s_add_u32 s45, s45, 4096
    buffer_load_dwordx4 v58, s[24:27], s45 offen lds
    s_waitcnt vmcnt(31)
    ds_read2st64_b32 v[202:203], v59 offset0:76 offset1:77
    ds_read2st64_b32 v[206:207], v59 offset0:78 offset1:79
    s_waitcnt lgkmcnt(0)
    s_add_u32 m0, s55, 19456
    s_xor_b32 s45, s28, 2
    s_lshl_b32 s45, s45, 15
    s_add_u32 s45, s45, 6144
    buffer_load_dwordx4 v58, s[24:27], s45 offen lds
    s_waitcnt vmcnt(31)
    ds_read2st64_b32 v[208:209], v59 offset0:80 offset1:81
    ds_read2st64_b32 v[212:213], v59 offset0:82 offset1:83
    s_waitcnt lgkmcnt(0)
    s_add_u32 m0, s55, 20480
    s_xor_b32 s45, s28, 2
    s_lshl_b32 s45, s45, 15
    s_add_u32 s45, s45, 16384
    buffer_load_dwordx4 v58, s[24:27], s45 offen lds
    s_waitcnt vmcnt(31)
    ds_read2st64_b32 v[210:211], v59 offset0:84 offset1:85
    ds_read2st64_b32 v[214:215], v59 offset0:86 offset1:87
    s_waitcnt lgkmcnt(0)
    s_add_u32 m0, s55, 21504
    s_xor_b32 s45, s28, 2
    s_lshl_b32 s45, s45, 15
    s_add_u32 s45, s45, 18432
    buffer_load_dwordx4 v58, s[24:27], s45 offen lds
    s_waitcnt vmcnt(31)
    ds_read2st64_b32 v[216:217], v59 offset0:88 offset1:89
    ds_read2st64_b32 v[220:221], v59 offset0:90 offset1:91
    s_waitcnt lgkmcnt(0)
    s_add_u32 m0, s55, 22528
    s_xor_b32 s45, s28, 2
    s_lshl_b32 s45, s45, 15
    s_add_u32 s45, s45, 20480
    buffer_load_dwordx4 v58, s[24:27], s45 offen lds
    s_waitcnt vmcnt(31)
    ds_read2st64_b32 v[218:219], v59 offset0:92 offset1:93
    ds_read2st64_b32 v[222:223], v59 offset0:94 offset1:95
    s_waitcnt lgkmcnt(0)
    s_add_u32 m0, s55, 23552
    s_xor_b32 s45, s28, 2
    s_lshl_b32 s45, s45, 15
    s_add_u32 s45, s45, 22528
    buffer_load_dwordx4 v58, s[24:27], s45 offen lds
    s_waitcnt vmcnt(31)
    ds_read2st64_b32 v[224:225], v59 offset0:96 offset1:97
    ds_read2st64_b32 v[228:229], v59 offset0:98 offset1:99
    s_waitcnt lgkmcnt(0)
    s_add_u32 m0, s55, 24576
    s_xor_b32 s45, s28, 3
    s_lshl_b32 s45, s45, 15
    s_add_u32 s45, s45, 0
    buffer_load_dwordx4 v58, s[24:27], s45 offen lds
    s_waitcnt vmcnt(31)
    ds_read2st64_b32 v[226:227], v59 offset0:100 offset1:101
    ds_read2st64_b32 v[230:231], v59 offset0:102 offset1:103
    s_waitcnt lgkmcnt(0)
    s_add_u32 m0, s55, 25600
    s_xor_b32 s45, s28, 3
    s_lshl_b32 s45, s45, 15
    s_add_u32 s45, s45, 2048
    buffer_load_dwordx4 v58, s[24:27], s45 offen lds
    s_waitcnt vmcnt(31)
    ds_read2st64_b32 v[232:233], v59 offset0:104 offset1:105
    ds_read2st64_b32 v[236:237], v59 offset0:106 offset1:107
    s_waitcnt lgkmcnt(0)
    s_add_u32 m0, s55, 26624
    s_xor_b32 s45, s28, 3
    s_lshl_b32 s45, s45, 15
    s_add_u32 s45, s45, 4096
    buffer_load_dwordx4 v58, s[24:27], s45 offen lds
    s_waitcnt vmcnt(31)
    ds_read2st64_b32 v[234:235], v59 offset0:108 offset1:109
    ds_read2st64_b32 v[238:239], v59 offset0:110 offset1:111
    s_waitcnt lgkmcnt(0)
    s_add_u32 m0, s55, 27648
    s_xor_b32 s45, s28, 3
    s_lshl_b32 s45, s45, 15
    s_add_u32 s45, s45, 6144
    buffer_load_dwordx4 v58, s[24:27], s45 offen lds
    s_waitcnt vmcnt(31)
    ds_read2st64_b32 v[240:241], v59 offset0:112 offset1:113
    ds_read2st64_b32 v[244:245], v59 offset0:114 offset1:115
    s_waitcnt lgkmcnt(0)
    s_add_u32 m0, s55, 28672
    s_xor_b32 s45, s28, 3
    s_lshl_b32 s45, s45, 15
    s_add_u32 s45, s45, 16384
    buffer_load_dwordx4 v58, s[24:27], s45 offen lds
    s_waitcnt vmcnt(31)
    ds_read2st64_b32 v[242:243], v59 offset0:116 offset1:117
    ds_read2st64_b32 v[246:247], v59 offset0:118 offset1:119
    s_waitcnt lgkmcnt(0)
    s_add_u32 m0, s55, 29696
    s_xor_b32 s45, s28, 3
    s_lshl_b32 s45, s45, 15
    s_add_u32 s45, s45, 18432
    buffer_load_dwordx4 v58, s[24:27], s45 offen lds
    s_waitcnt vmcnt(31)
    ds_read2st64_b32 v[248:249], v59 offset0:120 offset1:121
    ds_read2st64_b32 v[252:253], v59 offset0:122 offset1:123
    s_waitcnt lgkmcnt(0)
    s_add_u32 m0, s55, 30720
    s_xor_b32 s45, s28, 3
    s_lshl_b32 s45, s45, 15
    s_add_u32 s45, s45, 20480
    buffer_load_dwordx4 v58, s[24:27], s45 offen lds
    s_waitcnt vmcnt(31)
    ds_read2st64_b32 v[250:251], v59 offset0:124 offset1:125
    ds_read2st64_b32 v[254:255], v59 offset0:126 offset1:127
    s_waitcnt lgkmcnt(0)
    s_add_u32 m0, s55, 31744
    s_xor_b32 s45, s28, 3
    s_lshl_b32 s45, s45, 15
    s_add_u32 s45, s45, 22528
    buffer_load_dwordx4 v58, s[24:27], s45 offen lds
    s_waitcnt vmcnt(24)
    ds_read_b128 v[16:19], v106 offset:0
    ds_read_b128 v[20:23], v106 offset:1024
    ds_read_b128 v[24:27], v106 offset:2048
    ds_read_b128 v[28:31], v106 offset:3072
    ds_read_b128 v[32:35], v106 offset:4096
    ds_read_b128 v[36:39], v106 offset:5120
    ds_read_b128 v[40:43], v106 offset:6144
    ds_read_b128 v[44:47], v106 offset:7168
    s_waitcnt lgkmcnt(0)
    ds_write_b128 v106, a[128:131] offset:0
    ds_write_b128 v106, a[132:135] offset:1024
    ds_write_b128 v106, a[0:3] offset:2048
    ds_write_b128 v106, a[4:7] offset:3072
    ds_write_b128 v106, a[136:139] offset:4096
    ds_write_b128 v106, a[140:143] offset:5120
    ds_write_b128 v106, a[8:11] offset:6144
    ds_write_b128 v106, a[12:15] offset:7168
    s_waitcnt lgkmcnt(0)
    v_accvgpr_write_b32 a128, v16
    v_accvgpr_write_b32 a129, v20
    v_accvgpr_write_b32 a130, v24
    v_accvgpr_write_b32 a131, v28
    v_accvgpr_write_b32 a132, v32
    v_accvgpr_write_b32 a133, v36
    v_accvgpr_write_b32 a134, v40
    v_accvgpr_write_b32 a135, v44
    v_accvgpr_write_b32 a0, v17
    v_accvgpr_write_b32 a1, v21
    v_accvgpr_write_b32 a2, v25
    v_accvgpr_write_b32 a3, v29
    v_accvgpr_write_b32 a4, v33
    v_accvgpr_write_b32 a5, v37
    v_accvgpr_write_b32 a6, v41
    v_accvgpr_write_b32 a7, v45
    v_accvgpr_write_b32 a136, v18
    v_accvgpr_write_b32 a137, v22
    v_accvgpr_write_b32 a138, v26
    v_accvgpr_write_b32 a139, v30
    v_accvgpr_write_b32 a140, v34
    v_accvgpr_write_b32 a141, v38
    v_accvgpr_write_b32 a142, v42
    v_accvgpr_write_b32 a143, v46
    v_accvgpr_write_b32 a8, v19
    v_accvgpr_write_b32 a9, v23
    v_accvgpr_write_b32 a10, v27
    v_accvgpr_write_b32 a11, v31
    v_accvgpr_write_b32 a12, v35
    v_accvgpr_write_b32 a13, v39
    v_accvgpr_write_b32 a14, v43
    v_accvgpr_write_b32 a15, v47
    s_waitcnt vmcnt(16)
    ds_read_b128 v[16:19], v106 offset:8192
    ds_read_b128 v[20:23], v106 offset:9216
    ds_read_b128 v[24:27], v106 offset:10240
    ds_read_b128 v[28:31], v106 offset:11264
    ds_read_b128 v[32:35], v106 offset:12288
    ds_read_b128 v[36:39], v106 offset:13312
    ds_read_b128 v[40:43], v106 offset:14336
    ds_read_b128 v[44:47], v106 offset:15360
    s_waitcnt lgkmcnt(0)
    ds_write_b128 v106, a[80:83] offset:12288
    ds_write_b128 v106, a[84:87] offset:13312
    ds_write_b128 v106, a[104:107] offset:14336
    ds_write_b128 v106, a[108:111] offset:15360
    v_mov_b32 v60, v16
    v_mov_b32 v61, v20
    v_mov_b32 v62, v24
    v_mov_b32 v63, v28
    ds_write_b128 v106, v[60:63] offset:8192
    v_mov_b32 v64, v32
    v_mov_b32 v65, v36
    v_mov_b32 v66, v40
    v_mov_b32 v67, v44
    ds_write_b128 v106, v[64:67] offset:9216
    v_mov_b32 v68, v17
    v_mov_b32 v69, v21
    v_mov_b32 v70, v25
    v_mov_b32 v71, v29
    ds_write_b128 v106, v[68:71] offset:10240
    v_mov_b32 v72, v33
    v_mov_b32 v73, v37
    v_mov_b32 v74, v41
    v_mov_b32 v75, v45
    ds_write_b128 v106, v[72:75] offset:11264
    s_waitcnt lgkmcnt(0)
    v_accvgpr_write_b32 a80, v18
    v_accvgpr_write_b32 a81, v22
    v_accvgpr_write_b32 a82, v26
    v_accvgpr_write_b32 a83, v30
    v_accvgpr_write_b32 a84, v34
    v_accvgpr_write_b32 a85, v38
    v_accvgpr_write_b32 a86, v42
    v_accvgpr_write_b32 a87, v46
    v_accvgpr_write_b32 a104, v19
    v_accvgpr_write_b32 a105, v23
    v_accvgpr_write_b32 a106, v27
    v_accvgpr_write_b32 a107, v31
    v_accvgpr_write_b32 a108, v35
    v_accvgpr_write_b32 a109, v39
    v_accvgpr_write_b32 a110, v43
    v_accvgpr_write_b32 a111, v47
    s_waitcnt vmcnt(8)
    ds_read_b128 v[16:19], v106 offset:16384
    ds_read_b128 v[20:23], v106 offset:17408
    ds_read_b128 v[24:27], v106 offset:18432
    ds_read_b128 v[28:31], v106 offset:19456
    ds_read_b128 v[32:35], v106 offset:20480
    ds_read_b128 v[36:39], v106 offset:21504
    ds_read_b128 v[40:43], v106 offset:22528
    ds_read_b128 v[44:47], v106 offset:23552
    s_waitcnt lgkmcnt(0)
    ds_write_b128 v106, a[88:91] offset:20480
    ds_write_b128 v106, a[92:95] offset:21504
    ds_write_b128 v106, a[112:115] offset:22528
    ds_write_b128 v106, a[116:119] offset:23552
    v_mov_b32 v60, v16
    v_mov_b32 v61, v20
    v_mov_b32 v62, v24
    v_mov_b32 v63, v28
    ds_write_b128 v106, v[60:63] offset:16384
    v_mov_b32 v64, v32
    v_mov_b32 v65, v36
    v_mov_b32 v66, v40
    v_mov_b32 v67, v44
    ds_write_b128 v106, v[64:67] offset:17408
    v_mov_b32 v68, v17
    v_mov_b32 v69, v21
    v_mov_b32 v70, v25
    v_mov_b32 v71, v29
    ds_write_b128 v106, v[68:71] offset:18432
    v_mov_b32 v72, v33
    v_mov_b32 v73, v37
    v_mov_b32 v74, v41
    v_mov_b32 v75, v45
    ds_write_b128 v106, v[72:75] offset:19456
    s_waitcnt lgkmcnt(0)
    v_accvgpr_write_b32 a88, v18
    v_accvgpr_write_b32 a89, v22
    v_accvgpr_write_b32 a90, v26
    v_accvgpr_write_b32 a91, v30
    v_accvgpr_write_b32 a92, v34
    v_accvgpr_write_b32 a93, v38
    v_accvgpr_write_b32 a94, v42
    v_accvgpr_write_b32 a95, v46
    v_accvgpr_write_b32 a112, v19
    v_accvgpr_write_b32 a113, v23
    v_accvgpr_write_b32 a114, v27
    v_accvgpr_write_b32 a115, v31
    v_accvgpr_write_b32 a116, v35
    v_accvgpr_write_b32 a117, v39
    v_accvgpr_write_b32 a118, v43
    v_accvgpr_write_b32 a119, v47
    s_waitcnt vmcnt(0)
    v_lshrrev_b32 v4, 2, v2
    v_and_b32 v5, 3, v2
    v_and_b32 v6, 1, v4
    v_lshlrev_b32 v6, 4, v6
    v_mov_b32 v7, 0x3f80
    v_lshlrev_b32 v7, v6, v7
    v_lshrrev_b32 v4, 1, v4
    v_lshl_add_u32 v4, v5, 1, v4
    v_cmp_eq_u32 vcc, 0, v4
    s_nop 1
    v_cndmask_b32 v80, 0, v7, vcc
    v_cmp_eq_u32 vcc, 1, v4
    s_nop 1
    v_cndmask_b32 v81, 0, v7, vcc
    v_cmp_eq_u32 vcc, 2, v4
    s_nop 1
    v_cndmask_b32 v82, 0, v7, vcc
    v_cmp_eq_u32 vcc, 3, v4
    s_nop 1
    v_cndmask_b32 v83, 0, v7, vcc
    ds_write_b128 v104, v[80:83] offset:28672
    s_mov_b32 s45, 2
    v_mov_b32 v12, 0
    v_lshlrev_b32 v13, 2, v0
    v_add_u32 v13, 160768, v13
    ds_write_b32 v13, v12
    v_mov_b32 v73, 132
L_pd_4:
    buffer_load_dword v72, v73, s[8:11], 0 offen sc1
    s_waitcnt vmcnt(0)
    v_readfirstlane_b32 s30, v72
    s_and_b32 s57, s30, 0xffff
    s_cmp_ge_u32 s57, 32
    s_cbranch_scc1 L_pdd_5
    s_sleep 2
    s_add_u32 s100, s100, 1
    s_bitcmp1_b32 s100, 15
    s_cbranch_scc1 L_exit
    s_branch L_pd_4
L_pdd_5:
    s_lshr_b32 s51, s30, 16
    s_cmp_ge_u32 s42, s45
    s_cbranch_scc1 L_kvd_7
L_kvw_6:
    v_mov_b32 v76, 0
    buffer_load_dwordx4 v[72:75], v76, s[4:7], s50 offen sc1
    s_waitcnt vmcnt(0)
    v_min_u32 v72, v72, v74
    v_min_u32 v73, v73, v75
    v_lshlrev_b32 v72, 1, v72
    v_lshl_or_b32 v73, v73, 1, 1
    v_min_u32 v72, v72, v73
    s_nop 0
    v_readfirstlane_b32 s30, v72
    s_max_u32 s42, s42, s30
    s_cmp_ge_u32 s42, s45
    s_cbranch_scc1 L_kvd_7
    s_sleep 1
    s_add_u32 s100, s100, 1
    s_bitcmp1_b32 s100, 15
    s_cbranch_scc1 L_exit
    s_branch L_kvw_6
L_kvd_7:
    s_mov_b32 m0, s43
    s_nop 0
    buffer_load_dwordx4 v104, s[4:7], s39 offen sc1 lds
    buffer_load_dwordx4 v104, s[4:7], s39 offen offset:1024 sc1 lds
    s_add_u32 s39, s39, 0x40000
    s_xor_b32 s43, s43, 0x6000
    ds_read_b128 v[16:19], v106 offset:24576
    ds_read_b128 v[20:23], v106 offset:25600
    ds_read_b128 v[24:27], v106 offset:26624
    ds_read_b128 v[28:31], v106 offset:27648
    ds_read_b128 v[32:35], v106 offset:28672
    ds_read_b128 v[36:39], v106 offset:29696
    ds_read_b128 v[40:43], v106 offset:30720
    ds_read_b128 v[44:47], v106 offset:31744
    s_waitcnt lgkmcnt(0)
    ds_write_b128 v106, a[96:99] offset:28672
    ds_write_b128 v106, a[100:103] offset:29696
    ds_write_b128 v106, a[120:123] offset:30720
    ds_write_b128 v106, a[124:127] offset:31744
    v_mov_b32 v60, v16
    v_mov_b32 v61, v20
    v_mov_b32 v62, v24
    v_mov_b32 v63, v28
    ds_write_b128 v106, v[60:63] offset:24576
    v_mov_b32 v64, v32
    v_mov_b32 v65, v36
    v_mov_b32 v66, v40
    v_mov_b32 v67, v44
    ds_write_b128 v106, v[64:67] offset:25600
    v_mov_b32 v68, v17
    v_mov_b32 v69, v21
    v_mov_b32 v70, v25
    v_mov_b32 v71, v29
    ds_write_b128 v106, v[68:71] offset:26624
    v_mov_b32 v72, v33
    v_mov_b32 v73, v37
    v_mov_b32 v74, v41
    v_mov_b32 v75, v45
    ds_write_b128 v106, v[72:75] offset:27648
    s_waitcnt lgkmcnt(0)
    v_accvgpr_write_b32 a96, v18
    v_accvgpr_write_b32 a97, v22
    v_accvgpr_write_b32 a98, v26
    v_accvgpr_write_b32 a99, v30
    v_accvgpr_write_b32 a100, v34
    v_accvgpr_write_b32 a101, v38
    v_accvgpr_write_b32 a102, v42
    v_accvgpr_write_b32 a103, v46
    v_accvgpr_write_b32 a120, v19
    v_accvgpr_write_b32 a121, v23
    v_accvgpr_write_b32 a122, v27
    v_accvgpr_write_b32 a123, v31
    v_accvgpr_write_b32 a124, v35
    v_accvgpr_write_b32 a125, v39
    v_accvgpr_write_b32 a126, v43
    v_accvgpr_write_b32 a127, v47
    s_cmp_lt_u32 s28, 2
    s_cselect_b32 s45, s60, s61
    v_mov_b32 v6, s45
    v_perm_b32 v16, v89, v88, v6
    v_min_u32 v16, -2, v16
    v_perm_b32 v17, v91, v90, v6
    v_min_u32 v17, -2, v17
    v_perm_b32 v18, v93, v92, v6
    v_min_u32 v18, -2, v18
    v_perm_b32 v19, v95, v94, v6
    v_min_u32 v19, -2, v19
    v_perm_b32 v20, v97, v96, v6
    v_min_u32 v20, -2, v20
    v_perm_b32 v21, v99, v98, v6
    v_min_u32 v21, -2, v21
    v_perm_b32 v22, v101, v100, v6
    v_min_u32 v22, -2, v22
    v_perm_b32 v23, v103, v102, v6
    v_min_u32 v23, -2, v23
    v_mov_b32 v80, 0
    buffer_load_dwordx4 v[76:79], v80, s[4:7], s50 offen sc1
    s_waitcnt vmcnt(0)
    v_min_u32 v76, v76, v78
    v_min_u32 v77, v77, v79
    v_lshlrev_b32 v76, 1, v76
    v_lshl_or_b32 v77, v77, 1, 1
    v_min_u32 v76, v76, v77
    s_nop 0
    v_readfirstlane_b32 s30, v76
    s_max_u32 s42, s42, s30
    s_waitcnt vmcnt(0) lgkmcnt(0)
    s_barrier
    v_mov_b64 v[120:121], 0
    v_mov_b64 v[122:123], 0
    v_mov_b64 v[124:125], 0
    v_mov_b64 v[126:127], 0
    v_mov_b64 v[112:113], 0
    v_mov_b64 v[114:115], 0
    v_mov_b32 v72, v16
    v_mov_b32 v73, v17
    v_mov_b32 v74, v18
    v_mov_b32 v75, v19
    v_mov_b32 v76, v20
    v_mov_b32 v77, v21
    v_mov_b32 v78, v22
    v_mov_b32 v79, v23
    s_lshl_b32 s45, s28, 11
    s_add_u32 s47, s47, s45
    s_waitcnt lgkmcnt(0)
    s_cmp_eq_u32 s51, 0
    s_cbranch_scc0 L_go_safe
L_go_fast:
    s_cmp_eq_u32 s28, 0
    s_cbranch_scc1 L_enter_fast0
    s_cmp_eq_u32 s28, 1
    s_cbranch_scc1 L_enter_fast1
    s_cmp_eq_u32 s28, 2
    s_cbranch_scc1 L_enter_fast2
    s_branch L_enter_fast3
L_go_safe:
    s_cmp_eq_u32 s28, 0
    s_cbranch_scc1 L_enter_safe0
    s_cmp_eq_u32 s28, 1
    s_cbranch_scc1 L_enter_safe1
    s_cmp_eq_u32 s28, 2
    s_cbranch_scc1 L_enter_safe2
    s_branch L_enter_safe3
    .p2align 6
L_loop_fast0:
    s_add_u32 s46, s31, 2
    s_and_b32 s46, s46, 3
    s_lshl_b32 s46, s46, 13
    s_add_u32 s46, s46, 0xa00000
    buffer_store_dword v30, v109, s[4:7], s46 offen
    s_mov_b32 m0, s43
    ds_read_b128 v[64:67], v106 offset:12288
    ds_read_b128 v[68:71], v106 offset:13312
    ds_read_b128 v[80:83], v106 offset:20480
    ds_read_b128 v[84:87], v106 offset:21504
    ds_read_b128 v[32:35], v106 offset:0
    ds_read_b128 v[36:39], v106 offset:1024
    ds_read_b128 v[40:43], v106 offset:2048
    ds_read_b128 v[44:47], v106 offset:3072
    ds_read_b128 v[48:51], v106 offset:4096
    ds_read_b128 v[52:55], v106 offset:5120
    ds_read_b128 v[56:59], v106 offset:6144
    ds_read_b128 v[60:63], v106 offset:7168
    s_nop 11
    buffer_load_dwordx4 v[72:75], v104, s[4:7], s38 offen sc1
    buffer_load_dwordx4 v[76:79], v104, s[4:7], s38 offen offset:1024 sc1
    s_nop 15
    s_nop 15
    s_nop 11
    buffer_load_dwordx4 v[88:91], v104, s[4:7], s38 offen sc1
    buffer_load_dwordx4 v[92:95], v104, s[4:7], s38 offen offset:1024 sc1
    s_waitcnt vmcnt(3)
    ds_write_b128 v104, v[72:75] offset:0
    s_waitcnt vmcnt(2)
    ds_write_b128 v104, v[76:79] offset:1024
    v_max3_u32 v26, v72, v73, v74
    v_max3_u32 v27, v76, v77, v78
    v_max_u32 v26, v26, v75
    v_max_u32 v27, v27, v79
    v_cmp_eq_u32 vcc, -1, v26
    v_cmp_eq_u32 s[16:17], -1, v27
    s_or_b64 s[18:19], vcc, s[16:17]
    s_cbranch_scc1 L_p2b_fast0
L_go_fast0:
    s_waitcnt lgkmcnt(0)
    s_barrier
    ds_read_b128 v[0:3], v118 offset:0
    ds_read_b128 v[4:7], v119 offset:128
    ds_read_b128 v[8:11], v118 offset:256
    ds_read_b128 v[12:15], v119 offset:384
    ds_read_b128 v[16:19], v118 offset:512
    s_cmp_eq_u32 s31, 63
    s_cbranch_scc1 L_chain_end
    s_waitcnt lgkmcnt(4)
    v_smfmac_f32_16x16x64_bf16 v[124:127], v[0:3], v[32:39], v107
    ds_read_b128 v[20:23], v119 offset:640
    v_smfmac_f32_16x16x64_bf16 v[120:123], v[0:3], v[40:47], v107
    s_waitcnt lgkmcnt(4)
    v_smfmac_f32_16x16x64_bf16 v[124:127], v[4:7], v[48:55], v107
    ds_read_b128 v[24:27], v118 offset:768
    v_smfmac_f32_16x16x64_bf16 v[120:123], v[4:7], v[56:63], v107
    s_waitcnt lgkmcnt(4)
    v_smfmac_f32_16x16x64_bf16 v[124:127], v[8:11], a[144:151], v107
    ds_read_b128 v[28:31], v119 offset:896
    v_smfmac_f32_16x16x64_bf16 v[120:123], v[8:11], a[16:23], v107
    s_waitcnt lgkmcnt(4)
    v_smfmac_f32_16x16x64_bf16 v[124:127], v[12:15], a[152:159], v107
    ds_read_b128 v[32:35], v118 offset:1024
    v_smfmac_f32_16x16x64_bf16 v[120:123], v[12:15], a[24:31], v107
    buffer_load_dwordx4 v[96:99], v104, s[4:7], s40 offen sc1
    s_waitcnt lgkmcnt(4)
    v_smfmac_f32_16x16x64_bf16 v[124:127], v[16:19], a[160:167], v107
    ds_read_b128 v[36:39], v119 offset:1152
    v_smfmac_f32_16x16x64_bf16 v[120:123], v[16:19], a[32:39], v107
    s_waitcnt lgkmcnt(4)
    v_smfmac_f32_16x16x64_bf16 v[124:127], v[20:23], a[168:175], v107
    ds_read_b128 v[40:43], v118 offset:1280
    v_smfmac_f32_16x16x64_bf16 v[120:123], v[20:23], a[40:47], v107
    buffer_load_dwordx4 v[100:103], v104, s[4:7], s40 offen offset:1024 sc1
    s_waitcnt vmcnt(2)
    s_waitcnt lgkmcnt(4)
    v_smfmac_f32_16x16x64_bf16 v[124:127], v[24:27], a[176:183], v107
    ds_read_b128 v[44:47], v119 offset:1408
    v_smfmac_f32_16x16x64_bf16 v[120:123], v[24:27], a[48:55], v107
    ds_read_b128 v[72:75], v106 offset:28672
    s_waitcnt lgkmcnt(5)
    v_smfmac_f32_16x16x64_bf16 v[124:127], v[28:31], a[184:191], v107
    ds_read_b128 v[48:51], v118 offset:1536
    v_smfmac_f32_16x16x64_bf16 v[120:123], v[28:31], a[56:63], v107
    ds_read_b128 v[76:79], v106 offset:29696
    buffer_load_dwordx4 v104, s[4:7], s39 offen sc1 lds
    s_waitcnt lgkmcnt(6)
    v_smfmac_f32_16x16x64_bf16 v[124:127], v[32:35], a[192:199], v107
    ds_read_b128 v[52:55], v119 offset:1664
    v_smfmac_f32_16x16x64_bf16 v[120:123], v[32:35], a[64:71], v107
    ds_read_b128 v[88:91], v106 offset:14336
    s_waitcnt lgkmcnt(7)
    v_smfmac_f32_16x16x64_bf16 v[124:127], v[36:39], a[200:207], v107
    ds_read_b128 v[56:59], v118 offset:1792
    v_smfmac_f32_16x16x64_bf16 v[120:123], v[36:39], a[72:79], v107
    ds_read_b128 v[92:95], v106 offset:15360
    buffer_load_dwordx4 v104, s[4:7], s39 offen offset:1024 sc1 lds
    s_mov_b32 m0, 163072
    s_waitcnt lgkmcnt(8)
    v_smfmac_f32_16x16x64_bf16 v[124:127], v[40:43], a[208:215], v107
    ds_read_b128 v[60:63], v119 offset:1920
    v_smfmac_f32_16x16x64_bf16 v[120:123], v[40:43], v[64:71], v107
    ds_read_b128 v[64:67], v106 offset:22528
    ds_read_b128 v[68:71], v106 offset:23552
    s_waitcnt lgkmcnt(10)
    v_smfmac_f32_16x16x64_bf16 v[124:127], v[44:47], a[216:223], v107
    v_smfmac_f32_16x16x64_bf16 v[120:123], v[44:47], v[80:87], v107
    ds_read_b128 v[80:83], v106 offset:30720
    ds_read_b128 v[84:87], v106 offset:31744
    buffer_load_dword v117, s[4:7], s40 offen sc1 lds
    s_waitcnt lgkmcnt(10)
    v_smfmac_f32_16x16x64_bf16 v[124:127], v[48:51], a[224:231], v107
    s_waitcnt lgkmcnt(9)
    v_smfmac_f32_16x16x64_bf16 v[120:123], v[48:51], v[72:79], v107
    s_add_u32 s39, s39, 0x40000
    s_add_u32 s40, s40, 0x40000
    s_xor_b32 s43, s43, 0x6000
    s_waitcnt lgkmcnt(8)
    v_smfmac_f32_16x16x64_bf16 v[124:127], v[52:55], a[232:239], v107
    s_waitcnt lgkmcnt(5)
    v_smfmac_f32_16x16x64_bf16 v[120:123], v[52:55], v[88:95], v107
    v_smfmac_f32_16x16x64_bf16 v[124:127], v[56:59], a[240:247], v107
    s_waitcnt lgkmcnt(2)
    v_smfmac_f32_16x16x64_bf16 v[120:123], v[56:59], v[64:71], v107
    v_smfmac_f32_16x16x64_bf16 v[124:127], v[60:63], a[248:255], v107
    s_waitcnt lgkmcnt(0)
    v_smfmac_f32_16x16x64_bf16 v[120:123], v[60:63], v[80:87], v107
    v_smfmac_f32_16x16x64_bf16 v[112:115], v[0:3], v[128:135], v107
    v_smfmac_f32_16x16x64_bf16 v[112:115], v[4:7], v[136:143], v107
    v_cvt_pk_bf16_f32 v68, v124, v125
    v_smfmac_f32_16x16x64_bf16 v[112:115], v[8:11], v[144:151], v107
    v_cvt_pk_bf16_f32 v69, v126, v127
    ds_write_b64 v110, v[68:69]
    v_smfmac_f32_16x16x64_bf16 v[112:115], v[12:15], v[152:159], v107
    v_cvt_pk_bf16_f32 v120, v120, v121
    v_smfmac_f32_16x16x64_bf16 v[112:115], v[16:19], v[160:167], v107
    v_cvt_pk_bf16_f32 v121, v122, v123
    ds_write_b64 v110, v[120:121] offset:2048
    v_smfmac_f32_16x16x64_bf16 v[112:115], v[20:23], v[168:175], v107
    ds_read_b128 v[0:3], v116 offset:8192
    v_mov_b32 v125, 0
    v_smfmac_f32_16x16x64_bf16 v[112:115], v[24:27], v[176:183], v107
    ds_read_b128 v[4:7], v116 offset:9216
    v_mov_b32 v126, 0
    v_smfmac_f32_16x16x64_bf16 v[112:115], v[28:31], v[184:191], v107
    ds_read_b128 v[8:11], v116 offset:10240
    v_smfmac_f32_16x16x64_bf16 v[112:115], v[32:35], v[192:199], v107
    ds_read_b128 v[12:15], v116 offset:11264
    v_smfmac_f32_16x16x64_bf16 v[112:115], v[36:39], v[200:207], v107
    ds_read_b128 v[16:19], v116 offset:12288
    s_waitcnt lgkmcnt(5)
    s_barrier
    v_smfmac_f32_16x16x64_bf16 v[112:115], v[40:43], v[208:215], v107
    ds_read_b64_tr_b16 v[64:65], v111 offset:0
    ds_read_b64_tr_b16 v[66:67], v111 offset:256
    v_min_u32 v120, -2, v120
    v_smfmac_f32_16x16x64_bf16 v[112:115], v[44:47], v[216:223], v107
    ds_read_b64_tr_b16 v[68:69], v111 offset:512
    ds_read_b64_tr_b16 v[70:71], v111 offset:768
    v_smfmac_f32_16x16x64_bf16 v[112:115], v[48:51], v[224:231], v107
    ds_read_b64_tr_b16 v[72:73], v111 offset:1024
    ds_read_b64_tr_b16 v[74:75], v111 offset:1280
    v_smfmac_f32_16x16x64_bf16 v[112:115], v[52:55], v[232:239], v107
    ds_read_b64_tr_b16 v[76:77], v111 offset:1536
    ds_read_b64_tr_b16 v[78:79], v111 offset:1792
    v_smfmac_f32_16x16x64_bf16 v[112:115], v[56:59], v[240:247], v107
    ds_read_b128 v[20:23], v116 offset:13312
    v_mov_b64 v[48:49], s[98:99]
    v_smfmac_f32_16x16x64_bf16 v[112:115], v[60:63], v[248:255], v107
    ds_read_b128 v[24:27], v116 offset:14336
    v_mov_b64 v[50:51], s[98:99]
    s_waitcnt lgkmcnt(8)
    v_mfma_f32_16x16x32_bf16 v[32:35], v[0:3], v[64:67], 0
    ds_read_b128 v[28:31], v116 offset:15360
    ds_read_b64_tr_b16 v[80:81], v111 offset:2048
    ds_read_b64_tr_b16 v[82:83], v111 offset:2304
    s_waitcnt lgkmcnt(9)
    v_mfma_f32_16x16x32_bf16 v[32:35], v[4:7], v[68:71], v[32:35]
    ds_read_b64_tr_b16 v[84:85], v111 offset:2560
    ds_read_b64_tr_b16 v[86:87], v111 offset:2816
    s_waitcnt lgkmcnt(9)
    v_mfma_f32_16x16x32_bf16 v[32:35], v[8:11], v[72:75], v[32:35]
    ds_read_b64_tr_b16 v[88:89], v111 offset:3072
    ds_read_b64_tr_b16 v[90:91], v111 offset:3328
    v_cvt_pk_bf16_f32 v122, v112, v113
    s_waitcnt lgkmcnt(9)
    v_mfma_f32_16x16x32_bf16 v[32:35], v[12:15], v[76:79], v[32:35]
    ds_read_b64_tr_b16 v[92:93], v111 offset:3584
    ds_read_b64_tr_b16 v[94:95], v111 offset:3840
    v_cvt_pk_bf16_f32 v123, v114, v115
    s_waitcnt lgkmcnt(8)
    v_mfma_f32_16x16x32_bf16 v[36:39], v[16:19], v[64:67], 0
    v_xor_b32 v116, 0x2000, v116
    v_mfma_f32_16x16x32_bf16 v[36:39], v[20:23], v[68:71], v[36:39]
    v_permlane32_swap_b32 v122, v123
    v_mfma_f32_16x16x32_bf16 v[36:39], v[24:27], v[72:75], v[36:39]
    buffer_store_dwordx4 v[120:123], v104, s[4:7], s41 offen sc1
    v_mfma_f32_16x16x32_bf16 v[36:39], v[28:31], v[76:79], v[36:39]
    s_waitcnt lgkmcnt(0)
    v_mfma_f32_16x16x32_bf16 v[40:43], v[80:83], v[64:67], 0
    ds_read_b128 v[56:59], v106 offset:18432
    v_max3_f32 v44, v32, v33, v34
    v_mfma_f32_16x16x32_bf16 v[40:43], v[84:87], v[68:71], v[40:43]
    ds_read_b128 v[60:63], v106 offset:19456
    v_mfma_f32_16x16x32_bf16 v[40:43], v[88:91], v[72:75], v[40:43]
    ds_read_b128 v[0:3], v106 offset:8192
    v_max3_f32 v45, v35, v36, v37
    v_max3_f32 v44, v44, v38, v39
    v_mfma_f32_16x16x32_bf16 v[40:43], v[92:95], v[76:79], v[40:43]
    v_max_f32 v44, v44, v45
    v_mov_b32 v45, v44
    ds_read_b128 v[4:7], v106 offset:9216
    s_nop 0
    v_permlane32_swap_b32 v44, v45
    s_nop 2
    v_max3_f32 v46, v40, v41, v42
    v_max3_f32 v44, v44, v45, v43
    v_max_f32 v44, v44, v46
    v_mov_b32 v45, v44
    v_cndmask_b32 v40, v40, v42, s[48:49]
    v_cndmask_b32 v41, v41, v43, s[48:49]
    v_permlane16_swap_b32 v44, v45
    v_max_f32 v44, v44, v45
    v_mul_f32 v44, s34, v44
    v_pk_fma_f32 v[32:33], v[32:33], s[34:35], v[44:45] op_sel_hi:[1,1,0] neg_lo:[0,0,1] neg_hi:[0,0,1]
    v_pk_fma_f32 v[34:35], v[34:35], s[34:35], v[44:45] op_sel_hi:[1,1,0] neg_lo:[0,0,1] neg_hi:[0,0,1]
    v_pk_fma_f32 v[36:37], v[36:37], s[34:35], v[44:45] op_sel_hi:[1,1,0] neg_lo:[0,0,1] neg_hi:[0,0,1]
    v_pk_fma_f32 v[38:39], v[38:39], s[34:35], v[44:45] op_sel_hi:[1,1,0] neg_lo:[0,0,1] neg_hi:[0,0,1]
    v_pk_fma_f32 v[40:41], v[40:41], s[34:35], v[44:45] op_sel_hi:[1,1,0] neg_lo:[0,0,1] neg_hi:[0,0,1]
    v_exp_f32 v32, v32
    v_exp_f32 v33, v33
    v_exp_f32 v34, v34
    v_exp_f32 v35, v35
    v_exp_f32 v36, v36
    v_exp_f32 v37, v37
    v_exp_f32 v38, v38
    v_exp_f32 v39, v39
    v_cvt_pk_bf16_f32 v44, v32, v33
    v_cvt_pk_bf16_f32 v45, v34, v35
    v_cvt_pk_bf16_f32 v46, v36, v37
    v_cvt_pk_bf16_f32 v47, v38, v39
    v_exp_f32 v40, v40
    v_exp_f32 v41, v41
    s_waitcnt vmcnt(4)
    v_mfma_f32_16x16x32_bf16 v[52:55], v[48:51], v[44:47], 0
    ds_read_b128 v[8:11], v106 offset:16384
    v_cvt_pk_bf16_f32 v124, v40, v41
    v_cvt_pk_bf16_f32 v127, v40, v41
    v_mfma_f32_16x16x32_bf16 v[32:35], v[96:99], v[44:47], 0
    ds_read_b128 v[12:15], v106 offset:17408
    v_mov_b64 v[64:65], 0
    v_mov_b64 v[66:67], 0
    v_mfma_f32_16x16x32_bf16 v[36:39], v[100:103], v[44:47], 0
    ds_read_b128 v[16:19], v106 offset:24576
    v_mov_b64 v[68:69], 0
    v_mfma_f32_16x16x16_bf16 v[52:55], v[48:49], v[124:125], v[52:55]
    ds_read_b128 v[20:23], v106 offset:25600
    v_mov_b64 v[70:71], 0
    v_mfma_f32_16x16x16_bf16 v[32:35], v[122:123], v[124:125], v[32:35]
    ds_read_b128 v[24:27], v106 offset:10240
    v_mov_b64 v[72:73], 0
    v_mfma_f32_16x16x16_bf16 v[36:39], v[122:123], v[126:127], v[36:39]
    ds_read_b128 v[28:31], v106 offset:11264
    v_mov_b64 v[74:75], 0
    v_rcp_f32 v52, v52
    v_mov_b64 v[76:77], 0
    s_nop 0
    v_pk_mul_f32 v[32:33], v[32:33], v[52:53] op_sel_hi:[1,0]
    v_pk_mul_f32 v[34:35], v[34:35], v[52:53] op_sel_hi:[1,0]
    v_mov_b64 v[78:79], 0
    v_pk_mul_f32 v[36:37], v[36:37], v[52:53] op_sel_hi:[1,0]
    v_pk_mul_f32 v[38:39], v[38:39], v[52:53] op_sel_hi:[1,0]
    v_cvt_pk_bf16_f32 v48, v32, v33
    v_cvt_pk_bf16_f32 v49, v34, v35
    v_cvt_pk_bf16_f32 v50, v36, v37
    v_cvt_pk_bf16_f32 v51, v38, v39
    ds_write_b128 v105, v[48:51] offset:29952
    s_nop 0
    v_smfmac_f32_16x16x64_bf16 v[64:67], v[48:51], a[128:135], v107
    ds_read_b128 v[96:99], v106 offset:26624
    v_smfmac_f32_16x16x64_bf16 v[68:71], v[48:51], a[0:7], v107
    ds_read_b128 v[100:103], v106 offset:27648
    v_smfmac_f32_16x16x64_bf16 v[72:75], v[48:51], a[136:143], v107
    v_smfmac_f32_16x16x64_bf16 v[76:79], v[48:51], a[8:15], v107
    s_waitcnt lgkmcnt(2)
    s_barrier
    ds_read_b128 v[112:115], v105 offset:30464
    ds_read_b128 v[120:123], v105 offset:30976
    ds_read_b128 v[52:55], v105 offset:31488
    s_waitcnt lgkmcnt(2)
    v_smfmac_f32_16x16x64_bf16 v[64:67], v[112:115], v[0:7], v107
    s_waitcnt lgkmcnt(1)
    v_smfmac_f32_16x16x64_bf16 v[64:67], v[120:123], v[8:15], v107
    s_waitcnt lgkmcnt(0)
    v_smfmac_f32_16x16x64_bf16 v[64:67], v[52:55], v[16:23], v107
    v_smfmac_f32_16x16x64_bf16 v[68:71], v[112:115], v[24:31], v107
    ds_read_b128 v[88:91], v104 offset:28672
    v_smfmac_f32_16x16x64_bf16 v[68:71], v[120:123], v[56:63], v107
    v_smfmac_f32_16x16x64_bf16 v[68:71], v[52:55], v[96:103], v107
    v_cvt_pk_bf16_f32 v48, v64, v65
    v_smfmac_f32_16x16x64_bf16 v[72:75], v[112:115], a[80:87], v107
    v_cvt_pk_bf16_f32 v49, v66, v67
    v_smfmac_f32_16x16x64_bf16 v[72:75], v[120:123], a[88:95], v107
    v_and_or_b32 v48, v48, -2, s101
    v_smfmac_f32_16x16x64_bf16 v[72:75], v[52:55], a[96:103], v107
    v_cvt_pk_bf16_f32 v50, v68, v69
    v_cvt_pk_bf16_f32 v51, v70, v71
    v_smfmac_f32_16x16x64_bf16 v[76:79], v[112:115], a[104:111], v107
    buffer_store_dwordx4 v[48:51], v108, s[4:7], s32 offen
    v_smfmac_f32_16x16x64_bf16 v[76:79], v[120:123], a[112:119], v107
    v_smfmac_f32_16x16x64_bf16 v[76:79], v[52:55], a[120:127], v107
    v_cvt_pk_bf16_f32 v56, v72, v73
    v_cvt_pk_bf16_f32 v57, v74, v75
    v_and_or_b32 v56, v56, -2, s101
    s_add_u32 s36, s32, 8192
    s_and_b32 s45, s31, 3
    s_lshl_b32 s45, s45, 18
    s_add_u32 s33, s45, s47
    s_add_u32 s31, s31, 1
    v_cvt_pk_bf16_f32 v58, v76, v77
    v_cvt_pk_bf16_f32 v59, v78, v79
    buffer_store_dwordx4 v[56:59], v108, s[4:7], s36 offen
    s_add_u32 s41, s41, 0x20000
    s_and_b32 s45, s31, 3
    s_lshl_b32 s46, s45, 13
    s_add_u32 s37, s46, 0xa00000
    s_add_u32 s38, s46, 0x9e0000
    s_lshl_b32 s45, s45, 18
    s_add_u32 s32, s45, 0x900000
    s_cmp_lt_u32 s42, s44
    s_cbranch_scc1 L_prg_fast0
    s_nop 15
    s_nop 15
    s_nop 15
    s_nop 7
L_prd_fast0:
    buffer_load_dwordx4 v[0:3], v104, s[4:7], s33 offen sc1
    buffer_load_dwordx4 v[4:7], v104, s[4:7], s33 offen offset:1024 sc1
    v_mov_b64 v[120:121], 0
    s_nop 6
    v_mov_b64 v[122:123], 0
    s_nop 6
    buffer_load_dwordx4 v[8:11], v104, s[4:7], s33 offen sc1
    buffer_load_dwordx4 v[12:15], v104, s[4:7], s33 offen offset:1024 sc1
    v_mov_b64 v[124:125], 0
    s_nop 5
    v_mov_b64 v[126:127], 0
    s_nop 5
    v_mov_b64 v[112:113], 0
    s_nop 5
    v_mov_b64 v[114:115], 0
    s_nop 5
    v_mov_b32 v30, -1
    s_nop 5
    s_waitcnt lgkmcnt(0)
    s_waitcnt vmcnt(3)
    v_mfma_f32_16x16x32_bf16 v[92:95], v[88:91], v[0:3], 0
    v_and_b32 v28, 1, v0
    s_waitcnt vmcnt(2)
    v_mfma_f32_16x16x32_bf16 v[92:95], v[88:91], v[4:7], v[92:95]
    v_and_b32 v29, 1, v4
    v_cmp_ne_u32 vcc, s101, v28
    v_cmp_ne_u32 s[16:17], s101, v29
    s_or_b64 s[18:19], vcc, s[16:17]
    s_cbranch_scc1 L_p1b_fast0
L_p1ok_fast0:
    s_nop 2
    v_add_f32_dpp v92, v92, v92 row_ror:4 row_mask:0xf bank_mask:0xf
    v_add_f32_dpp v93, v93, v93 row_ror:4 row_mask:0xf bank_mask:0xf
    s_nop 0
    v_add_f32_dpp v92, v92, v92 row_ror:8 row_mask:0xf bank_mask:0xf
    v_add_f32_dpp v93, v93, v93 row_ror:8 row_mask:0xf bank_mask:0xf
    v_cvt_pk_bf16_f32 v92, v92, v93
    v_min_u32 v92, -2, v92
    buffer_store_dword v92, v109, s[4:7], s37 offen
    s_bfe_u32 s101, s31, 0x10002
    s_xor_b32 s101, s101, 1
    s_add_u32 s44, s31, 6
    s_cmp_eq_u32 s31, 1
    s_cselect_b32 s44, 64, s44
    s_min_u32 s44, s44, 64
    s_branch L_loop_fast0
L_p1b_fast0:
L_p1r_fast0:
    s_or_b64 exec, vcc, 1
    buffer_load_dwordx4 v[0:3], v104, s[4:7], s33 offen sc1
    s_or_b64 exec, s[16:17], 1
    buffer_load_dwordx4 v[4:7], v104, s[4:7], s33 offen offset:1024 sc1
    s_mov_b64 exec, -1
    s_waitcnt vmcnt(3)
    v_mfma_f32_16x16x32_bf16 v[92:95], v[88:91], v[8:11], 0
    v_and_b32 v28, 1, v8
    s_waitcnt vmcnt(2)
    v_mfma_f32_16x16x32_bf16 v[92:95], v[88:91], v[12:15], v[92:95]
    v_and_b32 v29, 1, v12
    v_cmp_ne_u32 vcc, s101, v28
    v_cmp_ne_u32 s[16:17], s101, v29
    s_or_b64 s[18:19], vcc, s[16:17]
    s_cbranch_scc0 L_p1k_fast0
    s_or_b64 exec, vcc, 1
    buffer_load_dwordx4 v[8:11], v104, s[4:7], s33 offen sc1
    s_or_b64 exec, s[16:17], 1
    buffer_load_dwordx4 v[12:15], v104, s[4:7], s33 offen offset:1024 sc1
    s_mov_b64 exec, -1
    s_add_u32 s100, s100, 1
    s_bitcmp1_b32 s100, 15
    s_cbranch_scc1 L_exit
    s_waitcnt vmcnt(3)
    v_mfma_f32_16x16x32_bf16 v[92:95], v[88:91], v[0:3], 0
    v_and_b32 v28, 1, v0
    s_waitcnt vmcnt(2)
    v_mfma_f32_16x16x32_bf16 v[92:95], v[88:91], v[4:7], v[92:95]
    v_and_b32 v29, 1, v4
    v_cmp_ne_u32 vcc, s101, v28
    v_cmp_ne_u32 s[16:17], s101, v29
    s_or_b64 s[18:19], vcc, s[16:17]
    s_cbranch_scc1 L_p1r_fast0
L_p1k_fast0:
    s_nop 2
    s_branch L_p1ok_fast0
L_p2b_fast0:
L_p2r_fast0:
    s_or_b64 exec, vcc, 1
    buffer_load_dwordx4 v[72:75], v104, s[4:7], s38 offen sc1
    s_or_b64 exec, s[16:17], 1
    buffer_load_dwordx4 v[76:79], v104, s[4:7], s38 offen offset:1024 sc1
    s_mov_b64 exec, -1
    s_waitcnt vmcnt(2)
    ds_write_b128 v104, v[88:91] offset:0
    ds_write_b128 v104, v[92:95] offset:1024
    v_max3_u32 v26, v88, v89, v90
    v_max3_u32 v27, v92, v93, v94
    v_max_u32 v26, v26, v91
    v_max_u32 v27, v27, v95
    v_cmp_eq_u32 vcc, -1, v26
    v_cmp_eq_u32 s[16:17], -1, v27
    s_or_b64 s[18:19], vcc, s[16:17]
    s_cbranch_scc0 L_go_fast0
    s_or_b64 exec, vcc, 1
    buffer_load_dwordx4 v[88:91], v104, s[4:7], s38 offen sc1
    s_or_b64 exec, s[16:17], 1
    buffer_load_dwordx4 v[92:95], v104, s[4:7], s38 offen offset:1024 sc1
    s_mov_b64 exec, -1
    s_add_u32 s100, s100, 1
    s_bitcmp1_b32 s100, 15
    s_cbranch_scc1 L_exit
    s_waitcnt vmcnt(2)
    ds_write_b128 v104, v[72:75] offset:0
    ds_write_b128 v104, v[76:79] offset:1024
    v_max3_u32 v26, v72, v73, v74
    v_max3_u32 v27, v76, v77, v78
    v_max_u32 v26, v26, v75
    v_max_u32 v27, v27, v79
    v_cmp_eq_u32 vcc, -1, v26
    v_cmp_eq_u32 s[16:17], -1, v27
    s_or_b64 s[18:19], vcc, s[16:17]
    s_cbranch_scc1 L_p2r_fast0
    s_branch L_go_fast0
L_enter_fast0:
    ds_write_b128 v104, v[72:75] offset:0
    ds_write_b128 v104, v[76:79] offset:1024
    ds_read_b128 v[64:67], v106 offset:12288
    ds_read_b128 v[68:71], v106 offset:13312
    ds_read_b128 v[80:83], v106 offset:20480
    ds_read_b128 v[84:87], v106 offset:21504
    ds_read_b128 v[32:35], v106 offset:0
    ds_read_b128 v[36:39], v106 offset:1024
    ds_read_b128 v[40:43], v106 offset:2048
    ds_read_b128 v[44:47], v106 offset:3072
    ds_read_b128 v[48:51], v106 offset:4096
    ds_read_b128 v[52:55], v106 offset:5120
    ds_read_b128 v[56:59], v106 offset:6144
    ds_read_b128 v[60:63], v106 offset:7168
    s_mov_b32 m0, s43
    s_branch L_go_fast0
L_prg_fast0:
    v_mov_b32 v72, 160768
    ds_read_b32 v92, v72
    ds_read_b128 v[72:75], v72 offset:16
    s_add_u32 s45, s31, 2
    s_min_u32 s45, s45, 64
    s_waitcnt lgkmcnt(0)
    v_readfirstlane_b32 s30, v92
    s_cmp_eq_u32 s30, 192
    s_cselect_b32 s42, 64, s42
    v_min_u32 v72, v72, v74
    v_min_u32 v73, v73, v75
    v_lshlrev_b32 v72, 1, v72
    v_lshl_or_b32 v73, v73, 1, 1
    v_min_u32 v72, v72, v73
    s_nop 0
    v_readfirstlane_b32 s30, v72
    s_max_u32 s42, s42, s30
    s_cmp_ge_u32 s42, s45
    s_cbranch_scc1 L_kvd_9
L_kvw_8:
    v_mov_b32 v76, 0
    buffer_load_dwordx4 v[72:75], v76, s[4:7], s50 offen sc1
    s_waitcnt vmcnt(0)
    v_min_u32 v72, v72, v74
    v_min_u32 v73, v73, v75
    v_lshlrev_b32 v72, 1, v72
    v_lshl_or_b32 v73, v73, 1, 1
    v_min_u32 v72, v72, v73
    s_nop 0
    v_readfirstlane_b32 s30, v72
    s_max_u32 s42, s42, s30
    s_cmp_ge_u32 s42, s45
    s_cbranch_scc1 L_kvd_9
    s_sleep 1
    s_add_u32 s100, s100, 1
    s_bitcmp1_b32 s100, 15
    s_cbranch_scc1 L_exit
    s_branch L_kvw_8
L_kvd_9:
    s_nop 15
    s_branch L_prd_fast0
    .p2align 6
L_loop_fast1:
    s_add_u32 s46, s31, 2
    s_and_b32 s46, s46, 3
    s_lshl_b32 s46, s46, 13
    s_add_u32 s46, s46, 0xa00000
    buffer_store_dword v30, v109, s[4:7], s46 offen
    s_mov_b32 m0, s43
    ds_read_b128 v[64:67], v106 offset:12288
    ds_read_b128 v[68:71], v106 offset:13312
    ds_read_b128 v[80:83], v106 offset:20480
    ds_read_b128 v[84:87], v106 offset:21504
    ds_read_b128 v[32:35], v106 offset:0
    ds_read_b128 v[36:39], v106 offset:1024
    ds_read_b128 v[40:43], v106 offset:2048
    ds_read_b128 v[44:47], v106 offset:3072
    ds_read_b128 v[48:51], v106 offset:4096
    ds_read_b128 v[52:55], v106 offset:5120
    ds_read_b128 v[56:59], v106 offset:6144
    ds_read_b128 v[60:63], v106 offset:7168
    s_nop 11
    buffer_load_dwordx4 v[72:75], v104, s[4:7], s38 offen sc1
    buffer_load_dwordx4 v[76:79], v104, s[4:7], s38 offen offset:1024 sc1
    s_nop 15
    s_nop 15
    s_nop 11
    buffer_load_dwordx4 v[88:91], v104, s[4:7], s38 offen sc1
    buffer_load_dwordx4 v[92:95], v104, s[4:7], s38 offen offset:1024 sc1
    s_waitcnt vmcnt(3)
    ds_write_b128 v104, v[72:75] offset:2048
    s_waitcnt vmcnt(2)
    ds_write_b128 v104, v[76:79] offset:3072
    v_max3_u32 v26, v72, v73, v74
    v_max3_u32 v27, v76, v77, v78
    v_max_u32 v26, v26, v75
    v_max_u32 v27, v27, v79
    v_cmp_eq_u32 vcc, -1, v26
    v_cmp_eq_u32 s[16:17], -1, v27
    s_or_b64 s[18:19], vcc, s[16:17]
    s_cbranch_scc1 L_p2b_fast1
L_go_fast1:
    s_waitcnt lgkmcnt(0)
    s_barrier
    ds_read_b128 v[0:3], v118 offset:0
    ds_read_b128 v[4:7], v119 offset:128
    ds_read_b128 v[8:11], v118 offset:256
    ds_read_b128 v[12:15], v119 offset:384
    ds_read_b128 v[16:19], v118 offset:512
    s_cmp_eq_u32 s31, 63
    s_cbranch_scc1 L_chain_end
    s_waitcnt lgkmcnt(4)
    v_smfmac_f32_16x16x64_bf16 v[124:127], v[0:3], v[32:39], v107
    ds_read_b128 v[20:23], v119 offset:640
    v_smfmac_f32_16x16x64_bf16 v[120:123], v[0:3], v[40:47], v107
    s_waitcnt lgkmcnt(4)
    v_smfmac_f32_16x16x64_bf16 v[124:127], v[4:7], v[48:55], v107
    ds_read_b128 v[24:27], v118 offset:768
    v_smfmac_f32_16x16x64_bf16 v[120:123], v[4:7], v[56:63], v107
    s_waitcnt lgkmcnt(4)
    v_smfmac_f32_16x16x64_bf16 v[124:127], v[8:11], a[144:151], v107
    ds_read_b128 v[28:31], v119 offset:896
    v_smfmac_f32_16x16x64_bf16 v[120:123], v[8:11], a[16:23], v107
    s_waitcnt lgkmcnt(4)
    v_smfmac_f32_16x16x64_bf16 v[124:127], v[12:15], a[152:159], v107
    ds_read_b128 v[32:35], v118 offset:1024
    v_smfmac_f32_16x16x64_bf16 v[120:123], v[12:15], a[24:31], v107
    buffer_load_dwordx4 v[96:99], v104, s[4:7], s40 offen sc1
    s_waitcnt lgkmcnt(4)
    v_smfmac_f32_16x16x64_bf16 v[124:127], v[16:19], a[160:167], v107
    ds_read_b128 v[36:39], v119 offset:1152
    v_smfmac_f32_16x16x64_bf16 v[120:123], v[16:19], a[32:39], v107
    s_waitcnt lgkmcnt(4)
    v_smfmac_f32_16x16x64_bf16 v[124:127], v[20:23], a[168:175], v107
    ds_read_b128 v[40:43], v118 offset:1280
    v_smfmac_f32_16x16x64_bf16 v[120:123], v[20:23], a[40:47], v107
    buffer_load_dwordx4 v[100:103], v104, s[4:7], s40 offen offset:1024 sc1
    s_waitcnt vmcnt(2)
    s_waitcnt lgkmcnt(4)
    v_smfmac_f32_16x16x64_bf16 v[124:127], v[24:27], a[176:183], v107
    ds_read_b128 v[44:47], v119 offset:1408
    v_smfmac_f32_16x16x64_bf16 v[120:123], v[24:27], a[48:55], v107
    ds_read_b128 v[72:75], v106 offset:28672
    s_waitcnt lgkmcnt(5)
    v_smfmac_f32_16x16x64_bf16 v[124:127], v[28:31], a[184:191], v107
    ds_read_b128 v[48:51], v118 offset:1536
    v_smfmac_f32_16x16x64_bf16 v[120:123], v[28:31], a[56:63], v107
    ds_read_b128 v[76:79], v106 offset:29696
    buffer_load_dwordx4 v104, s[4:7], s39 offen sc1 lds
    s_waitcnt lgkmcnt(6)
    v_smfmac_f32_16x16x64_bf16 v[124:127], v[32:35], a[192:199], v107
    ds_read_b128 v[52:55], v119 offset:1664
    v_smfmac_f32_16x16x64_bf16 v[120:123], v[32:35], a[64:71], v107
    ds_read_b128 v[88:91], v106 offset:14336
    s_waitcnt lgkmcnt(7)
    v_smfmac_f32_16x16x64_bf16 v[124:127], v[36:39], a[200:207], v107
    ds_read_b128 v[56:59], v118 offset:1792
    v_smfmac_f32_16x16x64_bf16 v[120:123], v[36:39], a[72:79], v107
    ds_read_b128 v[92:95], v106 offset:15360
    buffer_load_dwordx4 v104, s[4:7], s39 offen offset:1024 sc1 lds
    s_mov_b32 m0, 163072
    s_waitcnt lgkmcnt(8)
    v_smfmac_f32_16x16x64_bf16 v[124:127], v[40:43], a[208:215], v107
    ds_read_b128 v[60:63], v119 offset:1920
    v_smfmac_f32_16x16x64_bf16 v[120:123], v[40:43], v[64:71], v107
    ds_read_b128 v[64:67], v106 offset:22528
    ds_read_b128 v[68:71], v106 offset:23552
    s_waitcnt lgkmcnt(10)
    v_smfmac_f32_16x16x64_bf16 v[124:127], v[44:47], a[216:223], v107
    v_smfmac_f32_16x16x64_bf16 v[120:123], v[44:47], v[80:87], v107
    ds_read_b128 v[80:83], v106 offset:30720
    ds_read_b128 v[84:87], v106 offset:31744
    buffer_load_dword v117, s[4:7], s40 offen sc1 lds
    s_waitcnt lgkmcnt(10)
    v_smfmac_f32_16x16x64_bf16 v[124:127], v[48:51], a[224:231], v107
    s_waitcnt lgkmcnt(9)
    v_smfmac_f32_16x16x64_bf16 v[120:123], v[48:51], v[72:79], v107
    s_add_u32 s39, s39, 0x40000
    s_add_u32 s40, s40, 0x40000
    s_xor_b32 s43, s43, 0x6000
    s_waitcnt lgkmcnt(8)
    v_smfmac_f32_16x16x64_bf16 v[124:127], v[52:55], a[232:239], v107
    s_waitcnt lgkmcnt(5)
    v_smfmac_f32_16x16x64_bf16 v[120:123], v[52:55], v[88:95], v107
    s_cmp_lt_u32 s42, s44
    s_cbranch_scc1 L_prf_fast1
L_prfd_fast1:
    v_smfmac_f32_16x16x64_bf16 v[124:127], v[56:59], a[240:247], v107
    s_waitcnt lgkmcnt(2)
    v_smfmac_f32_16x16x64_bf16 v[120:123], v[56:59], v[64:71], v107
    v_smfmac_f32_16x16x64_bf16 v[124:127], v[60:63], a[248:255], v107
    s_waitcnt lgkmcnt(0)
    v_smfmac_f32_16x16x64_bf16 v[120:123], v[60:63], v[80:87], v107
    v_smfmac_f32_16x16x64_bf16 v[112:115], v[0:3], v[128:135], v107
    v_smfmac_f32_16x16x64_bf16 v[112:115], v[4:7], v[136:143], v107
    v_cvt_pk_bf16_f32 v68, v124, v125
    v_smfmac_f32_16x16x64_bf16 v[112:115], v[8:11], v[144:151], v107
    v_cvt_pk_bf16_f32 v69, v126, v127
    ds_write_b64 v110, v[68:69]
    v_smfmac_f32_16x16x64_bf16 v[112:115], v[12:15], v[152:159], v107
    v_cvt_pk_bf16_f32 v120, v120, v121
    v_smfmac_f32_16x16x64_bf16 v[112:115], v[16:19], v[160:167], v107
    v_cvt_pk_bf16_f32 v121, v122, v123
    ds_write_b64 v110, v[120:121] offset:2048
    v_smfmac_f32_16x16x64_bf16 v[112:115], v[20:23], v[168:175], v107
    ds_read_b128 v[0:3], v116 offset:8192
    v_mov_b32 v125, 0
    v_smfmac_f32_16x16x64_bf16 v[112:115], v[24:27], v[176:183], v107
    ds_read_b128 v[4:7], v116 offset:9216
    v_mov_b32 v126, 0
    v_smfmac_f32_16x16x64_bf16 v[112:115], v[28:31], v[184:191], v107
    ds_read_b128 v[8:11], v116 offset:10240
    v_smfmac_f32_16x16x64_bf16 v[112:115], v[32:35], v[192:199], v107
    ds_read_b128 v[12:15], v116 offset:11264
    v_smfmac_f32_16x16x64_bf16 v[112:115], v[36:39], v[200:207], v107
    ds_read_b128 v[16:19], v116 offset:12288
    s_waitcnt lgkmcnt(5)
    s_barrier
    v_smfmac_f32_16x16x64_bf16 v[112:115], v[40:43], v[208:215], v107
    ds_read_b64_tr_b16 v[64:65], v111 offset:0
    ds_read_b64_tr_b16 v[66:67], v111 offset:256
    v_min_u32 v120, -2, v120
    v_smfmac_f32_16x16x64_bf16 v[112:115], v[44:47], v[216:223], v107
    ds_read_b64_tr_b16 v[68:69], v111 offset:512
    ds_read_b64_tr_b16 v[70:71], v111 offset:768
    v_smfmac_f32_16x16x64_bf16 v[112:115], v[48:51], v[224:231], v107
    ds_read_b64_tr_b16 v[72:73], v111 offset:1024
    ds_read_b64_tr_b16 v[74:75], v111 offset:1280
    v_smfmac_f32_16x16x64_bf16 v[112:115], v[52:55], v[232:239], v107
    ds_read_b64_tr_b16 v[76:77], v111 offset:1536
    ds_read_b64_tr_b16 v[78:79], v111 offset:1792
    v_smfmac_f32_16x16x64_bf16 v[112:115], v[56:59], v[240:247], v107
    ds_read_b128 v[20:23], v116 offset:13312
    v_mov_b64 v[48:49], s[98:99]
    v_smfmac_f32_16x16x64_bf16 v[112:115], v[60:63], v[248:255], v107
    ds_read_b128 v[24:27], v116 offset:14336
    v_mov_b64 v[50:51], s[98:99]
    s_waitcnt lgkmcnt(8)
    v_mfma_f32_16x16x32_bf16 v[32:35], v[0:3], v[64:67], 0
    ds_read_b128 v[28:31], v116 offset:15360
    ds_read_b64_tr_b16 v[80:81], v111 offset:2048
    ds_read_b64_tr_b16 v[82:83], v111 offset:2304
    s_waitcnt lgkmcnt(9)
    v_mfma_f32_16x16x32_bf16 v[32:35], v[4:7], v[68:71], v[32:35]
    ds_read_b64_tr_b16 v[84:85], v111 offset:2560
    ds_read_b64_tr_b16 v[86:87], v111 offset:2816
    s_waitcnt lgkmcnt(9)
    v_mfma_f32_16x16x32_bf16 v[32:35], v[8:11], v[72:75], v[32:35]
    ds_read_b64_tr_b16 v[88:89], v111 offset:3072
    ds_read_b64_tr_b16 v[90:91], v111 offset:3328
    v_cvt_pk_bf16_f32 v122, v112, v113
    s_waitcnt lgkmcnt(9)
    v_mfma_f32_16x16x32_bf16 v[32:35], v[12:15], v[76:79], v[32:35]
    ds_read_b64_tr_b16 v[92:93], v111 offset:3584
    ds_read_b64_tr_b16 v[94:95], v111 offset:3840
    v_cvt_pk_bf16_f32 v123, v114, v115
    s_waitcnt lgkmcnt(8)
    v_mfma_f32_16x16x32_bf16 v[36:39], v[16:19], v[64:67], 0
    v_xor_b32 v116, 0x2000, v116
    v_mfma_f32_16x16x32_bf16 v[36:39], v[20:23], v[68:71], v[36:39]
    v_permlane32_swap_b32 v122, v123
    v_mfma_f32_16x16x32_bf16 v[36:39], v[24:27], v[72:75], v[36:39]
    v_mfma_f32_16x16x32_bf16 v[36:39], v[28:31], v[76:79], v[36:39]
    buffer_store_dwordx4 v[120:123], v104, s[4:7], s41 offen sc1
    s_waitcnt lgkmcnt(0)
    v_mfma_f32_16x16x32_bf16 v[40:43], v[80:83], v[64:67], 0
    ds_read_b128 v[56:59], v106 offset:18432
    v_max3_f32 v44, v32, v33, v34
    v_mfma_f32_16x16x32_bf16 v[40:43], v[84:87], v[68:71], v[40:43]
    ds_read_b128 v[60:63], v106 offset:19456
    v_mfma_f32_16x16x32_bf16 v[40:43], v[88:91], v[72:75], v[40:43]
    ds_read_b128 v[0:3], v106 offset:8192
    v_max3_f32 v45, v35, v36, v37
    v_max3_f32 v44, v44, v38, v39
    v_mfma_f32_16x16x32_bf16 v[40:43], v[92:95], v[76:79], v[40:43]
    v_max_f32 v44, v44, v45
    v_mov_b32 v45, v44
    ds_read_b128 v[4:7], v106 offset:9216
    s_nop 0
    v_permlane32_swap_b32 v44, v45
    s_nop 2
    v_max3_f32 v46, v40, v41, v42
    v_max3_f32 v44, v44, v45, v43
    v_max_f32 v44, v44, v46
    v_mov_b32 v45, v44
    v_cndmask_b32 v40, v40, v42, s[48:49]
    v_cndmask_b32 v41, v41, v43, s[48:49]
    v_permlane16_swap_b32 v44, v45
    v_max_f32 v44, v44, v45
    v_mul_f32 v44, s34, v44
    v_pk_fma_f32 v[32:33], v[32:33], s[34:35], v[44:45] op_sel_hi:[1,1,0] neg_lo:[0,0,1] neg_hi:[0,0,1]
    v_pk_fma_f32 v[34:35], v[34:35], s[34:35], v[44:45] op_sel_hi:[1,1,0] neg_lo:[0,0,1] neg_hi:[0,0,1]
    v_pk_fma_f32 v[36:37], v[36:37], s[34:35], v[44:45] op_sel_hi:[1,1,0] neg_lo:[0,0,1] neg_hi:[0,0,1]
    v_pk_fma_f32 v[38:39], v[38:39], s[34:35], v[44:45] op_sel_hi:[1,1,0] neg_lo:[0,0,1] neg_hi:[0,0,1]
    v_pk_fma_f32 v[40:41], v[40:41], s[34:35], v[44:45] op_sel_hi:[1,1,0] neg_lo:[0,0,1] neg_hi:[0,0,1]
    v_exp_f32 v32, v32
    v_exp_f32 v33, v33
    v_exp_f32 v34, v34
    v_exp_f32 v35, v35
    v_exp_f32 v36, v36
    v_exp_f32 v37, v37
    v_exp_f32 v38, v38
    v_exp_f32 v39, v39
    v_cvt_pk_bf16_f32 v44, v32, v33
    v_cvt_pk_bf16_f32 v45, v34, v35
    v_cvt_pk_bf16_f32 v46, v36, v37
    v_cvt_pk_bf16_f32 v47, v38, v39
    v_exp_f32 v40, v40
    v_exp_f32 v41, v41
    s_waitcnt vmcnt(4)
    v_mfma_f32_16x16x32_bf16 v[52:55], v[48:51], v[44:47], 0
    ds_read_b128 v[8:11], v106 offset:16384
    v_cvt_pk_bf16_f32 v124, v40, v41
    v_cvt_pk_bf16_f32 v127, v40, v41
    v_mfma_f32_16x16x32_bf16 v[32:35], v[96:99], v[44:47], 0
    ds_read_b128 v[12:15], v106 offset:17408
    v_mov_b64 v[64:65], 0
    v_mov_b64 v[66:67], 0
    v_mfma_f32_16x16x32_bf16 v[36:39], v[100:103], v[44:47], 0
    ds_read_b128 v[16:19], v106 offset:24576
    v_mov_b64 v[68:69], 0
    v_mfma_f32_16x16x16_bf16 v[52:55], v[48:49], v[124:125], v[52:55]
    ds_read_b128 v[20:23], v106 offset:25600
    v_mov_b64 v[70:71], 0
    v_mfma_f32_16x16x16_bf16 v[32:35], v[122:123], v[124:125], v[32:35]
    ds_read_b128 v[24:27], v106 offset:10240
    v_mov_b64 v[72:73], 0
    v_mfma_f32_16x16x16_bf16 v[36:39], v[122:123], v[126:127], v[36:39]
    ds_read_b128 v[28:31], v106 offset:11264
    v_mov_b64 v[74:75], 0
    v_rcp_f32 v52, v52
    v_mov_b64 v[76:77], 0
    s_nop 0
    v_pk_mul_f32 v[32:33], v[32:33], v[52:53] op_sel_hi:[1,0]
    v_pk_mul_f32 v[34:35], v[34:35], v[52:53] op_sel_hi:[1,0]
    v_mov_b64 v[78:79], 0
    v_pk_mul_f32 v[36:37], v[36:37], v[52:53] op_sel_hi:[1,0]
    v_pk_mul_f32 v[38:39], v[38:39], v[52:53] op_sel_hi:[1,0]
    v_cvt_pk_bf16_f32 v48, v32, v33
    v_cvt_pk_bf16_f32 v49, v34, v35
    v_cvt_pk_bf16_f32 v50, v36, v37
    v_cvt_pk_bf16_f32 v51, v38, v39
    ds_write_b128 v105, v[48:51] offset:30464
    s_nop 0
    v_smfmac_f32_16x16x64_bf16 v[64:67], v[48:51], a[128:135], v107
    ds_read_b128 v[96:99], v106 offset:26624
    v_smfmac_f32_16x16x64_bf16 v[68:71], v[48:51], a[0:7], v107
    ds_read_b128 v[100:103], v106 offset:27648
    v_smfmac_f32_16x16x64_bf16 v[72:75], v[48:51], a[136:143], v107
    v_smfmac_f32_16x16x64_bf16 v[76:79], v[48:51], a[8:15], v107
    s_waitcnt lgkmcnt(2)
    s_barrier
    ds_read_b128 v[112:115], v105 offset:29952
    ds_read_b128 v[120:123], v105 offset:31488
    ds_read_b128 v[52:55], v105 offset:30976
    s_waitcnt lgkmcnt(2)
    v_smfmac_f32_16x16x64_bf16 v[64:67], v[112:115], v[0:7], v107
    s_waitcnt lgkmcnt(1)
    v_smfmac_f32_16x16x64_bf16 v[64:67], v[120:123], v[8:15], v107
    s_waitcnt lgkmcnt(0)
    v_smfmac_f32_16x16x64_bf16 v[64:67], v[52:55], v[16:23], v107
    v_smfmac_f32_16x16x64_bf16 v[68:71], v[112:115], v[24:31], v107
    ds_read_b128 v[88:91], v104 offset:28672
    v_smfmac_f32_16x16x64_bf16 v[68:71], v[120:123], v[56:63], v107
    v_smfmac_f32_16x16x64_bf16 v[68:71], v[52:55], v[96:103], v107
    v_cvt_pk_bf16_f32 v48, v64, v65
    v_smfmac_f32_16x16x64_bf16 v[72:75], v[112:115], a[80:87], v107
    v_cvt_pk_bf16_f32 v49, v66, v67
    v_smfmac_f32_16x16x64_bf16 v[72:75], v[120:123], a[88:95], v107
    v_and_or_b32 v48, v48, -2, s101
    v_smfmac_f32_16x16x64_bf16 v[72:75], v[52:55], a[96:103], v107
    v_cvt_pk_bf16_f32 v50, v68, v69
    v_cvt_pk_bf16_f32 v51, v70, v71
    v_smfmac_f32_16x16x64_bf16 v[76:79], v[112:115], a[104:111], v107
    buffer_store_dwordx4 v[48:51], v108, s[4:7], s32 offen
    v_smfmac_f32_16x16x64_bf16 v[76:79], v[120:123], a[112:119], v107
    v_smfmac_f32_16x16x64_bf16 v[76:79], v[52:55], a[120:127], v107
    v_cvt_pk_bf16_f32 v56, v72, v73
    v_cvt_pk_bf16_f32 v57, v74, v75
    v_and_or_b32 v56, v56, -2, s101
    s_add_u32 s36, s32, 8192
    s_and_b32 s45, s31, 3
    s_lshl_b32 s45, s45, 18
    s_add_u32 s33, s45, s47
    s_add_u32 s31, s31, 1
    v_cvt_pk_bf16_f32 v58, v76, v77
    v_cvt_pk_bf16_f32 v59, v78, v79
    buffer_store_dwordx4 v[56:59], v108, s[4:7], s36 offen
    s_add_u32 s41, s41, 0x20000
    s_and_b32 s45, s31, 3
    s_lshl_b32 s46, s45, 13
    s_add_u32 s37, s46, 0xa00000
    s_add_u32 s38, s46, 0x9e0800
    s_lshl_b32 s45, s45, 18
    s_add_u32 s32, s45, 0x900000
    s_cmp_lt_u32 s42, s44
    s_cbranch_scc1 L_prg_fast1
    s_nop 15
    s_nop 15
    s_nop 15
    s_nop 7
L_prd_fast1:
    buffer_load_dwordx4 v[0:3], v104, s[4:7], s33 offen sc1
    buffer_load_dwordx4 v[4:7], v104, s[4:7], s33 offen offset:1024 sc1
    v_mov_b64 v[120:121], 0
    s_nop 6
    v_mov_b64 v[122:123], 0
    s_nop 6
    buffer_load_dwordx4 v[8:11], v104, s[4:7], s33 offen sc1
    buffer_load_dwordx4 v[12:15], v104, s[4:7], s33 offen offset:1024 sc1
    v_mov_b64 v[124:125], 0
    s_nop 5
    v_mov_b64 v[126:127], 0
    s_nop 5
    v_mov_b64 v[112:113], 0
    s_nop 5
    v_mov_b64 v[114:115], 0
    s_nop 5
    v_mov_b32 v30, -1
    s_nop 5
    s_waitcnt lgkmcnt(0)
    s_waitcnt vmcnt(3)
    v_mfma_f32_16x16x32_bf16 v[92:95], v[88:91], v[0:3], 0
    v_and_b32 v28, 1, v0
    s_waitcnt vmcnt(2)
    v_mfma_f32_16x16x32_bf16 v[92:95], v[88:91], v[4:7], v[92:95]
    v_and_b32 v29, 1, v4
    v_cmp_ne_u32 vcc, s101, v28
    v_cmp_ne_u32 s[16:17], s101, v29
    s_or_b64 s[18:19], vcc, s[16:17]
    s_cbranch_scc1 L_p1b_fast1
L_p1ok_fast1:
    s_nop 2
    v_add_f32_dpp v92, v92, v92 row_ror:4 row_mask:0xf bank_mask:0xf
    v_add_f32_dpp v93, v93, v93 row_ror:4 row_mask:0xf bank_mask:0xf
    s_nop 0
    v_add_f32_dpp v92, v92, v92 row_ror:8 row_mask:0xf bank_mask:0xf
    v_add_f32_dpp v93, v93, v93 row_ror:8 row_mask:0xf bank_mask:0xf
    v_cvt_pk_bf16_f32 v92, v92, v93
    v_min_u32 v92, -2, v92
    buffer_store_dword v92, v109, s[4:7], s37 offen
    s_bfe_u32 s101, s31, 0x10002
    s_xor_b32 s101, s101, 1
    s_add_u32 s44, s31, 6
    s_cmp_eq_u32 s31, 1
    s_cselect_b32 s44, 64, s44
    s_min_u32 s44, s44, 64
    s_branch L_loop_fast1
L_p1b_fast1:
L_p1r_fast1:
    s_or_b64 exec, vcc, 1
    buffer_load_dwordx4 v[0:3], v104, s[4:7], s33 offen sc1
    s_or_b64 exec, s[16:17], 1
    buffer_load_dwordx4 v[4:7], v104, s[4:7], s33 offen offset:1024 sc1
    s_mov_b64 exec, -1
    s_waitcnt vmcnt(3)
    v_mfma_f32_16x16x32_bf16 v[92:95], v[88:91], v[8:11], 0
    v_and_b32 v28, 1, v8
    s_waitcnt vmcnt(2)
    v_mfma_f32_16x16x32_bf16 v[92:95], v[88:91], v[12:15], v[92:95]
    v_and_b32 v29, 1, v12
    v_cmp_ne_u32 vcc, s101, v28
    v_cmp_ne_u32 s[16:17], s101, v29
    s_or_b64 s[18:19], vcc, s[16:17]
    s_cbranch_scc0 L_p1k_fast1
    s_or_b64 exec, vcc, 1
    buffer_load_dwordx4 v[8:11], v104, s[4:7], s33 offen sc1
    s_or_b64 exec, s[16:17], 1
    buffer_load_dwordx4 v[12:15], v104, s[4:7], s33 offen offset:1024 sc1
    s_mov_b64 exec, -1
    s_add_u32 s100, s100, 1
    s_bitcmp1_b32 s100, 15
    s_cbranch_scc1 L_exit
    s_waitcnt vmcnt(3)
    v_mfma_f32_16x16x32_bf16 v[92:95], v[88:91], v[0:3], 0
    v_and_b32 v28, 1, v0
    s_waitcnt vmcnt(2)
    v_mfma_f32_16x16x32_bf16 v[92:95], v[88:91], v[4:7], v[92:95]
    v_and_b32 v29, 1, v4
    v_cmp_ne_u32 vcc, s101, v28
    v_cmp_ne_u32 s[16:17], s101, v29
    s_or_b64 s[18:19], vcc, s[16:17]
    s_cbranch_scc1 L_p1r_fast1
L_p1k_fast1:
    s_nop 2
    s_branch L_p1ok_fast1
L_p2b_fast1:
L_p2r_fast1:
    s_or_b64 exec, vcc, 1
    buffer_load_dwordx4 v[72:75], v104, s[4:7], s38 offen sc1
    s_or_b64 exec, s[16:17], 1
    buffer_load_dwordx4 v[76:79], v104, s[4:7], s38 offen offset:1024 sc1
    s_mov_b64 exec, -1
    s_waitcnt vmcnt(2)
    ds_write_b128 v104, v[88:91] offset:2048
    ds_write_b128 v104, v[92:95] offset:3072
    v_max3_u32 v26, v88, v89, v90
    v_max3_u32 v27, v92, v93, v94
    v_max_u32 v26, v26, v91
    v_max_u32 v27, v27, v95
    v_cmp_eq_u32 vcc, -1, v26
    v_cmp_eq_u32 s[16:17], -1, v27
    s_or_b64 s[18:19], vcc, s[16:17]
    s_cbranch_scc0 L_go_fast1
    s_or_b64 exec, vcc, 1
    buffer_load_dwordx4 v[88:91], v104, s[4:7], s38 offen sc1
    s_or_b64 exec, s[16:17], 1
    buffer_load_dwordx4 v[92:95], v104, s[4:7], s38 offen offset:1024 sc1
    s_mov_b64 exec, -1
    s_add_u32 s100, s100, 1
    s_bitcmp1_b32 s100, 15
    s_cbranch_scc1 L_exit
    s_waitcnt vmcnt(2)
    ds_write_b128 v104, v[72:75] offset:2048
    ds_write_b128 v104, v[76:79] offset:3072
    v_max3_u32 v26, v72, v73, v74
    v_max3_u32 v27, v76, v77, v78
    v_max_u32 v26, v26, v75
    v_max_u32 v27, v27, v79
    v_cmp_eq_u32 vcc, -1, v26
    v_cmp_eq_u32 s[16:17], -1, v27
    s_or_b64 s[18:19], vcc, s[16:17]
    s_cbranch_scc1 L_p2r_fast1
    s_branch L_go_fast1
L_prf_fast1:
    v_mov_b32 v89, 148
    s_mov_b32 m0, 160768
    s_mov_b64 exec, 1
    buffer_load_dword v89, s[8:11], 0 offen sc1 lds
    s_cmp_lg_u32 s31, 1
    s_cbranch_scc1 L_prfx_fast1
    v_mov_b32 v89, 0
    s_mov_b32 m0, 160784
    s_nop 0
    buffer_load_dwordx4 v89, s[4:7], s50 offen sc1 lds
L_prfx_fast1:
    s_mov_b64 exec, -1
    s_branch L_prfd_fast1
L_enter_fast1:
    ds_write_b128 v104, v[72:75] offset:2048
    ds_write_b128 v104, v[76:79] offset:3072
    ds_read_b128 v[64:67], v106 offset:12288
    ds_read_b128 v[68:71], v106 offset:13312
    ds_read_b128 v[80:83], v106 offset:20480
    ds_read_b128 v[84:87], v106 offset:21504
    ds_read_b128 v[32:35], v106 offset:0
    ds_read_b128 v[36:39], v106 offset:1024
    ds_read_b128 v[40:43], v106 offset:2048
    ds_read_b128 v[44:47], v106 offset:3072
    ds_read_b128 v[48:51], v106 offset:4096
    ds_read_b128 v[52:55], v106 offset:5120
    ds_read_b128 v[56:59], v106 offset:6144
    ds_read_b128 v[60:63], v106 offset:7168
    s_mov_b32 m0, s43
    s_branch L_go_fast1
L_prg_fast1:
    v_mov_b32 v72, 160768
    ds_read_b32 v92, v72
    ds_read_b128 v[72:75], v72 offset:16
    s_add_u32 s45, s31, 2
    s_min_u32 s45, s45, 64
    s_waitcnt lgkmcnt(0)
    v_readfirstlane_b32 s30, v92
    s_cmp_eq_u32 s30, 192
    s_cselect_b32 s42, 64, s42
    v_min_u32 v72, v72, v74
    v_min_u32 v73, v73, v75
    v_lshlrev_b32 v72, 1, v72
    v_lshl_or_b32 v73, v73, 1, 1
    v_min_u32 v72, v72, v73
    s_nop 0
    v_readfirstlane_b32 s30, v72
    s_max_u32 s42, s42, s30
    s_cmp_ge_u32 s42, s45
    s_cbranch_scc1 L_kvd_11
L_kvw_10:
    v_mov_b32 v76, 0
    buffer_load_dwordx4 v[72:75], v76, s[4:7], s50 offen sc1
    s_waitcnt vmcnt(0)
    v_min_u32 v72, v72, v74
    v_min_u32 v73, v73, v75
    v_lshlrev_b32 v72, 1, v72
    v_lshl_or_b32 v73, v73, 1, 1
    v_min_u32 v72, v72, v73
    s_nop 0
    v_readfirstlane_b32 s30, v72
    s_max_u32 s42, s42, s30
    s_cmp_ge_u32 s42, s45
    s_cbranch_scc1 L_kvd_11
    s_sleep 1
    s_add_u32 s100, s100, 1
    s_bitcmp1_b32 s100, 15
    s_cbranch_scc1 L_exit
    s_branch L_kvw_10
L_kvd_11:
    s_nop 15
    s_branch L_prd_fast1
    .p2align 6
L_loop_fast2:
    s_add_u32 s46, s31, 2
    s_and_b32 s46, s46, 3
    s_lshl_b32 s46, s46, 13
    s_add_u32 s46, s46, 0xa00000
    buffer_store_dword v30, v109, s[4:7], s46 offen
    s_mov_b32 m0, s43
    ds_read_b128 v[64:67], v106 offset:12288
    ds_read_b128 v[68:71], v106 offset:13312
    ds_read_b128 v[80:83], v106 offset:20480
    ds_read_b128 v[84:87], v106 offset:21504
    ds_read_b128 v[32:35], v106 offset:0
    ds_read_b128 v[36:39], v106 offset:1024
    ds_read_b128 v[40:43], v106 offset:2048
    ds_read_b128 v[44:47], v106 offset:3072
    ds_read_b128 v[48:51], v106 offset:4096
    ds_read_b128 v[52:55], v106 offset:5120
    ds_read_b128 v[56:59], v106 offset:6144
    ds_read_b128 v[60:63], v106 offset:7168
    s_nop 11
    buffer_load_dwordx4 v[72:75], v104, s[4:7], s38 offen sc1
    buffer_load_dwordx4 v[76:79], v104, s[4:7], s38 offen offset:1024 sc1
    s_nop 15
    s_nop 15
    s_nop 11
    buffer_load_dwordx4 v[88:91], v104, s[4:7], s38 offen sc1
    buffer_load_dwordx4 v[92:95], v104, s[4:7], s38 offen offset:1024 sc1
    s_waitcnt vmcnt(3)
    ds_write_b128 v104, v[72:75] offset:4096
    s_waitcnt vmcnt(2)
    ds_write_b128 v104, v[76:79] offset:5120
    v_max3_u32 v26, v72, v73, v74
    v_max3_u32 v27, v76, v77, v78
    v_max_u32 v26, v26, v75
    v_max_u32 v27, v27, v79
    v_cmp_eq_u32 vcc, -1, v26
    v_cmp_eq_u32 s[16:17], -1, v27
    s_or_b64 s[18:19], vcc, s[16:17]
    s_cbranch_scc1 L_p2b_fast2
L_go_fast2:
    s_waitcnt lgkmcnt(0)
    s_barrier
    ds_read_b128 v[0:3], v118 offset:0
    ds_read_b128 v[4:7], v119 offset:128
    ds_read_b128 v[8:11], v118 offset:256
    ds_read_b128 v[12:15], v119 offset:384
    ds_read_b128 v[16:19], v118 offset:512
    s_cmp_eq_u32 s31, 63
    s_cbranch_scc1 L_chain_end
    s_waitcnt lgkmcnt(4)
    v_smfmac_f32_16x16x64_bf16 v[124:127], v[0:3], v[32:39], v107
    ds_read_b128 v[20:23], v119 offset:640
    v_smfmac_f32_16x16x64_bf16 v[120:123], v[0:3], v[40:47], v107
    s_waitcnt lgkmcnt(4)
    v_smfmac_f32_16x16x64_bf16 v[124:127], v[4:7], v[48:55], v107
    ds_read_b128 v[24:27], v118 offset:768
    v_smfmac_f32_16x16x64_bf16 v[120:123], v[4:7], v[56:63], v107
    s_waitcnt lgkmcnt(4)
    v_smfmac_f32_16x16x64_bf16 v[124:127], v[8:11], a[144:151], v107
    ds_read_b128 v[28:31], v119 offset:896
    v_smfmac_f32_16x16x64_bf16 v[120:123], v[8:11], a[16:23], v107
    s_waitcnt lgkmcnt(4)
    v_smfmac_f32_16x16x64_bf16 v[124:127], v[12:15], a[152:159], v107
    ds_read_b128 v[32:35], v118 offset:1024
    v_smfmac_f32_16x16x64_bf16 v[120:123], v[12:15], a[24:31], v107
    buffer_load_dwordx4 v[96:99], v104, s[4:7], s40 offen sc1
    s_waitcnt lgkmcnt(4)
    v_smfmac_f32_16x16x64_bf16 v[124:127], v[16:19], a[160:167], v107
    ds_read_b128 v[36:39], v119 offset:1152
    v_smfmac_f32_16x16x64_bf16 v[120:123], v[16:19], a[32:39], v107
    s_waitcnt lgkmcnt(4)
    v_smfmac_f32_16x16x64_bf16 v[124:127], v[20:23], a[168:175], v107
    ds_read_b128 v[40:43], v118 offset:1280
    v_smfmac_f32_16x16x64_bf16 v[120:123], v[20:23], a[40:47], v107
    buffer_load_dwordx4 v[100:103], v104, s[4:7], s40 offen offset:1024 sc1
    s_waitcnt vmcnt(2)
    s_waitcnt lgkmcnt(4)
    v_smfmac_f32_16x16x64_bf16 v[124:127], v[24:27], a[176:183], v107
    ds_read_b128 v[44:47], v119 offset:1408
    v_smfmac_f32_16x16x64_bf16 v[120:123], v[24:27], a[48:55], v107
    ds_read_b128 v[72:75], v106 offset:28672
    s_waitcnt lgkmcnt(5)
    v_smfmac_f32_16x16x64_bf16 v[124:127], v[28:31], a[184:191], v107
    ds_read_b128 v[48:51], v118 offset:1536
    v_smfmac_f32_16x16x64_bf16 v[120:123], v[28:31], a[56:63], v107
    ds_read_b128 v[76:79], v106 offset:29696
    buffer_load_dwordx4 v104, s[4:7], s39 offen sc1 lds
    s_waitcnt lgkmcnt(6)
    v_smfmac_f32_16x16x64_bf16 v[124:127], v[32:35], a[192:199], v107
    ds_read_b128 v[52:55], v119 offset:1664
    v_smfmac_f32_16x16x64_bf16 v[120:123], v[32:35], a[64:71], v107
    ds_read_b128 v[88:91], v106 offset:14336
    s_waitcnt lgkmcnt(7)
    v_smfmac_f32_16x16x64_bf16 v[124:127], v[36:39], a[200:207], v107
    ds_read_b128 v[56:59], v118 offset:1792
    v_smfmac_f32_16x16x64_bf16 v[120:123], v[36:39], a[72:79], v107
    ds_read_b128 v[92:95], v106 offset:15360
    buffer_load_dwordx4 v104, s[4:7], s39 offen offset:1024 sc1 lds
    s_mov_b32 m0, 163072
    s_waitcnt lgkmcnt(8)
    v_smfmac_f32_16x16x64_bf16 v[124:127], v[40:43], a[208:215], v107
    ds_read_b128 v[60:63], v119 offset:1920
    v_smfmac_f32_16x16x64_bf16 v[120:123], v[40:43], v[64:71], v107
    ds_read_b128 v[64:67], v106 offset:22528
    ds_read_b128 v[68:71], v106 offset:23552
    s_waitcnt lgkmcnt(10)
    v_smfmac_f32_16x16x64_bf16 v[124:127], v[44:47], a[216:223], v107
    v_smfmac_f32_16x16x64_bf16 v[120:123], v[44:47], v[80:87], v107
    ds_read_b128 v[80:83], v106 offset:30720
    ds_read_b128 v[84:87], v106 offset:31744
    buffer_load_dword v117, s[4:7], s40 offen sc1 lds
    s_waitcnt lgkmcnt(10)
    v_smfmac_f32_16x16x64_bf16 v[124:127], v[48:51], a[224:231], v107
    s_waitcnt lgkmcnt(9)
    v_smfmac_f32_16x16x64_bf16 v[120:123], v[48:51], v[72:79], v107
    s_add_u32 s39, s39, 0x40000
    s_add_u32 s40, s40, 0x40000
    s_xor_b32 s43, s43, 0x6000
    s_waitcnt lgkmcnt(8)
    v_smfmac_f32_16x16x64_bf16 v[124:127], v[52:55], a[232:239], v107
    s_waitcnt lgkmcnt(5)
    v_smfmac_f32_16x16x64_bf16 v[120:123], v[52:55], v[88:95], v107
    v_smfmac_f32_16x16x64_bf16 v[124:127], v[56:59], a[240:247], v107
    s_waitcnt lgkmcnt(2)
    v_smfmac_f32_16x16x64_bf16 v[120:123], v[56:59], v[64:71], v107
    v_smfmac_f32_16x16x64_bf16 v[124:127], v[60:63], a[248:255], v107
    s_waitcnt lgkmcnt(0)
    v_smfmac_f32_16x16x64_bf16 v[120:123], v[60:63], v[80:87], v107
    v_smfmac_f32_16x16x64_bf16 v[112:115], v[0:3], v[128:135], v107
    v_smfmac_f32_16x16x64_bf16 v[112:115], v[4:7], v[136:143], v107
    v_cvt_pk_bf16_f32 v68, v124, v125
    v_smfmac_f32_16x16x64_bf16 v[112:115], v[8:11], v[144:151], v107
    v_cvt_pk_bf16_f32 v69, v126, v127
    ds_write_b64 v110, v[68:69]
    v_smfmac_f32_16x16x64_bf16 v[112:115], v[12:15], v[152:159], v107
    v_cvt_pk_bf16_f32 v120, v120, v121
    v_smfmac_f32_16x16x64_bf16 v[112:115], v[16:19], v[160:167], v107
    v_cvt_pk_bf16_f32 v121, v122, v123
    ds_write_b64 v110, v[120:121] offset:2048
    v_smfmac_f32_16x16x64_bf16 v[112:115], v[20:23], v[168:175], v107
    ds_read_b128 v[0:3], v116 offset:8192
    v_mov_b32 v125, 0
    v_smfmac_f32_16x16x64_bf16 v[112:115], v[24:27], v[176:183], v107
    ds_read_b128 v[4:7], v116 offset:9216
    v_mov_b32 v126, 0
    v_smfmac_f32_16x16x64_bf16 v[112:115], v[28:31], v[184:191], v107
    ds_read_b128 v[8:11], v116 offset:10240
    v_smfmac_f32_16x16x64_bf16 v[112:115], v[32:35], v[192:199], v107
    ds_read_b128 v[12:15], v116 offset:11264
    v_smfmac_f32_16x16x64_bf16 v[112:115], v[36:39], v[200:207], v107
    ds_read_b128 v[16:19], v116 offset:12288
    s_waitcnt lgkmcnt(5)
    s_barrier
    v_smfmac_f32_16x16x64_bf16 v[112:115], v[40:43], v[208:215], v107
    ds_read_b64_tr_b16 v[64:65], v111 offset:0
    ds_read_b64_tr_b16 v[66:67], v111 offset:256
    v_min_u32 v120, -2, v120
    v_smfmac_f32_16x16x64_bf16 v[112:115], v[44:47], v[216:223], v107
    ds_read_b64_tr_b16 v[68:69], v111 offset:512
    ds_read_b64_tr_b16 v[70:71], v111 offset:768
    v_smfmac_f32_16x16x64_bf16 v[112:115], v[48:51], v[224:231], v107
    ds_read_b64_tr_b16 v[72:73], v111 offset:1024
    ds_read_b64_tr_b16 v[74:75], v111 offset:1280
    v_smfmac_f32_16x16x64_bf16 v[112:115], v[52:55], v[232:239], v107
    ds_read_b64_tr_b16 v[76:77], v111 offset:1536
    ds_read_b64_tr_b16 v[78:79], v111 offset:1792
    v_smfmac_f32_16x16x64_bf16 v[112:115], v[56:59], v[240:247], v107
    ds_read_b128 v[20:23], v116 offset:13312
    v_mov_b64 v[48:49], s[98:99]
    v_smfmac_f32_16x16x64_bf16 v[112:115], v[60:63], v[248:255], v107
    ds_read_b128 v[24:27], v116 offset:14336
    v_mov_b64 v[50:51], s[98:99]
    s_waitcnt lgkmcnt(8)
    v_mfma_f32_16x16x32_bf16 v[32:35], v[0:3], v[64:67], 0
    ds_read_b128 v[28:31], v116 offset:15360
    ds_read_b64_tr_b16 v[80:81], v111 offset:2048
    ds_read_b64_tr_b16 v[82:83], v111 offset:2304
    s_waitcnt lgkmcnt(9)
    v_mfma_f32_16x16x32_bf16 v[32:35], v[4:7], v[68:71], v[32:35]
    ds_read_b64_tr_b16 v[84:85], v111 offset:2560
    ds_read_b64_tr_b16 v[86:87], v111 offset:2816
    s_waitcnt lgkmcnt(9)
    v_mfma_f32_16x16x32_bf16 v[32:35], v[8:11], v[72:75], v[32:35]
    ds_read_b64_tr_b16 v[88:89], v111 offset:3072
    ds_read_b64_tr_b16 v[90:91], v111 offset:3328
    v_cvt_pk_bf16_f32 v122, v112, v113
    s_waitcnt lgkmcnt(9)
    v_mfma_f32_16x16x32_bf16 v[32:35], v[12:15], v[76:79], v[32:35]
    ds_read_b64_tr_b16 v[92:93], v111 offset:3584
    ds_read_b64_tr_b16 v[94:95], v111 offset:3840
    v_cvt_pk_bf16_f32 v123, v114, v115
    s_waitcnt lgkmcnt(8)
    v_mfma_f32_16x16x32_bf16 v[36:39], v[16:19], v[64:67], 0
    v_xor_b32 v116, 0x2000, v116
    v_mfma_f32_16x16x32_bf16 v[36:39], v[20:23], v[68:71], v[36:39]
    v_permlane32_swap_b32 v122, v123
    v_mfma_f32_16x16x32_bf16 v[36:39], v[24:27], v[72:75], v[36:39]
    v_mfma_f32_16x16x32_bf16 v[36:39], v[28:31], v[76:79], v[36:39]
    s_waitcnt lgkmcnt(0)
    v_mfma_f32_16x16x32_bf16 v[40:43], v[80:83], v[64:67], 0
    ds_read_b128 v[56:59], v106 offset:18432
    v_max3_f32 v44, v32, v33, v34
    v_mfma_f32_16x16x32_bf16 v[40:43], v[84:87], v[68:71], v[40:43]
    ds_read_b128 v[60:63], v106 offset:19456
    buffer_store_dwordx4 v[120:123], v104, s[4:7], s41 offen sc1
    v_mfma_f32_16x16x32_bf16 v[40:43], v[88:91], v[72:75], v[40:43]
    ds_read_b128 v[0:3], v106 offset:8192
    v_max3_f32 v45, v35, v36, v37
    v_max3_f32 v44, v44, v38, v39
    v_mfma_f32_16x16x32_bf16 v[40:43], v[92:95], v[76:79], v[40:43]
    v_max_f32 v44, v44, v45
    v_mov_b32 v45, v44
    ds_read_b128 v[4:7], v106 offset:9216
    s_nop 0
    v_permlane32_swap_b32 v44, v45
    s_nop 2
    v_max3_f32 v46, v40, v41, v42
    v_max3_f32 v44, v44, v45, v43
    v_max_f32 v44, v44, v46
    v_mov_b32 v45, v44
    v_cndmask_b32 v40, v40, v42, s[48:49]
    v_cndmask_b32 v41, v41, v43, s[48:49]
    v_permlane16_swap_b32 v44, v45
    v_max_f32 v44, v44, v45
    v_mul_f32 v44, s34, v44
    v_pk_fma_f32 v[32:33], v[32:33], s[34:35], v[44:45] op_sel_hi:[1,1,0] neg_lo:[0,0,1] neg_hi:[0,0,1]
    v_pk_fma_f32 v[34:35], v[34:35], s[34:35], v[44:45] op_sel_hi:[1,1,0] neg_lo:[0,0,1] neg_hi:[0,0,1]
    v_pk_fma_f32 v[36:37], v[36:37], s[34:35], v[44:45] op_sel_hi:[1,1,0] neg_lo:[0,0,1] neg_hi:[0,0,1]
    v_pk_fma_f32 v[38:39], v[38:39], s[34:35], v[44:45] op_sel_hi:[1,1,0] neg_lo:[0,0,1] neg_hi:[0,0,1]
    v_pk_fma_f32 v[40:41], v[40:41], s[34:35], v[44:45] op_sel_hi:[1,1,0] neg_lo:[0,0,1] neg_hi:[0,0,1]
    v_exp_f32 v32, v32
    v_exp_f32 v33, v33
    v_exp_f32 v34, v34
    v_exp_f32 v35, v35
    v_exp_f32 v36, v36
    v_exp_f32 v37, v37
    v_exp_f32 v38, v38
    v_exp_f32 v39, v39
    v_cvt_pk_bf16_f32 v44, v32, v33
    v_cvt_pk_bf16_f32 v45, v34, v35
    v_cvt_pk_bf16_f32 v46, v36, v37
    v_cvt_pk_bf16_f32 v47, v38, v39
    v_exp_f32 v40, v40
    v_exp_f32 v41, v41
    s_waitcnt vmcnt(4)
    v_mfma_f32_16x16x32_bf16 v[52:55], v[48:51], v[44:47], 0
    ds_read_b128 v[8:11], v106 offset:16384
    v_cvt_pk_bf16_f32 v124, v40, v41
    v_cvt_pk_bf16_f32 v127, v40, v41
    v_mfma_f32_16x16x32_bf16 v[32:35], v[96:99], v[44:47], 0
    ds_read_b128 v[12:15], v106 offset:17408
    v_mov_b64 v[64:65], 0
    v_mov_b64 v[66:67], 0
    v_mfma_f32_16x16x32_bf16 v[36:39], v[100:103], v[44:47], 0
    ds_read_b128 v[16:19], v106 offset:24576
    v_mov_b64 v[68:69], 0
    v_mfma_f32_16x16x16_bf16 v[52:55], v[48:49], v[124:125], v[52:55]
    ds_read_b128 v[20:23], v106 offset:25600
    v_mov_b64 v[70:71], 0
    v_mfma_f32_16x16x16_bf16 v[32:35], v[122:123], v[124:125], v[32:35]
    ds_read_b128 v[24:27], v106 offset:10240
    v_mov_b64 v[72:73], 0
    v_mfma_f32_16x16x16_bf16 v[36:39], v[122:123], v[126:127], v[36:39]
    ds_read_b128 v[28:31], v106 offset:11264
    v_mov_b64 v[74:75], 0
    v_rcp_f32 v52, v52
    v_mov_b64 v[76:77], 0
    s_nop 0
    v_pk_mul_f32 v[32:33], v[32:33], v[52:53] op_sel_hi:[1,0]
    v_pk_mul_f32 v[34:35], v[34:35], v[52:53] op_sel_hi:[1,0]
    v_mov_b64 v[78:79], 0
    v_pk_mul_f32 v[36:37], v[36:37], v[52:53] op_sel_hi:[1,0]
    v_pk_mul_f32 v[38:39], v[38:39], v[52:53] op_sel_hi:[1,0]
    v_cvt_pk_bf16_f32 v48, v32, v33
    v_cvt_pk_bf16_f32 v49, v34, v35
    v_cvt_pk_bf16_f32 v50, v36, v37
    v_cvt_pk_bf16_f32 v51, v38, v39
    ds_write_b128 v105, v[48:51] offset:30976
    s_nop 0
    v_smfmac_f32_16x16x64_bf16 v[64:67], v[48:51], a[128:135], v107
    ds_read_b128 v[96:99], v106 offset:26624
    v_smfmac_f32_16x16x64_bf16 v[68:71], v[48:51], a[0:7], v107
    ds_read_b128 v[100:103], v106 offset:27648
    v_smfmac_f32_16x16x64_bf16 v[72:75], v[48:51], a[136:143], v107
    v_smfmac_f32_16x16x64_bf16 v[76:79], v[48:51], a[8:15], v107
    s_waitcnt lgkmcnt(2)
    s_barrier
    ds_read_b128 v[112:115], v105 offset:31488
    ds_read_b128 v[120:123], v105 offset:29952
    ds_read_b128 v[52:55], v105 offset:30464
    s_waitcnt lgkmcnt(2)
    v_smfmac_f32_16x16x64_bf16 v[64:67], v[112:115], v[0:7], v107
    s_waitcnt lgkmcnt(1)
    v_smfmac_f32_16x16x64_bf16 v[64:67], v[120:123], v[8:15], v107
    s_waitcnt lgkmcnt(0)
    v_smfmac_f32_16x16x64_bf16 v[64:67], v[52:55], v[16:23], v107
    v_smfmac_f32_16x16x64_bf16 v[68:71], v[112:115], v[24:31], v107
    ds_read_b128 v[88:91], v104 offset:28672
    v_smfmac_f32_16x16x64_bf16 v[68:71], v[120:123], v[56:63], v107
    v_smfmac_f32_16x16x64_bf16 v[68:71], v[52:55], v[96:103], v107
    v_cvt_pk_bf16_f32 v48, v64, v65
    v_smfmac_f32_16x16x64_bf16 v[72:75], v[112:115], a[80:87], v107
    v_cvt_pk_bf16_f32 v49, v66, v67
    v_smfmac_f32_16x16x64_bf16 v[72:75], v[120:123], a[88:95], v107
    v_and_or_b32 v48, v48, -2, s101
    v_smfmac_f32_16x16x64_bf16 v[72:75], v[52:55], a[96:103], v107
    v_cvt_pk_bf16_f32 v50, v68, v69
    v_cvt_pk_bf16_f32 v51, v70, v71
    v_smfmac_f32_16x16x64_bf16 v[76:79], v[112:115], a[104:111], v107
    buffer_store_dwordx4 v[48:51], v108, s[4:7], s32 offen
    v_smfmac_f32_16x16x64_bf16 v[76:79], v[120:123], a[112:119], v107
    v_smfmac_f32_16x16x64_bf16 v[76:79], v[52:55], a[120:127], v107
    v_cvt_pk_bf16_f32 v56, v72, v73
    v_cvt_pk_bf16_f32 v57, v74, v75
    v_and_or_b32 v56, v56, -2, s101
    s_add_u32 s36, s32, 8192
    s_and_b32 s45, s31, 3
    s_lshl_b32 s45, s45, 18
    s_add_u32 s33, s45, s47
    s_add_u32 s31, s31, 1
    v_cvt_pk_bf16_f32 v58, v76, v77
    v_cvt_pk_bf16_f32 v59, v78, v79
    buffer_store_dwordx4 v[56:59], v108, s[4:7], s36 offen
    s_add_u32 s41, s41, 0x20000
    s_and_b32 s45, s31, 3
    s_lshl_b32 s46, s45, 13
    s_add_u32 s37, s46, 0xa00000
    s_add_u32 s38, s46, 0x9e1000
    s_lshl_b32 s45, s45, 18
    s_add_u32 s32, s45, 0x900000
    s_cmp_lt_u32 s42, s44
    s_cbranch_scc1 L_prg_fast2
    s_nop 15
    s_nop 15
    s_nop 15
    s_nop 7
L_prd_fast2:
    buffer_load_dwordx4 v[0:3], v104, s[4:7], s33 offen sc1
    buffer_load_dwordx4 v[4:7], v104, s[4:7], s33 offen offset:1024 sc1
    v_mov_b64 v[120:121], 0
    s_nop 6
    v_mov_b64 v[122:123], 0
    s_nop 6
    buffer_load_dwordx4 v[8:11], v104, s[4:7], s33 offen sc1
    buffer_load_dwordx4 v[12:15], v104, s[4:7], s33 offen offset:1024 sc1
    v_mov_b64 v[124:125], 0
    s_nop 5
    v_mov_b64 v[126:127], 0
    s_nop 5
    v_mov_b64 v[112:113], 0
    s_nop 5
    v_mov_b64 v[114:115], 0
    s_nop 5
    v_mov_b32 v30, -1
    s_nop 5
    s_waitcnt lgkmcnt(0)
    s_waitcnt vmcnt(3)
    v_mfma_f32_16x16x32_bf16 v[92:95], v[88:91], v[0:3], 0
    v_and_b32 v28, 1, v0
    s_waitcnt vmcnt(2)
    v_mfma_f32_16x16x32_bf16 v[92:95], v[88:91], v[4:7], v[92:95]
    v_and_b32 v29, 1, v4
    v_cmp_ne_u32 vcc, s101, v28
    v_cmp_ne_u32 s[16:17], s101, v29
    s_or_b64 s[18:19], vcc, s[16:17]
    s_cbranch_scc1 L_p1b_fast2
L_p1ok_fast2:
    s_nop 2
    v_add_f32_dpp v92, v92, v92 row_ror:4 row_mask:0xf bank_mask:0xf
    v_add_f32_dpp v93, v93, v93 row_ror:4 row_mask:0xf bank_mask:0xf
    s_nop 0
    v_add_f32_dpp v92, v92, v92 row_ror:8 row_mask:0xf bank_mask:0xf
    v_add_f32_dpp v93, v93, v93 row_ror:8 row_mask:0xf bank_mask:0xf
    v_cvt_pk_bf16_f32 v92, v92, v93
    v_min_u32 v92, -2, v92
    buffer_store_dword v92, v109, s[4:7], s37 offen
    s_bfe_u32 s101, s31, 0x10002
    s_xor_b32 s101, s101, 1
    s_add_u32 s44, s31, 6
    s_cmp_eq_u32 s31, 1
    s_cselect_b32 s44, 64, s44
    s_min_u32 s44, s44, 64
    s_branch L_loop_fast2
L_p1b_fast2:
L_p1r_fast2:
    s_or_b64 exec, vcc, 1
    buffer_load_dwordx4 v[0:3], v104, s[4:7], s33 offen sc1
    s_or_b64 exec, s[16:17], 1
    buffer_load_dwordx4 v[4:7], v104, s[4:7], s33 offen offset:1024 sc1
    s_mov_b64 exec, -1
    s_waitcnt vmcnt(3)
    v_mfma_f32_16x16x32_bf16 v[92:95], v[88:91], v[8:11], 0
    v_and_b32 v28, 1, v8
    s_waitcnt vmcnt(2)
    v_mfma_f32_16x16x32_bf16 v[92:95], v[88:91], v[12:15], v[92:95]
    v_and_b32 v29, 1, v12
    v_cmp_ne_u32 vcc, s101, v28
    v_cmp_ne_u32 s[16:17], s101, v29
    s_or_b64 s[18:19], vcc, s[16:17]
    s_cbranch_scc0 L_p1k_fast2
    s_or_b64 exec, vcc, 1
    buffer_load_dwordx4 v[8:11], v104, s[4:7], s33 offen sc1
    s_or_b64 exec, s[16:17], 1
    buffer_load_dwordx4 v[12:15], v104, s[4:7], s33 offen offset:1024 sc1
    s_mov_b64 exec, -1
    s_add_u32 s100, s100, 1
    s_bitcmp1_b32 s100, 15
    s_cbranch_scc1 L_exit
    s_waitcnt vmcnt(3)
    v_mfma_f32_16x16x32_bf16 v[92:95], v[88:91], v[0:3], 0
    v_and_b32 v28, 1, v0
    s_waitcnt vmcnt(2)
    v_mfma_f32_16x16x32_bf16 v[92:95], v[88:91], v[4:7], v[92:95]
    v_and_b32 v29, 1, v4
    v_cmp_ne_u32 vcc, s101, v28
    v_cmp_ne_u32 s[16:17], s101, v29
    s_or_b64 s[18:19], vcc, s[16:17]
    s_cbranch_scc1 L_p1r_fast2
L_p1k_fast2:
    s_nop 2
    s_branch L_p1ok_fast2
L_p2b_fast2:
L_p2r_fast2:
    s_or_b64 exec, vcc, 1
    buffer_load_dwordx4 v[72:75], v104, s[4:7], s38 offen sc1
    s_or_b64 exec, s[16:17], 1
    buffer_load_dwordx4 v[76:79], v104, s[4:7], s38 offen offset:1024 sc1
    s_mov_b64 exec, -1
    s_waitcnt vmcnt(2)
    ds_write_b128 v104, v[88:91] offset:4096
    ds_write_b128 v104, v[92:95] offset:5120
    v_max3_u32 v26, v88, v89, v90
    v_max3_u32 v27, v92, v93, v94
    v_max_u32 v26, v26, v91
    v_max_u32 v27, v27, v95
    v_cmp_eq_u32 vcc, -1, v26
    v_cmp_eq_u32 s[16:17], -1, v27
    s_or_b64 s[18:19], vcc, s[16:17]
    s_cbranch_scc0 L_go_fast2
    s_or_b64 exec, vcc, 1
    buffer_load_dwordx4 v[88:91], v104, s[4:7], s38 offen sc1
    s_or_b64 exec, s[16:17], 1
    buffer_load_dwordx4 v[92:95], v104, s[4:7], s38 offen offset:1024 sc1
    s_mov_b64 exec, -1
    s_add_u32 s100, s100, 1
    s_bitcmp1_b32 s100, 15
    s_cbranch_scc1 L_exit
    s_waitcnt vmcnt(2)
    ds_write_b128 v104, v[72:75] offset:4096
    ds_write_b128 v104, v[76:79] offset:5120
    v_max3_u32 v26, v72, v73, v74
    v_max3_u32 v27, v76, v77, v78
    v_max_u32 v26, v26, v75
    v_max_u32 v27, v27, v79
    v_cmp_eq_u32 vcc, -1, v26
    v_cmp_eq_u32 s[16:17], -1, v27
    s_or_b64 s[18:19], vcc, s[16:17]
    s_cbranch_scc1 L_p2r_fast2
    s_branch L_go_fast2
L_enter_fast2:
    ds_write_b128 v104, v[72:75] offset:4096
    ds_write_b128 v104, v[76:79] offset:5120
    ds_read_b128 v[64:67], v106 offset:12288
    ds_read_b128 v[68:71], v106 offset:13312
    ds_read_b128 v[80:83], v106 offset:20480
    ds_read_b128 v[84:87], v106 offset:21504
    ds_read_b128 v[32:35], v106 offset:0
    ds_read_b128 v[36:39], v106 offset:1024
    ds_read_b128 v[40:43], v106 offset:2048
    ds_read_b128 v[44:47], v106 offset:3072
    ds_read_b128 v[48:51], v106 offset:4096
    ds_read_b128 v[52:55], v106 offset:5120
    ds_read_b128 v[56:59], v106 offset:6144
    ds_read_b128 v[60:63], v106 offset:7168
    s_mov_b32 m0, s43
    s_branch L_go_fast2
L_prg_fast2:
    v_mov_b32 v72, 160768
    ds_read_b32 v92, v72
    ds_read_b128 v[72:75], v72 offset:16
    s_add_u32 s45, s31, 2
    s_min_u32 s45, s45, 64
    s_waitcnt lgkmcnt(0)
    v_readfirstlane_b32 s30, v92
    s_cmp_eq_u32 s30, 192
    s_cselect_b32 s42, 64, s42
    v_min_u32 v72, v72, v74
    v_min_u32 v73, v73, v75
    v_lshlrev_b32 v72, 1, v72
    v_lshl_or_b32 v73, v73, 1, 1
    v_min_u32 v72, v72, v73
    s_nop 0
    v_readfirstlane_b32 s30, v72
    s_max_u32 s42, s42, s30
    s_cmp_ge_u32 s42, s45
    s_cbranch_scc1 L_kvd_13
L_kvw_12:
    v_mov_b32 v76, 0
    buffer_load_dwordx4 v[72:75], v76, s[4:7], s50 offen sc1
    s_waitcnt vmcnt(0)
    v_min_u32 v72, v72, v74
    v_min_u32 v73, v73, v75
    v_lshlrev_b32 v72, 1, v72
    v_lshl_or_b32 v73, v73, 1, 1
    v_min_u32 v72, v72, v73
    s_nop 0
    v_readfirstlane_b32 s30, v72
    s_max_u32 s42, s42, s30
    s_cmp_ge_u32 s42, s45
    s_cbranch_scc1 L_kvd_13
    s_sleep 1
    s_add_u32 s100, s100, 1
    s_bitcmp1_b32 s100, 15
    s_cbranch_scc1 L_exit
    s_branch L_kvw_12
L_kvd_13:
    s_nop 15
    s_branch L_prd_fast2
    .p2align 6
L_loop_fast3:
    s_add_u32 s46, s31, 2
    s_and_b32 s46, s46, 3
    s_lshl_b32 s46, s46, 13
    s_add_u32 s46, s46, 0xa00000
    buffer_store_dword v30, v109, s[4:7], s46 offen
    s_mov_b32 m0, s43
    ds_read_b128 v[64:67], v106 offset:12288
    ds_read_b128 v[68:71], v106 offset:13312
    ds_read_b128 v[80:83], v106 offset:20480
    ds_read_b128 v[84:87], v106 offset:21504
    ds_read_b128 v[32:35], v106 offset:0
    ds_read_b128 v[36:39], v106 offset:1024
    ds_read_b128 v[40:43], v106 offset:2048
    ds_read_b128 v[44:47], v106 offset:3072
    ds_read_b128 v[48:51], v106 offset:4096
    ds_read_b128 v[52:55], v106 offset:5120
    ds_read_b128 v[56:59], v106 offset:6144
    ds_read_b128 v[60:63], v106 offset:7168
    s_nop 11
    buffer_load_dwordx4 v[72:75], v104, s[4:7], s38 offen sc1
    buffer_load_dwordx4 v[76:79], v104, s[4:7], s38 offen offset:1024 sc1
    s_nop 15
    s_nop 15
    s_nop 11
    buffer_load_dwordx4 v[88:91], v104, s[4:7], s38 offen sc1
    buffer_load_dwordx4 v[92:95], v104, s[4:7], s38 offen offset:1024 sc1
    s_waitcnt vmcnt(3)
    ds_write_b128 v104, v[72:75] offset:6144
    s_waitcnt vmcnt(2)
    ds_write_b128 v104, v[76:79] offset:7168
    v_max3_u32 v26, v72, v73, v74
    v_max3_u32 v27, v76, v77, v78
    v_max_u32 v26, v26, v75
    v_max_u32 v27, v27, v79
    v_cmp_eq_u32 vcc, -1, v26
    v_cmp_eq_u32 s[16:17], -1, v27
    s_or_b64 s[18:19], vcc, s[16:17]
    s_cbranch_scc1 L_p2b_fast3
L_go_fast3:
    s_waitcnt lgkmcnt(0)
    s_barrier
    ds_read_b128 v[0:3], v118 offset:0
    ds_read_b128 v[4:7], v119 offset:128
    ds_read_b128 v[8:11], v118 offset:256
    ds_read_b128 v[12:15], v119 offset:384
    ds_read_b128 v[16:19], v118 offset:512
    s_cmp_eq_u32 s31, 63
    s_cbranch_scc1 L_chain_end
    s_waitcnt lgkmcnt(4)
    v_smfmac_f32_16x16x64_bf16 v[124:127], v[0:3], v[32:39], v107
    ds_read_b128 v[20:23], v119 offset:640
    v_smfmac_f32_16x16x64_bf16 v[120:123], v[0:3], v[40:47], v107
    s_waitcnt lgkmcnt(4)
    v_smfmac_f32_16x16x64_bf16 v[124:127], v[4:7], v[48:55], v107
    ds_read_b128 v[24:27], v118 offset:768
    v_smfmac_f32_16x16x64_bf16 v[120:123], v[4:7], v[56:63], v107
    s_waitcnt lgkmcnt(4)
    v_smfmac_f32_16x16x64_bf16 v[124:127], v[8:11], a[144:151], v107
    ds_read_b128 v[28:31], v119 offset:896
    v_smfmac_f32_16x16x64_bf16 v[120:123], v[8:11], a[16:23], v107
    s_waitcnt lgkmcnt(4)
    v_smfmac_f32_16x16x64_bf16 v[124:127], v[12:15], a[152:159], v107
    ds_read_b128 v[32:35], v118 offset:1024
    v_smfmac_f32_16x16x64_bf16 v[120:123], v[12:15], a[24:31], v107
    buffer_load_dwordx4 v[96:99], v104, s[4:7], s40 offen sc1
    s_waitcnt lgkmcnt(4)
    v_smfmac_f32_16x16x64_bf16 v[124:127], v[16:19], a[160:167], v107
    ds_read_b128 v[36:39], v119 offset:1152
    v_smfmac_f32_16x16x64_bf16 v[120:123], v[16:19], a[32:39], v107
    s_waitcnt lgkmcnt(4)
    v_smfmac_f32_16x16x64_bf16 v[124:127], v[20:23], a[168:175], v107
    ds_read_b128 v[40:43], v118 offset:1280
    v_smfmac_f32_16x16x64_bf16 v[120:123], v[20:23], a[40:47], v107
    buffer_load_dwordx4 v[100:103], v104, s[4:7], s40 offen offset:1024 sc1
    s_waitcnt vmcnt(2)
    s_waitcnt lgkmcnt(4)
    v_smfmac_f32_16x16x64_bf16 v[124:127], v[24:27], a[176:183], v107
    ds_read_b128 v[44:47], v119 offset:1408
    v_smfmac_f32_16x16x64_bf16 v[120:123], v[24:27], a[48:55], v107
    ds_read_b128 v[72:75], v106 offset:28672
    s_waitcnt lgkmcnt(5)
    v_smfmac_f32_16x16x64_bf16 v[124:127], v[28:31], a[184:191], v107
    ds_read_b128 v[48:51], v118 offset:1536
    v_smfmac_f32_16x16x64_bf16 v[120:123], v[28:31], a[56:63], v107
    ds_read_b128 v[76:79], v106 offset:29696
    buffer_load_dwordx4 v104, s[4:7], s39 offen sc1 lds
    s_waitcnt lgkmcnt(6)
    v_smfmac_f32_16x16x64_bf16 v[124:127], v[32:35], a[192:199], v107
    ds_read_b128 v[52:55], v119 offset:1664
    v_smfmac_f32_16x16x64_bf16 v[120:123], v[32:35], a[64:71], v107
    ds_read_b128 v[88:91], v106 offset:14336
    s_waitcnt lgkmcnt(7)
    v_smfmac_f32_16x16x64_bf16 v[124:127], v[36:39], a[200:207], v107
    ds_read_b128 v[56:59], v118 offset:1792
    v_smfmac_f32_16x16x64_bf16 v[120:123], v[36:39], a[72:79], v107
    ds_read_b128 v[92:95], v106 offset:15360
    buffer_load_dwordx4 v104, s[4:7], s39 offen offset:1024 sc1 lds
    s_mov_b32 m0, 163072
    s_waitcnt lgkmcnt(8)
    v_smfmac_f32_16x16x64_bf16 v[124:127], v[40:43], a[208:215], v107
    ds_read_b128 v[60:63], v119 offset:1920
    v_smfmac_f32_16x16x64_bf16 v[120:123], v[40:43], v[64:71], v107
    ds_read_b128 v[64:67], v106 offset:22528
    ds_read_b128 v[68:71], v106 offset:23552
    s_waitcnt lgkmcnt(10)
    v_smfmac_f32_16x16x64_bf16 v[124:127], v[44:47], a[216:223], v107
    v_smfmac_f32_16x16x64_bf16 v[120:123], v[44:47], v[80:87], v107
    ds_read_b128 v[80:83], v106 offset:30720
    ds_read_b128 v[84:87], v106 offset:31744
    buffer_load_dword v117, s[4:7], s40 offen sc1 lds
    s_waitcnt lgkmcnt(10)
    v_smfmac_f32_16x16x64_bf16 v[124:127], v[48:51], a[224:231], v107
    s_waitcnt lgkmcnt(9)
    v_smfmac_f32_16x16x64_bf16 v[120:123], v[48:51], v[72:79], v107
    s_add_u32 s39, s39, 0x40000
    s_add_u32 s40, s40, 0x40000
    s_xor_b32 s43, s43, 0x6000
    s_waitcnt lgkmcnt(8)
    v_smfmac_f32_16x16x64_bf16 v[124:127], v[52:55], a[232:239], v107
    s_waitcnt lgkmcnt(5)
    v_smfmac_f32_16x16x64_bf16 v[120:123], v[52:55], v[88:95], v107
    v_mov_b32 v88, s31
    v_smfmac_f32_16x16x64_bf16 v[124:127], v[56:59], a[240:247], v107
    s_waitcnt lgkmcnt(2)
    v_smfmac_f32_16x16x64_bf16 v[120:123], v[56:59], v[64:71], v107
    v_mov_b32 v89, 32
    v_smfmac_f32_16x16x64_bf16 v[124:127], v[60:63], a[248:255], v107
    s_waitcnt lgkmcnt(0)
    v_smfmac_f32_16x16x64_bf16 v[120:123], v[60:63], v[80:87], v107
    s_mov_b64 exec, 1
    buffer_store_dword v88, v89, s[4:7], s50 offen sc1
    s_mov_b64 exec, -1
    v_smfmac_f32_16x16x64_bf16 v[112:115], v[0:3], v[128:135], v107
    v_smfmac_f32_16x16x64_bf16 v[112:115], v[4:7], v[136:143], v107
    v_cvt_pk_bf16_f32 v68, v124, v125
    v_smfmac_f32_16x16x64_bf16 v[112:115], v[8:11], v[144:151], v107
    v_cvt_pk_bf16_f32 v69, v126, v127
    ds_write_b64 v110, v[68:69]
    v_smfmac_f32_16x16x64_bf16 v[112:115], v[12:15], v[152:159], v107
    v_cvt_pk_bf16_f32 v120, v120, v121
    v_smfmac_f32_16x16x64_bf16 v[112:115], v[16:19], v[160:167], v107
    v_cvt_pk_bf16_f32 v121, v122, v123
    ds_write_b64 v110, v[120:121] offset:2048
    v_smfmac_f32_16x16x64_bf16 v[112:115], v[20:23], v[168:175], v107
    ds_read_b128 v[0:3], v116 offset:8192
    v_mov_b32 v125, 0
    v_smfmac_f32_16x16x64_bf16 v[112:115], v[24:27], v[176:183], v107
    ds_read_b128 v[4:7], v116 offset:9216
    v_mov_b32 v126, 0
    v_smfmac_f32_16x16x64_bf16 v[112:115], v[28:31], v[184:191], v107
    ds_read_b128 v[8:11], v116 offset:10240
    v_smfmac_f32_16x16x64_bf16 v[112:115], v[32:35], v[192:199], v107
    ds_read_b128 v[12:15], v116 offset:11264
    v_smfmac_f32_16x16x64_bf16 v[112:115], v[36:39], v[200:207], v107
    ds_read_b128 v[16:19], v116 offset:12288
    s_waitcnt lgkmcnt(5)
    s_barrier
    v_smfmac_f32_16x16x64_bf16 v[112:115], v[40:43], v[208:215], v107
    ds_read_b64_tr_b16 v[64:65], v111 offset:0
    ds_read_b64_tr_b16 v[66:67], v111 offset:256
    v_min_u32 v120, -2, v120
    v_smfmac_f32_16x16x64_bf16 v[112:115], v[44:47], v[216:223], v107
    ds_read_b64_tr_b16 v[68:69], v111 offset:512
    ds_read_b64_tr_b16 v[70:71], v111 offset:768
    v_smfmac_f32_16x16x64_bf16 v[112:115], v[48:51], v[224:231], v107
    ds_read_b64_tr_b16 v[72:73], v111 offset:1024
    ds_read_b64_tr_b16 v[74:75], v111 offset:1280
    v_smfmac_f32_16x16x64_bf16 v[112:115], v[52:55], v[232:239], v107
    ds_read_b64_tr_b16 v[76:77], v111 offset:1536
    ds_read_b64_tr_b16 v[78:79], v111 offset:1792
    v_smfmac_f32_16x16x64_bf16 v[112:115], v[56:59], v[240:247], v107
    ds_read_b128 v[20:23], v116 offset:13312
    v_mov_b64 v[48:49], s[98:99]
    v_smfmac_f32_16x16x64_bf16 v[112:115], v[60:63], v[248:255], v107
    ds_read_b128 v[24:27], v116 offset:14336
    v_mov_b64 v[50:51], s[98:99]
    s_waitcnt lgkmcnt(8)
    v_mfma_f32_16x16x32_bf16 v[32:35], v[0:3], v[64:67], 0
    ds_read_b128 v[28:31], v116 offset:15360
    ds_read_b64_tr_b16 v[80:81], v111 offset:2048
    ds_read_b64_tr_b16 v[82:83], v111 offset:2304
    s_waitcnt lgkmcnt(9)
    v_mfma_f32_16x16x32_bf16 v[32:35], v[4:7], v[68:71], v[32:35]
    ds_read_b64_tr_b16 v[84:85], v111 offset:2560
    ds_read_b64_tr_b16 v[86:87], v111 offset:2816
    s_waitcnt lgkmcnt(9)
    v_mfma_f32_16x16x32_bf16 v[32:35], v[8:11], v[72:75], v[32:35]
    ds_read_b64_tr_b16 v[88:89], v111 offset:3072
    ds_read_b64_tr_b16 v[90:91], v111 offset:3328
    v_cvt_pk_bf16_f32 v122, v112, v113
    s_waitcnt lgkmcnt(9)
    v_mfma_f32_16x16x32_bf16 v[32:35], v[12:15], v[76:79], v[32:35]
    ds_read_b64_tr_b16 v[92:93], v111 offset:3584
    ds_read_b64_tr_b16 v[94:95], v111 offset:3840
    v_cvt_pk_bf16_f32 v123, v114, v115
    s_waitcnt lgkmcnt(8)
    v_mfma_f32_16x16x32_bf16 v[36:39], v[16:19], v[64:67], 0
    v_xor_b32 v116, 0x2000, v116
    v_mfma_f32_16x16x32_bf16 v[36:39], v[20:23], v[68:71], v[36:39]
    v_permlane32_swap_b32 v122, v123
    v_mfma_f32_16x16x32_bf16 v[36:39], v[24:27], v[72:75], v[36:39]
    v_mfma_f32_16x16x32_bf16 v[36:39], v[28:31], v[76:79], v[36:39]
    s_waitcnt lgkmcnt(0)
    v_mfma_f32_16x16x32_bf16 v[40:43], v[80:83], v[64:67], 0
    ds_read_b128 v[56:59], v106 offset:18432
    v_max3_f32 v44, v32, v33, v34
    v_mfma_f32_16x16x32_bf16 v[40:43], v[84:87], v[68:71], v[40:43]
    ds_read_b128 v[60:63], v106 offset:19456
    v_mfma_f32_16x16x32_bf16 v[40:43], v[88:91], v[72:75], v[40:43]
    ds_read_b128 v[0:3], v106 offset:8192
    v_max3_f32 v45, v35, v36, v37
    v_max3_f32 v44, v44, v38, v39
    v_mfma_f32_16x16x32_bf16 v[40:43], v[92:95], v[76:79], v[40:43]
    v_max_f32 v44, v44, v45
    v_mov_b32 v45, v44
    ds_read_b128 v[4:7], v106 offset:9216
    s_nop 0
    v_permlane32_swap_b32 v44, v45
    buffer_store_dwordx4 v[120:123], v104, s[4:7], s41 offen sc1
    s_nop 1
    v_max3_f32 v46, v40, v41, v42
    v_max3_f32 v44, v44, v45, v43
    v_max_f32 v44, v44, v46
    v_mov_b32 v45, v44
    v_cndmask_b32 v40, v40, v42, s[48:49]
    v_cndmask_b32 v41, v41, v43, s[48:49]
    v_permlane16_swap_b32 v44, v45
    v_max_f32 v44, v44, v45
    v_mul_f32 v44, s34, v44
    v_pk_fma_f32 v[32:33], v[32:33], s[34:35], v[44:45] op_sel_hi:[1,1,0] neg_lo:[0,0,1] neg_hi:[0,0,1]
    v_pk_fma_f32 v[34:35], v[34:35], s[34:35], v[44:45] op_sel_hi:[1,1,0] neg_lo:[0,0,1] neg_hi:[0,0,1]
    v_pk_fma_f32 v[36:37], v[36:37], s[34:35], v[44:45] op_sel_hi:[1,1,0] neg_lo:[0,0,1] neg_hi:[0,0,1]
    v_pk_fma_f32 v[38:39], v[38:39], s[34:35], v[44:45] op_sel_hi:[1,1,0] neg_lo:[0,0,1] neg_hi:[0,0,1]
    v_pk_fma_f32 v[40:41], v[40:41], s[34:35], v[44:45] op_sel_hi:[1,1,0] neg_lo:[0,0,1] neg_hi:[0,0,1]
    v_exp_f32 v32, v32
    v_exp_f32 v33, v33
    v_exp_f32 v34, v34
    v_exp_f32 v35, v35
    v_exp_f32 v36, v36
    v_exp_f32 v37, v37
    v_exp_f32 v38, v38
    v_exp_f32 v39, v39
    v_cvt_pk_bf16_f32 v44, v32, v33
    v_cvt_pk_bf16_f32 v45, v34, v35
    v_cvt_pk_bf16_f32 v46, v36, v37
    v_cvt_pk_bf16_f32 v47, v38, v39
    v_exp_f32 v40, v40
    v_exp_f32 v41, v41
    s_waitcnt vmcnt(4)
    v_mfma_f32_16x16x32_bf16 v[52:55], v[48:51], v[44:47], 0
    ds_read_b128 v[8:11], v106 offset:16384
    v_cvt_pk_bf16_f32 v124, v40, v41
    v_cvt_pk_bf16_f32 v127, v40, v41
    v_mfma_f32_16x16x32_bf16 v[32:35], v[96:99], v[44:47], 0
    ds_read_b128 v[12:15], v106 offset:17408
    v_mov_b64 v[64:65], 0
    v_mov_b64 v[66:67], 0
    v_mfma_f32_16x16x32_bf16 v[36:39], v[100:103], v[44:47], 0
    ds_read_b128 v[16:19], v106 offset:24576
    v_mov_b64 v[68:69], 0
    v_mfma_f32_16x16x16_bf16 v[52:55], v[48:49], v[124:125], v[52:55]
    ds_read_b128 v[20:23], v106 offset:25600
    v_mov_b64 v[70:71], 0
    v_mfma_f32_16x16x16_bf16 v[32:35], v[122:123], v[124:125], v[32:35]
    ds_read_b128 v[24:27], v106 offset:10240
    v_mov_b64 v[72:73], 0
    v_mfma_f32_16x16x16_bf16 v[36:39], v[122:123], v[126:127], v[36:39]
    ds_read_b128 v[28:31], v106 offset:11264
    v_mov_b64 v[74:75], 0
    v_rcp_f32 v52, v52
    v_mov_b64 v[76:77], 0
    s_nop 0
    v_pk_mul_f32 v[32:33], v[32:33], v[52:53] op_sel_hi:[1,0]
    v_pk_mul_f32 v[34:35], v[34:35], v[52:53] op_sel_hi:[1,0]
    v_mov_b64 v[78:79], 0
    v_pk_mul_f32 v[36:37], v[36:37], v[52:53] op_sel_hi:[1,0]
    v_pk_mul_f32 v[38:39], v[38:39], v[52:53] op_sel_hi:[1,0]
    v_cvt_pk_bf16_f32 v48, v32, v33
    v_cvt_pk_bf16_f32 v49, v34, v35
    v_cvt_pk_bf16_f32 v50, v36, v37
    v_cvt_pk_bf16_f32 v51, v38, v39
    ds_write_b128 v105, v[48:51] offset:31488
    s_nop 0
    v_smfmac_f32_16x16x64_bf16 v[64:67], v[48:51], a[128:135], v107
    ds_read_b128 v[96:99], v106 offset:26624
    v_smfmac_f32_16x16x64_bf16 v[68:71], v[48:51], a[0:7], v107
    ds_read_b128 v[100:103], v106 offset:27648
    v_smfmac_f32_16x16x64_bf16 v[72:75], v[48:51], a[136:143], v107
    v_smfmac_f32_16x16x64_bf16 v[76:79], v[48:51], a[8:15], v107
    s_waitcnt lgkmcnt(2)
    s_barrier
    ds_read_b128 v[112:115], v105 offset:30976
    ds_read_b128 v[120:123], v105 offset:30464
    ds_read_b128 v[52:55], v105 offset:29952
    s_waitcnt lgkmcnt(2)
    v_smfmac_f32_16x16x64_bf16 v[64:67], v[112:115], v[0:7], v107
    s_waitcnt lgkmcnt(1)
    v_smfmac_f32_16x16x64_bf16 v[64:67], v[120:123], v[8:15], v107
    s_waitcnt lgkmcnt(0)
    v_smfmac_f32_16x16x64_bf16 v[64:67], v[52:55], v[16:23], v107
    v_smfmac_f32_16x16x64_bf16 v[68:71], v[112:115], v[24:31], v107
    ds_read_b128 v[88:91], v104 offset:28672
    v_smfmac_f32_16x16x64_bf16 v[68:71], v[120:123], v[56:63], v107
    v_smfmac_f32_16x16x64_bf16 v[68:71], v[52:55], v[96:103], v107
    v_cvt_pk_bf16_f32 v48, v64, v65
    v_smfmac_f32_16x16x64_bf16 v[72:75], v[112:115], a[80:87], v107
    v_cvt_pk_bf16_f32 v49, v66, v67
    v_smfmac_f32_16x16x64_bf16 v[72:75], v[120:123], a[88:95], v107
    v_and_or_b32 v48, v48, -2, s101
    v_smfmac_f32_16x16x64_bf16 v[72:75], v[52:55], a[96:103], v107
    v_cvt_pk_bf16_f32 v50, v68, v69
    v_cvt_pk_bf16_f32 v51, v70, v71
    v_smfmac_f32_16x16x64_bf16 v[76:79], v[112:115], a[104:111], v107
    buffer_store_dwordx4 v[48:51], v108, s[4:7], s32 offen
    v_smfmac_f32_16x16x64_bf16 v[76:79], v[120:123], a[112:119], v107
    v_smfmac_f32_16x16x64_bf16 v[76:79], v[52:55], a[120:127], v107
    v_cvt_pk_bf16_f32 v56, v72, v73
    v_cvt_pk_bf16_f32 v57, v74, v75
    v_and_or_b32 v56, v56, -2, s101
    s_add_u32 s36, s32, 8192
    s_and_b32 s45, s31, 3
    s_lshl_b32 s45, s45, 18
    s_add_u32 s33, s45, s47
    s_add_u32 s31, s31, 1
    v_cvt_pk_bf16_f32 v58, v76, v77
    v_cvt_pk_bf16_f32 v59, v78, v79
    buffer_store_dwordx4 v[56:59], v108, s[4:7], s36 offen
    s_add_u32 s41, s41, 0x20000
    s_and_b32 s45, s31, 3
    s_lshl_b32 s46, s45, 13
    s_add_u32 s37, s46, 0xa00000
    s_add_u32 s38, s46, 0x9e1800
    s_lshl_b32 s45, s45, 18
    s_add_u32 s32, s45, 0x900000
    s_cmp_lt_u32 s42, s44
    s_cbranch_scc1 L_prg_fast3
    s_nop 15
    s_nop 15
    s_nop 15
    s_nop 7
L_prd_fast3:
    buffer_load_dwordx4 v[0:3], v104, s[4:7], s33 offen sc1
    buffer_load_dwordx4 v[4:7], v104, s[4:7], s33 offen offset:1024 sc1
    v_mov_b64 v[120:121], 0
    s_nop 6
    v_mov_b64 v[122:123], 0
    s_nop 6
    buffer_load_dwordx4 v[8:11], v104, s[4:7], s33 offen sc1
    buffer_load_dwordx4 v[12:15], v104, s[4:7], s33 offen offset:1024 sc1
    v_mov_b64 v[124:125], 0
    s_nop 5
    v_mov_b64 v[126:127], 0
    s_nop 5
    v_mov_b64 v[112:113], 0
    s_nop 5
    v_mov_b64 v[114:115], 0
    s_nop 5
    v_mov_b32 v30, -1
    s_nop 5
    s_waitcnt lgkmcnt(0)
    s_waitcnt vmcnt(3)
    v_mfma_f32_16x16x32_bf16 v[92:95], v[88:91], v[0:3], 0
    v_and_b32 v28, 1, v0
    s_waitcnt vmcnt(2)
    v_mfma_f32_16x16x32_bf16 v[92:95], v[88:91], v[4:7], v[92:95]
    v_and_b32 v29, 1, v4
    v_cmp_ne_u32 vcc, s101, v28
    v_cmp_ne_u32 s[16:17], s101, v29
    s_or_b64 s[18:19], vcc, s[16:17]
    s_cbranch_scc1 L_p1b_fast3
L_p1ok_fast3:
    s_nop 2
    v_add_f32_dpp v92, v92, v92 row_ror:4 row_mask:0xf bank_mask:0xf
    v_add_f32_dpp v93, v93, v93 row_ror:4 row_mask:0xf bank_mask:0xf
    s_nop 0
    v_add_f32_dpp v92, v92, v92 row_ror:8 row_mask:0xf bank_mask:0xf
    v_add_f32_dpp v93, v93, v93 row_ror:8 row_mask:0xf bank_mask:0xf
    v_cvt_pk_bf16_f32 v92, v92, v93
    v_min_u32 v92, -2, v92
    buffer_store_dword v92, v109, s[4:7], s37 offen
    s_bfe_u32 s101, s31, 0x10002
    s_xor_b32 s101, s101, 1
    s_add_u32 s44, s31, 6
    s_cmp_eq_u32 s31, 1
    s_cselect_b32 s44, 64, s44
    s_min_u32 s44, s44, 64
    s_branch L_loop_fast3
L_p1b_fast3:
L_p1r_fast3:
    s_or_b64 exec, vcc, 1
    buffer_load_dwordx4 v[0:3], v104, s[4:7], s33 offen sc1
    s_or_b64 exec, s[16:17], 1
    buffer_load_dwordx4 v[4:7], v104, s[4:7], s33 offen offset:1024 sc1
    s_mov_b64 exec, -1
    s_waitcnt vmcnt(3)
    v_mfma_f32_16x16x32_bf16 v[92:95], v[88:91], v[8:11], 0
    v_and_b32 v28, 1, v8
    s_waitcnt vmcnt(2)
    v_mfma_f32_16x16x32_bf16 v[92:95], v[88:91], v[12:15], v[92:95]
    v_and_b32 v29, 1, v12
    v_cmp_ne_u32 vcc, s101, v28
    v_cmp_ne_u32 s[16:17], s101, v29
    s_or_b64 s[18:19], vcc, s[16:17]
    s_cbranch_scc0 L_p1k_fast3
    s_or_b64 exec, vcc, 1
    buffer_load_dwordx4 v[8:11], v104, s[4:7], s33 offen sc1
    s_or_b64 exec, s[16:17], 1
    buffer_load_dwordx4 v[12:15], v104, s[4:7], s33 offen offset:1024 sc1
    s_mov_b64 exec, -1
    s_add_u32 s100, s100, 1
    s_bitcmp1_b32 s100, 15
    s_cbranch_scc1 L_exit
    s_waitcnt vmcnt(3)
    v_mfma_f32_16x16x32_bf16 v[92:95], v[88:91], v[0:3], 0
    v_and_b32 v28, 1, v0
    s_waitcnt vmcnt(2)
    v_mfma_f32_16x16x32_bf16 v[92:95], v[88:91], v[4:7], v[92:95]
    v_and_b32 v29, 1, v4
    v_cmp_ne_u32 vcc, s101, v28
    v_cmp_ne_u32 s[16:17], s101, v29
    s_or_b64 s[18:19], vcc, s[16:17]
    s_cbranch_scc1 L_p1r_fast3
L_p1k_fast3:
    s_nop 2
    s_branch L_p1ok_fast3
L_p2b_fast3:
L_p2r_fast3:
    s_or_b64 exec, vcc, 1
    buffer_load_dwordx4 v[72:75], v104, s[4:7], s38 offen sc1
    s_or_b64 exec, s[16:17], 1
    buffer_load_dwordx4 v[76:79], v104, s[4:7], s38 offen offset:1024 sc1
    s_mov_b64 exec, -1
    s_waitcnt vmcnt(2)
    ds_write_b128 v104, v[88:91] offset:6144
    ds_write_b128 v104, v[92:95] offset:7168
    v_max3_u32 v26, v88, v89, v90
    v_max3_u32 v27, v92, v93, v94
    v_max_u32 v26, v26, v91
    v_max_u32 v27, v27, v95
    v_cmp_eq_u32 vcc, -1, v26
    v_cmp_eq_u32 s[16:17], -1, v27
    s_or_b64 s[18:19], vcc, s[16:17]
    s_cbranch_scc0 L_go_fast3
    s_or_b64 exec, vcc, 1
    buffer_load_dwordx4 v[88:91], v104, s[4:7], s38 offen sc1
    s_or_b64 exec, s[16:17], 1
    buffer_load_dwordx4 v[92:95], v104, s[4:7], s38 offen offset:1024 sc1
    s_mov_b64 exec, -1
    s_add_u32 s100, s100, 1
    s_bitcmp1_b32 s100, 15
    s_cbranch_scc1 L_exit
    s_waitcnt vmcnt(2)
    ds_write_b128 v104, v[72:75] offset:6144
    ds_write_b128 v104, v[76:79] offset:7168
    v_max3_u32 v26, v72, v73, v74
    v_max3_u32 v27, v76, v77, v78
    v_max_u32 v26, v26, v75
    v_max_u32 v27, v27, v79
    v_cmp_eq_u32 vcc, -1, v26
    v_cmp_eq_u32 s[16:17], -1, v27
    s_or_b64 s[18:19], vcc, s[16:17]
    s_cbranch_scc1 L_p2r_fast3
    s_branch L_go_fast3
L_enter_fast3:
    ds_write_b128 v104, v[72:75] offset:6144
    ds_write_b128 v104, v[76:79] offset:7168
    ds_read_b128 v[64:67], v106 offset:12288
    ds_read_b128 v[68:71], v106 offset:13312
    ds_read_b128 v[80:83], v106 offset:20480
    ds_read_b128 v[84:87], v106 offset:21504
    ds_read_b128 v[32:35], v106 offset:0
    ds_read_b128 v[36:39], v106 offset:1024
    ds_read_b128 v[40:43], v106 offset:2048
    ds_read_b128 v[44:47], v106 offset:3072
    ds_read_b128 v[48:51], v106 offset:4096
    ds_read_b128 v[52:55], v106 offset:5120
    ds_read_b128 v[56:59], v106 offset:6144
    ds_read_b128 v[60:63], v106 offset:7168
    s_mov_b32 m0, s43
    s_branch L_go_fast3
L_prg_fast3:
    v_mov_b32 v72, 160768
    ds_read_b32 v92, v72
    ds_read_b128 v[72:75], v72 offset:16
    s_add_u32 s45, s31, 2
    s_min_u32 s45, s45, 64
    s_waitcnt lgkmcnt(0)
    v_readfirstlane_b32 s30, v92
    s_cmp_eq_u32 s30, 192
    s_cselect_b32 s42, 64, s42
    v_min_u32 v72, v72, v74
    v_min_u32 v73, v73, v75
    v_lshlrev_b32 v72, 1, v72
    v_lshl_or_b32 v73, v73, 1, 1
    v_min_u32 v72, v72, v73
    s_nop 0
    v_readfirstlane_b32 s30, v72
    s_max_u32 s42, s42, s30
    s_cmp_ge_u32 s42, s45
    s_cbranch_scc1 L_kvd_15
L_kvw_14:
    v_mov_b32 v76, 0
    buffer_load_dwordx4 v[72:75], v76, s[4:7], s50 offen sc1
    s_waitcnt vmcnt(0)
    v_min_u32 v72, v72, v74
    v_min_u32 v73, v73, v75
    v_lshlrev_b32 v72, 1, v72
    v_lshl_or_b32 v73, v73, 1, 1
    v_min_u32 v72, v72, v73
    s_nop 0
    v_readfirstlane_b32 s30, v72
    s_max_u32 s42, s42, s30
    s_cmp_ge_u32 s42, s45
    s_cbranch_scc1 L_kvd_15
    s_sleep 1
    s_add_u32 s100, s100, 1
    s_bitcmp1_b32 s100, 15
    s_cbranch_scc1 L_exit
    s_branch L_kvw_14
L_kvd_15:
    s_nop 15
    s_branch L_prd_fast3
    .p2align 6
L_loop_safe0:
    s_add_u32 s46, s31, 2
    s_and_b32 s46, s46, 3
    s_lshl_b32 s46, s46, 13
    s_add_u32 s46, s46, 0xa00000
    buffer_store_dword v30, v109, s[4:7], s46 offen sc1
    s_mov_b32 m0, s43
    ds_read_b128 v[64:67], v106 offset:12288
    ds_read_b128 v[68:71], v106 offset:13312
    ds_read_b128 v[80:83], v106 offset:20480
    ds_read_b128 v[84:87], v106 offset:21504
    ds_read_b128 v[32:35], v106 offset:0
    ds_read_b128 v[36:39], v106 offset:1024
    ds_read_b128 v[40:43], v106 offset:2048
    ds_read_b128 v[44:47], v106 offset:3072
    ds_read_b128 v[48:51], v106 offset:4096
    ds_read_b128 v[52:55], v106 offset:5120
    ds_read_b128 v[56:59], v106 offset:6144
    ds_read_b128 v[60:63], v106 offset:7168
    s_nop 11
    buffer_load_dwordx4 v[72:75], v104, s[4:7], s38 offen sc1
    buffer_load_dwordx4 v[76:79], v104, s[4:7], s38 offen offset:1024 sc1
    s_nop 15
    s_nop 15
    s_nop 11
    buffer_load_dwordx4 v[88:91], v104, s[4:7], s38 offen sc1
    buffer_load_dwordx4 v[92:95], v104, s[4:7], s38 offen offset:1024 sc1
    s_waitcnt vmcnt(3)
    ds_write_b128 v104, v[72:75] offset:0
    s_waitcnt vmcnt(2)
    ds_write_b128 v104, v[76:79] offset:1024
    v_max3_u32 v26, v72, v73, v74
    v_max3_u32 v27, v76, v77, v78
    v_max_u32 v26, v26, v75
    v_max_u32 v27, v27, v79
    v_cmp_eq_u32 vcc, -1, v26
    v_cmp_eq_u32 s[16:17], -1, v27
    s_or_b64 s[18:19], vcc, s[16:17]
    s_cbranch_scc1 L_p2b_safe0
L_go_safe0:
    s_waitcnt lgkmcnt(0)
    s_barrier
    ds_read_b128 v[0:3], v118 offset:0
    ds_read_b128 v[4:7], v119 offset:128
    ds_read_b128 v[8:11], v118 offset:256
    ds_read_b128 v[12:15], v119 offset:384
    ds_read_b128 v[16:19], v118 offset:512
    s_cmp_eq_u32 s31, 63
    s_cbranch_scc1 L_chain_end
    s_waitcnt lgkmcnt(4)
    v_smfmac_f32_16x16x64_bf16 v[124:127], v[0:3], v[32:39], v107
    ds_read_b128 v[20:23], v119 offset:640
    v_smfmac_f32_16x16x64_bf16 v[120:123], v[0:3], v[40:47], v107
    s_waitcnt lgkmcnt(4)
    v_smfmac_f32_16x16x64_bf16 v[124:127], v[4:7], v[48:55], v107
    ds_read_b128 v[24:27], v118 offset:768
    v_smfmac_f32_16x16x64_bf16 v[120:123], v[4:7], v[56:63], v107
    s_waitcnt lgkmcnt(4)
    v_smfmac_f32_16x16x64_bf16 v[124:127], v[8:11], a[144:151], v107
    ds_read_b128 v[28:31], v119 offset:896
    v_smfmac_f32_16x16x64_bf16 v[120:123], v[8:11], a[16:23], v107
    s_waitcnt lgkmcnt(4)
    v_smfmac_f32_16x16x64_bf16 v[124:127], v[12:15], a[152:159], v107
    ds_read_b128 v[32:35], v118 offset:1024
    v_smfmac_f32_16x16x64_bf16 v[120:123], v[12:15], a[24:31], v107
    buffer_load_dwordx4 v[96:99], v104, s[4:7], s40 offen sc1
    s_waitcnt lgkmcnt(4)
    v_smfmac_f32_16x16x64_bf16 v[124:127], v[16:19], a[160:167], v107
    ds_read_b128 v[36:39], v119 offset:1152
    v_smfmac_f32_16x16x64_bf16 v[120:123], v[16:19], a[32:39], v107
    s_waitcnt lgkmcnt(4)
    v_smfmac_f32_16x16x64_bf16 v[124:127], v[20:23], a[168:175], v107
    ds_read_b128 v[40:43], v118 offset:1280
    v_smfmac_f32_16x16x64_bf16 v[120:123], v[20:23], a[40:47], v107
    buffer_load_dwordx4 v[100:103], v104, s[4:7], s40 offen offset:1024 sc1
    s_waitcnt vmcnt(2)
    s_waitcnt lgkmcnt(4)
    v_smfmac_f32_16x16x64_bf16 v[124:127], v[24:27], a[176:183], v107
    ds_read_b128 v[44:47], v119 offset:1408
    v_smfmac_f32_16x16x64_bf16 v[120:123], v[24:27], a[48:55], v107
    ds_read_b128 v[72:75], v106 offset:28672
    s_waitcnt lgkmcnt(5)
    v_smfmac_f32_16x16x64_bf16 v[124:127], v[28:31], a[184:191], v107
    ds_read_b128 v[48:51], v118 offset:1536
    v_smfmac_f32_16x16x64_bf16 v[120:123], v[28:31], a[56:63], v107
    ds_read_b128 v[76:79], v106 offset:29696
    buffer_load_dwordx4 v104, s[4:7], s39 offen sc1 lds
    s_waitcnt lgkmcnt(6)
    v_smfmac_f32_16x16x64_bf16 v[124:127], v[32:35], a[192:199], v107
    ds_read_b128 v[52:55], v119 offset:1664
    v_smfmac_f32_16x16x64_bf16 v[120:123], v[32:35], a[64:71], v107
    ds_read_b128 v[88:91], v106 offset:14336
    s_waitcnt lgkmcnt(7)
    v_smfmac_f32_16x16x64_bf16 v[124:127], v[36:39], a[200:207], v107
    ds_read_b128 v[56:59], v118 offset:1792
    v_smfmac_f32_16x16x64_bf16 v[120:123], v[36:39], a[72:79], v107
    ds_read_b128 v[92:95], v106 offset:15360
    buffer_load_dwordx4 v104, s[4:7], s39 offen offset:1024 sc1 lds
    s_mov_b32 m0, 163072
    s_waitcnt lgkmcnt(8)
    v_smfmac_f32_16x16x64_bf16 v[124:127], v[40:43], a[208:215], v107
    ds_read_b128 v[60:63], v119 offset:1920
    v_smfmac_f32_16x16x64_bf16 v[120:123], v[40:43], v[64:71], v107
    ds_read_b128 v[64:67], v106 offset:22528
    ds_read_b128 v[68:71], v106 offset:23552
    s_waitcnt lgkmcnt(10)
    v_smfmac_f32_16x16x64_bf16 v[124:127], v[44:47], a[216:223], v107
    v_smfmac_f32_16x16x64_bf16 v[120:123], v[44:47], v[80:87], v107
    ds_read_b128 v[80:83], v106 offset:30720
    ds_read_b128 v[84:87], v106 offset:31744
    buffer_load_dword v117, s[4:7], s40 offen sc1 lds
    s_waitcnt lgkmcnt(10)
    v_smfmac_f32_16x16x64_bf16 v[124:127], v[48:51], a[224:231], v107
    s_waitcnt lgkmcnt(9)
    v_smfmac_f32_16x16x64_bf16 v[120:123], v[48:51], v[72:79], v107
    s_add_u32 s39, s39, 0x40000
    s_add_u32 s40, s40, 0x40000
    s_xor_b32 s43, s43, 0x6000
    s_waitcnt lgkmcnt(8)
    v_smfmac_f32_16x16x64_bf16 v[124:127], v[52:55], a[232:239], v107
    s_waitcnt lgkmcnt(5)
    v_smfmac_f32_16x16x64_bf16 v[120:123], v[52:55], v[88:95], v107
    v_smfmac_f32_16x16x64_bf16 v[124:127], v[56:59], a[240:247], v107
    s_waitcnt lgkmcnt(2)
    v_smfmac_f32_16x16x64_bf16 v[120:123], v[56:59], v[64:71], v107
    v_smfmac_f32_16x16x64_bf16 v[124:127], v[60:63], a[248:255], v107
    s_waitcnt lgkmcnt(0)
    v_smfmac_f32_16x16x64_bf16 v[120:123], v[60:63], v[80:87], v107
    v_smfmac_f32_16x16x64_bf16 v[112:115], v[0:3], v[128:135], v107
    v_smfmac_f32_16x16x64_bf16 v[112:115], v[4:7], v[136:143], v107
    v_cvt_pk_bf16_f32 v68, v124, v125
    v_smfmac_f32_16x16x64_bf16 v[112:115], v[8:11], v[144:151], v107
    v_cvt_pk_bf16_f32 v69, v126, v127
    ds_write_b64 v110, v[68:69]
    v_smfmac_f32_16x16x64_bf16 v[112:115], v[12:15], v[152:159], v107
    v_cvt_pk_bf16_f32 v120, v120, v121
    v_smfmac_f32_16x16x64_bf16 v[112:115], v[16:19], v[160:167], v107
    v_cvt_pk_bf16_f32 v121, v122, v123
    ds_write_b64 v110, v[120:121] offset:2048
    v_smfmac_f32_16x16x64_bf16 v[112:115], v[20:23], v[168:175], v107
    ds_read_b128 v[0:3], v116 offset:8192
    v_mov_b32 v125, 0
    v_smfmac_f32_16x16x64_bf16 v[112:115], v[24:27], v[176:183], v107
    ds_read_b128 v[4:7], v116 offset:9216
    v_mov_b32 v126, 0
    v_smfmac_f32_16x16x64_bf16 v[112:115], v[28:31], v[184:191], v107
    ds_read_b128 v[8:11], v116 offset:10240
    v_smfmac_f32_16x16x64_bf16 v[112:115], v[32:35], v[192:199], v107
    ds_read_b128 v[12:15], v116 offset:11264
    v_smfmac_f32_16x16x64_bf16 v[112:115], v[36:39], v[200:207], v107
    ds_read_b128 v[16:19], v116 offset:12288
    s_waitcnt lgkmcnt(5)
    s_barrier
    v_smfmac_f32_16x16x64_bf16 v[112:115], v[40:43], v[208:215], v107
    ds_read_b64_tr_b16 v[64:65], v111 offset:0
    ds_read_b64_tr_b16 v[66:67], v111 offset:256
    v_min_u32 v120, -2, v120
    v_smfmac_f32_16x16x64_bf16 v[112:115], v[44:47], v[216:223], v107
    ds_read_b64_tr_b16 v[68:69], v111 offset:512
    ds_read_b64_tr_b16 v[70:71], v111 offset:768
    v_smfmac_f32_16x16x64_bf16 v[112:115], v[48:51], v[224:231], v107
    ds_read_b64_tr_b16 v[72:73], v111 offset:1024
    ds_read_b64_tr_b16 v[74:75], v111 offset:1280
    v_smfmac_f32_16x16x64_bf16 v[112:115], v[52:55], v[232:239], v107
    ds_read_b64_tr_b16 v[76:77], v111 offset:1536
    ds_read_b64_tr_b16 v[78:79], v111 offset:1792
    v_smfmac_f32_16x16x64_bf16 v[112:115], v[56:59], v[240:247], v107
    ds_read_b128 v[20:23], v116 offset:13312
    v_mov_b64 v[48:49], s[98:99]
    v_smfmac_f32_16x16x64_bf16 v[112:115], v[60:63], v[248:255], v107
    ds_read_b128 v[24:27], v116 offset:14336
    v_mov_b64 v[50:51], s[98:99]
    s_waitcnt lgkmcnt(8)
    v_mfma_f32_16x16x32_bf16 v[32:35], v[0:3], v[64:67], 0
    ds_read_b128 v[28:31], v116 offset:15360
    ds_read_b64_tr_b16 v[80:81], v111 offset:2048
    ds_read_b64_tr_b16 v[82:83], v111 offset:2304
    s_waitcnt lgkmcnt(9)
    v_mfma_f32_16x16x32_bf16 v[32:35], v[4:7], v[68:71], v[32:35]
    ds_read_b64_tr_b16 v[84:85], v111 offset:2560
    ds_read_b64_tr_b16 v[86:87], v111 offset:2816
    s_waitcnt lgkmcnt(9)
    v_mfma_f32_16x16x32_bf16 v[32:35], v[8:11], v[72:75], v[32:35]
    ds_read_b64_tr_b16 v[88:89], v111 offset:3072
    ds_read_b64_tr_b16 v[90:91], v111 offset:3328
    v_cvt_pk_bf16_f32 v122, v112, v113
    s_waitcnt lgkmcnt(9)
    v_mfma_f32_16x16x32_bf16 v[32:35], v[12:15], v[76:79], v[32:35]
    ds_read_b64_tr_b16 v[92:93], v111 offset:3584
    ds_read_b64_tr_b16 v[94:95], v111 offset:3840
    v_cvt_pk_bf16_f32 v123, v114, v115
    s_waitcnt lgkmcnt(8)
    v_mfma_f32_16x16x32_bf16 v[36:39], v[16:19], v[64:67], 0
    v_xor_b32 v116, 0x2000, v116
    v_mfma_f32_16x16x32_bf16 v[36:39], v[20:23], v[68:71], v[36:39]
    v_permlane32_swap_b32 v122, v123
    v_mfma_f32_16x16x32_bf16 v[36:39], v[24:27], v[72:75], v[36:39]
    buffer_store_dwordx4 v[120:123], v104, s[4:7], s41 offen sc1
    v_mfma_f32_16x16x32_bf16 v[36:39], v[28:31], v[76:79], v[36:39]
    s_waitcnt lgkmcnt(0)
    v_mfma_f32_16x16x32_bf16 v[40:43], v[80:83], v[64:67], 0
    ds_read_b128 v[56:59], v106 offset:18432
    v_max3_f32 v44, v32, v33, v34
    v_mfma_f32_16x16x32_bf16 v[40:43], v[84:87], v[68:71], v[40:43]
    ds_read_b128 v[60:63], v106 offset:19456
    v_mfma_f32_16x16x32_bf16 v[40:43], v[88:91], v[72:75], v[40:43]
    ds_read_b128 v[0:3], v106 offset:8192
    v_max3_f32 v45, v35, v36, v37
    v_max3_f32 v44, v44, v38, v39
    v_mfma_f32_16x16x32_bf16 v[40:43], v[92:95], v[76:79], v[40:43]
    v_max_f32 v44, v44, v45
    v_mov_b32 v45, v44
    ds_read_b128 v[4:7], v106 offset:9216
    s_nop 0
    v_permlane32_swap_b32 v44, v45
    s_nop 2
    v_max3_f32 v46, v40, v41, v42
    v_max3_f32 v44, v44, v45, v43
    v_max_f32 v44, v44, v46
    v_mov_b32 v45, v44
    v_cndmask_b32 v40, v40, v42, s[48:49]
    v_cndmask_b32 v41, v41, v43, s[48:49]
    v_permlane16_swap_b32 v44, v45
    v_max_f32 v44, v44, v45
    v_mul_f32 v44, s34, v44
    v_pk_fma_f32 v[32:33], v[32:33], s[34:35], v[44:45] op_sel_hi:[1,1,0] neg_lo:[0,0,1] neg_hi:[0,0,1]
    v_pk_fma_f32 v[34:35], v[34:35], s[34:35], v[44:45] op_sel_hi:[1,1,0] neg_lo:[0,0,1] neg_hi:[0,0,1]
    v_pk_fma_f32 v[36:37], v[36:37], s[34:35], v[44:45] op_sel_hi:[1,1,0] neg_lo:[0,0,1] neg_hi:[0,0,1]
    v_pk_fma_f32 v[38:39], v[38:39], s[34:35], v[44:45] op_sel_hi:[1,1,0] neg_lo:[0,0,1] neg_hi:[0,0,1]
    v_pk_fma_f32 v[40:41], v[40:41], s[34:35], v[44:45] op_sel_hi:[1,1,0] neg_lo:[0,0,1] neg_hi:[0,0,1]
    v_exp_f32 v32, v32
    v_exp_f32 v33, v33
    v_exp_f32 v34, v34
    v_exp_f32 v35, v35
    v_exp_f32 v36, v36
    v_exp_f32 v37, v37
    v_exp_f32 v38, v38
    v_exp_f32 v39, v39
    v_cvt_pk_bf16_f32 v44, v32, v33
    v_cvt_pk_bf16_f32 v45, v34, v35
    v_cvt_pk_bf16_f32 v46, v36, v37
    v_cvt_pk_bf16_f32 v47, v38, v39
    v_exp_f32 v40, v40
    v_exp_f32 v41, v41
    s_waitcnt vmcnt(4)
    v_mfma_f32_16x16x32_bf16 v[52:55], v[48:51], v[44:47], 0
    ds_read_b128 v[8:11], v106 offset:16384
    v_cvt_pk_bf16_f32 v124, v40, v41
    v_cvt_pk_bf16_f32 v127, v40, v41
    v_mfma_f32_16x16x32_bf16 v[32:35], v[96:99], v[44:47], 0
    ds_read_b128 v[12:15], v106 offset:17408
    v_mov_b64 v[64:65], 0
    v_mov_b64 v[66:67], 0
    v_mfma_f32_16x16x32_bf16 v[36:39], v[100:103], v[44:47], 0
    ds_read_b128 v[16:19], v106 offset:24576
    v_mov_b64 v[68:69], 0
    v_mfma_f32_16x16x16_bf16 v[52:55], v[48:49], v[124:125], v[52:55]
    ds_read_b128 v[20:23], v106 offset:25600
    v_mov_b64 v[70:71], 0
    v_mfma_f32_16x16x16_bf16 v[32:35], v[122:123], v[124:125], v[32:35]
    ds_read_b128 v[24:27], v106 offset:10240
    v_mov_b64 v[72:73], 0
    v_mfma_f32_16x16x16_bf16 v[36:39], v[122:123], v[126:127], v[36:39]
    ds_read_b128 v[28:31], v106 offset:11264
    v_mov_b64 v[74:75], 0
    v_rcp_f32 v52, v52
    v_mov_b64 v[76:77], 0
    s_nop 0
    v_pk_mul_f32 v[32:33], v[32:33], v[52:53] op_sel_hi:[1,0]
    v_pk_mul_f32 v[34:35], v[34:35], v[52:53] op_sel_hi:[1,0]
    v_mov_b64 v[78:79], 0
    v_pk_mul_f32 v[36:37], v[36:37], v[52:53] op_sel_hi:[1,0]
    v_pk_mul_f32 v[38:39], v[38:39], v[52:53] op_sel_hi:[1,0]
    v_cvt_pk_bf16_f32 v48, v32, v33
    v_cvt_pk_bf16_f32 v49, v34, v35
    v_cvt_pk_bf16_f32 v50, v36, v37
    v_cvt_pk_bf16_f32 v51, v38, v39
    ds_write_b128 v105, v[48:51] offset:29952
    s_nop 0
    v_smfmac_f32_16x16x64_bf16 v[64:67], v[48:51], a[128:135], v107
    ds_read_b128 v[96:99], v106 offset:26624
    v_smfmac_f32_16x16x64_bf16 v[68:71], v[48:51], a[0:7], v107
    ds_read_b128 v[100:103], v106 offset:27648
    v_smfmac_f32_16x16x64_bf16 v[72:75], v[48:51], a[136:143], v107
    v_smfmac_f32_16x16x64_bf16 v[76:79], v[48:51], a[8:15], v107
    s_waitcnt lgkmcnt(2)
    s_barrier
    ds_read_b128 v[112:115], v105 offset:30464
    ds_read_b128 v[120:123], v105 offset:30976
    ds_read_b128 v[52:55], v105 offset:31488
    s_waitcnt lgkmcnt(2)
    v_smfmac_f32_16x16x64_bf16 v[64:67], v[112:115], v[0:7], v107
    s_waitcnt lgkmcnt(1)
    v_smfmac_f32_16x16x64_bf16 v[64:67], v[120:123], v[8:15], v107
    s_waitcnt lgkmcnt(0)
    v_smfmac_f32_16x16x64_bf16 v[64:67], v[52:55], v[16:23], v107
    v_smfmac_f32_16x16x64_bf16 v[68:71], v[112:115], v[24:31], v107
    ds_read_b128 v[88:91], v104 offset:28672
    v_smfmac_f32_16x16x64_bf16 v[68:71], v[120:123], v[56:63], v107
    v_smfmac_f32_16x16x64_bf16 v[68:71], v[52:55], v[96:103], v107
    v_cvt_pk_bf16_f32 v48, v64, v65
    v_smfmac_f32_16x16x64_bf16 v[72:75], v[112:115], a[80:87], v107
    v_cvt_pk_bf16_f32 v49, v66, v67
    v_smfmac_f32_16x16x64_bf16 v[72:75], v[120:123], a[88:95], v107
    v_and_or_b32 v48, v48, -2, s101
    v_smfmac_f32_16x16x64_bf16 v[72:75], v[52:55], a[96:103], v107
    v_cvt_pk_bf16_f32 v50, v68, v69
    v_cvt_pk_bf16_f32 v51, v70, v71
    v_smfmac_f32_16x16x64_bf16 v[76:79], v[112:115], a[104:111], v107
    buffer_store_dwordx4 v[48:51], v108, s[4:7], s32 offen sc1
    v_smfmac_f32_16x16x64_bf16 v[76:79], v[120:123], a[112:119], v107
    v_smfmac_f32_16x16x64_bf16 v[76:79], v[52:55], a[120:127], v107
    v_cvt_pk_bf16_f32 v56, v72, v73
    v_cvt_pk_bf16_f32 v57, v74, v75
    v_and_or_b32 v56, v56, -2, s101
    s_add_u32 s36, s32, 8192
    s_and_b32 s45, s31, 3
    s_lshl_b32 s45, s45, 18
    s_add_u32 s33, s45, s47
    s_add_u32 s31, s31, 1
    v_cvt_pk_bf16_f32 v58, v76, v77
    v_cvt_pk_bf16_f32 v59, v78, v79
    buffer_store_dwordx4 v[56:59], v108, s[4:7], s36 offen sc1
    s_add_u32 s41, s41, 0x20000
    s_and_b32 s45, s31, 3
    s_lshl_b32 s46, s45, 13
    s_add_u32 s37, s46, 0xa00000
    s_add_u32 s38, s46, 0x9e0000
    s_lshl_b32 s45, s45, 18
    s_add_u32 s32, s45, 0x900000
    s_cmp_lt_u32 s42, s44
    s_cbranch_scc1 L_prg_safe0
    s_nop 15
    s_nop 15
    s_nop 15
    s_nop 7
L_prd_safe0:
    buffer_load_dwordx4 v[0:3], v104, s[4:7], s33 offen sc1
    buffer_load_dwordx4 v[4:7], v104, s[4:7], s33 offen offset:1024 sc1
    v_mov_b64 v[120:121], 0
    s_nop 6
    v_mov_b64 v[122:123], 0
    s_nop 6
    buffer_load_dwordx4 v[8:11], v104, s[4:7], s33 offen sc1
    buffer_load_dwordx4 v[12:15], v104, s[4:7], s33 offen offset:1024 sc1
    v_mov_b64 v[124:125], 0
    s_nop 5
    v_mov_b64 v[126:127], 0
    s_nop 5
    v_mov_b64 v[112:113], 0
    s_nop 5
    v_mov_b64 v[114:115], 0
    s_nop 5
    v_mov_b32 v30, -1
    s_nop 5
    s_waitcnt lgkmcnt(0)
    s_waitcnt vmcnt(3)
    v_mfma_f32_16x16x32_bf16 v[92:95], v[88:91], v[0:3], 0
    v_and_b32 v28, 1, v0
    s_waitcnt vmcnt(2)
    v_mfma_f32_16x16x32_bf16 v[92:95], v[88:91], v[4:7], v[92:95]
    v_and_b32 v29, 1, v4
    v_cmp_ne_u32 vcc, s101, v28
    v_cmp_ne_u32 s[16:17], s101, v29
    s_or_b64 s[18:19], vcc, s[16:17]
    s_cbranch_scc1 L_p1b_safe0
L_p1ok_safe0:
    s_nop 2
    v_add_f32_dpp v92, v92, v92 row_ror:4 row_mask:0xf bank_mask:0xf
    v_add_f32_dpp v93, v93, v93 row_ror:4 row_mask:0xf bank_mask:0xf
    s_nop 0
    v_add_f32_dpp v92, v92, v92 row_ror:8 row_mask:0xf bank_mask:0xf
    v_add_f32_dpp v93, v93, v93 row_ror:8 row_mask:0xf bank_mask:0xf
    v_cvt_pk_bf16_f32 v92, v92, v93
    v_min_u32 v92, -2, v92
    buffer_store_dword v92, v109, s[4:7], s37 offen sc1
    s_bfe_u32 s101, s31, 0x10002
    s_xor_b32 s101, s101, 1
    s_add_u32 s44, s31, 6
    s_cmp_eq_u32 s31, 1
    s_cselect_b32 s44, 64, s44
    s_min_u32 s44, s44, 64
    s_branch L_loop_safe0
L_p1b_safe0:
L_p1r_safe0:
    s_or_b64 exec, vcc, 1
    buffer_load_dwordx4 v[0:3], v104, s[4:7], s33 offen sc1
    s_or_b64 exec, s[16:17], 1
    buffer_load_dwordx4 v[4:7], v104, s[4:7], s33 offen offset:1024 sc1
    s_mov_b64 exec, -1
    s_waitcnt vmcnt(3)
    v_mfma_f32_16x16x32_bf16 v[92:95], v[88:91], v[8:11], 0
    v_and_b32 v28, 1, v8
    s_waitcnt vmcnt(2)
    v_mfma_f32_16x16x32_bf16 v[92:95], v[88:91], v[12:15], v[92:95]
    v_and_b32 v29, 1, v12
    v_cmp_ne_u32 vcc, s101, v28
    v_cmp_ne_u32 s[16:17], s101, v29
    s_or_b64 s[18:19], vcc, s[16:17]
    s_cbranch_scc0 L_p1k_safe0
    s_or_b64 exec, vcc, 1
    buffer_load_dwordx4 v[8:11], v104, s[4:7], s33 offen sc1
    s_or_b64 exec, s[16:17], 1
    buffer_load_dwordx4 v[12:15], v104, s[4:7], s33 offen offset:1024 sc1
    s_mov_b64 exec, -1
    s_add_u32 s100, s100, 1
    s_bitcmp1_b32 s100, 15
    s_cbranch_scc1 L_exit
    s_waitcnt vmcnt(3)
    v_mfma_f32_16x16x32_bf16 v[92:95], v[88:91], v[0:3], 0
    v_and_b32 v28, 1, v0
    s_waitcnt vmcnt(2)
    v_mfma_f32_16x16x32_bf16 v[92:95], v[88:91], v[4:7], v[92:95]
    v_and_b32 v29, 1, v4
    v_cmp_ne_u32 vcc, s101, v28
    v_cmp_ne_u32 s[16:17], s101, v29
    s_or_b64 s[18:19], vcc, s[16:17]
    s_cbranch_scc1 L_p1r_safe0
L_p1k_safe0:
    s_nop 2
    s_branch L_p1ok_safe0
L_p2b_safe0:
L_p2r_safe0:
    s_or_b64 exec, vcc, 1
    buffer_load_dwordx4 v[72:75], v104, s[4:7], s38 offen sc1
    s_or_b64 exec, s[16:17], 1
    buffer_load_dwordx4 v[76:79], v104, s[4:7], s38 offen offset:1024 sc1
    s_mov_b64 exec, -1
    s_waitcnt vmcnt(2)
    ds_write_b128 v104, v[88:91] offset:0
    ds_write_b128 v104, v[92:95] offset:1024
    v_max3_u32 v26, v88, v89, v90
    v_max3_u32 v27, v92, v93, v94
    v_max_u32 v26, v26, v91
    v_max_u32 v27, v27, v95
    v_cmp_eq_u32 vcc, -1, v26
    v_cmp_eq_u32 s[16:17], -1, v27
    s_or_b64 s[18:19], vcc, s[16:17]
    s_cbranch_scc0 L_go_safe0
    s_or_b64 exec, vcc, 1
    buffer_load_dwordx4 v[88:91], v104, s[4:7], s38 offen sc1
    s_or_b64 exec, s[16:17], 1
    buffer_load_dwordx4 v[92:95], v104, s[4:7], s38 offen offset:1024 sc1
    s_mov_b64 exec, -1
    s_add_u32 s100, s100, 1
    s_bitcmp1_b32 s100, 15
    s_cbranch_scc1 L_exit
    s_waitcnt vmcnt(2)
    ds_write_b128 v104, v[72:75] offset:0
    ds_write_b128 v104, v[76:79] offset:1024
    v_max3_u32 v26, v72, v73, v74
    v_max3_u32 v27, v76, v77, v78
    v_max_u32 v26, v26, v75
    v_max_u32 v27, v27, v79
    v_cmp_eq_u32 vcc, -1, v26
    v_cmp_eq_u32 s[16:17], -1, v27
    s_or_b64 s[18:19], vcc, s[16:17]
    s_cbranch_scc1 L_p2r_safe0
    s_branch L_go_safe0
L_enter_safe0:
    ds_write_b128 v104, v[72:75] offset:0
    ds_write_b128 v104, v[76:79] offset:1024
    ds_read_b128 v[64:67], v106 offset:12288
    ds_read_b128 v[68:71], v106 offset:13312
    ds_read_b128 v[80:83], v106 offset:20480
    ds_read_b128 v[84:87], v106 offset:21504
    ds_read_b128 v[32:35], v106 offset:0
    ds_read_b128 v[36:39], v106 offset:1024
    ds_read_b128 v[40:43], v106 offset:2048
    ds_read_b128 v[44:47], v106 offset:3072
    ds_read_b128 v[48:51], v106 offset:4096
    ds_read_b128 v[52:55], v106 offset:5120
    ds_read_b128 v[56:59], v106 offset:6144
    ds_read_b128 v[60:63], v106 offset:7168
    s_mov_b32 m0, s43
    s_branch L_go_safe0
L_prg_safe0:
    v_mov_b32 v72, 160768
    ds_read_b32 v92, v72
    ds_read_b128 v[72:75], v72 offset:16
    s_add_u32 s45, s31, 2
    s_min_u32 s45, s45, 64
    s_waitcnt lgkmcnt(0)
    v_readfirstlane_b32 s30, v92
    s_cmp_eq_u32 s30, 192
    s_cselect_b32 s42, 64, s42
    v_min_u32 v72, v72, v74
    v_min_u32 v73, v73, v75
    v_lshlrev_b32 v72, 1, v72
    v_lshl_or_b32 v73, v73, 1, 1
    v_min_u32 v72, v72, v73
    s_nop 0
    v_readfirstlane_b32 s30, v72
    s_max_u32 s42, s42, s30
    s_cmp_ge_u32 s42, s45
    s_cbranch_scc1 L_kvd_17
L_kvw_16:
    v_mov_b32 v76, 0
    buffer_load_dwordx4 v[72:75], v76, s[4:7], s50 offen sc1
    s_waitcnt vmcnt(0)
    v_min_u32 v72, v72, v74
    v_min_u32 v73, v73, v75
    v_lshlrev_b32 v72, 1, v72
    v_lshl_or_b32 v73, v73, 1, 1
    v_min_u32 v72, v72, v73
    s_nop 0
    v_readfirstlane_b32 s30, v72
    s_max_u32 s42, s42, s30
    s_cmp_ge_u32 s42, s45
    s_cbranch_scc1 L_kvd_17
    s_sleep 1
    s_add_u32 s100, s100, 1
    s_bitcmp1_b32 s100, 15
    s_cbranch_scc1 L_exit
    s_branch L_kvw_16
L_kvd_17:
    s_nop 15
    s_branch L_prd_safe0
    .p2align 6
L_loop_safe1:
    s_add_u32 s46, s31, 2
    s_and_b32 s46, s46, 3
    s_lshl_b32 s46, s46, 13
    s_add_u32 s46, s46, 0xa00000
    buffer_store_dword v30, v109, s[4:7], s46 offen sc1
    s_mov_b32 m0, s43
    ds_read_b128 v[64:67], v106 offset:12288
    ds_read_b128 v[68:71], v106 offset:13312
    ds_read_b128 v[80:83], v106 offset:20480
    ds_read_b128 v[84:87], v106 offset:21504
    ds_read_b128 v[32:35], v106 offset:0
    ds_read_b128 v[36:39], v106 offset:1024
    ds_read_b128 v[40:43], v106 offset:2048
    ds_read_b128 v[44:47], v106 offset:3072
    ds_read_b128 v[48:51], v106 offset:4096
    ds_read_b128 v[52:55], v106 offset:5120
    ds_read_b128 v[56:59], v106 offset:6144
    ds_read_b128 v[60:63], v106 offset:7168
    s_nop 11
    buffer_load_dwordx4 v[72:75], v104, s[4:7], s38 offen sc1
    buffer_load_dwordx4 v[76:79], v104, s[4:7], s38 offen offset:1024 sc1
    s_nop 15
    s_nop 15
    s_nop 11
    buffer_load_dwordx4 v[88:91], v104, s[4:7], s38 offen sc1
    buffer_load_dwordx4 v[92:95], v104, s[4:7], s38 offen offset:1024 sc1
    s_waitcnt vmcnt(3)
    ds_write_b128 v104, v[72:75] offset:2048
    s_waitcnt vmcnt(2)
    ds_write_b128 v104, v[76:79] offset:3072
    v_max3_u32 v26, v72, v73, v74
    v_max3_u32 v27, v76, v77, v78
    v_max_u32 v26, v26, v75
    v_max_u32 v27, v27, v79
    v_cmp_eq_u32 vcc, -1, v26
    v_cmp_eq_u32 s[16:17], -1, v27
    s_or_b64 s[18:19], vcc, s[16:17]
    s_cbranch_scc1 L_p2b_safe1
L_go_safe1:
    s_waitcnt lgkmcnt(0)
    s_barrier
    ds_read_b128 v[0:3], v118 offset:0
    ds_read_b128 v[4:7], v119 offset:128
    ds_read_b128 v[8:11], v118 offset:256
    ds_read_b128 v[12:15], v119 offset:384
    ds_read_b128 v[16:19], v118 offset:512
    s_cmp_eq_u32 s31, 63
    s_cbranch_scc1 L_chain_end
    s_waitcnt lgkmcnt(4)
    v_smfmac_f32_16x16x64_bf16 v[124:127], v[0:3], v[32:39], v107
    ds_read_b128 v[20:23], v119 offset:640
    v_smfmac_f32_16x16x64_bf16 v[120:123], v[0:3], v[40:47], v107
    s_waitcnt lgkmcnt(4)
    v_smfmac_f32_16x16x64_bf16 v[124:127], v[4:7], v[48:55], v107
    ds_read_b128 v[24:27], v118 offset:768
    v_smfmac_f32_16x16x64_bf16 v[120:123], v[4:7], v[56:63], v107
    s_waitcnt lgkmcnt(4)
    v_smfmac_f32_16x16x64_bf16 v[124:127], v[8:11], a[144:151], v107
    ds_read_b128 v[28:31], v119 offset:896
    v_smfmac_f32_16x16x64_bf16 v[120:123], v[8:11], a[16:23], v107
    s_waitcnt lgkmcnt(4)
    v_smfmac_f32_16x16x64_bf16 v[124:127], v[12:15], a[152:159], v107
    ds_read_b128 v[32:35], v118 offset:1024
    v_smfmac_f32_16x16x64_bf16 v[120:123], v[12:15], a[24:31], v107
    buffer_load_dwordx4 v[96:99], v104, s[4:7], s40 offen sc1
    s_waitcnt lgkmcnt(4)
    v_smfmac_f32_16x16x64_bf16 v[124:127], v[16:19], a[160:167], v107
    ds_read_b128 v[36:39], v119 offset:1152
    v_smfmac_f32_16x16x64_bf16 v[120:123], v[16:19], a[32:39], v107
    s_waitcnt lgkmcnt(4)
    v_smfmac_f32_16x16x64_bf16 v[124:127], v[20:23], a[168:175], v107
    ds_read_b128 v[40:43], v118 offset:1280
    v_smfmac_f32_16x16x64_bf16 v[120:123], v[20:23], a[40:47], v107
    buffer_load_dwordx4 v[100:103], v104, s[4:7], s40 offen offset:1024 sc1
    s_waitcnt vmcnt(2)
    s_waitcnt lgkmcnt(4)
    v_smfmac_f32_16x16x64_bf16 v[124:127], v[24:27], a[176:183], v107
    ds_read_b128 v[44:47], v119 offset:1408
    v_smfmac_f32_16x16x64_bf16 v[120:123], v[24:27], a[48:55], v107
    ds_read_b128 v[72:75], v106 offset:28672
    s_waitcnt lgkmcnt(5)
    v_smfmac_f32_16x16x64_bf16 v[124:127], v[28:31], a[184:191], v107
    ds_read_b128 v[48:51], v118 offset:1536
    v_smfmac_f32_16x16x64_bf16 v[120:123], v[28:31], a[56:63], v107
    ds_read_b128 v[76:79], v106 offset:29696
    buffer_load_dwordx4 v104, s[4:7], s39 offen sc1 lds
    s_waitcnt lgkmcnt(6)
    v_smfmac_f32_16x16x64_bf16 v[124:127], v[32:35], a[192:199], v107
    ds_read_b128 v[52:55], v119 offset:1664
    v_smfmac_f32_16x16x64_bf16 v[120:123], v[32:35], a[64:71], v107
    ds_read_b128 v[88:91], v106 offset:14336
    s_waitcnt lgkmcnt(7)
    v_smfmac_f32_16x16x64_bf16 v[124:127], v[36:39], a[200:207], v107
    ds_read_b128 v[56:59], v118 offset:1792
    v_smfmac_f32_16x16x64_bf16 v[120:123], v[36:39], a[72:79], v107
    ds_read_b128 v[92:95], v106 offset:15360
    buffer_load_dwordx4 v104, s[4:7], s39 offen offset:1024 sc1 lds
    s_mov_b32 m0, 163072
    s_waitcnt lgkmcnt(8)
    v_smfmac_f32_16x16x64_bf16 v[124:127], v[40:43], a[208:215], v107
    ds_read_b128 v[60:63], v119 offset:1920
    v_smfmac_f32_16x16x64_bf16 v[120:123], v[40:43], v[64:71], v107
    ds_read_b128 v[64:67], v106 offset:22528
    ds_read_b128 v[68:71], v106 offset:23552
    s_waitcnt lgkmcnt(10)
    v_smfmac_f32_16x16x64_bf16 v[124:127], v[44:47], a[216:223], v107
    v_smfmac_f32_16x16x64_bf16 v[120:123], v[44:47], v[80:87], v107
    ds_read_b128 v[80:83], v106 offset:30720
    ds_read_b128 v[84:87], v106 offset:31744
    buffer_load_dword v117, s[4:7], s40 offen sc1 lds
    s_waitcnt lgkmcnt(10)
    v_smfmac_f32_16x16x64_bf16 v[124:127], v[48:51], a[224:231], v107
    s_waitcnt lgkmcnt(9)
    v_smfmac_f32_16x16x64_bf16 v[120:123], v[48:51], v[72:79], v107
    s_add_u32 s39, s39, 0x40000
    s_add_u32 s40, s40, 0x40000
    s_xor_b32 s43, s43, 0x6000
    s_waitcnt lgkmcnt(8)
    v_smfmac_f32_16x16x64_bf16 v[124:127], v[52:55], a[232:239], v107
    s_waitcnt lgkmcnt(5)
    v_smfmac_f32_16x16x64_bf16 v[120:123], v[52:55], v[88:95], v107
    s_cmp_lt_u32 s42, s44
    s_cbranch_scc1 L_prf_safe1
L_prfd_safe1:
    v_smfmac_f32_16x16x64_bf16 v[124:127], v[56:59], a[240:247], v107
    s_waitcnt lgkmcnt(2)
    v_smfmac_f32_16x16x64_bf16 v[120:123], v[56:59], v[64:71], v107
    v_smfmac_f32_16x16x64_bf16 v[124:127], v[60:63], a[248:255], v107
    s_waitcnt lgkmcnt(0)
    v_smfmac_f32_16x16x64_bf16 v[120:123], v[60:63], v[80:87], v107
    v_smfmac_f32_16x16x64_bf16 v[112:115], v[0:3], v[128:135], v107
    v_smfmac_f32_16x16x64_bf16 v[112:115], v[4:7], v[136:143], v107
    v_cvt_pk_bf16_f32 v68, v124, v125
    v_smfmac_f32_16x16x64_bf16 v[112:115], v[8:11], v[144:151], v107
    v_cvt_pk_bf16_f32 v69, v126, v127
    ds_write_b64 v110, v[68:69]
    v_smfmac_f32_16x16x64_bf16 v[112:115], v[12:15], v[152:159], v107
    v_cvt_pk_bf16_f32 v120, v120, v121
    v_smfmac_f32_16x16x64_bf16 v[112:115], v[16:19], v[160:167], v107
    v_cvt_pk_bf16_f32 v121, v122, v123
    ds_write_b64 v110, v[120:121] offset:2048
    v_smfmac_f32_16x16x64_bf16 v[112:115], v[20:23], v[168:175], v107
    ds_read_b128 v[0:3], v116 offset:8192
    v_mov_b32 v125, 0
    v_smfmac_f32_16x16x64_bf16 v[112:115], v[24:27], v[176:183], v107
    ds_read_b128 v[4:7], v116 offset:9216
    v_mov_b32 v126, 0
    v_smfmac_f32_16x16x64_bf16 v[112:115], v[28:31], v[184:191], v107
    ds_read_b128 v[8:11], v116 offset:10240
    v_smfmac_f32_16x16x64_bf16 v[112:115], v[32:35], v[192:199], v107
    ds_read_b128 v[12:15], v116 offset:11264
    v_smfmac_f32_16x16x64_bf16 v[112:115], v[36:39], v[200:207], v107
    ds_read_b128 v[16:19], v116 offset:12288
    s_waitcnt lgkmcnt(5)
    s_barrier
    v_smfmac_f32_16x16x64_bf16 v[112:115], v[40:43], v[208:215], v107
    ds_read_b64_tr_b16 v[64:65], v111 offset:0
    ds_read_b64_tr_b16 v[66:67], v111 offset:256
    v_min_u32 v120, -2, v120
    v_smfmac_f32_16x16x64_bf16 v[112:115], v[44:47], v[216:223], v107
    ds_read_b64_tr_b16 v[68:69], v111 offset:512
    ds_read_b64_tr_b16 v[70:71], v111 offset:768
    v_smfmac_f32_16x16x64_bf16 v[112:115], v[48:51], v[224:231], v107
    ds_read_b64_tr_b16 v[72:73], v111 offset:1024
    ds_read_b64_tr_b16 v[74:75], v111 offset:1280
    v_smfmac_f32_16x16x64_bf16 v[112:115], v[52:55], v[232:239], v107
    ds_read_b64_tr_b16 v[76:77], v111 offset:1536
    ds_read_b64_tr_b16 v[78:79], v111 offset:1792
    v_smfmac_f32_16x16x64_bf16 v[112:115], v[56:59], v[240:247], v107
    ds_read_b128 v[20:23], v116 offset:13312
    v_mov_b64 v[48:49], s[98:99]
    v_smfmac_f32_16x16x64_bf16 v[112:115], v[60:63], v[248:255], v107
    ds_read_b128 v[24:27], v116 offset:14336
    v_mov_b64 v[50:51], s[98:99]
    s_waitcnt lgkmcnt(8)
    v_mfma_f32_16x16x32_bf16 v[32:35], v[0:3], v[64:67], 0
    ds_read_b128 v[28:31], v116 offset:15360
    ds_read_b64_tr_b16 v[80:81], v111 offset:2048
    ds_read_b64_tr_b16 v[82:83], v111 offset:2304
    s_waitcnt lgkmcnt(9)
    v_mfma_f32_16x16x32_bf16 v[32:35], v[4:7], v[68:71], v[32:35]
    ds_read_b64_tr_b16 v[84:85], v111 offset:2560
    ds_read_b64_tr_b16 v[86:87], v111 offset:2816
    s_waitcnt lgkmcnt(9)
    v_mfma_f32_16x16x32_bf16 v[32:35], v[8:11], v[72:75], v[32:35]
    ds_read_b64_tr_b16 v[88:89], v111 offset:3072
    ds_read_b64_tr_b16 v[90:91], v111 offset:3328
    v_cvt_pk_bf16_f32 v122, v112, v113
    s_waitcnt lgkmcnt(9)
    v_mfma_f32_16x16x32_bf16 v[32:35], v[12:15], v[76:79], v[32:35]
    ds_read_b64_tr_b16 v[92:93], v111 offset:3584
    ds_read_b64_tr_b16 v[94:95], v111 offset:3840
    v_cvt_pk_bf16_f32 v123, v114, v115
    s_waitcnt lgkmcnt(8)
    v_mfma_f32_16x16x32_bf16 v[36:39], v[16:19], v[64:67], 0
    v_xor_b32 v116, 0x2000, v116
    v_mfma_f32_16x16x32_bf16 v[36:39], v[20:23], v[68:71], v[36:39]
    v_permlane32_swap_b32 v122, v123
    v_mfma_f32_16x16x32_bf16 v[36:39], v[24:27], v[72:75], v[36:39]
    v_mfma_f32_16x16x32_bf16 v[36:39], v[28:31], v[76:79], v[36:39]
    buffer_store_dwordx4 v[120:123], v104, s[4:7], s41 offen sc1
    s_waitcnt lgkmcnt(0)
    v_mfma_f32_16x16x32_bf16 v[40:43], v[80:83], v[64:67], 0
    ds_read_b128 v[56:59], v106 offset:18432
    v_max3_f32 v44, v32, v33, v34
    v_mfma_f32_16x16x32_bf16 v[40:43], v[84:87], v[68:71], v[40:43]
    ds_read_b128 v[60:63], v106 offset:19456
    v_mfma_f32_16x16x32_bf16 v[40:43], v[88:91], v[72:75], v[40:43]
    ds_read_b128 v[0:3], v106 offset:8192
    v_max3_f32 v45, v35, v36, v37
    v_max3_f32 v44, v44, v38, v39
    v_mfma_f32_16x16x32_bf16 v[40:43], v[92:95], v[76:79], v[40:43]
    v_max_f32 v44, v44, v45
    v_mov_b32 v45, v44
    ds_read_b128 v[4:7], v106 offset:9216
    s_nop 0
    v_permlane32_swap_b32 v44, v45
    s_nop 2
    v_max3_f32 v46, v40, v41, v42
    v_max3_f32 v44, v44, v45, v43
    v_max_f32 v44, v44, v46
    v_mov_b32 v45, v44
    v_cndmask_b32 v40, v40, v42, s[48:49]
    v_cndmask_b32 v41, v41, v43, s[48:49]
    v_permlane16_swap_b32 v44, v45
    v_max_f32 v44, v44, v45
    v_mul_f32 v44, s34, v44
    v_pk_fma_f32 v[32:33], v[32:33], s[34:35], v[44:45] op_sel_hi:[1,1,0] neg_lo:[0,0,1] neg_hi:[0,0,1]
    v_pk_fma_f32 v[34:35], v[34:35], s[34:35], v[44:45] op_sel_hi:[1,1,0] neg_lo:[0,0,1] neg_hi:[0,0,1]
    v_pk_fma_f32 v[36:37], v[36:37], s[34:35], v[44:45] op_sel_hi:[1,1,0] neg_lo:[0,0,1] neg_hi:[0,0,1]
    v_pk_fma_f32 v[38:39], v[38:39], s[34:35], v[44:45] op_sel_hi:[1,1,0] neg_lo:[0,0,1] neg_hi:[0,0,1]
    v_pk_fma_f32 v[40:41], v[40:41], s[34:35], v[44:45] op_sel_hi:[1,1,0] neg_lo:[0,0,1] neg_hi:[0,0,1]
    v_exp_f32 v32, v32
    v_exp_f32 v33, v33
    v_exp_f32 v34, v34
    v_exp_f32 v35, v35
    v_exp_f32 v36, v36
    v_exp_f32 v37, v37
    v_exp_f32 v38, v38
    v_exp_f32 v39, v39
    v_cvt_pk_bf16_f32 v44, v32, v33
    v_cvt_pk_bf16_f32 v45, v34, v35
    v_cvt_pk_bf16_f32 v46, v36, v37
    v_cvt_pk_bf16_f32 v47, v38, v39
    v_exp_f32 v40, v40
    v_exp_f32 v41, v41
    s_waitcnt vmcnt(4)
    v_mfma_f32_16x16x32_bf16 v[52:55], v[48:51], v[44:47], 0
    ds_read_b128 v[8:11], v106 offset:16384
    v_cvt_pk_bf16_f32 v124, v40, v41
    v_cvt_pk_bf16_f32 v127, v40, v41
    v_mfma_f32_16x16x32_bf16 v[32:35], v[96:99], v[44:47], 0
    ds_read_b128 v[12:15], v106 offset:17408
    v_mov_b64 v[64:65], 0
    v_mov_b64 v[66:67], 0
    v_mfma_f32_16x16x32_bf16 v[36:39], v[100:103], v[44:47], 0
    ds_read_b128 v[16:19], v106 offset:24576
    v_mov_b64 v[68:69], 0
    v_mfma_f32_16x16x16_bf16 v[52:55], v[48:49], v[124:125], v[52:55]
    ds_read_b128 v[20:23], v106 offset:25600
    v_mov_b64 v[70:71], 0
    v_mfma_f32_16x16x16_bf16 v[32:35], v[122:123], v[124:125], v[32:35]
    ds_read_b128 v[24:27], v106 offset:10240
    v_mov_b64 v[72:73], 0
    v_mfma_f32_16x16x16_bf16 v[36:39], v[122:123], v[126:127], v[36:39]
    ds_read_b128 v[28:31], v106 offset:11264
    v_mov_b64 v[74:75], 0
    v_rcp_f32 v52, v52
    v_mov_b64 v[76:77], 0
    s_nop 0
    v_pk_mul_f32 v[32:33], v[32:33], v[52:53] op_sel_hi:[1,0]
    v_pk_mul_f32 v[34:35], v[34:35], v[52:53] op_sel_hi:[1,0]
    v_mov_b64 v[78:79], 0
    v_pk_mul_f32 v[36:37], v[36:37], v[52:53] op_sel_hi:[1,0]
    v_pk_mul_f32 v[38:39], v[38:39], v[52:53] op_sel_hi:[1,0]
    v_cvt_pk_bf16_f32 v48, v32, v33
    v_cvt_pk_bf16_f32 v49, v34, v35
    v_cvt_pk_bf16_f32 v50, v36, v37
    v_cvt_pk_bf16_f32 v51, v38, v39
    ds_write_b128 v105, v[48:51] offset:30464
    s_nop 0
    v_smfmac_f32_16x16x64_bf16 v[64:67], v[48:51], a[128:135], v107
    ds_read_b128 v[96:99], v106 offset:26624
    v_smfmac_f32_16x16x64_bf16 v[68:71], v[48:51], a[0:7], v107
    ds_read_b128 v[100:103], v106 offset:27648
    v_smfmac_f32_16x16x64_bf16 v[72:75], v[48:51], a[136:143], v107
    v_smfmac_f32_16x16x64_bf16 v[76:79], v[48:51], a[8:15], v107
    s_waitcnt lgkmcnt(2)
    s_barrier
    ds_read_b128 v[112:115], v105 offset:29952
    ds_read_b128 v[120:123], v105 offset:31488
    ds_read_b128 v[52:55], v105 offset:30976
    s_waitcnt lgkmcnt(2)
    v_smfmac_f32_16x16x64_bf16 v[64:67], v[112:115], v[0:7], v107
    s_waitcnt lgkmcnt(1)
    v_smfmac_f32_16x16x64_bf16 v[64:67], v[120:123], v[8:15], v107
    s_waitcnt lgkmcnt(0)
    v_smfmac_f32_16x16x64_bf16 v[64:67], v[52:55], v[16:23], v107
    v_smfmac_f32_16x16x64_bf16 v[68:71], v[112:115], v[24:31], v107
    ds_read_b128 v[88:91], v104 offset:28672
    v_smfmac_f32_16x16x64_bf16 v[68:71], v[120:123], v[56:63], v107
    v_smfmac_f32_16x16x64_bf16 v[68:71], v[52:55], v[96:103], v107
    v_cvt_pk_bf16_f32 v48, v64, v65
    v_smfmac_f32_16x16x64_bf16 v[72:75], v[112:115], a[80:87], v107
    v_cvt_pk_bf16_f32 v49, v66, v67
    v_smfmac_f32_16x16x64_bf16 v[72:75], v[120:123], a[88:95], v107
    v_and_or_b32 v48, v48, -2, s101
    v_smfmac_f32_16x16x64_bf16 v[72:75], v[52:55], a[96:103], v107
    v_cvt_pk_bf16_f32 v50, v68, v69
    v_cvt_pk_bf16_f32 v51, v70, v71
    v_smfmac_f32_16x16x64_bf16 v[76:79], v[112:115], a[104:111], v107
    buffer_store_dwordx4 v[48:51], v108, s[4:7], s32 offen sc1
    v_smfmac_f32_16x16x64_bf16 v[76:79], v[120:123], a[112:119], v107
    v_smfmac_f32_16x16x64_bf16 v[76:79], v[52:55], a[120:127], v107
    v_cvt_pk_bf16_f32 v56, v72, v73
    v_cvt_pk_bf16_f32 v57, v74, v75
    v_and_or_b32 v56, v56, -2, s101
    s_add_u32 s36, s32, 8192
    s_and_b32 s45, s31, 3
    s_lshl_b32 s45, s45, 18
    s_add_u32 s33, s45, s47
    s_add_u32 s31, s31, 1
    v_cvt_pk_bf16_f32 v58, v76, v77
    v_cvt_pk_bf16_f32 v59, v78, v79
    buffer_store_dwordx4 v[56:59], v108, s[4:7], s36 offen sc1
    s_add_u32 s41, s41, 0x20000
    s_and_b32 s45, s31, 3
    s_lshl_b32 s46, s45, 13
    s_add_u32 s37, s46, 0xa00000
    s_add_u32 s38, s46, 0x9e0800
    s_lshl_b32 s45, s45, 18
    s_add_u32 s32, s45, 0x900000
    s_cmp_lt_u32 s42, s44
    s_cbranch_scc1 L_prg_safe1
    s_nop 15
    s_nop 15
    s_nop 15
    s_nop 7
L_prd_safe1:
    buffer_load_dwordx4 v[0:3], v104, s[4:7], s33 offen sc1
    buffer_load_dwordx4 v[4:7], v104, s[4:7], s33 offen offset:1024 sc1
    v_mov_b64 v[120:121], 0
    s_nop 6
    v_mov_b64 v[122:123], 0
    s_nop 6
    buffer_load_dwordx4 v[8:11], v104, s[4:7], s33 offen sc1
    buffer_load_dwordx4 v[12:15], v104, s[4:7], s33 offen offset:1024 sc1
    v_mov_b64 v[124:125], 0
    s_nop 5
    v_mov_b64 v[126:127], 0
    s_nop 5
    v_mov_b64 v[112:113], 0
    s_nop 5
    v_mov_b64 v[114:115], 0
    s_nop 5
    v_mov_b32 v30, -1
    s_nop 5
    s_waitcnt lgkmcnt(0)
    s_waitcnt vmcnt(3)
    v_mfma_f32_16x16x32_bf16 v[92:95], v[88:91], v[0:3], 0
    v_and_b32 v28, 1, v0
    s_waitcnt vmcnt(2)
    v_mfma_f32_16x16x32_bf16 v[92:95], v[88:91], v[4:7], v[92:95]
    v_and_b32 v29, 1, v4
    v_cmp_ne_u32 vcc, s101, v28
    v_cmp_ne_u32 s[16:17], s101, v29
    s_or_b64 s[18:19], vcc, s[16:17]
    s_cbranch_scc1 L_p1b_safe1
L_p1ok_safe1:
    s_nop 2
    v_add_f32_dpp v92, v92, v92 row_ror:4 row_mask:0xf bank_mask:0xf
    v_add_f32_dpp v93, v93, v93 row_ror:4 row_mask:0xf bank_mask:0xf
    s_nop 0
    v_add_f32_dpp v92, v92, v92 row_ror:8 row_mask:0xf bank_mask:0xf
    v_add_f32_dpp v93, v93, v93 row_ror:8 row_mask:0xf bank_mask:0xf
    v_cvt_pk_bf16_f32 v92, v92, v93
    v_min_u32 v92, -2, v92
    buffer_store_dword v92, v109, s[4:7], s37 offen sc1
    s_bfe_u32 s101, s31, 0x10002
    s_xor_b32 s101, s101, 1
    s_add_u32 s44, s31, 6
    s_cmp_eq_u32 s31, 1
    s_cselect_b32 s44, 64, s44
    s_min_u32 s44, s44, 64
    s_branch L_loop_safe1
L_p1b_safe1:
L_p1r_safe1:
    s_or_b64 exec, vcc, 1
    buffer_load_dwordx4 v[0:3], v104, s[4:7], s33 offen sc1
    s_or_b64 exec, s[16:17], 1
    buffer_load_dwordx4 v[4:7], v104, s[4:7], s33 offen offset:1024 sc1
    s_mov_b64 exec, -1
    s_waitcnt vmcnt(3)
    v_mfma_f32_16x16x32_bf16 v[92:95], v[88:91], v[8:11], 0
    v_and_b32 v28, 1, v8
    s_waitcnt vmcnt(2)
    v_mfma_f32_16x16x32_bf16 v[92:95], v[88:91], v[12:15], v[92:95]
    v_and_b32 v29, 1, v12
    v_cmp_ne_u32 vcc, s101, v28
    v_cmp_ne_u32 s[16:17], s101, v29
    s_or_b64 s[18:19], vcc, s[16:17]
    s_cbranch_scc0 L_p1k_safe1
    s_or_b64 exec, vcc, 1
    buffer_load_dwordx4 v[8:11], v104, s[4:7], s33 offen sc1
    s_or_b64 exec, s[16:17], 1
    buffer_load_dwordx4 v[12:15], v104, s[4:7], s33 offen offset:1024 sc1
    s_mov_b64 exec, -1
    s_add_u32 s100, s100, 1
    s_bitcmp1_b32 s100, 15
    s_cbranch_scc1 L_exit
    s_waitcnt vmcnt(3)
    v_mfma_f32_16x16x32_bf16 v[92:95], v[88:91], v[0:3], 0
    v_and_b32 v28, 1, v0
    s_waitcnt vmcnt(2)
    v_mfma_f32_16x16x32_bf16 v[92:95], v[88:91], v[4:7], v[92:95]
    v_and_b32 v29, 1, v4
    v_cmp_ne_u32 vcc, s101, v28
    v_cmp_ne_u32 s[16:17], s101, v29
    s_or_b64 s[18:19], vcc, s[16:17]
    s_cbranch_scc1 L_p1r_safe1
L_p1k_safe1:
    s_nop 2
    s_branch L_p1ok_safe1
L_p2b_safe1:
L_p2r_safe1:
    s_or_b64 exec, vcc, 1
    buffer_load_dwordx4 v[72:75], v104, s[4:7], s38 offen sc1
    s_or_b64 exec, s[16:17], 1
    buffer_load_dwordx4 v[76:79], v104, s[4:7], s38 offen offset:1024 sc1
    s_mov_b64 exec, -1
    s_waitcnt vmcnt(2)
    ds_write_b128 v104, v[88:91] offset:2048
    ds_write_b128 v104, v[92:95] offset:3072
    v_max3_u32 v26, v88, v89, v90
    v_max3_u32 v27, v92, v93, v94
    v_max_u32 v26, v26, v91
    v_max_u32 v27, v27, v95
    v_cmp_eq_u32 vcc, -1, v26
    v_cmp_eq_u32 s[16:17], -1, v27
    s_or_b64 s[18:19], vcc, s[16:17]
    s_cbranch_scc0 L_go_safe1
    s_or_b64 exec, vcc, 1
    buffer_load_dwordx4 v[88:91], v104, s[4:7], s38 offen sc1
    s_or_b64 exec, s[16:17], 1
    buffer_load_dwordx4 v[92:95], v104, s[4:7], s38 offen offset:1024 sc1
    s_mov_b64 exec, -1
    s_add_u32 s100, s100, 1
    s_bitcmp1_b32 s100, 15
    s_cbranch_scc1 L_exit
    s_waitcnt vmcnt(2)
    ds_write_b128 v104, v[72:75] offset:2048
    ds_write_b128 v104, v[76:79] offset:3072
    v_max3_u32 v26, v72, v73, v74
    v_max3_u32 v27, v76, v77, v78
    v_max_u32 v26, v26, v75
    v_max_u32 v27, v27, v79
    v_cmp_eq_u32 vcc, -1, v26
    v_cmp_eq_u32 s[16:17], -1, v27
    s_or_b64 s[18:19], vcc, s[16:17]
    s_cbranch_scc1 L_p2r_safe1
    s_branch L_go_safe1
L_prf_safe1:
    v_mov_b32 v89, 148
    s_mov_b32 m0, 160768
    s_mov_b64 exec, 1
    buffer_load_dword v89, s[8:11], 0 offen sc1 lds
    s_cmp_lg_u32 s31, 1
    s_cbranch_scc1 L_prfx_safe1
    v_mov_b32 v89, 0
    s_mov_b32 m0, 160784
    s_nop 0
    buffer_load_dwordx4 v89, s[4:7], s50 offen sc1 lds
L_prfx_safe1:
    s_mov_b64 exec, -1
    s_branch L_prfd_safe1
L_enter_safe1:
    ds_write_b128 v104, v[72:75] offset:2048
    ds_write_b128 v104, v[76:79] offset:3072
    ds_read_b128 v[64:67], v106 offset:12288
    ds_read_b128 v[68:71], v106 offset:13312
    ds_read_b128 v[80:83], v106 offset:20480
    ds_read_b128 v[84:87], v106 offset:21504
    ds_read_b128 v[32:35], v106 offset:0
    ds_read_b128 v[36:39], v106 offset:1024
    ds_read_b128 v[40:43], v106 offset:2048
    ds_read_b128 v[44:47], v106 offset:3072
    ds_read_b128 v[48:51], v106 offset:4096
    ds_read_b128 v[52:55], v106 offset:5120
    ds_read_b128 v[56:59], v106 offset:6144
    ds_read_b128 v[60:63], v106 offset:7168
    s_mov_b32 m0, s43
    s_branch L_go_safe1
L_prg_safe1:
    v_mov_b32 v72, 160768
    ds_read_b32 v92, v72
    ds_read_b128 v[72:75], v72 offset:16
    s_add_u32 s45, s31, 2
    s_min_u32 s45, s45, 64
    s_waitcnt lgkmcnt(0)
    v_readfirstlane_b32 s30, v92
    s_cmp_eq_u32 s30, 192
    s_cselect_b32 s42, 64, s42
    v_min_u32 v72, v72, v74
    v_min_u32 v73, v73, v75
    v_lshlrev_b32 v72, 1, v72
    v_lshl_or_b32 v73, v73, 1, 1
    v_min_u32 v72, v72, v73
    s_nop 0
    v_readfirstlane_b32 s30, v72
    s_max_u32 s42, s42, s30
    s_cmp_ge_u32 s42, s45
    s_cbranch_scc1 L_kvd_19
L_kvw_18:
    v_mov_b32 v76, 0
    buffer_load_dwordx4 v[72:75], v76, s[4:7], s50 offen sc1
    s_waitcnt vmcnt(0)
    v_min_u32 v72, v72, v74
    v_min_u32 v73, v73, v75
    v_lshlrev_b32 v72, 1, v72
    v_lshl_or_b32 v73, v73, 1, 1
    v_min_u32 v72, v72, v73
    s_nop 0
    v_readfirstlane_b32 s30, v72
    s_max_u32 s42, s42, s30
    s_cmp_ge_u32 s42, s45
    s_cbranch_scc1 L_kvd_19
    s_sleep 1
    s_add_u32 s100, s100, 1
    s_bitcmp1_b32 s100, 15
    s_cbranch_scc1 L_exit
    s_branch L_kvw_18
L_kvd_19:
    s_nop 15
    s_branch L_prd_safe1
    .p2align 6
L_loop_safe2:
    s_add_u32 s46, s31, 2
    s_and_b32 s46, s46, 3
    s_lshl_b32 s46, s46, 13
    s_add_u32 s46, s46, 0xa00000
    buffer_store_dword v30, v109, s[4:7], s46 offen sc1
    s_mov_b32 m0, s43
    ds_read_b128 v[64:67], v106 offset:12288
    ds_read_b128 v[68:71], v106 offset:13312
    ds_read_b128 v[80:83], v106 offset:20480
    ds_read_b128 v[84:87], v106 offset:21504
    ds_read_b128 v[32:35], v106 offset:0
    ds_read_b128 v[36:39], v106 offset:1024
    ds_read_b128 v[40:43], v106 offset:2048
    ds_read_b128 v[44:47], v106 offset:3072
    ds_read_b128 v[48:51], v106 offset:4096
    ds_read_b128 v[52:55], v106 offset:5120
    ds_read_b128 v[56:59], v106 offset:6144
    ds_read_b128 v[60:63], v106 offset:7168
    s_nop 11
    buffer_load_dwordx4 v[72:75], v104, s[4:7], s38 offen sc1
    buffer_load_dwordx4 v[76:79], v104, s[4:7], s38 offen offset:1024 sc1
    s_nop 15
    s_nop 15
    s_nop 11
    buffer_load_dwordx4 v[88:91], v104, s[4:7], s38 offen sc1
    buffer_load_dwordx4 v[92:95], v104, s[4:7], s38 offen offset:1024 sc1
    s_waitcnt vmcnt(3)
    ds_write_b128 v104, v[72:75] offset:4096
    s_waitcnt vmcnt(2)
    ds_write_b128 v104, v[76:79] offset:5120
    v_max3_u32 v26, v72, v73, v74
    v_max3_u32 v27, v76, v77, v78
    v_max_u32 v26, v26, v75
    v_max_u32 v27, v27, v79
    v_cmp_eq_u32 vcc, -1, v26
    v_cmp_eq_u32 s[16:17], -1, v27
    s_or_b64 s[18:19], vcc, s[16:17]
    s_cbranch_scc1 L_p2b_safe2
L_go_safe2:
    s_waitcnt lgkmcnt(0)
    s_barrier
    ds_read_b128 v[0:3], v118 offset:0
    ds_read_b128 v[4:7], v119 offset:128
    ds_read_b128 v[8:11], v118 offset:256
    ds_read_b128 v[12:15], v119 offset:384
    ds_read_b128 v[16:19], v118 offset:512
    s_cmp_eq_u32 s31, 63
    s_cbranch_scc1 L_chain_end
    s_waitcnt lgkmcnt(4)
    v_smfmac_f32_16x16x64_bf16 v[124:127], v[0:3], v[32:39], v107
    ds_read_b128 v[20:23], v119 offset:640
    v_smfmac_f32_16x16x64_bf16 v[120:123], v[0:3], v[40:47], v107
    s_waitcnt lgkmcnt(4)
    v_smfmac_f32_16x16x64_bf16 v[124:127], v[4:7], v[48:55], v107
    ds_read_b128 v[24:27], v118 offset:768
    v_smfmac_f32_16x16x64_bf16 v[120:123], v[4:7], v[56:63], v107
    s_waitcnt lgkmcnt(4)
    v_smfmac_f32_16x16x64_bf16 v[124:127], v[8:11], a[144:151], v107
    ds_read_b128 v[28:31], v119 offset:896
    v_smfmac_f32_16x16x64_bf16 v[120:123], v[8:11], a[16:23], v107
    s_waitcnt lgkmcnt(4)
    v_smfmac_f32_16x16x64_bf16 v[124:127], v[12:15], a[152:159], v107
    ds_read_b128 v[32:35], v118 offset:1024
    v_smfmac_f32_16x16x64_bf16 v[120:123], v[12:15], a[24:31], v107
    buffer_load_dwordx4 v[96:99], v104, s[4:7], s40 offen sc1
    s_waitcnt lgkmcnt(4)
    v_smfmac_f32_16x16x64_bf16 v[124:127], v[16:19], a[160:167], v107
    ds_read_b128 v[36:39], v119 offset:1152
    v_smfmac_f32_16x16x64_bf16 v[120:123], v[16:19], a[32:39], v107
    s_waitcnt lgkmcnt(4)
    v_smfmac_f32_16x16x64_bf16 v[124:127], v[20:23], a[168:175], v107
    ds_read_b128 v[40:43], v118 offset:1280
    v_smfmac_f32_16x16x64_bf16 v[120:123], v[20:23], a[40:47], v107
    buffer_load_dwordx4 v[100:103], v104, s[4:7], s40 offen offset:1024 sc1
    s_waitcnt vmcnt(2)
    s_waitcnt lgkmcnt(4)
    v_smfmac_f32_16x16x64_bf16 v[124:127], v[24:27], a[176:183], v107
    ds_read_b128 v[44:47], v119 offset:1408
    v_smfmac_f32_16x16x64_bf16 v[120:123], v[24:27], a[48:55], v107
    ds_read_b128 v[72:75], v106 offset:28672
    s_waitcnt lgkmcnt(5)
    v_smfmac_f32_16x16x64_bf16 v[124:127], v[28:31], a[184:191], v107
    ds_read_b128 v[48:51], v118 offset:1536
    v_smfmac_f32_16x16x64_bf16 v[120:123], v[28:31], a[56:63], v107
    ds_read_b128 v[76:79], v106 offset:29696
    buffer_load_dwordx4 v104, s[4:7], s39 offen sc1 lds
    s_waitcnt lgkmcnt(6)
    v_smfmac_f32_16x16x64_bf16 v[124:127], v[32:35], a[192:199], v107
    ds_read_b128 v[52:55], v119 offset:1664
    v_smfmac_f32_16x16x64_bf16 v[120:123], v[32:35], a[64:71], v107
    ds_read_b128 v[88:91], v106 offset:14336
    s_waitcnt lgkmcnt(7)
    v_smfmac_f32_16x16x64_bf16 v[124:127], v[36:39], a[200:207], v107
    ds_read_b128 v[56:59], v118 offset:1792
    v_smfmac_f32_16x16x64_bf16 v[120:123], v[36:39], a[72:79], v107
    ds_read_b128 v[92:95], v106 offset:15360
    buffer_load_dwordx4 v104, s[4:7], s39 offen offset:1024 sc1 lds
    s_mov_b32 m0, 163072
    s_waitcnt lgkmcnt(8)
    v_smfmac_f32_16x16x64_bf16 v[124:127], v[40:43], a[208:215], v107
    ds_read_b128 v[60:63], v119 offset:1920
    v_smfmac_f32_16x16x64_bf16 v[120:123], v[40:43], v[64:71], v107
    ds_read_b128 v[64:67], v106 offset:22528
    ds_read_b128 v[68:71], v106 offset:23552
    s_waitcnt lgkmcnt(10)
    v_smfmac_f32_16x16x64_bf16 v[124:127], v[44:47], a[216:223], v107
    v_smfmac_f32_16x16x64_bf16 v[120:123], v[44:47], v[80:87], v107
    ds_read_b128 v[80:83], v106 offset:30720
    ds_read_b128 v[84:87], v106 offset:31744
    buffer_load_dword v117, s[4:7], s40 offen sc1 lds
    s_waitcnt lgkmcnt(10)
    v_smfmac_f32_16x16x64_bf16 v[124:127], v[48:51], a[224:231], v107
    s_waitcnt lgkmcnt(9)
    v_smfmac_f32_16x16x64_bf16 v[120:123], v[48:51], v[72:79], v107
    s_add_u32 s39, s39, 0x40000
    s_add_u32 s40, s40, 0x40000
    s_xor_b32 s43, s43, 0x6000
    s_waitcnt lgkmcnt(8)
    v_smfmac_f32_16x16x64_bf16 v[124:127], v[52:55], a[232:239], v107
    s_waitcnt lgkmcnt(5)
    v_smfmac_f32_16x16x64_bf16 v[120:123], v[52:55], v[88:95], v107
    v_smfmac_f32_16x16x64_bf16 v[124:127], v[56:59], a[240:247], v107
    s_waitcnt lgkmcnt(2)
    v_smfmac_f32_16x16x64_bf16 v[120:123], v[56:59], v[64:71], v107
    v_smfmac_f32_16x16x64_bf16 v[124:127], v[60:63], a[248:255], v107
    s_waitcnt lgkmcnt(0)
    v_smfmac_f32_16x16x64_bf16 v[120:123], v[60:63], v[80:87], v107
    v_smfmac_f32_16x16x64_bf16 v[112:115], v[0:3], v[128:135], v107
    v_smfmac_f32_16x16x64_bf16 v[112:115], v[4:7], v[136:143], v107
    v_cvt_pk_bf16_f32 v68, v124, v125
    v_smfmac_f32_16x16x64_bf16 v[112:115], v[8:11], v[144:151], v107
    v_cvt_pk_bf16_f32 v69, v126, v127
    ds_write_b64 v110, v[68:69]
    v_smfmac_f32_16x16x64_bf16 v[112:115], v[12:15], v[152:159], v107
    v_cvt_pk_bf16_f32 v120, v120, v121
    v_smfmac_f32_16x16x64_bf16 v[112:115], v[16:19], v[160:167], v107
    v_cvt_pk_bf16_f32 v121, v122, v123
    ds_write_b64 v110, v[120:121] offset:2048
    v_smfmac_f32_16x16x64_bf16 v[112:115], v[20:23], v[168:175], v107
    ds_read_b128 v[0:3], v116 offset:8192
    v_mov_b32 v125, 0
    v_smfmac_f32_16x16x64_bf16 v[112:115], v[24:27], v[176:183], v107
    ds_read_b128 v[4:7], v116 offset:9216
    v_mov_b32 v126, 0
    v_smfmac_f32_16x16x64_bf16 v[112:115], v[28:31], v[184:191], v107
    ds_read_b128 v[8:11], v116 offset:10240
    v_smfmac_f32_16x16x64_bf16 v[112:115], v[32:35], v[192:199], v107
    ds_read_b128 v[12:15], v116 offset:11264
    v_smfmac_f32_16x16x64_bf16 v[112:115], v[36:39], v[200:207], v107
    ds_read_b128 v[16:19], v116 offset:12288
    s_waitcnt lgkmcnt(5)
    s_barrier
    v_smfmac_f32_16x16x64_bf16 v[112:115], v[40:43], v[208:215], v107
    ds_read_b64_tr_b16 v[64:65], v111 offset:0
    ds_read_b64_tr_b16 v[66:67], v111 offset:256
    v_min_u32 v120, -2, v120
    v_smfmac_f32_16x16x64_bf16 v[112:115], v[44:47], v[216:223], v107
    ds_read_b64_tr_b16 v[68:69], v111 offset:512
    ds_read_b64_tr_b16 v[70:71], v111 offset:768
    v_smfmac_f32_16x16x64_bf16 v[112:115], v[48:51], v[224:231], v107
    ds_read_b64_tr_b16 v[72:73], v111 offset:1024
    ds_read_b64_tr_b16 v[74:75], v111 offset:1280
    v_smfmac_f32_16x16x64_bf16 v[112:115], v[52:55], v[232:239], v107
    ds_read_b64_tr_b16 v[76:77], v111 offset:1536
    ds_read_b64_tr_b16 v[78:79], v111 offset:1792
    v_smfmac_f32_16x16x64_bf16 v[112:115], v[56:59], v[240:247], v107
    ds_read_b128 v[20:23], v116 offset:13312
    v_mov_b64 v[48:49], s[98:99]
    v_smfmac_f32_16x16x64_bf16 v[112:115], v[60:63], v[248:255], v107
    ds_read_b128 v[24:27], v116 offset:14336
    v_mov_b64 v[50:51], s[98:99]
    s_waitcnt lgkmcnt(8)
    v_mfma_f32_16x16x32_bf16 v[32:35], v[0:3], v[64:67], 0
    ds_read_b128 v[28:31], v116 offset:15360
    ds_read_b64_tr_b16 v[80:81], v111 offset:2048
    ds_read_b64_tr_b16 v[82:83], v111 offset:2304
    s_waitcnt lgkmcnt(9)
    v_mfma_f32_16x16x32_bf16 v[32:35], v[4:7], v[68:71], v[32:35]
    ds_read_b64_tr_b16 v[84:85], v111 offset:2560
    ds_read_b64_tr_b16 v[86:87], v111 offset:2816
    s_waitcnt lgkmcnt(9)
    v_mfma_f32_16x16x32_bf16 v[32:35], v[8:11], v[72:75], v[32:35]
    ds_read_b64_tr_b16 v[88:89], v111 offset:3072
    ds_read_b64_tr_b16 v[90:91], v111 offset:3328
    v_cvt_pk_bf16_f32 v122, v112, v113
    s_waitcnt lgkmcnt(9)
    v_mfma_f32_16x16x32_bf16 v[32:35], v[12:15], v[76:79], v[32:35]
    ds_read_b64_tr_b16 v[92:93], v111 offset:3584
    ds_read_b64_tr_b16 v[94:95], v111 offset:3840
    v_cvt_pk_bf16_f32 v123, v114, v115
    s_waitcnt lgkmcnt(8)
    v_mfma_f32_16x16x32_bf16 v[36:39], v[16:19], v[64:67], 0
    v_xor_b32 v116, 0x2000, v116
    v_mfma_f32_16x16x32_bf16 v[36:39], v[20:23], v[68:71], v[36:39]
    v_permlane32_swap_b32 v122, v123
    v_mfma_f32_16x16x32_bf16 v[36:39], v[24:27], v[72:75], v[36:39]
    v_mfma_f32_16x16x32_bf16 v[36:39], v[28:31], v[76:79], v[36:39]
    s_waitcnt lgkmcnt(0)
    v_mfma_f32_16x16x32_bf16 v[40:43], v[80:83], v[64:67], 0
    ds_read_b128 v[56:59], v106 offset:18432
    v_max3_f32 v44, v32, v33, v34
    v_mfma_f32_16x16x32_bf16 v[40:43], v[84:87], v[68:71], v[40:43]
    ds_read_b128 v[60:63], v106 offset:19456
    buffer_store_dwordx4 v[120:123], v104, s[4:7], s41 offen sc1
    v_mfma_f32_16x16x32_bf16 v[40:43], v[88:91], v[72:75], v[40:43]
    ds_read_b128 v[0:3], v106 offset:8192
    v_max3_f32 v45, v35, v36, v37
    v_max3_f32 v44, v44, v38, v39
    v_mfma_f32_16x16x32_bf16 v[40:43], v[92:95], v[76:79], v[40:43]
    v_max_f32 v44, v44, v45
    v_mov_b32 v45, v44
    ds_read_b128 v[4:7], v106 offset:9216
    s_nop 0
    v_permlane32_swap_b32 v44, v45
    s_nop 2
    v_max3_f32 v46, v40, v41, v42
    v_max3_f32 v44, v44, v45, v43
    v_max_f32 v44, v44, v46
    v_mov_b32 v45, v44
    v_cndmask_b32 v40, v40, v42, s[48:49]
    v_cndmask_b32 v41, v41, v43, s[48:49]
    v_permlane16_swap_b32 v44, v45
    v_max_f32 v44, v44, v45
    v_mul_f32 v44, s34, v44
    v_pk_fma_f32 v[32:33], v[32:33], s[34:35], v[44:45] op_sel_hi:[1,1,0] neg_lo:[0,0,1] neg_hi:[0,0,1]
    v_pk_fma_f32 v[34:35], v[34:35], s[34:35], v[44:45] op_sel_hi:[1,1,0] neg_lo:[0,0,1] neg_hi:[0,0,1]
    v_pk_fma_f32 v[36:37], v[36:37], s[34:35], v[44:45] op_sel_hi:[1,1,0] neg_lo:[0,0,1] neg_hi:[0,0,1]
    v_pk_fma_f32 v[38:39], v[38:39], s[34:35], v[44:45] op_sel_hi:[1,1,0] neg_lo:[0,0,1] neg_hi:[0,0,1]
    v_pk_fma_f32 v[40:41], v[40:41], s[34:35], v[44:45] op_sel_hi:[1,1,0] neg_lo:[0,0,1] neg_hi:[0,0,1]
    v_exp_f32 v32, v32
    v_exp_f32 v33, v33
    v_exp_f32 v34, v34
    v_exp_f32 v35, v35
    v_exp_f32 v36, v36
    v_exp_f32 v37, v37
    v_exp_f32 v38, v38
    v_exp_f32 v39, v39
    v_cvt_pk_bf16_f32 v44, v32, v33
    v_cvt_pk_bf16_f32 v45, v34, v35
    v_cvt_pk_bf16_f32 v46, v36, v37
    v_cvt_pk_bf16_f32 v47, v38, v39
    v_exp_f32 v40, v40
    v_exp_f32 v41, v41
    s_waitcnt vmcnt(4)
    v_mfma_f32_16x16x32_bf16 v[52:55], v[48:51], v[44:47], 0
    ds_read_b128 v[8:11], v106 offset:16384
    v_cvt_pk_bf16_f32 v124, v40, v41
    v_cvt_pk_bf16_f32 v127, v40, v41
    v_mfma_f32_16x16x32_bf16 v[32:35], v[96:99], v[44:47], 0
    ds_read_b128 v[12:15], v106 offset:17408
    v_mov_b64 v[64:65], 0
    v_mov_b64 v[66:67], 0
    v_mfma_f32_16x16x32_bf16 v[36:39], v[100:103], v[44:47], 0
    ds_read_b128 v[16:19], v106 offset:24576
    v_mov_b64 v[68:69], 0
    v_mfma_f32_16x16x16_bf16 v[52:55], v[48:49], v[124:125], v[52:55]
    ds_read_b128 v[20:23], v106 offset:25600
    v_mov_b64 v[70:71], 0
    v_mfma_f32_16x16x16_bf16 v[32:35], v[122:123], v[124:125], v[32:35]
    ds_read_b128 v[24:27], v106 offset:10240
    v_mov_b64 v[72:73], 0
    v_mfma_f32_16x16x16_bf16 v[36:39], v[122:123], v[126:127], v[36:39]
    ds_read_b128 v[28:31], v106 offset:11264
    v_mov_b64 v[74:75], 0
    v_rcp_f32 v52, v52
    v_mov_b64 v[76:77], 0
    s_nop 0
    v_pk_mul_f32 v[32:33], v[32:33], v[52:53] op_sel_hi:[1,0]
    v_pk_mul_f32 v[34:35], v[34:35], v[52:53] op_sel_hi:[1,0]
    v_mov_b64 v[78:79], 0
    v_pk_mul_f32 v[36:37], v[36:37], v[52:53] op_sel_hi:[1,0]
    v_pk_mul_f32 v[38:39], v[38:39], v[52:53] op_sel_hi:[1,0]
    v_cvt_pk_bf16_f32 v48, v32, v33
    v_cvt_pk_bf16_f32 v49, v34, v35
    v_cvt_pk_bf16_f32 v50, v36, v37
    v_cvt_pk_bf16_f32 v51, v38, v39
    ds_write_b128 v105, v[48:51] offset:30976
    s_nop 0
    v_smfmac_f32_16x16x64_bf16 v[64:67], v[48:51], a[128:135], v107
    ds_read_b128 v[96:99], v106 offset:26624
    v_smfmac_f32_16x16x64_bf16 v[68:71], v[48:51], a[0:7], v107
    ds_read_b128 v[100:103], v106 offset:27648
    v_smfmac_f32_16x16x64_bf16 v[72:75], v[48:51], a[136:143], v107
    v_smfmac_f32_16x16x64_bf16 v[76:79], v[48:51], a[8:15], v107
    s_waitcnt lgkmcnt(2)
    s_barrier
    ds_read_b128 v[112:115], v105 offset:31488
    ds_read_b128 v[120:123], v105 offset:29952
    ds_read_b128 v[52:55], v105 offset:30464
    s_waitcnt lgkmcnt(2)
    v_smfmac_f32_16x16x64_bf16 v[64:67], v[112:115], v[0:7], v107
    s_waitcnt lgkmcnt(1)
    v_smfmac_f32_16x16x64_bf16 v[64:67], v[120:123], v[8:15], v107
    s_waitcnt lgkmcnt(0)
    v_smfmac_f32_16x16x64_bf16 v[64:67], v[52:55], v[16:23], v107
    v_smfmac_f32_16x16x64_bf16 v[68:71], v[112:115], v[24:31], v107
    ds_read_b128 v[88:91], v104 offset:28672
    v_smfmac_f32_16x16x64_bf16 v[68:71], v[120:123], v[56:63], v107
    v_smfmac_f32_16x16x64_bf16 v[68:71], v[52:55], v[96:103], v107
    v_cvt_pk_bf16_f32 v48, v64, v65
    v_smfmac_f32_16x16x64_bf16 v[72:75], v[112:115], a[80:87], v107
    v_cvt_pk_bf16_f32 v49, v66, v67
    v_smfmac_f32_16x16x64_bf16 v[72:75], v[120:123], a[88:95], v107
    v_and_or_b32 v48, v48, -2, s101
    v_smfmac_f32_16x16x64_bf16 v[72:75], v[52:55], a[96:103], v107
    v_cvt_pk_bf16_f32 v50, v68, v69
    v_cvt_pk_bf16_f32 v51, v70, v71
    v_smfmac_f32_16x16x64_bf16 v[76:79], v[112:115], a[104:111], v107
    buffer_store_dwordx4 v[48:51], v108, s[4:7], s32 offen sc1
    v_smfmac_f32_16x16x64_bf16 v[76:79], v[120:123], a[112:119], v107
    v_smfmac_f32_16x16x64_bf16 v[76:79], v[52:55], a[120:127], v107
    v_cvt_pk_bf16_f32 v56, v72, v73
    v_cvt_pk_bf16_f32 v57, v74, v75
    v_and_or_b32 v56, v56, -2, s101
    s_add_u32 s36, s32, 8192
    s_and_b32 s45, s31, 3
    s_lshl_b32 s45, s45, 18
    s_add_u32 s33, s45, s47
    s_add_u32 s31, s31, 1
    v_cvt_pk_bf16_f32 v58, v76, v77
    v_cvt_pk_bf16_f32 v59, v78, v79
    buffer_store_dwordx4 v[56:59], v108, s[4:7], s36 offen sc1
    s_add_u32 s41, s41, 0x20000
    s_and_b32 s45, s31, 3
    s_lshl_b32 s46, s45, 13
    s_add_u32 s37, s46, 0xa00000
    s_add_u32 s38, s46, 0x9e1000
    s_lshl_b32 s45, s45, 18
    s_add_u32 s32, s45, 0x900000
    s_cmp_lt_u32 s42, s44
    s_cbranch_scc1 L_prg_safe2
    s_nop 15
    s_nop 15
    s_nop 15
    s_nop 7
L_prd_safe2:
    buffer_load_dwordx4 v[0:3], v104, s[4:7], s33 offen sc1
    buffer_load_dwordx4 v[4:7], v104, s[4:7], s33 offen offset:1024 sc1
    v_mov_b64 v[120:121], 0
    s_nop 6
    v_mov_b64 v[122:123], 0
    s_nop 6
    buffer_load_dwordx4 v[8:11], v104, s[4:7], s33 offen sc1
    buffer_load_dwordx4 v[12:15], v104, s[4:7], s33 offen offset:1024 sc1
    v_mov_b64 v[124:125], 0
    s_nop 5
    v_mov_b64 v[126:127], 0
    s_nop 5
    v_mov_b64 v[112:113], 0
    s_nop 5
    v_mov_b64 v[114:115], 0
    s_nop 5
    v_mov_b32 v30, -1
    s_nop 5
    s_waitcnt lgkmcnt(0)
    s_waitcnt vmcnt(3)
    v_mfma_f32_16x16x32_bf16 v[92:95], v[88:91], v[0:3], 0
    v_and_b32 v28, 1, v0
    s_waitcnt vmcnt(2)
    v_mfma_f32_16x16x32_bf16 v[92:95], v[88:91], v[4:7], v[92:95]
    v_and_b32 v29, 1, v4
    v_cmp_ne_u32 vcc, s101, v28
    v_cmp_ne_u32 s[16:17], s101, v29
    s_or_b64 s[18:19], vcc, s[16:17]
    s_cbranch_scc1 L_p1b_safe2
L_p1ok_safe2:
    s_nop 2
    v_add_f32_dpp v92, v92, v92 row_ror:4 row_mask:0xf bank_mask:0xf
    v_add_f32_dpp v93, v93, v93 row_ror:4 row_mask:0xf bank_mask:0xf
    s_nop 0
    v_add_f32_dpp v92, v92, v92 row_ror:8 row_mask:0xf bank_mask:0xf
    v_add_f32_dpp v93, v93, v93 row_ror:8 row_mask:0xf bank_mask:0xf
    v_cvt_pk_bf16_f32 v92, v92, v93
    v_min_u32 v92, -2, v92
    buffer_store_dword v92, v109, s[4:7], s37 offen sc1
    s_bfe_u32 s101, s31, 0x10002
    s_xor_b32 s101, s101, 1
    s_add_u32 s44, s31, 6
    s_cmp_eq_u32 s31, 1
    s_cselect_b32 s44, 64, s44
    s_min_u32 s44, s44, 64
    s_branch L_loop_safe2
L_p1b_safe2:
L_p1r_safe2:
    s_or_b64 exec, vcc, 1
    buffer_load_dwordx4 v[0:3], v104, s[4:7], s33 offen sc1
    s_or_b64 exec, s[16:17], 1
    buffer_load_dwordx4 v[4:7], v104, s[4:7], s33 offen offset:1024 sc1
    s_mov_b64 exec, -1
    s_waitcnt vmcnt(3)
    v_mfma_f32_16x16x32_bf16 v[92:95], v[88:91], v[8:11], 0
    v_and_b32 v28, 1, v8
    s_waitcnt vmcnt(2)
    v_mfma_f32_16x16x32_bf16 v[92:95], v[88:91], v[12:15], v[92:95]
    v_and_b32 v29, 1, v12
    v_cmp_ne_u32 vcc, s101, v28
    v_cmp_ne_u32 s[16:17], s101, v29
    s_or_b64 s[18:19], vcc, s[16:17]
    s_cbranch_scc0 L_p1k_safe2
    s_or_b64 exec, vcc, 1
    buffer_load_dwordx4 v[8:11], v104, s[4:7], s33 offen sc1
    s_or_b64 exec, s[16:17], 1
    buffer_load_dwordx4 v[12:15], v104, s[4:7], s33 offen offset:1024 sc1
    s_mov_b64 exec, -1
    s_add_u32 s100, s100, 1
    s_bitcmp1_b32 s100, 15
    s_cbranch_scc1 L_exit
    s_waitcnt vmcnt(3)
    v_mfma_f32_16x16x32_bf16 v[92:95], v[88:91], v[0:3], 0
    v_and_b32 v28, 1, v0
    s_waitcnt vmcnt(2)
    v_mfma_f32_16x16x32_bf16 v[92:95], v[88:91], v[4:7], v[92:95]
    v_and_b32 v29, 1, v4
    v_cmp_ne_u32 vcc, s101, v28
    v_cmp_ne_u32 s[16:17], s101, v29
    s_or_b64 s[18:19], vcc, s[16:17]
    s_cbranch_scc1 L_p1r_safe2
L_p1k_safe2:
    s_nop 2
    s_branch L_p1ok_safe2
L_p2b_safe2:
L_p2r_safe2:
    s_or_b64 exec, vcc, 1
    buffer_load_dwordx4 v[72:75], v104, s[4:7], s38 offen sc1
    s_or_b64 exec, s[16:17], 1
    buffer_load_dwordx4 v[76:79], v104, s[4:7], s38 offen offset:1024 sc1
    s_mov_b64 exec, -1
    s_waitcnt vmcnt(2)
    ds_write_b128 v104, v[88:91] offset:4096
    ds_write_b128 v104, v[92:95] offset:5120
    v_max3_u32 v26, v88, v89, v90
    v_max3_u32 v27, v92, v93, v94
    v_max_u32 v26, v26, v91
    v_max_u32 v27, v27, v95
    v_cmp_eq_u32 vcc, -1, v26
    v_cmp_eq_u32 s[16:17], -1, v27
    s_or_b64 s[18:19], vcc, s[16:17]
    s_cbranch_scc0 L_go_safe2
    s_or_b64 exec, vcc, 1
    buffer_load_dwordx4 v[88:91], v104, s[4:7], s38 offen sc1
    s_or_b64 exec, s[16:17], 1
    buffer_load_dwordx4 v[92:95], v104, s[4:7], s38 offen offset:1024 sc1
    s_mov_b64 exec, -1
    s_add_u32 s100, s100, 1
    s_bitcmp1_b32 s100, 15
    s_cbranch_scc1 L_exit
    s_waitcnt vmcnt(2)
    ds_write_b128 v104, v[72:75] offset:4096
    ds_write_b128 v104, v[76:79] offset:5120
    v_max3_u32 v26, v72, v73, v74
    v_max3_u32 v27, v76, v77, v78
    v_max_u32 v26, v26, v75
    v_max_u32 v27, v27, v79
    v_cmp_eq_u32 vcc, -1, v26
    v_cmp_eq_u32 s[16:17], -1, v27
    s_or_b64 s[18:19], vcc, s[16:17]
    s_cbranch_scc1 L_p2r_safe2
    s_branch L_go_safe2
L_enter_safe2:
    ds_write_b128 v104, v[72:75] offset:4096
    ds_write_b128 v104, v[76:79] offset:5120
    ds_read_b128 v[64:67], v106 offset:12288
    ds_read_b128 v[68:71], v106 offset:13312
    ds_read_b128 v[80:83], v106 offset:20480
    ds_read_b128 v[84:87], v106 offset:21504
    ds_read_b128 v[32:35], v106 offset:0
    ds_read_b128 v[36:39], v106 offset:1024
    ds_read_b128 v[40:43], v106 offset:2048
    ds_read_b128 v[44:47], v106 offset:3072
    ds_read_b128 v[48:51], v106 offset:4096
    ds_read_b128 v[52:55], v106 offset:5120
    ds_read_b128 v[56:59], v106 offset:6144
    ds_read_b128 v[60:63], v106 offset:7168
    s_mov_b32 m0, s43
    s_branch L_go_safe2
L_prg_safe2:
    v_mov_b32 v72, 160768
    ds_read_b32 v92, v72
    ds_read_b128 v[72:75], v72 offset:16
    s_add_u32 s45, s31, 2
    s_min_u32 s45, s45, 64
    s_waitcnt lgkmcnt(0)
    v_readfirstlane_b32 s30, v92
    s_cmp_eq_u32 s30, 192
    s_cselect_b32 s42, 64, s42
    v_min_u32 v72, v72, v74
    v_min_u32 v73, v73, v75
    v_lshlrev_b32 v72, 1, v72
    v_lshl_or_b32 v73, v73, 1, 1
    v_min_u32 v72, v72, v73
    s_nop 0
    v_readfirstlane_b32 s30, v72
    s_max_u32 s42, s42, s30
    s_cmp_ge_u32 s42, s45
    s_cbranch_scc1 L_kvd_21
L_kvw_20:
    v_mov_b32 v76, 0
    buffer_load_dwordx4 v[72:75], v76, s[4:7], s50 offen sc1
    s_waitcnt vmcnt(0)
    v_min_u32 v72, v72, v74
    v_min_u32 v73, v73, v75
    v_lshlrev_b32 v72, 1, v72
    v_lshl_or_b32 v73, v73, 1, 1
    v_min_u32 v72, v72, v73
    s_nop 0
    v_readfirstlane_b32 s30, v72
    s_max_u32 s42, s42, s30
    s_cmp_ge_u32 s42, s45
    s_cbranch_scc1 L_kvd_21
    s_sleep 1
    s_add_u32 s100, s100, 1
    s_bitcmp1_b32 s100, 15
    s_cbranch_scc1 L_exit
    s_branch L_kvw_20
L_kvd_21:
    s_nop 15
    s_branch L_prd_safe2
    .p2align 6
L_loop_safe3:
    s_add_u32 s46, s31, 2
    s_and_b32 s46, s46, 3
    s_lshl_b32 s46, s46, 13
    s_add_u32 s46, s46, 0xa00000
    buffer_store_dword v30, v109, s[4:7], s46 offen sc1
    s_mov_b32 m0, s43
    ds_read_b128 v[64:67], v106 offset:12288
    ds_read_b128 v[68:71], v106 offset:13312
    ds_read_b128 v[80:83], v106 offset:20480
    ds_read_b128 v[84:87], v106 offset:21504
    ds_read_b128 v[32:35], v106 offset:0
    ds_read_b128 v[36:39], v106 offset:1024
    ds_read_b128 v[40:43], v106 offset:2048
    ds_read_b128 v[44:47], v106 offset:3072
    ds_read_b128 v[48:51], v106 offset:4096
    ds_read_b128 v[52:55], v106 offset:5120
    ds_read_b128 v[56:59], v106 offset:6144
    ds_read_b128 v[60:63], v106 offset:7168
    s_nop 11
    buffer_load_dwordx4 v[72:75], v104, s[4:7], s38 offen sc1
    buffer_load_dwordx4 v[76:79], v104, s[4:7], s38 offen offset:1024 sc1
    s_nop 15
    s_nop 15
    s_nop 11
    buffer_load_dwordx4 v[88:91], v104, s[4:7], s38 offen sc1
    buffer_load_dwordx4 v[92:95], v104, s[4:7], s38 offen offset:1024 sc1
    s_waitcnt vmcnt(3)
    ds_write_b128 v104, v[72:75] offset:6144
    s_waitcnt vmcnt(2)
    ds_write_b128 v104, v[76:79] offset:7168
    v_max3_u32 v26, v72, v73, v74
    v_max3_u32 v27, v76, v77, v78
    v_max_u32 v26, v26, v75
    v_max_u32 v27, v27, v79
    v_cmp_eq_u32 vcc, -1, v26
    v_cmp_eq_u32 s[16:17], -1, v27
    s_or_b64 s[18:19], vcc, s[16:17]
    s_cbranch_scc1 L_p2b_safe3
L_go_safe3:
    s_waitcnt lgkmcnt(0)
    s_barrier
    ds_read_b128 v[0:3], v118 offset:0
    ds_read_b128 v[4:7], v119 offset:128
    ds_read_b128 v[8:11], v118 offset:256
    ds_read_b128 v[12:15], v119 offset:384
    ds_read_b128 v[16:19], v118 offset:512
    s_cmp_eq_u32 s31, 63
    s_cbranch_scc1 L_chain_end
    s_waitcnt lgkmcnt(4)
    v_smfmac_f32_16x16x64_bf16 v[124:127], v[0:3], v[32:39], v107
    ds_read_b128 v[20:23], v119 offset:640
    v_smfmac_f32_16x16x64_bf16 v[120:123], v[0:3], v[40:47], v107
    s_waitcnt lgkmcnt(4)
    v_smfmac_f32_16x16x64_bf16 v[124:127], v[4:7], v[48:55], v107
    ds_read_b128 v[24:27], v118 offset:768
    v_smfmac_f32_16x16x64_bf16 v[120:123], v[4:7], v[56:63], v107
    s_waitcnt lgkmcnt(4)
    v_smfmac_f32_16x16x64_bf16 v[124:127], v[8:11], a[144:151], v107
    ds_read_b128 v[28:31], v119 offset:896
    v_smfmac_f32_16x16x64_bf16 v[120:123], v[8:11], a[16:23], v107
    s_waitcnt lgkmcnt(4)
    v_smfmac_f32_16x16x64_bf16 v[124:127], v[12:15], a[152:159], v107
    ds_read_b128 v[32:35], v118 offset:1024
    v_smfmac_f32_16x16x64_bf16 v[120:123], v[12:15], a[24:31], v107
    buffer_load_dwordx4 v[96:99], v104, s[4:7], s40 offen sc1
    s_waitcnt lgkmcnt(4)
    v_smfmac_f32_16x16x64_bf16 v[124:127], v[16:19], a[160:167], v107
    ds_read_b128 v[36:39], v119 offset:1152
    v_smfmac_f32_16x16x64_bf16 v[120:123], v[16:19], a[32:39], v107
    s_waitcnt lgkmcnt(4)
    v_smfmac_f32_16x16x64_bf16 v[124:127], v[20:23], a[168:175], v107
    ds_read_b128 v[40:43], v118 offset:1280
    v_smfmac_f32_16x16x64_bf16 v[120:123], v[20:23], a[40:47], v107
    buffer_load_dwordx4 v[100:103], v104, s[4:7], s40 offen offset:1024 sc1
    s_waitcnt vmcnt(2)
    s_waitcnt lgkmcnt(4)
    v_smfmac_f32_16x16x64_bf16 v[124:127], v[24:27], a[176:183], v107
    ds_read_b128 v[44:47], v119 offset:1408
    v_smfmac_f32_16x16x64_bf16 v[120:123], v[24:27], a[48:55], v107
    ds_read_b128 v[72:75], v106 offset:28672
    s_waitcnt lgkmcnt(5)
    v_smfmac_f32_16x16x64_bf16 v[124:127], v[28:31], a[184:191], v107
    ds_read_b128 v[48:51], v118 offset:1536
    v_smfmac_f32_16x16x64_bf16 v[120:123], v[28:31], a[56:63], v107
    ds_read_b128 v[76:79], v106 offset:29696
    buffer_load_dwordx4 v104, s[4:7], s39 offen sc1 lds
    s_waitcnt lgkmcnt(6)
    v_smfmac_f32_16x16x64_bf16 v[124:127], v[32:35], a[192:199], v107
    ds_read_b128 v[52:55], v119 offset:1664
    v_smfmac_f32_16x16x64_bf16 v[120:123], v[32:35], a[64:71], v107
    ds_read_b128 v[88:91], v106 offset:14336
    s_waitcnt lgkmcnt(7)
    v_smfmac_f32_16x16x64_bf16 v[124:127], v[36:39], a[200:207], v107
    ds_read_b128 v[56:59], v118 offset:1792
    v_smfmac_f32_16x16x64_bf16 v[120:123], v[36:39], a[72:79], v107
    ds_read_b128 v[92:95], v106 offset:15360
    buffer_load_dwordx4 v104, s[4:7], s39 offen offset:1024 sc1 lds
    s_mov_b32 m0, 163072
    s_waitcnt lgkmcnt(8)
    v_smfmac_f32_16x16x64_bf16 v[124:127], v[40:43], a[208:215], v107
    ds_read_b128 v[60:63], v119 offset:1920
    v_smfmac_f32_16x16x64_bf16 v[120:123], v[40:43], v[64:71], v107
    ds_read_b128 v[64:67], v106 offset:22528
    ds_read_b128 v[68:71], v106 offset:23552
    s_waitcnt lgkmcnt(10)
    v_smfmac_f32_16x16x64_bf16 v[124:127], v[44:47], a[216:223], v107
    v_smfmac_f32_16x16x64_bf16 v[120:123], v[44:47], v[80:87], v107
    ds_read_b128 v[80:83], v106 offset:30720
    ds_read_b128 v[84:87], v106 offset:31744
    buffer_load_dword v117, s[4:7], s40 offen sc1 lds
    s_waitcnt lgkmcnt(10)
    v_smfmac_f32_16x16x64_bf16 v[124:127], v[48:51], a[224:231], v107
    s_waitcnt lgkmcnt(9)
    v_smfmac_f32_16x16x64_bf16 v[120:123], v[48:51], v[72:79], v107
    s_add_u32 s39, s39, 0x40000
    s_add_u32 s40, s40, 0x40000
    s_xor_b32 s43, s43, 0x6000
    s_waitcnt lgkmcnt(8)
    v_smfmac_f32_16x16x64_bf16 v[124:127], v[52:55], a[232:239], v107
    s_waitcnt lgkmcnt(5)
    v_smfmac_f32_16x16x64_bf16 v[120:123], v[52:55], v[88:95], v107
    v_mov_b32 v88, s31
    v_smfmac_f32_16x16x64_bf16 v[124:127], v[56:59], a[240:247], v107
    s_waitcnt lgkmcnt(2)
    v_smfmac_f32_16x16x64_bf16 v[120:123], v[56:59], v[64:71], v107
    v_mov_b32 v89, 32
    v_smfmac_f32_16x16x64_bf16 v[124:127], v[60:63], a[248:255], v107
    s_waitcnt lgkmcnt(0)
    v_smfmac_f32_16x16x64_bf16 v[120:123], v[60:63], v[80:87], v107
    s_mov_b64 exec, 1
    buffer_store_dword v88, v89, s[4:7], s50 offen sc1
    s_mov_b64 exec, -1
    v_smfmac_f32_16x16x64_bf16 v[112:115], v[0:3], v[128:135], v107
    v_smfmac_f32_16x16x64_bf16 v[112:115], v[4:7], v[136:143], v107
    v_cvt_pk_bf16_f32 v68, v124, v125
    v_smfmac_f32_16x16x64_bf16 v[112:115], v[8:11], v[144:151], v107
    v_cvt_pk_bf16_f32 v69, v126, v127
    ds_write_b64 v110, v[68:69]
    v_smfmac_f32_16x16x64_bf16 v[112:115], v[12:15], v[152:159], v107
    v_cvt_pk_bf16_f32 v120, v120, v121
    v_smfmac_f32_16x16x64_bf16 v[112:115], v[16:19], v[160:167], v107
    v_cvt_pk_bf16_f32 v121, v122, v123
    ds_write_b64 v110, v[120:121] offset:2048
    v_smfmac_f32_16x16x64_bf16 v[112:115], v[20:23], v[168:175], v107
    ds_read_b128 v[0:3], v116 offset:8192
    v_mov_b32 v125, 0
    v_smfmac_f32_16x16x64_bf16 v[112:115], v[24:27], v[176:183], v107
    ds_read_b128 v[4:7], v116 offset:9216
    v_mov_b32 v126, 0
    v_smfmac_f32_16x16x64_bf16 v[112:115], v[28:31], v[184:191], v107
    ds_read_b128 v[8:11], v116 offset:10240
    v_smfmac_f32_16x16x64_bf16 v[112:115], v[32:35], v[192:199], v107
    ds_read_b128 v[12:15], v116 offset:11264
    v_smfmac_f32_16x16x64_bf16 v[112:115], v[36:39], v[200:207], v107
    ds_read_b128 v[16:19], v116 offset:12288
    s_waitcnt lgkmcnt(5)
    s_barrier
    v_smfmac_f32_16x16x64_bf16 v[112:115], v[40:43], v[208:215], v107
    ds_read_b64_tr_b16 v[64:65], v111 offset:0
    ds_read_b64_tr_b16 v[66:67], v111 offset:256
    v_min_u32 v120, -2, v120
    v_smfmac_f32_16x16x64_bf16 v[112:115], v[44:47], v[216:223], v107
    ds_read_b64_tr_b16 v[68:69], v111 offset:512
    ds_read_b64_tr_b16 v[70:71], v111 offset:768
    v_smfmac_f32_16x16x64_bf16 v[112:115], v[48:51], v[224:231], v107
    ds_read_b64_tr_b16 v[72:73], v111 offset:1024
    ds_read_b64_tr_b16 v[74:75], v111 offset:1280
    v_smfmac_f32_16x16x64_bf16 v[112:115], v[52:55], v[232:239], v107
    ds_read_b64_tr_b16 v[76:77], v111 offset:1536
    ds_read_b64_tr_b16 v[78:79], v111 offset:1792
    v_smfmac_f32_16x16x64_bf16 v[112:115], v[56:59], v[240:247], v107
    ds_read_b128 v[20:23], v116 offset:13312
    v_mov_b64 v[48:49], s[98:99]
    v_smfmac_f32_16x16x64_bf16 v[112:115], v[60:63], v[248:255], v107
    ds_read_b128 v[24:27], v116 offset:14336
    v_mov_b64 v[50:51], s[98:99]
    s_waitcnt lgkmcnt(8)
    v_mfma_f32_16x16x32_bf16 v[32:35], v[0:3], v[64:67], 0
    ds_read_b128 v[28:31], v116 offset:15360
    ds_read_b64_tr_b16 v[80:81], v111 offset:2048
    ds_read_b64_tr_b16 v[82:83], v111 offset:2304
    s_waitcnt lgkmcnt(9)
    v_mfma_f32_16x16x32_bf16 v[32:35], v[4:7], v[68:71], v[32:35]
    ds_read_b64_tr_b16 v[84:85], v111 offset:2560
    ds_read_b64_tr_b16 v[86:87], v111 offset:2816
    s_waitcnt lgkmcnt(9)
    v_mfma_f32_16x16x32_bf16 v[32:35], v[8:11], v[72:75], v[32:35]
    ds_read_b64_tr_b16 v[88:89], v111 offset:3072
    ds_read_b64_tr_b16 v[90:91], v111 offset:3328
    v_cvt_pk_bf16_f32 v122, v112, v113
    s_waitcnt lgkmcnt(9)
    v_mfma_f32_16x16x32_bf16 v[32:35], v[12:15], v[76:79], v[32:35]
    ds_read_b64_tr_b16 v[92:93], v111 offset:3584
    ds_read_b64_tr_b16 v[94:95], v111 offset:3840
    v_cvt_pk_bf16_f32 v123, v114, v115
    s_waitcnt lgkmcnt(8)
    v_mfma_f32_16x16x32_bf16 v[36:39], v[16:19], v[64:67], 0
    v_xor_b32 v116, 0x2000, v116
    v_mfma_f32_16x16x32_bf16 v[36:39], v[20:23], v[68:71], v[36:39]
    v_permlane32_swap_b32 v122, v123
    v_mfma_f32_16x16x32_bf16 v[36:39], v[24:27], v[72:75], v[36:39]
    v_mfma_f32_16x16x32_bf16 v[36:39], v[28:31], v[76:79], v[36:39]
    s_waitcnt lgkmcnt(0)
    v_mfma_f32_16x16x32_bf16 v[40:43], v[80:83], v[64:67], 0
    ds_read_b128 v[56:59], v106 offset:18432
    v_max3_f32 v44, v32, v33, v34
    v_mfma_f32_16x16x32_bf16 v[40:43], v[84:87], v[68:71], v[40:43]
    ds_read_b128 v[60:63], v106 offset:19456
    v_mfma_f32_16x16x32_bf16 v[40:43], v[88:91], v[72:75], v[40:43]
    ds_read_b128 v[0:3], v106 offset:8192
    v_max3_f32 v45, v35, v36, v37
    v_max3_f32 v44, v44, v38, v39
    v_mfma_f32_16x16x32_bf16 v[40:43], v[92:95], v[76:79], v[40:43]
    v_max_f32 v44, v44, v45
    v_mov_b32 v45, v44
    ds_read_b128 v[4:7], v106 offset:9216
    s_nop 0
    v_permlane32_swap_b32 v44, v45
    buffer_store_dwordx4 v[120:123], v104, s[4:7], s41 offen sc1
    s_nop 1
    v_max3_f32 v46, v40, v41, v42
    v_max3_f32 v44, v44, v45, v43
    v_max_f32 v44, v44, v46
    v_mov_b32 v45, v44
    v_cndmask_b32 v40, v40, v42, s[48:49]
    v_cndmask_b32 v41, v41, v43, s[48:49]
    v_permlane16_swap_b32 v44, v45
    v_max_f32 v44, v44, v45
    v_mul_f32 v44, s34, v44
    v_pk_fma_f32 v[32:33], v[32:33], s[34:35], v[44:45] op_sel_hi:[1,1,0] neg_lo:[0,0,1] neg_hi:[0,0,1]
    v_pk_fma_f32 v[34:35], v[34:35], s[34:35], v[44:45] op_sel_hi:[1,1,0] neg_lo:[0,0,1] neg_hi:[0,0,1]
    v_pk_fma_f32 v[36:37], v[36:37], s[34:35], v[44:45] op_sel_hi:[1,1,0] neg_lo:[0,0,1] neg_hi:[0,0,1]
    v_pk_fma_f32 v[38:39], v[38:39], s[34:35], v[44:45] op_sel_hi:[1,1,0] neg_lo:[0,0,1] neg_hi:[0,0,1]
    v_pk_fma_f32 v[40:41], v[40:41], s[34:35], v[44:45] op_sel_hi:[1,1,0] neg_lo:[0,0,1] neg_hi:[0,0,1]
    v_exp_f32 v32, v32
    v_exp_f32 v33, v33
    v_exp_f32 v34, v34
    v_exp_f32 v35, v35
    v_exp_f32 v36, v36
    v_exp_f32 v37, v37
    v_exp_f32 v38, v38
    v_exp_f32 v39, v39
    v_cvt_pk_bf16_f32 v44, v32, v33
    v_cvt_pk_bf16_f32 v45, v34, v35
    v_cvt_pk_bf16_f32 v46, v36, v37
    v_cvt_pk_bf16_f32 v47, v38, v39
    v_exp_f32 v40, v40
    v_exp_f32 v41, v41
    s_waitcnt vmcnt(4)
    v_mfma_f32_16x16x32_bf16 v[52:55], v[48:51], v[44:47], 0
    ds_read_b128 v[8:11], v106 offset:16384
    v_cvt_pk_bf16_f32 v124, v40, v41
    v_cvt_pk_bf16_f32 v127, v40, v41
    v_mfma_f32_16x16x32_bf16 v[32:35], v[96:99], v[44:47], 0
    ds_read_b128 v[12:15], v106 offset:17408
    v_mov_b64 v[64:65], 0
    v_mov_b64 v[66:67], 0
    v_mfma_f32_16x16x32_bf16 v[36:39], v[100:103], v[44:47], 0
    ds_read_b128 v[16:19], v106 offset:24576
    v_mov_b64 v[68:69], 0
    v_mfma_f32_16x16x16_bf16 v[52:55], v[48:49], v[124:125], v[52:55]
    ds_read_b128 v[20:23], v106 offset:25600
    v_mov_b64 v[70:71], 0
    v_mfma_f32_16x16x16_bf16 v[32:35], v[122:123], v[124:125], v[32:35]
    ds_read_b128 v[24:27], v106 offset:10240
    v_mov_b64 v[72:73], 0
    v_mfma_f32_16x16x16_bf16 v[36:39], v[122:123], v[126:127], v[36:39]
    ds_read_b128 v[28:31], v106 offset:11264
    v_mov_b64 v[74:75], 0
    v_rcp_f32 v52, v52
    v_mov_b64 v[76:77], 0
    s_nop 0
    v_pk_mul_f32 v[32:33], v[32:33], v[52:53] op_sel_hi:[1,0]
    v_pk_mul_f32 v[34:35], v[34:35], v[52:53] op_sel_hi:[1,0]
    v_mov_b64 v[78:79], 0
    v_pk_mul_f32 v[36:37], v[36:37], v[52:53] op_sel_hi:[1,0]
    v_pk_mul_f32 v[38:39], v[38:39], v[52:53] op_sel_hi:[1,0]
    v_cvt_pk_bf16_f32 v48, v32, v33
    v_cvt_pk_bf16_f32 v49, v34, v35
    v_cvt_pk_bf16_f32 v50, v36, v37
    v_cvt_pk_bf16_f32 v51, v38, v39
    ds_write_b128 v105, v[48:51] offset:31488
    s_nop 0
    v_smfmac_f32_16x16x64_bf16 v[64:67], v[48:51], a[128:135], v107
    ds_read_b128 v[96:99], v106 offset:26624
    v_smfmac_f32_16x16x64_bf16 v[68:71], v[48:51], a[0:7], v107
    ds_read_b128 v[100:103], v106 offset:27648
    v_smfmac_f32_16x16x64_bf16 v[72:75], v[48:51], a[136:143], v107
    v_smfmac_f32_16x16x64_bf16 v[76:79], v[48:51], a[8:15], v107
    s_waitcnt lgkmcnt(2)
    s_barrier
    ds_read_b128 v[112:115], v105 offset:30976
    ds_read_b128 v[120:123], v105 offset:30464
    ds_read_b128 v[52:55], v105 offset:29952
    s_waitcnt lgkmcnt(2)
    v_smfmac_f32_16x16x64_bf16 v[64:67], v[112:115], v[0:7], v107
    s_waitcnt lgkmcnt(1)
    v_smfmac_f32_16x16x64_bf16 v[64:67], v[120:123], v[8:15], v107
    s_waitcnt lgkmcnt(0)
    v_smfmac_f32_16x16x64_bf16 v[64:67], v[52:55], v[16:23], v107
    v_smfmac_f32_16x16x64_bf16 v[68:71], v[112:115], v[24:31], v107
    ds_read_b128 v[88:91], v104 offset:28672
    v_smfmac_f32_16x16x64_bf16 v[68:71], v[120:123], v[56:63], v107
    v_smfmac_f32_16x16x64_bf16 v[68:71], v[52:55], v[96:103], v107
    v_cvt_pk_bf16_f32 v48, v64, v65
    v_smfmac_f32_16x16x64_bf16 v[72:75], v[112:115], a[80:87], v107
    v_cvt_pk_bf16_f32 v49, v66, v67
    v_smfmac_f32_16x16x64_bf16 v[72:75], v[120:123], a[88:95], v107
    v_and_or_b32 v48, v48, -2, s101
    v_smfmac_f32_16x16x64_bf16 v[72:75], v[52:55], a[96:103], v107
    v_cvt_pk_bf16_f32 v50, v68, v69
    v_cvt_pk_bf16_f32 v51, v70, v71
    v_smfmac_f32_16x16x64_bf16 v[76:79], v[112:115], a[104:111], v107
    buffer_store_dwordx4 v[48:51], v108, s[4:7], s32 offen sc1
    v_smfmac_f32_16x16x64_bf16 v[76:79], v[120:123], a[112:119], v107
    v_smfmac_f32_16x16x64_bf16 v[76:79], v[52:55], a[120:127], v107
    v_cvt_pk_bf16_f32 v56, v72, v73
    v_cvt_pk_bf16_f32 v57, v74, v75
    v_and_or_b32 v56, v56, -2, s101
    s_add_u32 s36, s32, 8192
    s_and_b32 s45, s31, 3
    s_lshl_b32 s45, s45, 18
    s_add_u32 s33, s45, s47
    s_add_u32 s31, s31, 1
    v_cvt_pk_bf16_f32 v58, v76, v77
    v_cvt_pk_bf16_f32 v59, v78, v79
    buffer_store_dwordx4 v[56:59], v108, s[4:7], s36 offen sc1
    s_add_u32 s41, s41, 0x20000
    s_and_b32 s45, s31, 3
    s_lshl_b32 s46, s45, 13
    s_add_u32 s37, s46, 0xa00000
    s_add_u32 s38, s46, 0x9e1800
    s_lshl_b32 s45, s45, 18
    s_add_u32 s32, s45, 0x900000
    s_cmp_lt_u32 s42, s44
    s_cbranch_scc1 L_prg_safe3
    s_nop 15
    s_nop 15
    s_nop 15
    s_nop 7
L_prd_safe3:
    buffer_load_dwordx4 v[0:3], v104, s[4:7], s33 offen sc1
    buffer_load_dwordx4 v[4:7], v104, s[4:7], s33 offen offset:1024 sc1
    v_mov_b64 v[120:121], 0
    s_nop 6
    v_mov_b64 v[122:123], 0
    s_nop 6
    buffer_load_dwordx4 v[8:11], v104, s[4:7], s33 offen sc1
    buffer_load_dwordx4 v[12:15], v104, s[4:7], s33 offen offset:1024 sc1
    v_mov_b64 v[124:125], 0
    s_nop 5
    v_mov_b64 v[126:127], 0
    s_nop 5
    v_mov_b64 v[112:113], 0
    s_nop 5
    v_mov_b64 v[114:115], 0
    s_nop 5
    v_mov_b32 v30, -1
    s_nop 5
    s_waitcnt lgkmcnt(0)
    s_waitcnt vmcnt(3)
    v_mfma_f32_16x16x32_bf16 v[92:95], v[88:91], v[0:3], 0
    v_and_b32 v28, 1, v0
    s_waitcnt vmcnt(2)
    v_mfma_f32_16x16x32_bf16 v[92:95], v[88:91], v[4:7], v[92:95]
    v_and_b32 v29, 1, v4
    v_cmp_ne_u32 vcc, s101, v28
    v_cmp_ne_u32 s[16:17], s101, v29
    s_or_b64 s[18:19], vcc, s[16:17]
    s_cbranch_scc1 L_p1b_safe3
L_p1ok_safe3:
    s_nop 2
    v_add_f32_dpp v92, v92, v92 row_ror:4 row_mask:0xf bank_mask:0xf
    v_add_f32_dpp v93, v93, v93 row_ror:4 row_mask:0xf bank_mask:0xf
    s_nop 0
    v_add_f32_dpp v92, v92, v92 row_ror:8 row_mask:0xf bank_mask:0xf
    v_add_f32_dpp v93, v93, v93 row_ror:8 row_mask:0xf bank_mask:0xf
    v_cvt_pk_bf16_f32 v92, v92, v93
    v_min_u32 v92, -2, v92
    buffer_store_dword v92, v109, s[4:7], s37 offen sc1
    s_bfe_u32 s101, s31, 0x10002
    s_xor_b32 s101, s101, 1
    s_add_u32 s44, s31, 6
    s_cmp_eq_u32 s31, 1
    s_cselect_b32 s44, 64, s44
    s_min_u32 s44, s44, 64
    s_branch L_loop_safe3
L_p1b_safe3:
L_p1r_safe3:
    s_or_b64 exec, vcc, 1
    buffer_load_dwordx4 v[0:3], v104, s[4:7], s33 offen sc1
    s_or_b64 exec, s[16:17], 1
    buffer_load_dwordx4 v[4:7], v104, s[4:7], s33 offen offset:1024 sc1
    s_mov_b64 exec, -1
    s_waitcnt vmcnt(3)
    v_mfma_f32_16x16x32_bf16 v[92:95], v[88:91], v[8:11], 0
    v_and_b32 v28, 1, v8
    s_waitcnt vmcnt(2)
    v_mfma_f32_16x16x32_bf16 v[92:95], v[88:91], v[12:15], v[92:95]
    v_and_b32 v29, 1, v12
    v_cmp_ne_u32 vcc, s101, v28
    v_cmp_ne_u32 s[16:17], s101, v29
    s_or_b64 s[18:19], vcc, s[16:17]
    s_cbranch_scc0 L_p1k_safe3
    s_or_b64 exec, vcc, 1
    buffer_load_dwordx4 v[8:11], v104, s[4:7], s33 offen sc1
    s_or_b64 exec, s[16:17], 1
    buffer_load_dwordx4 v[12:15], v104, s[4:7], s33 offen offset:1024 sc1
    s_mov_b64 exec, -1
    s_add_u32 s100, s100, 1
    s_bitcmp1_b32 s100, 15
    s_cbranch_scc1 L_exit
    s_waitcnt vmcnt(3)
    v_mfma_f32_16x16x32_bf16 v[92:95], v[88:91], v[0:3], 0
    v_and_b32 v28, 1, v0
    s_waitcnt vmcnt(2)
    v_mfma_f32_16x16x32_bf16 v[92:95], v[88:91], v[4:7], v[92:95]
    v_and_b32 v29, 1, v4
    v_cmp_ne_u32 vcc, s101, v28
    v_cmp_ne_u32 s[16:17], s101, v29
    s_or_b64 s[18:19], vcc, s[16:17]
    s_cbranch_scc1 L_p1r_safe3
L_p1k_safe3:
    s_nop 2
    s_branch L_p1ok_safe3
L_p2b_safe3:
L_p2r_safe3:
    s_or_b64 exec, vcc, 1
    buffer_load_dwordx4 v[72:75], v104, s[4:7], s38 offen sc1
    s_or_b64 exec, s[16:17], 1
    buffer_load_dwordx4 v[76:79], v104, s[4:7], s38 offen offset:1024 sc1
    s_mov_b64 exec, -1
    s_waitcnt vmcnt(2)
    ds_write_b128 v104, v[88:91] offset:6144
    ds_write_b128 v104, v[92:95] offset:7168
    v_max3_u32 v26, v88, v89, v90
    v_max3_u32 v27, v92, v93, v94
    v_max_u32 v26, v26, v91
    v_max_u32 v27, v27, v95
    v_cmp_eq_u32 vcc, -1, v26
    v_cmp_eq_u32 s[16:17], -1, v27
    s_or_b64 s[18:19], vcc, s[16:17]
    s_cbranch_scc0 L_go_safe3
    s_or_b64 exec, vcc, 1
    buffer_load_dwordx4 v[88:91], v104, s[4:7], s38 offen sc1
    s_or_b64 exec, s[16:17], 1
    buffer_load_dwordx4 v[92:95], v104, s[4:7], s38 offen offset:1024 sc1
    s_mov_b64 exec, -1
    s_add_u32 s100, s100, 1
    s_bitcmp1_b32 s100, 15
    s_cbranch_scc1 L_exit
    s_waitcnt vmcnt(2)
    ds_write_b128 v104, v[72:75] offset:6144
    ds_write_b128 v104, v[76:79] offset:7168
    v_max3_u32 v26, v72, v73, v74
    v_max3_u32 v27, v76, v77, v78
    v_max_u32 v26, v26, v75
    v_max_u32 v27, v27, v79
    v_cmp_eq_u32 vcc, -1, v26
    v_cmp_eq_u32 s[16:17], -1, v27
    s_or_b64 s[18:19], vcc, s[16:17]
    s_cbranch_scc1 L_p2r_safe3
    s_branch L_go_safe3
L_enter_safe3:
    ds_write_b128 v104, v[72:75] offset:6144
    ds_write_b128 v104, v[76:79] offset:7168
    ds_read_b128 v[64:67], v106 offset:12288
    ds_read_b128 v[68:71], v106 offset:13312
    ds_read_b128 v[80:83], v106 offset:20480
    ds_read_b128 v[84:87], v106 offset:21504
    ds_read_b128 v[32:35], v106 offset:0
    ds_read_b128 v[36:39], v106 offset:1024
    ds_read_b128 v[40:43], v106 offset:2048
    ds_read_b128 v[44:47], v106 offset:3072
    ds_read_b128 v[48:51], v106 offset:4096
    ds_read_b128 v[52:55], v106 offset:5120
    ds_read_b128 v[56:59], v106 offset:6144
    ds_read_b128 v[60:63], v106 offset:7168
    s_mov_b32 m0, s43
    s_branch L_go_safe3
L_prg_safe3:
    v_mov_b32 v72, 160768
    ds_read_b32 v92, v72
    ds_read_b128 v[72:75], v72 offset:16
    s_add_u32 s45, s31, 2
    s_min_u32 s45, s45, 64
    s_waitcnt lgkmcnt(0)
    v_readfirstlane_b32 s30, v92
    s_cmp_eq_u32 s30, 192
    s_cselect_b32 s42, 64, s42
    v_min_u32 v72, v72, v74
    v_min_u32 v73, v73, v75
    v_lshlrev_b32 v72, 1, v72
    v_lshl_or_b32 v73, v73, 1, 1
    v_min_u32 v72, v72, v73
    s_nop 0
    v_readfirstlane_b32 s30, v72
    s_max_u32 s42, s42, s30
    s_cmp_ge_u32 s42, s45
    s_cbranch_scc1 L_kvd_23
L_kvw_22:
    v_mov_b32 v76, 0
    buffer_load_dwordx4 v[72:75], v76, s[4:7], s50 offen sc1
    s_waitcnt vmcnt(0)
    v_min_u32 v72, v72, v74
    v_min_u32 v73, v73, v75
    v_lshlrev_b32 v72, 1, v72
    v_lshl_or_b32 v73, v73, 1, 1
    v_min_u32 v72, v72, v73
    s_nop 0
    v_readfirstlane_b32 s30, v72
    s_max_u32 s42, s42, s30
    s_cmp_ge_u32 s42, s45
    s_cbranch_scc1 L_kvd_23
    s_sleep 1
    s_add_u32 s100, s100, 1
    s_bitcmp1_b32 s100, 15
    s_cbranch_scc1 L_exit
    s_branch L_kvw_22
L_kvd_23:
    s_nop 15
    s_branch L_prd_safe3
L_chain_end:
    s_waitcnt vmcnt(0)
    ds_read_b128 v[72:75], v106 offset:28672
    ds_read_b128 v[76:79], v106 offset:29696
    ds_read_b128 v[88:91], v106 offset:14336
    ds_read_b128 v[92:95], v106 offset:15360
    ds_read_b128 v[96:99], v106 offset:22528
    ds_read_b128 v[100:103], v106 offset:23552
    s_waitcnt lgkmcnt(0)
    v_smfmac_f32_16x16x64_bf16 v[120:123], v[0:3], v[40:47], v107
    v_smfmac_f32_16x16x64_bf16 v[112:115], v[0:3], v[128:135], v107
    v_smfmac_f32_16x16x64_bf16 v[120:123], v[4:7], v[56:63], v107
    v_smfmac_f32_16x16x64_bf16 v[112:115], v[4:7], v[136:143], v107
    ds_read_b128 v[20:23], v119 offset:640
    ds_read_b128 v[24:27], v118 offset:768
    ds_read_b128 v[28:31], v119 offset:896
    ds_read_b128 v[32:35], v118 offset:1024
    ds_read_b128 v[36:39], v119 offset:1152
    ds_read_b128 v[40:43], v118 offset:1280
    ds_read_b128 v[44:47], v119 offset:1408
    ds_read_b128 v[48:51], v118 offset:1536
    ds_read_b128 v[52:55], v119 offset:1664
    ds_read_b128 v[56:59], v118 offset:1792
    ds_read_b128 v[60:63], v119 offset:1920
    v_smfmac_f32_16x16x64_bf16 v[120:123], v[8:11], a[16:23], v107
    v_smfmac_f32_16x16x64_bf16 v[112:115], v[8:11], v[144:151], v107
    v_smfmac_f32_16x16x64_bf16 v[120:123], v[12:15], a[24:31], v107
    v_smfmac_f32_16x16x64_bf16 v[112:115], v[12:15], v[152:159], v107
    v_smfmac_f32_16x16x64_bf16 v[120:123], v[16:19], a[32:39], v107
    v_smfmac_f32_16x16x64_bf16 v[112:115], v[16:19], v[160:167], v107
    s_waitcnt lgkmcnt(0)
    v_smfmac_f32_16x16x64_bf16 v[120:123], v[20:23], a[40:47], v107
    v_smfmac_f32_16x16x64_bf16 v[112:115], v[20:23], v[168:175], v107
    v_smfmac_f32_16x16x64_bf16 v[120:123], v[24:27], a[48:55], v107
    v_smfmac_f32_16x16x64_bf16 v[112:115], v[24:27], v[176:183], v107
    v_smfmac_f32_16x16x64_bf16 v[120:123], v[28:31], a[56:63], v107
    v_smfmac_f32_16x16x64_bf16 v[112:115], v[28:31], v[184:191], v107
    v_smfmac_f32_16x16x64_bf16 v[120:123], v[32:35], a[64:71], v107
    v_smfmac_f32_16x16x64_bf16 v[112:115], v[32:35], v[192:199], v107
    v_smfmac_f32_16x16x64_bf16 v[120:123], v[36:39], a[72:79], v107
    v_smfmac_f32_16x16x64_bf16 v[112:115], v[36:39], v[200:207], v107
    v_smfmac_f32_16x16x64_bf16 v[120:123], v[40:43], v[64:71], v107
    ds_read_b128 v[64:67], v106 offset:30720
    ds_read_b128 v[68:71], v106 offset:31744
    v_smfmac_f32_16x16x64_bf16 v[112:115], v[40:43], v[208:215], v107
    v_smfmac_f32_16x16x64_bf16 v[120:123], v[44:47], v[80:87], v107
    v_smfmac_f32_16x16x64_bf16 v[112:115], v[44:47], v[216:223], v107
    v_smfmac_f32_16x16x64_bf16 v[120:123], v[48:51], v[72:79], v107
    v_smfmac_f32_16x16x64_bf16 v[112:115], v[48:51], v[224:231], v107
    v_smfmac_f32_16x16x64_bf16 v[120:123], v[52:55], v[88:95], v107
    v_smfmac_f32_16x16x64_bf16 v[112:115], v[52:55], v[232:239], v107
    v_smfmac_f32_16x16x64_bf16 v[120:123], v[56:59], v[96:103], v107
    v_smfmac_f32_16x16x64_bf16 v[112:115], v[56:59], v[240:247], v107
    s_waitcnt lgkmcnt(0)
    v_smfmac_f32_16x16x64_bf16 v[120:123], v[60:63], v[64:71], v107
    v_smfmac_f32_16x16x64_bf16 v[112:115], v[60:63], v[248:255], v107
    s_nop 4
    v_cvt_pk_bf16_f32 v120, v120, v121
    v_cvt_pk_bf16_f32 v121, v122, v123
    s_nop 0
    v_cvt_pk_bf16_f32 v122, v112, v113
    v_cvt_pk_bf16_f32 v123, v114, v115
    v_min_u32 v120, -2, v120
    s_nop 0
    v_permlane32_swap_b32 v122, v123
    buffer_store_dwordx4 v[120:123], v104, s[4:7], s41 offen sc1
    s_waitcnt vmcnt(0)
    s_endpgm
L_worker:
    s_sub_u32 s31, s29, 64
    s_add_u32 s36, s29, 160
    s_cmp_lt_u32 s29, 64
    s_cselect_b32 s31, s36, s31
    s_add_u32 s29, s31, 32
    v_mov_b32 v255, v0
    s_cmp_ge_u32 s31, 192
    s_cbranch_scc1 L_att_wg
    s_cmp_ge_u32 s31, 32
    s_cbranch_scc1 L_id_no
    s_lshl_b32 s35, s31, 1
    s_add_u32 s35, s35, 192
    v_mov_b32 v57, s35
L_id:
    buffer_load_ushort v56, v57, s[8:11], 0 offen sc1
    s_waitcnt vmcnt(0)
    v_readfirstlane_b32 s35, v56
    s_cmp_lg_u32 s35, 0
    s_cbranch_scc1 L_id_ok
    s_sleep 4
    s_add_u32 s100, s100, 1
    s_bitcmp1_b32 s100, 15
    s_cbranch_scc1 L_exit
    s_branch L_id
L_id_ok:
    s_sub_u32 s35, s35, 1
    v_lshrrev_b32 v1, 5, v0
    s_lshl_b32 s52, s28, 1
    v_add_u32 v1, s52, v1
    v_and_b32 v12, 31, v0
    v_lshlrev_b32 v13, 10, v1
    v_lshl_add_u32 v13, v12, 5, v13
    s_lshl_b32 s52, s35, 13
    buffer_load_dwordx4 v[240:243], v13, s[12:15], s52 offen
    buffer_load_dwordx4 v[244:247], v13, s[12:15], s52 offen offset:16
L_id_no:
    s_lshr_b32 s40, s31, 6
    s_bfe_u32 s41, s31, 0x50001
    s_and_b32 s42, s31, 1
    s_cmp_eq_u32 s40, 0
    s_cselect_b32 s16, s70, s72
    s_cselect_b32 s17, s71, s73
    s_cmp_eq_u32 s40, 2
    s_cselect_b32 s16, s68, s16
    s_cselect_b32 s17, s69, s17
    s_mov_b32 s18, 0x400000
    s_mov_b32 s19, 0x20000
    v_lshrrev_b32 v60, 4, v255
    v_lshlrev_b32 v60, 16, v60
    v_and_b32 v61, 15, v255
    v_lshl_add_u32 v60, v61, 2, v60
    s_lshl_b32 s36, s41, 8
    s_lshl_b32 s37, s28, 6
    s_add_u32 s36, s36, s37
    v_add_u32 v60, s36, v60
    s_mov_b32 s36, 0x0
    buffer_load_dword v64, v60, s[16:19], s36 offen offset:0
    s_mov_b32 s37, 0x2000
    buffer_load_dword v65, v60, s[16:19], s37 offen offset:0
    s_mov_b32 s36, 0x4000
    buffer_load_dword v66, v60, s[16:19], s36 offen offset:0
    s_mov_b32 s37, 0x6000
    buffer_load_dword v67, v60, s[16:19], s37 offen offset:0
    s_mov_b32 s36, 0x8000
    buffer_load_dword v68, v60, s[16:19], s36 offen offset:0
    s_mov_b32 s37, 0xa000
    buffer_load_dword v69, v60, s[16:19], s37 offen offset:0
    s_mov_b32 s36, 0xc000
    buffer_load_dword v70, v60, s[16:19], s36 offen offset:0
    s_mov_b32 s37, 0xe000
    buffer_load_dword v71, v60, s[16:19], s37 offen offset:0
    s_mov_b32 s36, 0x40000
    buffer_load_dword v72, v60, s[16:19], s36 offen offset:0
    s_mov_b32 s37, 0x42000
    buffer_load_dword v73, v60, s[16:19], s37 offen offset:0
    s_mov_b32 s36, 0x44000
    buffer_load_dword v74, v60, s[16:19], s36 offen offset:0
    s_mov_b32 s37, 0x46000
    buffer_load_dword v75, v60, s[16:19], s37 offen offset:0
    s_mov_b32 s36, 0x48000
    buffer_load_dword v76, v60, s[16:19], s36 offen offset:0
    s_mov_b32 s37, 0x4a000
    buffer_load_dword v77, v60, s[16:19], s37 offen offset:0
    s_mov_b32 s36, 0x4c000
    buffer_load_dword v78, v60, s[16:19], s36 offen offset:0
    s_mov_b32 s37, 0x4e000
    buffer_load_dword v79, v60, s[16:19], s37 offen offset:0
    s_mov_b32 s36, 0x80000
    buffer_load_dword v80, v60, s[16:19], s36 offen offset:0
    s_mov_b32 s37, 0x82000
    buffer_load_dword v81, v60, s[16:19], s37 offen offset:0
    s_mov_b32 s36, 0x84000
    buffer_load_dword v82, v60, s[16:19], s36 offen offset:0
    s_mov_b32 s37, 0x86000
    buffer_load_dword v83, v60, s[16:19], s37 offen offset:0
    s_mov_b32 s36, 0x88000
    buffer_load_dword v84, v60, s[16:19], s36 offen offset:0
    s_mov_b32 s37, 0x8a000
    buffer_load_dword v85, v60, s[16:19], s37 offen offset:0
    s_mov_b32 s36, 0x8c000
    buffer_load_dword v86, v60, s[16:19], s36 offen offset:0
    s_mov_b32 s37, 0x8e000
    buffer_load_dword v87, v60, s[16:19], s37 offen offset:0
    s_mov_b32 s36, 0xc0000
    buffer_load_dword v88, v60, s[16:19], s36 offen offset:0
    s_mov_b32 s37, 0xc2000
    buffer_load_dword v89, v60, s[16:19], s37 offen offset:0
    s_mov_b32 s36, 0xc4000
    buffer_load_dword v90, v60, s[16:19], s36 offen offset:0
    s_mov_b32 s37, 0xc6000
    buffer_load_dword v91, v60, s[16:19], s37 offen offset:0
    s_mov_b32 s36, 0xc8000
    buffer_load_dword v92, v60, s[16:19], s36 offen offset:0
    s_mov_b32 s37, 0xca000
    buffer_load_dword v93, v60, s[16:19], s37 offen offset:0
    s_mov_b32 s36, 0xcc000
    buffer_load_dword v94, v60, s[16:19], s36 offen offset:0
    s_mov_b32 s37, 0xce000
    buffer_load_dword v95, v60, s[16:19], s37 offen offset:0
    s_mov_b32 s36, 0x100000
    buffer_load_dword v96, v60, s[16:19], s36 offen offset:0
    s_mov_b32 s37, 0x102000
    buffer_load_dword v97, v60, s[16:19], s37 offen offset:0
    s_mov_b32 s36, 0x104000
    buffer_load_dword v98, v60, s[16:19], s36 offen offset:0
    s_mov_b32 s37, 0x106000
    buffer_load_dword v99, v60, s[16:19], s37 offen offset:0
    s_mov_b32 s36, 0x108000
    buffer_load_dword v100, v60, s[16:19], s36 offen offset:0
    s_mov_b32 s37, 0x10a000
    buffer_load_dword v101, v60, s[16:19], s37 offen offset:0
    s_mov_b32 s36, 0x10c000
    buffer_load_dword v102, v60, s[16:19], s36 offen offset:0
    s_mov_b32 s37, 0x10e000
    buffer_load_dword v103, v60, s[16:19], s37 offen offset:0
    s_mov_b32 s36, 0x140000
    buffer_load_dword v104, v60, s[16:19], s36 offen offset:0
    s_mov_b32 s37, 0x142000
    buffer_load_dword v105, v60, s[16:19], s37 offen offset:0
    s_mov_b32 s36, 0x144000
    buffer_load_dword v106, v60, s[16:19], s36 offen offset:0
    s_mov_b32 s37, 0x146000
    buffer_load_dword v107, v60, s[16:19], s37 offen offset:0
    s_mov_b32 s36, 0x148000
    buffer_load_dword v108, v60, s[16:19], s36 offen offset:0
    s_mov_b32 s37, 0x14a000
    buffer_load_dword v109, v60, s[16:19], s37 offen offset:0
    s_mov_b32 s36, 0x14c000
    buffer_load_dword v110, v60, s[16:19], s36 offen offset:0
    s_mov_b32 s37, 0x14e000
    buffer_load_dword v111, v60, s[16:19], s37 offen offset:0
    s_mov_b32 s36, 0x180000
    buffer_load_dword v112, v60, s[16:19], s36 offen offset:0
    s_mov_b32 s37, 0x182000
    buffer_load_dword v113, v60, s[16:19], s37 offen offset:0
    s_mov_b32 s36, 0x184000
    buffer_load_dword v114, v60, s[16:19], s36 offen offset:0
    s_mov_b32 s37, 0x186000
    buffer_load_dword v115, v60, s[16:19], s37 offen offset:0
    s_mov_b32 s36, 0x188000
    buffer_load_dword v116, v60, s[16:19], s36 offen offset:0
    s_mov_b32 s37, 0x18a000
    buffer_load_dword v117, v60, s[16:19], s37 offen offset:0
    s_mov_b32 s36, 0x18c000
    buffer_load_dword v118, v60, s[16:19], s36 offen offset:0
    s_mov_b32 s37, 0x18e000
    buffer_load_dword v119, v60, s[16:19], s37 offen offset:0
    v_lshrrev_b32 v1, 5, v0
    s_lshl_b32 s52, s28, 1
    v_add_u32 v1, s52, v1
    v_and_b32 v2, 31, v0
    v_mul_u32_u24 v3, 1040, v1
    v_lshl_add_u32 v3, v2, 5, v3
    v_add_u32 v3, 131072, v3
    v_lshlrev_b32 v16, 16, v4
    v_and_b32 v17, s62, v4
    v_lshlrev_b32 v18, 16, v5
    v_and_b32 v19, s62, v5
    v_lshlrev_b32 v20, 16, v6
    v_and_b32 v21, s62, v6
    v_lshlrev_b32 v22, 16, v7
    v_and_b32 v23, s62, v7
    v_lshlrev_b32 v24, 16, v8
    v_and_b32 v25, s62, v8
    v_lshlrev_b32 v26, 16, v9
    v_and_b32 v27, s62, v9
    v_lshlrev_b32 v28, 16, v10
    v_and_b32 v29, s62, v10
    v_lshlrev_b32 v30, 16, v11
    v_and_b32 v31, s62, v11
    v_add_f32 v12, v16, v17
    v_add_f32 v12, v12, v18
    v_add_f32 v12, v12, v19
    v_add_f32 v12, v12, v20
    v_add_f32 v12, v12, v21
    v_add_f32 v12, v12, v22
    v_add_f32 v12, v12, v23
    v_add_f32 v12, v12, v24
    v_add_f32 v12, v12, v25
    v_add_f32 v12, v12, v26
    v_add_f32 v12, v12, v27
    v_add_f32 v12, v12, v28
    v_add_f32 v12, v12, v29
    v_add_f32 v12, v12, v30
    v_add_f32 v12, v12, v31
    s_nop 1
    v_add_f32_dpp v12, v12, v12 row_ror:1 row_mask:0xf bank_mask:0xf
    s_nop 1
    v_add_f32_dpp v12, v12, v12 row_ror:2 row_mask:0xf bank_mask:0xf
    s_nop 1
    v_add_f32_dpp v12, v12, v12 row_ror:4 row_mask:0xf bank_mask:0xf
    s_nop 1
    v_add_f32_dpp v12, v12, v12 row_ror:8 row_mask:0xf bank_mask:0xf
    v_mov_b32 v13, v12
    s_nop 1
    v_permlane16_swap_b32 v12, v13
    v_add_f32 v12, v12, v13
    v_mul_f32 v12, 0x3b000000, v12
    v_sub_f32 v32, v16, v12
    v_sub_f32 v33, v17, v12
    v_sub_f32 v34, v18, v12
    v_sub_f32 v35, v19, v12
    v_sub_f32 v36, v20, v12
    v_sub_f32 v37, v21, v12
    v_sub_f32 v38, v22, v12
    v_sub_f32 v39, v23, v12
    v_sub_f32 v40, v24, v12
    v_sub_f32 v41, v25, v12
    v_sub_f32 v42, v26, v12
    v_sub_f32 v43, v27, v12
    v_sub_f32 v44, v28, v12
    v_sub_f32 v45, v29, v12
    v_sub_f32 v46, v30, v12
    v_sub_f32 v47, v31, v12
    v_mul_f32 v14, v32, v32
    v_fmac_f32 v14, v33, v33
    v_fmac_f32 v14, v34, v34
    v_fmac_f32 v14, v35, v35
    v_fmac_f32 v14, v36, v36
    v_fmac_f32 v14, v37, v37
    v_fmac_f32 v14, v38, v38
    v_fmac_f32 v14, v39, v39
    v_fmac_f32 v14, v40, v40
    v_fmac_f32 v14, v41, v41
    v_fmac_f32 v14, v42, v42
    v_fmac_f32 v14, v43, v43
    v_fmac_f32 v14, v44, v44
    v_fmac_f32 v14, v45, v45
    v_fmac_f32 v14, v46, v46
    v_fmac_f32 v14, v47, v47
    s_nop 1
    v_add_f32_dpp v14, v14, v14 row_ror:1 row_mask:0xf bank_mask:0xf
    s_nop 1
    v_add_f32_dpp v14, v14, v14 row_ror:2 row_mask:0xf bank_mask:0xf
    s_nop 1
    v_add_f32_dpp v14, v14, v14 row_ror:4 row_mask:0xf bank_mask:0xf
    s_nop 1
    v_add_f32_dpp v14, v14, v14 row_ror:8 row_mask:0xf bank_mask:0xf
    v_mov_b32 v13, v14
    s_nop 1
    v_permlane16_swap_b32 v14, v13
    v_add_f32 v14, v14, v13
    v_mul_f32 v14, 0x3b000000, v14
    v_cvt_pk_bf16_f32 v12, v12, v12
    v_and_b32 v12, s62, v12
    v_cvt_pk_bf16_f32 v14, v14, v14
    v_and_b32 v14, s62, v14
    v_add_f32 v14, 0x3727c5ac, v14
    v_cvt_pk_bf16_f32 v14, v14, v14
    v_and_b32 v14, s62, v14
    v_sqrt_f32 v14, v14
    s_nop 0
    v_cvt_pk_bf16_f32 v14, v14, v14
    v_and_b32 v14, s62, v14
    v_rcp_f32 v14, v14
    v_sub_f32 v32, v16, v12
    v_cvt_pk_bf16_f32 v32, v32, v32
    v_and_b32 v32, s62, v32
    v_mul_f32 v32, v32, v14
    v_cvt_pk_bf16_f32 v32, v32, v32
    v_and_b32 v32, s62, v32
    v_sub_f32 v33, v17, v12
    v_cvt_pk_bf16_f32 v33, v33, v33
    v_and_b32 v33, s62, v33
    v_mul_f32 v33, v33, v14
    v_cvt_pk_bf16_f32 v33, v33, v33
    v_and_b32 v33, s62, v33
    v_sub_f32 v34, v18, v12
    v_cvt_pk_bf16_f32 v34, v34, v34
    v_and_b32 v34, s62, v34
    v_mul_f32 v34, v34, v14
    v_cvt_pk_bf16_f32 v34, v34, v34
    v_and_b32 v34, s62, v34
    v_sub_f32 v35, v19, v12
    v_cvt_pk_bf16_f32 v35, v35, v35
    v_and_b32 v35, s62, v35
    v_mul_f32 v35, v35, v14
    v_cvt_pk_bf16_f32 v35, v35, v35
    v_and_b32 v35, s62, v35
    v_sub_f32 v36, v20, v12
    v_cvt_pk_bf16_f32 v36, v36, v36
    v_and_b32 v36, s62, v36
    v_mul_f32 v36, v36, v14
    v_cvt_pk_bf16_f32 v36, v36, v36
    v_and_b32 v36, s62, v36
    v_sub_f32 v37, v21, v12
    v_cvt_pk_bf16_f32 v37, v37, v37
    v_and_b32 v37, s62, v37
    v_mul_f32 v37, v37, v14
    v_cvt_pk_bf16_f32 v37, v37, v37
    v_and_b32 v37, s62, v37
    v_sub_f32 v38, v22, v12
    v_cvt_pk_bf16_f32 v38, v38, v38
    v_and_b32 v38, s62, v38
    v_mul_f32 v38, v38, v14
    v_cvt_pk_bf16_f32 v38, v38, v38
    v_and_b32 v38, s62, v38
    v_sub_f32 v39, v23, v12
    v_cvt_pk_bf16_f32 v39, v39, v39
    v_and_b32 v39, s62, v39
    v_mul_f32 v39, v39, v14
    v_cvt_pk_bf16_f32 v39, v39, v39
    v_and_b32 v39, s62, v39
    v_sub_f32 v40, v24, v12
    v_cvt_pk_bf16_f32 v40, v40, v40
    v_and_b32 v40, s62, v40
    v_mul_f32 v40, v40, v14
    v_cvt_pk_bf16_f32 v40, v40, v40
    v_and_b32 v40, s62, v40
    v_sub_f32 v41, v25, v12
    v_cvt_pk_bf16_f32 v41, v41, v41
    v_and_b32 v41, s62, v41
    v_mul_f32 v41, v41, v14
    v_cvt_pk_bf16_f32 v41, v41, v41
    v_and_b32 v41, s62, v41
    v_sub_f32 v42, v26, v12
    v_cvt_pk_bf16_f32 v42, v42, v42
    v_and_b32 v42, s62, v42
    v_mul_f32 v42, v42, v14
    v_cvt_pk_bf16_f32 v42, v42, v42
    v_and_b32 v42, s62, v42
    v_sub_f32 v43, v27, v12
    v_cvt_pk_bf16_f32 v43, v43, v43
    v_and_b32 v43, s62, v43
    v_mul_f32 v43, v43, v14
    v_cvt_pk_bf16_f32 v43, v43, v43
    v_and_b32 v43, s62, v43
    v_sub_f32 v44, v28, v12
    v_cvt_pk_bf16_f32 v44, v44, v44
    v_and_b32 v44, s62, v44
    v_mul_f32 v44, v44, v14
    v_cvt_pk_bf16_f32 v44, v44, v44
    v_and_b32 v44, s62, v44
    v_sub_f32 v45, v29, v12
    v_cvt_pk_bf16_f32 v45, v45, v45
    v_and_b32 v45, s62, v45
    v_mul_f32 v45, v45, v14
    v_cvt_pk_bf16_f32 v45, v45, v45
    v_and_b32 v45, s62, v45
    v_sub_f32 v46, v30, v12
    v_cvt_pk_bf16_f32 v46, v46, v46
    v_and_b32 v46, s62, v46
    v_mul_f32 v46, v46, v14
    v_cvt_pk_bf16_f32 v46, v46, v46
    v_and_b32 v46, s62, v46
    v_sub_f32 v47, v31, v12
    v_cvt_pk_bf16_f32 v47, v47, v47
    v_and_b32 v47, s62, v47
    v_mul_f32 v47, v47, v14
    v_cvt_pk_bf16_f32 v47, v47, v47
    v_and_b32 v47, s62, v47
    v_perm_b32 v4, v33, v32, s61
    v_perm_b32 v5, v35, v34, s61
    v_perm_b32 v6, v37, v36, s61
    v_perm_b32 v7, v39, v38, s61
    v_perm_b32 v8, v41, v40, s61
    v_perm_b32 v9, v43, v42, s61
    v_perm_b32 v10, v45, v44, s61
    v_perm_b32 v11, v47, v46, s61
    ds_write_b128 v3, v[4:7]
    ds_write_b128 v3, v[8:11] offset:16
    v_add_f32 v12, v32, v33
    v_add_f32 v12, v12, v34
    v_add_f32 v12, v12, v35
    v_add_f32 v12, v12, v36
    v_add_f32 v12, v12, v37
    v_add_f32 v12, v12, v38
    v_add_f32 v12, v12, v39
    v_add_f32 v12, v12, v40
    v_add_f32 v12, v12, v41
    v_add_f32 v12, v12, v42
    v_add_f32 v12, v12, v43
    v_add_f32 v12, v12, v44
    v_add_f32 v12, v12, v45
    v_add_f32 v12, v12, v46
    v_add_f32 v12, v12, v47
    s_nop 1
    v_add_f32_dpp v12, v12, v12 row_ror:1 row_mask:0xf bank_mask:0xf
    s_nop 1
    v_add_f32_dpp v12, v12, v12 row_ror:2 row_mask:0xf bank_mask:0xf
    s_nop 1
    v_add_f32_dpp v12, v12, v12 row_ror:4 row_mask:0xf bank_mask:0xf
    s_nop 1
    v_add_f32_dpp v12, v12, v12 row_ror:8 row_mask:0xf bank_mask:0xf
    v_mov_b32 v13, v12
    s_nop 1
    v_permlane16_swap_b32 v12, v13
    v_add_f32 v12, v12, v13
    v_mul_f32 v12, 0x3b000000, v12
    v_sub_f32 v16, v32, v12
    v_sub_f32 v17, v33, v12
    v_sub_f32 v18, v34, v12
    v_sub_f32 v19, v35, v12
    v_sub_f32 v20, v36, v12
    v_sub_f32 v21, v37, v12
    v_sub_f32 v22, v38, v12
    v_sub_f32 v23, v39, v12
    v_sub_f32 v24, v40, v12
    v_sub_f32 v25, v41, v12
    v_sub_f32 v26, v42, v12
    v_sub_f32 v27, v43, v12
    v_sub_f32 v28, v44, v12
    v_sub_f32 v29, v45, v12
    v_sub_f32 v30, v46, v12
    v_sub_f32 v31, v47, v12
    v_mul_f32 v14, v16, v16
    v_fmac_f32 v14, v17, v17
    v_fmac_f32 v14, v18, v18
    v_fmac_f32 v14, v19, v19
    v_fmac_f32 v14, v20, v20
    v_fmac_f32 v14, v21, v21
    v_fmac_f32 v14, v22, v22
    v_fmac_f32 v14, v23, v23
    v_fmac_f32 v14, v24, v24
    v_fmac_f32 v14, v25, v25
    v_fmac_f32 v14, v26, v26
    v_fmac_f32 v14, v27, v27
    v_fmac_f32 v14, v28, v28
    v_fmac_f32 v14, v29, v29
    v_fmac_f32 v14, v30, v30
    v_fmac_f32 v14, v31, v31
    s_nop 1
    v_add_f32_dpp v14, v14, v14 row_ror:1 row_mask:0xf bank_mask:0xf
    s_nop 1
    v_add_f32_dpp v14, v14, v14 row_ror:2 row_mask:0xf bank_mask:0xf
    s_nop 1
    v_add_f32_dpp v14, v14, v14 row_ror:4 row_mask:0xf bank_mask:0xf
    s_nop 1
    v_add_f32_dpp v14, v14, v14 row_ror:8 row_mask:0xf bank_mask:0xf
    v_mov_b32 v13, v14
    s_nop 1
    v_permlane16_swap_b32 v14, v13
    v_add_f32 v14, v14, v13
    v_mul_f32 v14, 0x3b000000, v14
    v_cvt_pk_bf16_f32 v12, v12, v12
    v_and_b32 v12, s62, v12
    v_cvt_pk_bf16_f32 v14, v14, v14
    v_and_b32 v14, s62, v14
    v_add_f32 v14, 0x3727c5ac, v14
    v_cvt_pk_bf16_f32 v14, v14, v14
    v_and_b32 v14, s62, v14
    v_sqrt_f32 v14, v14
    s_nop 0
    v_cvt_pk_bf16_f32 v14, v14, v14
    v_and_b32 v14, s62, v14
    v_rcp_f32 v14, v14
    v_sub_f32 v16, v32, v12
    v_cvt_pk_bf16_f32 v16, v16, v16
    v_and_b32 v16, s62, v16
    v_mul_f32 v16, v16, v14
    v_cvt_pk_bf16_f32 v16, v16, v16
    v_and_b32 v16, s62, v16
    v_sub_f32 v17, v33, v12
    v_cvt_pk_bf16_f32 v17, v17, v17
    v_and_b32 v17, s62, v17
    v_mul_f32 v17, v17, v14
    v_cvt_pk_bf16_f32 v17, v17, v17
    v_and_b32 v17, s62, v17
    v_sub_f32 v18, v34, v12
    v_cvt_pk_bf16_f32 v18, v18, v18
    v_and_b32 v18, s62, v18
    v_mul_f32 v18, v18, v14
    v_cvt_pk_bf16_f32 v18, v18, v18
    v_and_b32 v18, s62, v18
    v_sub_f32 v19, v35, v12
    v_cvt_pk_bf16_f32 v19, v19, v19
    v_and_b32 v19, s62, v19
    v_mul_f32 v19, v19, v14
    v_cvt_pk_bf16_f32 v19, v19, v19
    v_and_b32 v19, s62, v19
    v_sub_f32 v20, v36, v12
    v_cvt_pk_bf16_f32 v20, v20, v20
    v_and_b32 v20, s62, v20
    v_mul_f32 v20, v20, v14
    v_cvt_pk_bf16_f32 v20, v20, v20
    v_and_b32 v20, s62, v20
    v_sub_f32 v21, v37, v12
    v_cvt_pk_bf16_f32 v21, v21, v21
    v_and_b32 v21, s62, v21
    v_mul_f32 v21, v21, v14
    v_cvt_pk_bf16_f32 v21, v21, v21
    v_and_b32 v21, s62, v21
    v_sub_f32 v22, v38, v12
    v_cvt_pk_bf16_f32 v22, v22, v22
    v_and_b32 v22, s62, v22
    v_mul_f32 v22, v22, v14
    v_cvt_pk_bf16_f32 v22, v22, v22
    v_and_b32 v22, s62, v22
    v_sub_f32 v23, v39, v12
    v_cvt_pk_bf16_f32 v23, v23, v23
    v_and_b32 v23, s62, v23
    v_mul_f32 v23, v23, v14
    v_cvt_pk_bf16_f32 v23, v23, v23
    v_and_b32 v23, s62, v23
    v_sub_f32 v24, v40, v12
    v_cvt_pk_bf16_f32 v24, v24, v24
    v_and_b32 v24, s62, v24
    v_mul_f32 v24, v24, v14
    v_cvt_pk_bf16_f32 v24, v24, v24
    v_and_b32 v24, s62, v24
    v_sub_f32 v25, v41, v12
    v_cvt_pk_bf16_f32 v25, v25, v25
    v_and_b32 v25, s62, v25
    v_mul_f32 v25, v25, v14
    v_cvt_pk_bf16_f32 v25, v25, v25
    v_and_b32 v25, s62, v25
    v_sub_f32 v26, v42, v12
    v_cvt_pk_bf16_f32 v26, v26, v26
    v_and_b32 v26, s62, v26
    v_mul_f32 v26, v26, v14
    v_cvt_pk_bf16_f32 v26, v26, v26
    v_and_b32 v26, s62, v26
    v_sub_f32 v27, v43, v12
    v_cvt_pk_bf16_f32 v27, v27, v27
    v_and_b32 v27, s62, v27
    v_mul_f32 v27, v27, v14
    v_cvt_pk_bf16_f32 v27, v27, v27
    v_and_b32 v27, s62, v27
    v_sub_f32 v28, v44, v12
    v_cvt_pk_bf16_f32 v28, v28, v28
    v_and_b32 v28, s62, v28
    v_mul_f32 v28, v28, v14
    v_cvt_pk_bf16_f32 v28, v28, v28
    v_and_b32 v28, s62, v28
    v_sub_f32 v29, v45, v12
    v_cvt_pk_bf16_f32 v29, v29, v29
    v_and_b32 v29, s62, v29
    v_mul_f32 v29, v29, v14
    v_cvt_pk_bf16_f32 v29, v29, v29
    v_and_b32 v29, s62, v29
    v_sub_f32 v30, v46, v12
    v_cvt_pk_bf16_f32 v30, v30, v30
    v_and_b32 v30, s62, v30
    v_mul_f32 v30, v30, v14
    v_cvt_pk_bf16_f32 v30, v30, v30
    v_and_b32 v30, s62, v30
    v_sub_f32 v31, v47, v12
    v_cvt_pk_bf16_f32 v31, v31, v31
    v_and_b32 v31, s62, v31
    v_mul_f32 v31, v31, v14
    v_cvt_pk_bf16_f32 v31, v31, v31
    v_and_b32 v31, s62, v31
    v_perm_b32 v48, v17, v16, s61
    v_perm_b32 v49, v19, v18, s61
    v_perm_b32 v50, v21, v20, s61
    v_perm_b32 v51, v23, v22, s61
    v_perm_b32 v52, v25, v24, s61
    v_perm_b32 v53, v27, v26, s61
    v_perm_b32 v54, v29, v28, s61
    v_perm_b32 v55, v31, v30, s61
    ds_write_b128 v3, v[48:51] offset:8320
    ds_write_b128 v3, v[52:55] offset:8336
    v_and_b32 v1, 7, v0
    v_lshrrev_b32 v2, 3, v0
    s_lshl_b32 s52, s28, 4
    v_add_u32 v2, s52, v2
    v_mul_u32_u24 v4, 1040, v1
    v_lshl_add_u32 v4, v2, 4, v4
    v_add_u32 v4, 131072, v4
    v_lshlrev_b32 v5, 8, v2
    v_lshl_add_u32 v5, v1, 4, v5
    v_bfe_u32 v1, v0, 2, 2
    v_mul_u32_u24 v6, 1040, v1
    v_and_b32 v1, 3, v0
    v_lshl_add_u32 v6, v1, 3, v6
    v_lshrrev_b32 v1, 4, v0
    v_lshl_add_u32 v6, v1, 5, v6
    s_lshl_b32 s52, s28, 8
    s_add_u32 s52, s52, 131072
    v_add_u32 v6, s52, v6
    v_lshlrev_b32 v7, 4, v0
    s_lshr_b32 s52, s2, 1
    s_lshl_b32 s52, s52, 14
    s_and_b32 s53, s2, 1
    s_lshl_b32 s53, s53, 7
    s_add_u32 s52, s52, s53
    s_add_u32 s52, s52, 0x0
    s_lshl_b32 s53, s2, 13
    s_lshl_b32 s54, s28, 11
    s_add_u32 s53, s53, s54
    s_add_u32 s53, s53, 0x200000
    s_waitcnt lgkmcnt(0)
    s_barrier
    ds_read_b128 v[8:11], v4
    ds_read_b128 v[12:15], v4 offset:128
    ds_read_b64_tr_b16 v[16:17], v6 offset:8320
    ds_read_b64_tr_b16 v[18:19], v6 offset:12480
    ds_read_b64_tr_b16 v[20:21], v6 offset:8448
    ds_read_b64_tr_b16 v[22:23], v6 offset:12608
    s_waitcnt lgkmcnt(4)
    buffer_store_dwordx4 v[8:11], v5, s[4:7], s52 offen sc1
    buffer_store_dwordx4 v[12:15], v5, s[4:7], s52 offen offset:2048 sc1
    s_waitcnt lgkmcnt(0)
    buffer_store_dwordx4 v[16:19], v7, s[4:7], s53 offen sc1
    buffer_store_dwordx4 v[20:23], v7, s[4:7], s53 offen offset:1024 sc1
    s_cmp_ge_u32 s31, 32
    s_cbranch_scc1 L_ln2_no
    s_waitcnt vmcnt(60)
    v_mov_b32 v4, v240
    v_mov_b32 v5, v241
    v_mov_b32 v6, v242
    v_mov_b32 v7, v243
    v_mov_b32 v8, v244
    v_mov_b32 v9, v245
    v_mov_b32 v10, v246
    v_mov_b32 v11, v247
    s_barrier
    v_lshrrev_b32 v1, 5, v0
    s_lshl_b32 s52, s28, 1
    v_add_u32 v1, s52, v1
    v_and_b32 v2, 31, v0
    v_mul_u32_u24 v3, 1040, v1
    v_lshl_add_u32 v3, v2, 5, v3
    v_add_u32 v3, 131072, v3
    v_lshlrev_b32 v16, 16, v4
    v_and_b32 v17, s62, v4
    v_lshlrev_b32 v18, 16, v5
    v_and_b32 v19, s62, v5
    v_lshlrev_b32 v20, 16, v6
    v_and_b32 v21, s62, v6
    v_lshlrev_b32 v22, 16, v7
    v_and_b32 v23, s62, v7
    v_lshlrev_b32 v24, 16, v8
    v_and_b32 v25, s62, v8
    v_lshlrev_b32 v26, 16, v9
    v_and_b32 v27, s62, v9
    v_lshlrev_b32 v28, 16, v10
    v_and_b32 v29, s62, v10
    v_lshlrev_b32 v30, 16, v11
    v_and_b32 v31, s62, v11
    v_add_f32 v12, v16, v17
    v_add_f32 v12, v12, v18
    v_add_f32 v12, v12, v19
    v_add_f32 v12, v12, v20
    v_add_f32 v12, v12, v21
    v_add_f32 v12, v12, v22
    v_add_f32 v12, v12, v23
    v_add_f32 v12, v12, v24
    v_add_f32 v12, v12, v25
    v_add_f32 v12, v12, v26
    v_add_f32 v12, v12, v27
    v_add_f32 v12, v12, v28
    v_add_f32 v12, v12, v29
    v_add_f32 v12, v12, v30
    v_add_f32 v12, v12, v31
    s_nop 1
    v_add_f32_dpp v12, v12, v12 row_ror:1 row_mask:0xf bank_mask:0xf
    s_nop 1
    v_add_f32_dpp v12, v12, v12 row_ror:2 row_mask:0xf bank_mask:0xf
    s_nop 1
    v_add_f32_dpp v12, v12, v12 row_ror:4 row_mask:0xf bank_mask:0xf
    s_nop 1
    v_add_f32_dpp v12, v12, v12 row_ror:8 row_mask:0xf bank_mask:0xf
    v_mov_b32 v13, v12
    s_nop 1
    v_permlane16_swap_b32 v12, v13
    v_add_f32 v12, v12, v13
    v_mul_f32 v12, 0x3b000000, v12
    v_sub_f32 v32, v16, v12
    v_sub_f32 v33, v17, v12
    v_sub_f32 v34, v18, v12
    v_sub_f32 v35, v19, v12
    v_sub_f32 v36, v20, v12
    v_sub_f32 v37, v21, v12
    v_sub_f32 v38, v22, v12
    v_sub_f32 v39, v23, v12
    v_sub_f32 v40, v24, v12
    v_sub_f32 v41, v25, v12
    v_sub_f32 v42, v26, v12
    v_sub_f32 v43, v27, v12
    v_sub_f32 v44, v28, v12
    v_sub_f32 v45, v29, v12
    v_sub_f32 v46, v30, v12
    v_sub_f32 v47, v31, v12
    v_mul_f32 v14, v32, v32
    v_fmac_f32 v14, v33, v33
    v_fmac_f32 v14, v34, v34
    v_fmac_f32 v14, v35, v35
    v_fmac_f32 v14, v36, v36
    v_fmac_f32 v14, v37, v37
    v_fmac_f32 v14, v38, v38
    v_fmac_f32 v14, v39, v39
    v_fmac_f32 v14, v40, v40
    v_fmac_f32 v14, v41, v41
    v_fmac_f32 v14, v42, v42
    v_fmac_f32 v14, v43, v43
    v_fmac_f32 v14, v44, v44
    v_fmac_f32 v14, v45, v45
    v_fmac_f32 v14, v46, v46
    v_fmac_f32 v14, v47, v47
    s_nop 1
    v_add_f32_dpp v14, v14, v14 row_ror:1 row_mask:0xf bank_mask:0xf
    s_nop 1
    v_add_f32_dpp v14, v14, v14 row_ror:2 row_mask:0xf bank_mask:0xf
    s_nop 1
    v_add_f32_dpp v14, v14, v14 row_ror:4 row_mask:0xf bank_mask:0xf
    s_nop 1
    v_add_f32_dpp v14, v14, v14 row_ror:8 row_mask:0xf bank_mask:0xf
    v_mov_b32 v13, v14
    s_nop 1
    v_permlane16_swap_b32 v14, v13
    v_add_f32 v14, v14, v13
    v_mul_f32 v14, 0x3b000000, v14
    v_cvt_pk_bf16_f32 v12, v12, v12
    v_and_b32 v12, s62, v12
    v_cvt_pk_bf16_f32 v14, v14, v14
    v_and_b32 v14, s62, v14
    v_add_f32 v14, 0x3727c5ac, v14
    v_cvt_pk_bf16_f32 v14, v14, v14
    v_and_b32 v14, s62, v14
    v_sqrt_f32 v14, v14
    s_nop 0
    v_cvt_pk_bf16_f32 v14, v14, v14
    v_and_b32 v14, s62, v14
    v_rcp_f32 v14, v14
    v_sub_f32 v32, v16, v12
    v_cvt_pk_bf16_f32 v32, v32, v32
    v_and_b32 v32, s62, v32
    v_mul_f32 v32, v32, v14
    v_cvt_pk_bf16_f32 v32, v32, v32
    v_and_b32 v32, s62, v32
    v_sub_f32 v33, v17, v12
    v_cvt_pk_bf16_f32 v33, v33, v33
    v_and_b32 v33, s62, v33
    v_mul_f32 v33, v33, v14
    v_cvt_pk_bf16_f32 v33, v33, v33
    v_and_b32 v33, s62, v33
    v_sub_f32 v34, v18, v12
    v_cvt_pk_bf16_f32 v34, v34, v34
    v_and_b32 v34, s62, v34
    v_mul_f32 v34, v34, v14
    v_cvt_pk_bf16_f32 v34, v34, v34
    v_and_b32 v34, s62, v34
    v_sub_f32 v35, v19, v12
    v_cvt_pk_bf16_f32 v35, v35, v35
    v_and_b32 v35, s62, v35
    v_mul_f32 v35, v35, v14
    v_cvt_pk_bf16_f32 v35, v35, v35
    v_and_b32 v35, s62, v35
    v_sub_f32 v36, v20, v12
    v_cvt_pk_bf16_f32 v36, v36, v36
    v_and_b32 v36, s62, v36
    v_mul_f32 v36, v36, v14
    v_cvt_pk_bf16_f32 v36, v36, v36
    v_and_b32 v36, s62, v36
    v_sub_f32 v37, v21, v12
    v_cvt_pk_bf16_f32 v37, v37, v37
    v_and_b32 v37, s62, v37
    v_mul_f32 v37, v37, v14
    v_cvt_pk_bf16_f32 v37, v37, v37
    v_and_b32 v37, s62, v37
    v_sub_f32 v38, v22, v12
    v_cvt_pk_bf16_f32 v38, v38, v38
    v_and_b32 v38, s62, v38
    v_mul_f32 v38, v38, v14
    v_cvt_pk_bf16_f32 v38, v38, v38
    v_and_b32 v38, s62, v38
    v_sub_f32 v39, v23, v12
    v_cvt_pk_bf16_f32 v39, v39, v39
    v_and_b32 v39, s62, v39
    v_mul_f32 v39, v39, v14
    v_cvt_pk_bf16_f32 v39, v39, v39
    v_and_b32 v39, s62, v39
    v_sub_f32 v40, v24, v12
    v_cvt_pk_bf16_f32 v40, v40, v40
    v_and_b32 v40, s62, v40
    v_mul_f32 v40, v40, v14
    v_cvt_pk_bf16_f32 v40, v40, v40
    v_and_b32 v40, s62, v40
    v_sub_f32 v41, v25, v12
    v_cvt_pk_bf16_f32 v41, v41, v41
    v_and_b32 v41, s62, v41
    v_mul_f32 v41, v41, v14
    v_cvt_pk_bf16_f32 v41, v41, v41
    v_and_b32 v41, s62, v41
    v_sub_f32 v42, v26, v12
    v_cvt_pk_bf16_f32 v42, v42, v42
    v_and_b32 v42, s62, v42
    v_mul_f32 v42, v42, v14
    v_cvt_pk_bf16_f32 v42, v42, v42
    v_and_b32 v42, s62, v42
    v_sub_f32 v43, v27, v12
    v_cvt_pk_bf16_f32 v43, v43, v43
    v_and_b32 v43, s62, v43
    v_mul_f32 v43, v43, v14
    v_cvt_pk_bf16_f32 v43, v43, v43
    v_and_b32 v43, s62, v43
    v_sub_f32 v44, v28, v12
    v_cvt_pk_bf16_f32 v44, v44, v44
    v_and_b32 v44, s62, v44
    v_mul_f32 v44, v44, v14
    v_cvt_pk_bf16_f32 v44, v44, v44
    v_and_b32 v44, s62, v44
    v_sub_f32 v45, v29, v12
    v_cvt_pk_bf16_f32 v45, v45, v45
    v_and_b32 v45, s62, v45
    v_mul_f32 v45, v45, v14
    v_cvt_pk_bf16_f32 v45, v45, v45
    v_and_b32 v45, s62, v45
    v_sub_f32 v46, v30, v12
    v_cvt_pk_bf16_f32 v46, v46, v46
    v_and_b32 v46, s62, v46
    v_mul_f32 v46, v46, v14
    v_cvt_pk_bf16_f32 v46, v46, v46
    v_and_b32 v46, s62, v46
    v_sub_f32 v47, v31, v12
    v_cvt_pk_bf16_f32 v47, v47, v47
    v_and_b32 v47, s62, v47
    v_mul_f32 v47, v47, v14
    v_cvt_pk_bf16_f32 v47, v47, v47
    v_and_b32 v47, s62, v47
    v_perm_b32 v4, v33, v32, s61
    v_perm_b32 v5, v35, v34, s61
    v_perm_b32 v6, v37, v36, s61
    v_perm_b32 v7, v39, v38, s61
    v_perm_b32 v8, v41, v40, s61
    v_perm_b32 v9, v43, v42, s61
    v_perm_b32 v10, v45, v44, s61
    v_perm_b32 v11, v47, v46, s61
    ds_write_b128 v3, v[4:7]
    ds_write_b128 v3, v[8:11] offset:16
    v_add_f32 v12, v32, v33
    v_add_f32 v12, v12, v34
    v_add_f32 v12, v12, v35
    v_add_f32 v12, v12, v36
    v_add_f32 v12, v12, v37
    v_add_f32 v12, v12, v38
    v_add_f32 v12, v12, v39
    v_add_f32 v12, v12, v40
    v_add_f32 v12, v12, v41
    v_add_f32 v12, v12, v42
    v_add_f32 v12, v12, v43
    v_add_f32 v12, v12, v44
    v_add_f32 v12, v12, v45
    v_add_f32 v12, v12, v46
    v_add_f32 v12, v12, v47
    s_nop 1
    v_add_f32_dpp v12, v12, v12 row_ror:1 row_mask:0xf bank_mask:0xf
    s_nop 1
    v_add_f32_dpp v12, v12, v12 row_ror:2 row_mask:0xf bank_mask:0xf
    s_nop 1
    v_add_f32_dpp v12, v12, v12 row_ror:4 row_mask:0xf bank_mask:0xf
    s_nop 1
    v_add_f32_dpp v12, v12, v12 row_ror:8 row_mask:0xf bank_mask:0xf
    v_mov_b32 v13, v12
    s_nop 1
    v_permlane16_swap_b32 v12, v13
    v_add_f32 v12, v12, v13
    v_mul_f32 v12, 0x3b000000, v12
    v_sub_f32 v16, v32, v12
    v_sub_f32 v17, v33, v12
    v_sub_f32 v18, v34, v12
    v_sub_f32 v19, v35, v12
    v_sub_f32 v20, v36, v12
    v_sub_f32 v21, v37, v12
    v_sub_f32 v22, v38, v12
    v_sub_f32 v23, v39, v12
    v_sub_f32 v24, v40, v12
    v_sub_f32 v25, v41, v12
    v_sub_f32 v26, v42, v12
    v_sub_f32 v27, v43, v12
    v_sub_f32 v28, v44, v12
    v_sub_f32 v29, v45, v12
    v_sub_f32 v30, v46, v12
    v_sub_f32 v31, v47, v12
    v_mul_f32 v14, v16, v16
    v_fmac_f32 v14, v17, v17
    v_fmac_f32 v14, v18, v18
    v_fmac_f32 v14, v19, v19
    v_fmac_f32 v14, v20, v20
    v_fmac_f32 v14, v21, v21
    v_fmac_f32 v14, v22, v22
    v_fmac_f32 v14, v23, v23
    v_fmac_f32 v14, v24, v24
    v_fmac_f32 v14, v25, v25
    v_fmac_f32 v14, v26, v26
    v_fmac_f32 v14, v27, v27
    v_fmac_f32 v14, v28, v28
    v_fmac_f32 v14, v29, v29
    v_fmac_f32 v14, v30, v30
    v_fmac_f32 v14, v31, v31
    s_nop 1
    v_add_f32_dpp v14, v14, v14 row_ror:1 row_mask:0xf bank_mask:0xf
    s_nop 1
    v_add_f32_dpp v14, v14, v14 row_ror:2 row_mask:0xf bank_mask:0xf
    s_nop 1
    v_add_f32_dpp v14, v14, v14 row_ror:4 row_mask:0xf bank_mask:0xf
    s_nop 1
    v_add_f32_dpp v14, v14, v14 row_ror:8 row_mask:0xf bank_mask:0xf
    v_mov_b32 v13, v14
    s_nop 1
    v_permlane16_swap_b32 v14, v13
    v_add_f32 v14, v14, v13
    v_mul_f32 v14, 0x3b000000, v14
    v_cvt_pk_bf16_f32 v12, v12, v12
    v_and_b32 v12, s62, v12
    v_cvt_pk_bf16_f32 v14, v14, v14
    v_and_b32 v14, s62, v14
    v_add_f32 v14, 0x3727c5ac, v14
    v_cvt_pk_bf16_f32 v14, v14, v14
    v_and_b32 v14, s62, v14
    v_sqrt_f32 v14, v14
    s_nop 0
    v_cvt_pk_bf16_f32 v14, v14, v14
    v_and_b32 v14, s62, v14
    v_rcp_f32 v14, v14
    v_sub_f32 v16, v32, v12
    v_cvt_pk_bf16_f32 v16, v16, v16
    v_and_b32 v16, s62, v16
    v_mul_f32 v16, v16, v14
    v_cvt_pk_bf16_f32 v16, v16, v16
    v_and_b32 v16, s62, v16
    v_sub_f32 v17, v33, v12
    v_cvt_pk_bf16_f32 v17, v17, v17
    v_and_b32 v17, s62, v17
    v_mul_f32 v17, v17, v14
    v_cvt_pk_bf16_f32 v17, v17, v17
    v_and_b32 v17, s62, v17
    v_sub_f32 v18, v34, v12
    v_cvt_pk_bf16_f32 v18, v18, v18
    v_and_b32 v18, s62, v18
    v_mul_f32 v18, v18, v14
    v_cvt_pk_bf16_f32 v18, v18, v18
    v_and_b32 v18, s62, v18
    v_sub_f32 v19, v35, v12
    v_cvt_pk_bf16_f32 v19, v19, v19
    v_and_b32 v19, s62, v19
    v_mul_f32 v19, v19, v14
    v_cvt_pk_bf16_f32 v19, v19, v19
    v_and_b32 v19, s62, v19
    v_sub_f32 v20, v36, v12
    v_cvt_pk_bf16_f32 v20, v20, v20
    v_and_b32 v20, s62, v20
    v_mul_f32 v20, v20, v14
    v_cvt_pk_bf16_f32 v20, v20, v20
    v_and_b32 v20, s62, v20
    v_sub_f32 v21, v37, v12
    v_cvt_pk_bf16_f32 v21, v21, v21
    v_and_b32 v21, s62, v21
    v_mul_f32 v21, v21, v14
    v_cvt_pk_bf16_f32 v21, v21, v21
    v_and_b32 v21, s62, v21
    v_sub_f32 v22, v38, v12
    v_cvt_pk_bf16_f32 v22, v22, v22
    v_and_b32 v22, s62, v22
    v_mul_f32 v22, v22, v14
    v_cvt_pk_bf16_f32 v22, v22, v22
    v_and_b32 v22, s62, v22
    v_sub_f32 v23, v39, v12
    v_cvt_pk_bf16_f32 v23, v23, v23
    v_and_b32 v23, s62, v23
    v_mul_f32 v23, v23, v14
    v_cvt_pk_bf16_f32 v23, v23, v23
    v_and_b32 v23, s62, v23
    v_sub_f32 v24, v40, v12
    v_cvt_pk_bf16_f32 v24, v24, v24
    v_and_b32 v24, s62, v24
    v_mul_f32 v24, v24, v14
    v_cvt_pk_bf16_f32 v24, v24, v24
    v_and_b32 v24, s62, v24
    v_sub_f32 v25, v41, v12
    v_cvt_pk_bf16_f32 v25, v25, v25
    v_and_b32 v25, s62, v25
    v_mul_f32 v25, v25, v14
    v_cvt_pk_bf16_f32 v25, v25, v25
    v_and_b32 v25, s62, v25
    v_sub_f32 v26, v42, v12
    v_cvt_pk_bf16_f32 v26, v26, v26
    v_and_b32 v26, s62, v26
    v_mul_f32 v26, v26, v14
    v_cvt_pk_bf16_f32 v26, v26, v26
    v_and_b32 v26, s62, v26
    v_sub_f32 v27, v43, v12
    v_cvt_pk_bf16_f32 v27, v27, v27
    v_and_b32 v27, s62, v27
    v_mul_f32 v27, v27, v14
    v_cvt_pk_bf16_f32 v27, v27, v27
    v_and_b32 v27, s62, v27
    v_sub_f32 v28, v44, v12
    v_cvt_pk_bf16_f32 v28, v28, v28
    v_and_b32 v28, s62, v28
    v_mul_f32 v28, v28, v14
    v_cvt_pk_bf16_f32 v28, v28, v28
    v_and_b32 v28, s62, v28
    v_sub_f32 v29, v45, v12
    v_cvt_pk_bf16_f32 v29, v29, v29
    v_and_b32 v29, s62, v29
    v_mul_f32 v29, v29, v14
    v_cvt_pk_bf16_f32 v29, v29, v29
    v_and_b32 v29, s62, v29
    v_sub_f32 v30, v46, v12
    v_cvt_pk_bf16_f32 v30, v30, v30
    v_and_b32 v30, s62, v30
    v_mul_f32 v30, v30, v14
    v_cvt_pk_bf16_f32 v30, v30, v30
    v_and_b32 v30, s62, v30
    v_sub_f32 v31, v47, v12
    v_cvt_pk_bf16_f32 v31, v31, v31
    v_and_b32 v31, s62, v31
    v_mul_f32 v31, v31, v14
    v_cvt_pk_bf16_f32 v31, v31, v31
    v_and_b32 v31, s62, v31
    v_perm_b32 v48, v17, v16, s61
    v_perm_b32 v49, v19, v18, s61
    v_perm_b32 v50, v21, v20, s61
    v_perm_b32 v51, v23, v22, s61
    v_perm_b32 v52, v25, v24, s61
    v_perm_b32 v53, v27, v26, s61
    v_perm_b32 v54, v29, v28, s61
    v_perm_b32 v55, v31, v30, s61
    ds_write_b128 v3, v[48:51] offset:8320
    ds_write_b128 v3, v[52:55] offset:8336
    v_and_b32 v1, 7, v0
    v_lshrrev_b32 v2, 3, v0
    s_lshl_b32 s52, s28, 4
    v_add_u32 v2, s52, v2
    v_mul_u32_u24 v4, 1040, v1
    v_lshl_add_u32 v4, v2, 4, v4
    v_add_u32 v4, 131072, v4
    v_lshlrev_b32 v5, 8, v2
    v_lshl_add_u32 v5, v1, 4, v5
    v_bfe_u32 v1, v0, 2, 2
    v_mul_u32_u24 v6, 1040, v1
    v_and_b32 v1, 3, v0
    v_lshl_add_u32 v6, v1, 3, v6
    v_lshrrev_b32 v1, 4, v0
    v_lshl_add_u32 v6, v1, 5, v6
    s_lshl_b32 s52, s28, 8
    s_add_u32 s52, s52, 131072
    v_add_u32 v6, s52, v6
    v_lshlrev_b32 v7, 4, v0
    s_lshr_b32 s52, s35, 1
    s_lshl_b32 s52, s52, 14
    s_and_b32 s53, s35, 1
    s_lshl_b32 s53, s53, 7
    s_add_u32 s52, s52, s53
    s_add_u32 s52, s52, 0x0
    s_lshl_b32 s53, s35, 13
    s_lshl_b32 s54, s28, 11
    s_add_u32 s53, s53, s54
    s_add_u32 s53, s53, 0x200000
    s_waitcnt lgkmcnt(0)
    s_barrier
    ds_read_b128 v[8:11], v4
    ds_read_b128 v[12:15], v4 offset:128
    ds_read_b64_tr_b16 v[16:17], v6 offset:8320
    ds_read_b64_tr_b16 v[18:19], v6 offset:12480
    ds_read_b64_tr_b16 v[20:21], v6 offset:8448
    ds_read_b64_tr_b16 v[22:23], v6 offset:12608
    s_waitcnt lgkmcnt(4)
    buffer_store_dwordx4 v[8:11], v5, s[4:7], s52 offen sc1
    buffer_store_dwordx4 v[12:15], v5, s[4:7], s52 offen offset:2048 sc1
    s_waitcnt lgkmcnt(0)
    buffer_store_dwordx4 v[16:19], v7, s[4:7], s53 offen sc1
    buffer_store_dwordx4 v[20:23], v7, s[4:7], s53 offen offset:1024 sc1
L_ln2_no:
    s_waitcnt vmcnt(58)
    v_perm_b32 v62, v65, v64, s60
    v_accvgpr_write_b32 a0, v62
    v_perm_b32 v63, v65, v64, s61
    v_accvgpr_write_b32 a4, v63
    s_mov_b32 s36, 0x1c0000
    buffer_load_dword v64, v60, s[16:19], s36 offen offset:0
    s_mov_b32 s37, 0x1c2000
    buffer_load_dword v65, v60, s[16:19], s37 offen offset:0
    s_waitcnt vmcnt(58)
    v_perm_b32 v62, v67, v66, s60
    v_accvgpr_write_b32 a1, v62
    v_perm_b32 v63, v67, v66, s61
    v_accvgpr_write_b32 a5, v63
    s_mov_b32 s36, 0x1c4000
    buffer_load_dword v66, v60, s[16:19], s36 offen offset:0
    s_mov_b32 s37, 0x1c6000
    buffer_load_dword v67, v60, s[16:19], s37 offen offset:0
    s_waitcnt vmcnt(58)
    v_perm_b32 v62, v69, v68, s60
    v_accvgpr_write_b32 a2, v62
    v_perm_b32 v63, v69, v68, s61
    v_accvgpr_write_b32 a6, v63
    s_mov_b32 s36, 0x1c8000
    buffer_load_dword v68, v60, s[16:19], s36 offen offset:0
    s_mov_b32 s37, 0x1ca000
    buffer_load_dword v69, v60, s[16:19], s37 offen offset:0
    s_waitcnt vmcnt(58)
    v_perm_b32 v62, v71, v70, s60
    v_accvgpr_write_b32 a3, v62
    v_perm_b32 v63, v71, v70, s61
    v_accvgpr_write_b32 a7, v63
    s_mov_b32 s36, 0x1cc000
    buffer_load_dword v70, v60, s[16:19], s36 offen offset:0
    s_mov_b32 s37, 0x1ce000
    buffer_load_dword v71, v60, s[16:19], s37 offen offset:0
    s_waitcnt vmcnt(58)
    v_perm_b32 v62, v73, v72, s60
    v_accvgpr_write_b32 a8, v62
    v_perm_b32 v63, v73, v72, s61
    v_accvgpr_write_b32 a12, v63
    s_mov_b32 s36, 0x200000
    buffer_load_dword v72, v60, s[16:19], s36 offen offset:0
    s_mov_b32 s37, 0x202000
    buffer_load_dword v73, v60, s[16:19], s37 offen offset:0
    s_waitcnt vmcnt(58)
    v_perm_b32 v62, v75, v74, s60
    v_accvgpr_write_b32 a9, v62
    v_perm_b32 v63, v75, v74, s61
    v_accvgpr_write_b32 a13, v63
    s_mov_b32 s36, 0x204000
    buffer_load_dword v74, v60, s[16:19], s36 offen offset:0
    s_mov_b32 s37, 0x206000
    buffer_load_dword v75, v60, s[16:19], s37 offen offset:0
    s_waitcnt vmcnt(58)
    v_perm_b32 v62, v77, v76, s60
    v_accvgpr_write_b32 a10, v62
    v_perm_b32 v63, v77, v76, s61
    v_accvgpr_write_b32 a14, v63
    s_mov_b32 s36, 0x208000
    buffer_load_dword v76, v60, s[16:19], s36 offen offset:0
    s_mov_b32 s37, 0x20a000
    buffer_load_dword v77, v60, s[16:19], s37 offen offset:0
    s_waitcnt vmcnt(58)
    v_perm_b32 v62, v79, v78, s60
    v_accvgpr_write_b32 a11, v62
    v_perm_b32 v63, v79, v78, s61
    v_accvgpr_write_b32 a15, v63
    s_mov_b32 s36, 0x20c000
    buffer_load_dword v78, v60, s[16:19], s36 offen offset:0
    s_mov_b32 s37, 0x20e000
    buffer_load_dword v79, v60, s[16:19], s37 offen offset:0
    s_waitcnt vmcnt(58)
    v_perm_b32 v62, v81, v80, s60
    v_accvgpr_write_b32 a16, v62
    v_perm_b32 v63, v81, v80, s61
    v_accvgpr_write_b32 a20, v63
    s_mov_b32 s36, 0x240000
    buffer_load_dword v80, v60, s[16:19], s36 offen offset:0
    s_mov_b32 s37, 0x242000
    buffer_load_dword v81, v60, s[16:19], s37 offen offset:0
    s_waitcnt vmcnt(58)
    v_perm_b32 v62, v83, v82, s60
    v_accvgpr_write_b32 a17, v62
    v_perm_b32 v63, v83, v82, s61
    v_accvgpr_write_b32 a21, v63
    s_mov_b32 s36, 0x244000
    buffer_load_dword v82, v60, s[16:19], s36 offen offset:0
    s_mov_b32 s37, 0x246000
    buffer_load_dword v83, v60, s[16:19], s37 offen offset:0
    s_waitcnt vmcnt(58)
    v_perm_b32 v62, v85, v84, s60
    v_accvgpr_write_b32 a18, v62
    v_perm_b32 v63, v85, v84, s61
    v_accvgpr_write_b32 a22, v63
    s_mov_b32 s36, 0x248000
    buffer_load_dword v84, v60, s[16:19], s36 offen offset:0
    s_mov_b32 s37, 0x24a000
    buffer_load_dword v85, v60, s[16:19], s37 offen offset:0
    s_waitcnt vmcnt(58)
    v_perm_b32 v62, v87, v86, s60
    v_accvgpr_write_b32 a19, v62
    v_perm_b32 v63, v87, v86, s61
    v_accvgpr_write_b32 a23, v63
    s_mov_b32 s36, 0x24c000
    buffer_load_dword v86, v60, s[16:19], s36 offen offset:0
    s_mov_b32 s37, 0x24e000
    buffer_load_dword v87, v60, s[16:19], s37 offen offset:0
    s_waitcnt vmcnt(58)
    v_perm_b32 v62, v89, v88, s60
    v_accvgpr_write_b32 a24, v62
    v_perm_b32 v63, v89, v88, s61
    v_accvgpr_write_b32 a28, v63
    s_mov_b32 s36, 0x280000
    buffer_load_dword v88, v60, s[16:19], s36 offen offset:0
    s_mov_b32 s37, 0x282000
    buffer_load_dword v89, v60, s[16:19], s37 offen offset:0
    s_waitcnt vmcnt(58)
    v_perm_b32 v62, v91, v90, s60
    v_accvgpr_write_b32 a25, v62
    v_perm_b32 v63, v91, v90, s61
    v_accvgpr_write_b32 a29, v63
    s_mov_b32 s36, 0x284000
    buffer_load_dword v90, v60, s[16:19], s36 offen offset:0
    s_mov_b32 s37, 0x286000
    buffer_load_dword v91, v60, s[16:19], s37 offen offset:0
    s_waitcnt vmcnt(58)
    v_perm_b32 v62, v93, v92, s60
    v_accvgpr_write_b32 a26, v62
    v_perm_b32 v63, v93, v92, s61
    v_accvgpr_write_b32 a30, v63
    s_mov_b32 s36, 0x288000
    buffer_load_dword v92, v60, s[16:19], s36 offen offset:0
    s_mov_b32 s37, 0x28a000
    buffer_load_dword v93, v60, s[16:19], s37 offen offset:0
    s_waitcnt vmcnt(58)
    v_perm_b32 v62, v95, v94, s60
    v_accvgpr_write_b32 a27, v62
    v_perm_b32 v63, v95, v94, s61
    v_accvgpr_write_b32 a31, v63
    s_mov_b32 s36, 0x28c000
    buffer_load_dword v94, v60, s[16:19], s36 offen offset:0
    s_mov_b32 s37, 0x28e000
    buffer_load_dword v95, v60, s[16:19], s37 offen offset:0
    s_waitcnt vmcnt(58)
    v_perm_b32 v62, v97, v96, s60
    v_accvgpr_write_b32 a32, v62
    v_perm_b32 v63, v97, v96, s61
    v_accvgpr_write_b32 a36, v63
    s_mov_b32 s36, 0x2c0000
    buffer_load_dword v96, v60, s[16:19], s36 offen offset:0
    s_mov_b32 s37, 0x2c2000
    buffer_load_dword v97, v60, s[16:19], s37 offen offset:0
    s_waitcnt vmcnt(58)
    v_perm_b32 v62, v99, v98, s60
    v_accvgpr_write_b32 a33, v62
    v_perm_b32 v63, v99, v98, s61
    v_accvgpr_write_b32 a37, v63
    s_mov_b32 s36, 0x2c4000
    buffer_load_dword v98, v60, s[16:19], s36 offen offset:0
    s_mov_b32 s37, 0x2c6000
    buffer_load_dword v99, v60, s[16:19], s37 offen offset:0
    s_waitcnt vmcnt(58)
    v_perm_b32 v62, v101, v100, s60
    v_accvgpr_write_b32 a34, v62
    v_perm_b32 v63, v101, v100, s61
    v_accvgpr_write_b32 a38, v63
    s_mov_b32 s36, 0x2c8000
    buffer_load_dword v100, v60, s[16:19], s36 offen offset:0
    s_mov_b32 s37, 0x2ca000
    buffer_load_dword v101, v60, s[16:19], s37 offen offset:0
    s_waitcnt vmcnt(58)
    v_perm_b32 v62, v103, v102, s60
    v_accvgpr_write_b32 a35, v62
    v_perm_b32 v63, v103, v102, s61
    v_accvgpr_write_b32 a39, v63
    s_mov_b32 s36, 0x2cc000
    buffer_load_dword v102, v60, s[16:19], s36 offen offset:0
    s_mov_b32 s37, 0x2ce000
    buffer_load_dword v103, v60, s[16:19], s37 offen offset:0
    s_waitcnt vmcnt(58)
    v_perm_b32 v62, v105, v104, s60
    v_accvgpr_write_b32 a40, v62
    v_perm_b32 v63, v105, v104, s61
    v_accvgpr_write_b32 a44, v63
    s_mov_b32 s36, 0x300000
    buffer_load_dword v104, v60, s[16:19], s36 offen offset:0
    s_mov_b32 s37, 0x302000
    buffer_load_dword v105, v60, s[16:19], s37 offen offset:0
    s_waitcnt vmcnt(58)
    v_perm_b32 v62, v107, v106, s60
    v_accvgpr_write_b32 a41, v62
    v_perm_b32 v63, v107, v106, s61
    v_accvgpr_write_b32 a45, v63
    s_mov_b32 s36, 0x304000
    buffer_load_dword v106, v60, s[16:19], s36 offen offset:0
    s_mov_b32 s37, 0x306000
    buffer_load_dword v107, v60, s[16:19], s37 offen offset:0
    s_waitcnt vmcnt(58)
    v_perm_b32 v62, v109, v108, s60
    v_accvgpr_write_b32 a42, v62
    v_perm_b32 v63, v109, v108, s61
    v_accvgpr_write_b32 a46, v63
    s_mov_b32 s36, 0x308000
    buffer_load_dword v108, v60, s[16:19], s36 offen offset:0
    s_mov_b32 s37, 0x30a000
    buffer_load_dword v109, v60, s[16:19], s37 offen offset:0
    s_waitcnt vmcnt(58)
    v_perm_b32 v62, v111, v110, s60
    v_accvgpr_write_b32 a43, v62
    v_perm_b32 v63, v111, v110, s61
    v_accvgpr_write_b32 a47, v63
    s_mov_b32 s36, 0x30c000
    buffer_load_dword v110, v60, s[16:19], s36 offen offset:0
    s_mov_b32 s37, 0x30e000
    buffer_load_dword v111, v60, s[16:19], s37 offen offset:0
    s_waitcnt vmcnt(58)
    v_perm_b32 v62, v113, v112, s60
    v_accvgpr_write_b32 a48, v62
    v_perm_b32 v63, v113, v112, s61
    v_accvgpr_write_b32 a52, v63
    s_mov_b32 s36, 0x340000
    buffer_load_dword v112, v60, s[16:19], s36 offen offset:0
    s_mov_b32 s37, 0x342000
    buffer_load_dword v113, v60, s[16:19], s37 offen offset:0
    s_waitcnt vmcnt(58)
    v_perm_b32 v62, v115, v114, s60
    v_accvgpr_write_b32 a49, v62
    v_perm_b32 v63, v115, v114, s61
    v_accvgpr_write_b32 a53, v63
    s_mov_b32 s36, 0x344000
    buffer_load_dword v114, v60, s[16:19], s36 offen offset:0
    s_mov_b32 s37, 0x346000
    buffer_load_dword v115, v60, s[16:19], s37 offen offset:0
    s_waitcnt vmcnt(58)
    v_perm_b32 v62, v117, v116, s60
    v_accvgpr_write_b32 a50, v62
    v_perm_b32 v63, v117, v116, s61
    v_accvgpr_write_b32 a54, v63
    s_mov_b32 s36, 0x348000
    buffer_load_dword v116, v60, s[16:19], s36 offen offset:0
    s_mov_b32 s37, 0x34a000
    buffer_load_dword v117, v60, s[16:19], s37 offen offset:0
    s_waitcnt vmcnt(58)
    v_perm_b32 v62, v119, v118, s60
    v_accvgpr_write_b32 a51, v62
    v_perm_b32 v63, v119, v118, s61
    v_accvgpr_write_b32 a55, v63
    s_mov_b32 s36, 0x34c000
    buffer_load_dword v118, v60, s[16:19], s36 offen offset:0
    s_mov_b32 s37, 0x34e000
    buffer_load_dword v119, v60, s[16:19], s37 offen offset:0
    s_waitcnt vmcnt(54)
    s_barrier
    s_cmp_lg_u32 s28, 0
    s_cbranch_scc1 L_arr_24
    v_mov_b32 v250, 1
    v_mov_b32 v251, 8
    s_mov_b64 exec, 1
    buffer_atomic_add v250, v251, s[8:11], 0 offen sc0
    s_mov_b64 exec, -1
L_arr_24:
    v_perm_b32 v62, v65, v64, s60
    v_accvgpr_write_b32 a56, v62
    v_perm_b32 v63, v65, v64, s61
    v_accvgpr_write_b32 a60, v63
    s_mov_b32 s36, 0x380000
    buffer_load_dword v64, v60, s[16:19], s36 offen offset:0
    s_mov_b32 s37, 0x382000
    buffer_load_dword v65, v60, s[16:19], s37 offen offset:0
    s_waitcnt vmcnt(54)
    v_perm_b32 v62, v67, v66, s60
    v_accvgpr_write_b32 a57, v62
    v_perm_b32 v63, v67, v66, s61
    v_accvgpr_write_b32 a61, v63
    s_mov_b32 s36, 0x384000
    buffer_load_dword v66, v60, s[16:19], s36 offen offset:0
    s_mov_b32 s37, 0x386000
    buffer_load_dword v67, v60, s[16:19], s37 offen offset:0
    s_waitcnt vmcnt(54)
    v_perm_b32 v62, v69, v68, s60
    v_accvgpr_write_b32 a58, v62
    v_perm_b32 v63, v69, v68, s61
    v_accvgpr_write_b32 a62, v63
    s_mov_b32 s36, 0x388000
    buffer_load_dword v68, v60, s[16:19], s36 offen offset:0
    s_mov_b32 s37, 0x38a000
    buffer_load_dword v69, v60, s[16:19], s37 offen offset:0
    s_waitcnt vmcnt(54)
    v_perm_b32 v62, v71, v70, s60
    v_accvgpr_write_b32 a59, v62
    v_perm_b32 v63, v71, v70, s61
    v_accvgpr_write_b32 a63, v63
    s_mov_b32 s36, 0x38c000
    buffer_load_dword v70, v60, s[16:19], s36 offen offset:0
    s_mov_b32 s37, 0x38e000
    buffer_load_dword v71, v60, s[16:19], s37 offen offset:0
    s_waitcnt vmcnt(54)
    v_perm_b32 v62, v73, v72, s60
    v_accvgpr_write_b32 a64, v62
    v_perm_b32 v63, v73, v72, s61
    v_accvgpr_write_b32 a68, v63
    s_mov_b32 s36, 0x3c0000
    buffer_load_dword v72, v60, s[16:19], s36 offen offset:0
    s_mov_b32 s37, 0x3c2000
    buffer_load_dword v73, v60, s[16:19], s37 offen offset:0
    s_waitcnt vmcnt(54)
    v_perm_b32 v62, v75, v74, s60
    v_accvgpr_write_b32 a65, v62
    v_perm_b32 v63, v75, v74, s61
    v_accvgpr_write_b32 a69, v63
    s_mov_b32 s36, 0x3c4000
    buffer_load_dword v74, v60, s[16:19], s36 offen offset:0
    s_mov_b32 s37, 0x3c6000
    buffer_load_dword v75, v60, s[16:19], s37 offen offset:0
    s_waitcnt vmcnt(54)
    v_perm_b32 v62, v77, v76, s60
    v_accvgpr_write_b32 a66, v62
    v_perm_b32 v63, v77, v76, s61
    v_accvgpr_write_b32 a70, v63
    s_mov_b32 s36, 0x3c8000
    buffer_load_dword v76, v60, s[16:19], s36 offen offset:0
    s_mov_b32 s37, 0x3ca000
    buffer_load_dword v77, v60, s[16:19], s37 offen offset:0
    s_waitcnt vmcnt(54)
    v_perm_b32 v62, v79, v78, s60
    v_accvgpr_write_b32 a67, v62
    v_perm_b32 v63, v79, v78, s61
    v_accvgpr_write_b32 a71, v63
    s_mov_b32 s36, 0x3cc000
    buffer_load_dword v78, v60, s[16:19], s36 offen offset:0
    s_mov_b32 s37, 0x3ce000
    buffer_load_dword v79, v60, s[16:19], s37 offen offset:0
    s_waitcnt vmcnt(54)
    v_perm_b32 v62, v81, v80, s60
    v_accvgpr_write_b32 a72, v62
    v_perm_b32 v63, v81, v80, s61
    v_accvgpr_write_b32 a76, v63
    s_waitcnt vmcnt(52)
    v_perm_b32 v62, v83, v82, s60
    v_accvgpr_write_b32 a73, v62
    v_perm_b32 v63, v83, v82, s61
    v_accvgpr_write_b32 a77, v63
    s_waitcnt vmcnt(50)
    v_perm_b32 v62, v85, v84, s60
    v_accvgpr_write_b32 a74, v62
    v_perm_b32 v63, v85, v84, s61
    v_accvgpr_write_b32 a78, v63
    s_waitcnt vmcnt(48)
    v_perm_b32 v62, v87, v86, s60
    v_accvgpr_write_b32 a75, v62
    v_perm_b32 v63, v87, v86, s61
    v_accvgpr_write_b32 a79, v63
    s_waitcnt vmcnt(46)
    v_perm_b32 v62, v89, v88, s60
    v_accvgpr_write_b32 a80, v62
    v_perm_b32 v63, v89, v88, s61
    v_accvgpr_write_b32 a84, v63
    s_waitcnt vmcnt(44)
    v_perm_b32 v62, v91, v90, s60
    v_accvgpr_write_b32 a81, v62
    v_perm_b32 v63, v91, v90, s61
    v_accvgpr_write_b32 a85, v63
    s_waitcnt vmcnt(42)
    v_perm_b32 v62, v93, v92, s60
    v_accvgpr_write_b32 a82, v62
    v_perm_b32 v63, v93, v92, s61
    v_accvgpr_write_b32 a86, v63
    s_waitcnt vmcnt(40)
    v_perm_b32 v62, v95, v94, s60
    v_accvgpr_write_b32 a83, v62
    v_perm_b32 v63, v95, v94, s61
    v_accvgpr_write_b32 a87, v63
    s_waitcnt vmcnt(38)
    v_perm_b32 v62, v97, v96, s60
    v_accvgpr_write_b32 a88, v62
    v_perm_b32 v63, v97, v96, s61
    v_accvgpr_write_b32 a92, v63
    s_waitcnt vmcnt(36)
    v_perm_b32 v62, v99, v98, s60
    v_accvgpr_write_b32 a89, v62
    v_perm_b32 v63, v99, v98, s61
    v_accvgpr_write_b32 a93, v63
    s_waitcnt vmcnt(34)
    v_perm_b32 v62, v101, v100, s60
    v_accvgpr_write_b32 a90, v62
    v_perm_b32 v63, v101, v100, s61
    v_accvgpr_write_b32 a94, v63
    s_waitcnt vmcnt(32)
    v_perm_b32 v62, v103, v102, s60
    v_accvgpr_write_b32 a91, v62
    v_perm_b32 v63, v103, v102, s61
    v_accvgpr_write_b32 a95, v63
    s_waitcnt vmcnt(30)
    v_perm_b32 v62, v105, v104, s60
    v_accvgpr_write_b32 a96, v62
    v_perm_b32 v63, v105, v104, s61
    v_accvgpr_write_b32 a100, v63
    s_waitcnt vmcnt(28)
    v_perm_b32 v62, v107, v106, s60
    v_accvgpr_write_b32 a97, v62
    v_perm_b32 v63, v107, v106, s61
    v_accvgpr_write_b32 a101, v63
    s_waitcnt vmcnt(26)
    v_perm_b32 v62, v109, v108, s60
    v_accvgpr_write_b32 a98, v62
    v_perm_b32 v63, v109, v108, s61
    v_accvgpr_write_b32 a102, v63
    s_waitcnt vmcnt(24)
    v_perm_b32 v62, v111, v110, s60
    v_accvgpr_write_b32 a99, v62
    v_perm_b32 v63, v111, v110, s61
    v_accvgpr_write_b32 a103, v63
    s_waitcnt vmcnt(22)
    v_perm_b32 v62, v113, v112, s60
    v_accvgpr_write_b32 a104, v62
    v_perm_b32 v63, v113, v112, s61
    v_accvgpr_write_b32 a108, v63
    s_waitcnt vmcnt(20)
    v_perm_b32 v62, v115, v114, s60
    v_accvgpr_write_b32 a105, v62
    v_perm_b32 v63, v115, v114, s61
    v_accvgpr_write_b32 a109, v63
    s_waitcnt vmcnt(18)
    v_perm_b32 v62, v117, v116, s60
    v_accvgpr_write_b32 a106, v62
    v_perm_b32 v63, v117, v116, s61
    v_accvgpr_write_b32 a110, v63
    s_waitcnt vmcnt(16)
    v_perm_b32 v62, v119, v118, s60
    v_accvgpr_write_b32 a107, v62
    v_perm_b32 v63, v119, v118, s61
    v_accvgpr_write_b32 a111, v63
    s_waitcnt vmcnt(14)
    v_perm_b32 v62, v65, v64, s60
    v_accvgpr_write_b32 a112, v62
    v_perm_b32 v63, v65, v64, s61
    v_accvgpr_write_b32 a116, v63
    s_waitcnt vmcnt(12)
    v_perm_b32 v62, v67, v66, s60
    v_accvgpr_write_b32 a113, v62
    v_perm_b32 v63, v67, v66, s61
    v_accvgpr_write_b32 a117, v63
    s_waitcnt vmcnt(10)
    v_perm_b32 v62, v69, v68, s60
    v_accvgpr_write_b32 a114, v62
    v_perm_b32 v63, v69, v68, s61
    v_accvgpr_write_b32 a118, v63
    s_waitcnt vmcnt(8)
    v_perm_b32 v62, v71, v70, s60
    v_accvgpr_write_b32 a115, v62
    v_perm_b32 v63, v71, v70, s61
    v_accvgpr_write_b32 a119, v63
    s_waitcnt vmcnt(6)
    v_perm_b32 v62, v73, v72, s60
    v_accvgpr_write_b32 a120, v62
    v_perm_b32 v63, v73, v72, s61
    v_accvgpr_write_b32 a124, v63
    s_waitcnt vmcnt(4)
    v_perm_b32 v62, v75, v74, s60
    v_accvgpr_write_b32 a121, v62
    v_perm_b32 v63, v75, v74, s61
    v_accvgpr_write_b32 a125, v63
    s_waitcnt vmcnt(2)
    v_perm_b32 v62, v77, v76, s60
    v_accvgpr_write_b32 a122, v62
    v_perm_b32 v63, v77, v76, s61
    v_accvgpr_write_b32 a126, v63
    s_waitcnt vmcnt(0)
    v_perm_b32 v62, v79, v78, s60
    v_accvgpr_write_b32 a123, v62
    v_perm_b32 v63, v79, v78, s61
    v_accvgpr_write_b32 a127, v63
    s_cmp_lg_u32 s28, 0
    s_cbranch_scc1 L_arr_25
    s_waitcnt vmcnt(0)
    v_readfirstlane_b32 s30, v250
    s_add_u32 s30, s30, 1
    s_and_b32 s57, s30, 0xffff
    s_cmp_lg_u32 s57, 224
    s_cbranch_scc1 L_ae_26
    v_mov_b32 v251, 4
L_pd_27:
    buffer_load_dword v250, v251, s[8:11], 0 offen sc1
    s_waitcnt vmcnt(0)
    v_readfirstlane_b32 s30, v250
    s_and_b32 s57, s30, 0xffff
    s_cmp_ge_u32 s57, 32
    s_cbranch_scc1 L_pdd_28
    s_sleep 4
    s_add_u32 s100, s100, 1
    s_bitcmp1_b32 s100, 15
    s_cbranch_scc1 L_exit
    s_branch L_pd_27
L_pdd_28:
    v_mov_b32 v250, s30
    v_mov_b32 v251, 132
    s_mov_b64 exec, 1
    buffer_store_dword v250, v251, s[8:11], 0 offen sc1
    s_mov_b64 exec, -1
L_ae_26:
L_arr_25:
    s_cmp_lg_u32 s28, 0
    s_cbranch_scc1 L_wgw_29
    v_mov_b32 v251, 132
L_pd_30:
    buffer_load_dword v250, v251, s[8:11], 0 offen sc1
    s_waitcnt vmcnt(0)
    v_readfirstlane_b32 s30, v250
    s_and_b32 s57, s30, 0xffff
    s_cmp_ge_u32 s57, 32
    s_cbranch_scc1 L_pdd_31
    s_sleep 4
    s_add_u32 s100, s100, 1
    s_bitcmp1_b32 s100, 15
    s_cbranch_scc1 L_exit
    s_branch L_pd_30
L_pdd_31:
L_wgw_29:
    s_barrier
    v_lshlrev_b32 v1, 4, v255
    s_lshl_b32 s36, s28, 13
    v_add_u32 v2, s36, v1
    s_lshl_b32 s45, s42, 15
    s_add_u32 s45, s45, 0x0
    s_lshl_b32 s48, s28, 13
    s_mov_b32 s36, 0x3000000
    s_cmp_eq_u32 s40, 0
    s_cselect_b32 s36, 0x2000000, s36
    s_cmp_eq_u32 s40, 2
    s_cselect_b32 s36, 0x4000000, s36
    s_lshl_b32 s37, s42, 5
    s_add_u32 s37, s37, s41
    s_lshl_b32 s37, s37, 13
    s_add_u32 s46, s36, s37
    s_cmp_eq_u32 s40, 1
    s_cselect_b32 s36, 11, 10
    s_lshl_b32 s36, s28, s36
    s_add_u32 s46, s46, s36
    s_lshl_b32 s36, s41, 7
    s_lshl_b32 s37, s40, 3
    s_add_u32 s36, s36, s37
    s_lshl_b32 s37, s42, 2
    s_add_u32 s36, s36, s37
    s_add_u32 s47, s36, 0x8b0000
    s_mov_b32 s44, 0
    v_mov_b32 v3, 0
    s_mov_b32 s49, 0
    s_add_u32 m0, s49, s48
    s_nop 0
    buffer_load_dwordx4 v2, s[4:7], s45 offen offset:0 sc1 lds
    buffer_load_dwordx4 v2, s[4:7], s45 offen offset:1024 sc1 lds
    buffer_load_dwordx4 v2, s[4:7], s45 offen offset:2048 sc1 lds
    buffer_load_dwordx4 v2, s[4:7], s45 offen offset:3072 sc1 lds
    s_add_u32 m0, m0, 4096
    s_add_u32 s36, s45, 4096
    buffer_load_dwordx4 v2, s[4:7], s36 offen offset:0 sc1 lds
    buffer_load_dwordx4 v2, s[4:7], s36 offen offset:1024 sc1 lds
    buffer_load_dwordx4 v2, s[4:7], s36 offen offset:2048 sc1 lds
    buffer_load_dwordx4 v2, s[4:7], s36 offen offset:3072 sc1 lds
    s_add_u32 s45, s45, 0x10000
    s_mov_b32 s49, 32768
    s_add_u32 m0, s49, s48
    s_nop 0
    buffer_load_dwordx4 v2, s[4:7], s45 offen offset:0 sc1 lds
    buffer_load_dwordx4 v2, s[4:7], s45 offen offset:1024 sc1 lds
    buffer_load_dwordx4 v2, s[4:7], s45 offen offset:2048 sc1 lds
    buffer_load_dwordx4 v2, s[4:7], s45 offen offset:3072 sc1 lds
    s_add_u32 m0, m0, 4096
    s_add_u32 s36, s45, 4096
    buffer_load_dwordx4 v2, s[4:7], s36 offen offset:0 sc1 lds
    buffer_load_dwordx4 v2, s[4:7], s36 offen offset:1024 sc1 lds
    buffer_load_dwordx4 v2, s[4:7], s36 offen offset:2048 sc1 lds
    buffer_load_dwordx4 v2, s[4:7], s36 offen offset:3072 sc1 lds
    s_add_u32 s45, s45, 0x10000
    s_mov_b32 s49, 65536
    s_add_u32 m0, s49, s48
    s_nop 0
    buffer_load_dwordx4 v2, s[4:7], s45 offen offset:0 sc1 lds
    buffer_load_dwordx4 v2, s[4:7], s45 offen offset:1024 sc1 lds
    buffer_load_dwordx4 v2, s[4:7], s45 offen offset:2048 sc1 lds
    buffer_load_dwordx4 v2, s[4:7], s45 offen offset:3072 sc1 lds
    s_add_u32 m0, m0, 4096
    s_add_u32 s36, s45, 4096
    buffer_load_dwordx4 v2, s[4:7], s36 offen offset:0 sc1 lds
    buffer_load_dwordx4 v2, s[4:7], s36 offen offset:1024 sc1 lds
    buffer_load_dwordx4 v2, s[4:7], s36 offen offset:2048 sc1 lds
    buffer_load_dwordx4 v2, s[4:7], s36 offen offset:3072 sc1 lds
    s_add_u32 s45, s45, 0x10000
    s_waitcnt vmcnt(0)
    s_cmp_eq_u32 s40, 1
    s_cbranch_scc1 L_qkv_v
L_qkv_kq:
    s_waitcnt vmcnt(10)
    s_barrier
    s_and_b32 s49, s44, 3
    s_lshl_b32 s50, s49, 15
    v_add_u32 v5, s50, v1
    s_add_u32 s49, s49, 3
    s_and_b32 s49, s49, 3
    s_lshl_b32 s49, s49, 15
    ds_read_b128 v[8:11], v5 offset:0
    ds_read_b128 v[12:15], v5 offset:16384
    ds_read_b128 v[16:19], v5 offset:1024
    ds_read_b128 v[20:23], v5 offset:17408
    s_cmp_lg_u32 s28, 0
    s_cbranch_scc1 L_qf_32
    s_cmp_lt_u32 s44, 2
    s_cbranch_scc1 L_qf_32
    s_sub_u32 s36, s44, 1
    v_mov_b32 v4, s36
    s_mov_b64 exec, 1
    buffer_store_dword v4, v3, s[4:7], s47 offen sc1
    s_mov_b64 exec, -1
L_qf_32:
    ds_read_b128 v[24:27], v5 offset:2048
    ds_read_b128 v[28:31], v5 offset:18432
    s_waitcnt lgkmcnt(4)
    v_mfma_f32_16x16x32_bf16 v[40:43], a[0:3], v[8:11], 0
    s_add_u32 m0, s49, s48
    s_add_u32 s36, s45, 4096
    v_mfma_f32_16x16x32_bf16 v[44:47], a[4:7], v[8:11], 0
    v_mfma_f32_16x16x32_bf16 v[48:51], a[0:3], v[12:15], 0
    v_mfma_f32_16x16x32_bf16 v[52:55], a[4:7], v[12:15], 0
    ds_read_b128 v[32:35], v5 offset:3072
    ds_read_b128 v[36:39], v5 offset:19456
    s_waitcnt lgkmcnt(4)
    v_mfma_f32_16x16x32_bf16 v[40:43], a[8:11], v[16:19], v[40:43]
    buffer_load_dwordx4 v2, s[4:7], s45 offen offset:0 sc1 lds
    v_mfma_f32_16x16x32_bf16 v[44:47], a[12:15], v[16:19], v[44:47]
    v_mfma_f32_16x16x32_bf16 v[48:51], a[8:11], v[20:23], v[48:51]
    v_mfma_f32_16x16x32_bf16 v[52:55], a[12:15], v[20:23], v[52:55]
    ds_read_b128 v[8:11], v5 offset:4096
    ds_read_b128 v[12:15], v5 offset:20480
    s_waitcnt lgkmcnt(4)
    v_mfma_f32_16x16x32_bf16 v[40:43], a[16:19], v[24:27], v[40:43]
    buffer_load_dwordx4 v2, s[4:7], s45 offen offset:1024 sc1 lds
    v_mfma_f32_16x16x32_bf16 v[44:47], a[20:23], v[24:27], v[44:47]
    v_mfma_f32_16x16x32_bf16 v[48:51], a[16:19], v[28:31], v[48:51]
    v_mfma_f32_16x16x32_bf16 v[52:55], a[20:23], v[28:31], v[52:55]
    ds_read_b128 v[16:19], v5 offset:5120
    ds_read_b128 v[20:23], v5 offset:21504
    s_waitcnt lgkmcnt(4)
    v_mfma_f32_16x16x32_bf16 v[40:43], a[24:27], v[32:35], v[40:43]
    buffer_load_dwordx4 v2, s[4:7], s45 offen offset:2048 sc1 lds
    v_mfma_f32_16x16x32_bf16 v[44:47], a[28:31], v[32:35], v[44:47]
    v_mfma_f32_16x16x32_bf16 v[48:51], a[24:27], v[36:39], v[48:51]
    v_mfma_f32_16x16x32_bf16 v[52:55], a[28:31], v[36:39], v[52:55]
    ds_read_b128 v[24:27], v5 offset:6144
    ds_read_b128 v[28:31], v5 offset:22528
    s_waitcnt lgkmcnt(4)
    v_mfma_f32_16x16x32_bf16 v[40:43], a[32:35], v[8:11], v[40:43]
    buffer_load_dwordx4 v2, s[4:7], s45 offen offset:3072 sc1 lds
    s_add_u32 m0, m0, 4096
    v_mfma_f32_16x16x32_bf16 v[44:47], a[36:39], v[8:11], v[44:47]
    v_mfma_f32_16x16x32_bf16 v[48:51], a[32:35], v[12:15], v[48:51]
    v_mfma_f32_16x16x32_bf16 v[52:55], a[36:39], v[12:15], v[52:55]
    ds_read_b128 v[32:35], v5 offset:7168
    ds_read_b128 v[36:39], v5 offset:23552
    s_waitcnt lgkmcnt(4)
    v_mfma_f32_16x16x32_bf16 v[40:43], a[40:43], v[16:19], v[40:43]
    buffer_load_dwordx4 v2, s[4:7], s36 offen offset:0 sc1 lds
    v_mfma_f32_16x16x32_bf16 v[44:47], a[44:47], v[16:19], v[44:47]
    v_mfma_f32_16x16x32_bf16 v[48:51], a[40:43], v[20:23], v[48:51]
    v_mfma_f32_16x16x32_bf16 v[52:55], a[44:47], v[20:23], v[52:55]
    ds_read_b128 v[8:11], v5 offset:8192
    ds_read_b128 v[12:15], v5 offset:24576
    s_waitcnt lgkmcnt(4)
    v_mfma_f32_16x16x32_bf16 v[40:43], a[48:51], v[24:27], v[40:43]
    buffer_load_dwordx4 v2, s[4:7], s36 offen offset:1024 sc1 lds
    v_mfma_f32_16x16x32_bf16 v[44:47], a[52:55], v[24:27], v[44:47]
    v_mfma_f32_16x16x32_bf16 v[48:51], a[48:51], v[28:31], v[48:51]
    v_mfma_f32_16x16x32_bf16 v[52:55], a[52:55], v[28:31], v[52:55]
    ds_read_b128 v[16:19], v5 offset:9216
    ds_read_b128 v[20:23], v5 offset:25600
    s_waitcnt lgkmcnt(4)
    v_mfma_f32_16x16x32_bf16 v[40:43], a[56:59], v[32:35], v[40:43]
    buffer_load_dwordx4 v2, s[4:7], s36 offen offset:2048 sc1 lds
    v_mfma_f32_16x16x32_bf16 v[44:47], a[60:63], v[32:35], v[44:47]
    v_mfma_f32_16x16x32_bf16 v[48:51], a[56:59], v[36:39], v[48:51]
    v_mfma_f32_16x16x32_bf16 v[52:55], a[60:63], v[36:39], v[52:55]
    ds_read_b128 v[24:27], v5 offset:10240
    ds_read_b128 v[28:31], v5 offset:26624
    s_waitcnt lgkmcnt(4)
    v_mfma_f32_16x16x32_bf16 v[40:43], a[64:67], v[8:11], v[40:43]
    buffer_load_dwordx4 v2, s[4:7], s36 offen offset:3072 sc1 lds
    s_add_u32 s45, s45, 0x10000
    v_mfma_f32_16x16x32_bf16 v[44:47], a[68:71], v[8:11], v[44:47]
    v_mfma_f32_16x16x32_bf16 v[48:51], a[64:67], v[12:15], v[48:51]
    v_mfma_f32_16x16x32_bf16 v[52:55], a[68:71], v[12:15], v[52:55]
    ds_read_b128 v[32:35], v5 offset:11264
    ds_read_b128 v[36:39], v5 offset:27648
    s_waitcnt lgkmcnt(4)
    v_mfma_f32_16x16x32_bf16 v[40:43], a[72:75], v[16:19], v[40:43]
    v_mfma_f32_16x16x32_bf16 v[44:47], a[76:79], v[16:19], v[44:47]
    v_mfma_f32_16x16x32_bf16 v[48:51], a[72:75], v[20:23], v[48:51]
    v_mfma_f32_16x16x32_bf16 v[52:55], a[76:79], v[20:23], v[52:55]
    ds_read_b128 v[8:11], v5 offset:12288
    ds_read_b128 v[12:15], v5 offset:28672
    s_waitcnt lgkmcnt(4)
    v_mfma_f32_16x16x32_bf16 v[40:43], a[80:83], v[24:27], v[40:43]
    v_mfma_f32_16x16x32_bf16 v[44:47], a[84:87], v[24:27], v[44:47]
    v_mfma_f32_16x16x32_bf16 v[48:51], a[80:83], v[28:31], v[48:51]
    v_mfma_f32_16x16x32_bf16 v[52:55], a[84:87], v[28:31], v[52:55]
    ds_read_b128 v[16:19], v5 offset:13312
    ds_read_b128 v[20:23], v5 offset:29696
    s_waitcnt lgkmcnt(4)
    v_mfma_f32_16x16x32_bf16 v[40:43], a[88:91], v[32:35], v[40:43]
    v_mfma_f32_16x16x32_bf16 v[44:47], a[92:95], v[32:35], v[44:47]
    v_mfma_f32_16x16x32_bf16 v[48:51], a[88:91], v[36:39], v[48:51]
    v_mfma_f32_16x16x32_bf16 v[52:55], a[92:95], v[36:39], v[52:55]
    ds_read_b128 v[24:27], v5 offset:14336
    ds_read_b128 v[28:31], v5 offset:30720
    s_waitcnt lgkmcnt(4)
    v_mfma_f32_16x16x32_bf16 v[40:43], a[96:99], v[8:11], v[40:43]
    v_mfma_f32_16x16x32_bf16 v[44:47], a[100:103], v[8:11], v[44:47]
    v_mfma_f32_16x16x32_bf16 v[48:51], a[96:99], v[12:15], v[48:51]
    v_mfma_f32_16x16x32_bf16 v[52:55], a[100:103], v[12:15], v[52:55]
    ds_read_b128 v[32:35], v5 offset:15360
    ds_read_b128 v[36:39], v5 offset:31744
    s_waitcnt lgkmcnt(4)
    v_mfma_f32_16x16x32_bf16 v[40:43], a[104:107], v[16:19], v[40:43]
    v_mfma_f32_16x16x32_bf16 v[44:47], a[108:111], v[16:19], v[44:47]
    v_mfma_f32_16x16x32_bf16 v[48:51], a[104:107], v[20:23], v[48:51]
    v_mfma_f32_16x16x32_bf16 v[52:55], a[108:111], v[20:23], v[52:55]
    s_waitcnt lgkmcnt(2)
    v_mfma_f32_16x16x32_bf16 v[40:43], a[112:115], v[24:27], v[40:43]
    v_mfma_f32_16x16x32_bf16 v[44:47], a[116:119], v[24:27], v[44:47]
    v_mfma_f32_16x16x32_bf16 v[48:51], a[112:115], v[28:31], v[48:51]
    v_mfma_f32_16x16x32_bf16 v[52:55], a[116:119], v[28:31], v[52:55]
    s_waitcnt lgkmcnt(0)
    v_mfma_f32_16x16x32_bf16 v[40:43], a[120:123], v[32:35], v[40:43]
    v_mfma_f32_16x16x32_bf16 v[44:47], a[124:127], v[32:35], v[44:47]
    v_mfma_f32_16x16x32_bf16 v[48:51], a[120:123], v[36:39], v[48:51]
    v_mfma_f32_16x16x32_bf16 v[52:55], a[124:127], v[36:39], v[52:55]
    v_cvt_pk_bf16_f32 v56, v40, v41
    v_cvt_pk_bf16_f32 v57, v42, v43
    v_cvt_pk_bf16_f32 v58, v44, v45
    v_cvt_pk_bf16_f32 v59, v46, v47
    s_nop 0
    v_cvt_pk_bf16_f32 v60, v48, v49
    v_cvt_pk_bf16_f32 v61, v50, v51
    s_nop 0
    v_cvt_pk_bf16_f32 v62, v52, v53
    v_cvt_pk_bf16_f32 v63, v54, v55
    s_add_u32 s36, s46, 4096
    buffer_store_dwordx4 v[56:59], v1, s[4:7], s46 offen sc1
    buffer_store_dwordx4 v[60:63], v1, s[4:7], s36 offen sc1
    s_add_u32 s46, s46, 0x80000
    s_add_u32 s44, s44, 1
    s_cmp_lt_u32 s44, 32
    s_cbranch_scc1 L_qkv_kq
    s_branch L_qkv_end
L_qkv_v:
    s_waitcnt vmcnt(10)
    s_barrier
    s_and_b32 s49, s44, 3
    s_lshl_b32 s50, s49, 15
    v_add_u32 v5, s50, v1
    s_add_u32 s49, s49, 3
    s_and_b32 s49, s49, 3
    s_lshl_b32 s49, s49, 15
    ds_read_b128 v[8:11], v5 offset:0
    ds_read_b128 v[12:15], v5 offset:16384
    ds_read_b128 v[16:19], v5 offset:1024
    ds_read_b128 v[20:23], v5 offset:17408
    s_cmp_lg_u32 s28, 0
    s_cbranch_scc1 L_qf_34
    s_cmp_lt_u32 s44, 2
    s_cbranch_scc1 L_qf_34
    s_sub_u32 s36, s44, 1
    v_mov_b32 v4, s36
    s_mov_b64 exec, 1
    buffer_store_dword v4, v3, s[4:7], s47 offen sc1
    s_mov_b64 exec, -1
L_qf_34:
    ds_read_b128 v[24:27], v5 offset:2048
    ds_read_b128 v[28:31], v5 offset:18432
    s_waitcnt lgkmcnt(4)
    v_mfma_f32_16x16x32_bf16 v[40:43], v[8:11], a[0:3], 0
    s_add_u32 m0, s49, s48
    s_add_u32 s36, s45, 4096
    v_mfma_f32_16x16x32_bf16 v[44:47], v[8:11], a[4:7], 0
    v_mfma_f32_16x16x32_bf16 v[48:51], v[12:15], a[0:3], 0
    v_mfma_f32_16x16x32_bf16 v[52:55], v[12:15], a[4:7], 0
    ds_read_b128 v[32:35], v5 offset:3072
    ds_read_b128 v[36:39], v5 offset:19456
    s_waitcnt lgkmcnt(4)
    v_mfma_f32_16x16x32_bf16 v[40:43], v[16:19], a[8:11], v[40:43]
    buffer_load_dwordx4 v2, s[4:7], s45 offen offset:0 sc1 lds
    v_mfma_f32_16x16x32_bf16 v[44:47], v[16:19], a[12:15], v[44:47]
    v_mfma_f32_16x16x32_bf16 v[48:51], v[20:23], a[8:11], v[48:51]
    v_mfma_f32_16x16x32_bf16 v[52:55], v[20:23], a[12:15], v[52:55]
    ds_read_b128 v[8:11], v5 offset:4096
    ds_read_b128 v[12:15], v5 offset:20480
    s_waitcnt lgkmcnt(4)
    v_mfma_f32_16x16x32_bf16 v[40:43], v[24:27], a[16:19], v[40:43]
    buffer_load_dwordx4 v2, s[4:7], s45 offen offset:1024 sc1 lds
    v_mfma_f32_16x16x32_bf16 v[44:47], v[24:27], a[20:23], v[44:47]
    v_mfma_f32_16x16x32_bf16 v[48:51], v[28:31], a[16:19], v[48:51]
    v_mfma_f32_16x16x32_bf16 v[52:55], v[28:31], a[20:23], v[52:55]
    ds_read_b128 v[16:19], v5 offset:5120
    ds_read_b128 v[20:23], v5 offset:21504
    s_waitcnt lgkmcnt(4)
    v_mfma_f32_16x16x32_bf16 v[40:43], v[32:35], a[24:27], v[40:43]
    buffer_load_dwordx4 v2, s[4:7], s45 offen offset:2048 sc1 lds
    v_mfma_f32_16x16x32_bf16 v[44:47], v[32:35], a[28:31], v[44:47]
    v_mfma_f32_16x16x32_bf16 v[48:51], v[36:39], a[24:27], v[48:51]
    v_mfma_f32_16x16x32_bf16 v[52:55], v[36:39], a[28:31], v[52:55]
    ds_read_b128 v[24:27], v5 offset:6144
    ds_read_b128 v[28:31], v5 offset:22528
    s_waitcnt lgkmcnt(4)
    v_mfma_f32_16x16x32_bf16 v[40:43], v[8:11], a[32:35], v[40:43]
    buffer_load_dwordx4 v2, s[4:7], s45 offen offset:3072 sc1 lds
    s_add_u32 m0, m0, 4096
    v_mfma_f32_16x16x32_bf16 v[44:47], v[8:11], a[36:39], v[44:47]
    v_mfma_f32_16x16x32_bf16 v[48:51], v[12:15], a[32:35], v[48:51]
    v_mfma_f32_16x16x32_bf16 v[52:55], v[12:15], a[36:39], v[52:55]
    ds_read_b128 v[32:35], v5 offset:7168
    ds_read_b128 v[36:39], v5 offset:23552
    s_waitcnt lgkmcnt(4)
    v_mfma_f32_16x16x32_bf16 v[40:43], v[16:19], a[40:43], v[40:43]
    buffer_load_dwordx4 v2, s[4:7], s36 offen offset:0 sc1 lds
    v_mfma_f32_16x16x32_bf16 v[44:47], v[16:19], a[44:47], v[44:47]
    v_mfma_f32_16x16x32_bf16 v[48:51], v[20:23], a[40:43], v[48:51]
    v_mfma_f32_16x16x32_bf16 v[52:55], v[20:23], a[44:47], v[52:55]
    ds_read_b128 v[8:11], v5 offset:8192
    ds_read_b128 v[12:15], v5 offset:24576
    s_waitcnt lgkmcnt(4)
    v_mfma_f32_16x16x32_bf16 v[40:43], v[24:27], a[48:51], v[40:43]
    buffer_load_dwordx4 v2, s[4:7], s36 offen offset:1024 sc1 lds
    v_mfma_f32_16x16x32_bf16 v[44:47], v[24:27], a[52:55], v[44:47]
    v_mfma_f32_16x16x32_bf16 v[48:51], v[28:31], a[48:51], v[48:51]
    v_mfma_f32_16x16x32_bf16 v[52:55], v[28:31], a[52:55], v[52:55]
    ds_read_b128 v[16:19], v5 offset:9216
    ds_read_b128 v[20:23], v5 offset:25600
    s_waitcnt lgkmcnt(4)
    v_mfma_f32_16x16x32_bf16 v[40:43], v[32:35], a[56:59], v[40:43]
    buffer_load_dwordx4 v2, s[4:7], s36 offen offset:2048 sc1 lds
    v_mfma_f32_16x16x32_bf16 v[44:47], v[32:35], a[60:63], v[44:47]
    v_mfma_f32_16x16x32_bf16 v[48:51], v[36:39], a[56:59], v[48:51]
    v_mfma_f32_16x16x32_bf16 v[52:55], v[36:39], a[60:63], v[52:55]
    ds_read_b128 v[24:27], v5 offset:10240
    ds_read_b128 v[28:31], v5 offset:26624
    s_waitcnt lgkmcnt(4)
    v_mfma_f32_16x16x32_bf16 v[40:43], v[8:11], a[64:67], v[40:43]
    buffer_load_dwordx4 v2, s[4:7], s36 offen offset:3072 sc1 lds
    s_add_u32 s45, s45, 0x10000
    v_mfma_f32_16x16x32_bf16 v[44:47], v[8:11], a[68:71], v[44:47]
    v_mfma_f32_16x16x32_bf16 v[48:51], v[12:15], a[64:67], v[48:51]
    v_mfma_f32_16x16x32_bf16 v[52:55], v[12:15], a[68:71], v[52:55]
    ds_read_b128 v[32:35], v5 offset:11264
    ds_read_b128 v[36:39], v5 offset:27648
    s_waitcnt lgkmcnt(4)
    v_mfma_f32_16x16x32_bf16 v[40:43], v[16:19], a[72:75], v[40:43]
    v_mfma_f32_16x16x32_bf16 v[44:47], v[16:19], a[76:79], v[44:47]
    v_mfma_f32_16x16x32_bf16 v[48:51], v[20:23], a[72:75], v[48:51]
    v_mfma_f32_16x16x32_bf16 v[52:55], v[20:23], a[76:79], v[52:55]
    ds_read_b128 v[8:11], v5 offset:12288
    ds_read_b128 v[12:15], v5 offset:28672
    s_waitcnt lgkmcnt(4)
    v_mfma_f32_16x16x32_bf16 v[40:43], v[24:27], a[80:83], v[40:43]
    v_mfma_f32_16x16x32_bf16 v[44:47], v[24:27], a[84:87], v[44:47]
    v_mfma_f32_16x16x32_bf16 v[48:51], v[28:31], a[80:83], v[48:51]
    v_mfma_f32_16x16x32_bf16 v[52:55], v[28:31], a[84:87], v[52:55]
    ds_read_b128 v[16:19], v5 offset:13312
    ds_read_b128 v[20:23], v5 offset:29696
    s_waitcnt lgkmcnt(4)
    v_mfma_f32_16x16x32_bf16 v[40:43], v[32:35], a[88:91], v[40:43]
    v_mfma_f32_16x16x32_bf16 v[44:47], v[32:35], a[92:95], v[44:47]
    v_mfma_f32_16x16x32_bf16 v[48:51], v[36:39], a[88:91], v[48:51]
    v_mfma_f32_16x16x32_bf16 v[52:55], v[36:39], a[92:95], v[52:55]
    ds_read_b128 v[24:27], v5 offset:14336
    ds_read_b128 v[28:31], v5 offset:30720
    s_waitcnt lgkmcnt(4)
    v_mfma_f32_16x16x32_bf16 v[40:43], v[8:11], a[96:99], v[40:43]
    v_mfma_f32_16x16x32_bf16 v[44:47], v[8:11], a[100:103], v[44:47]
    v_mfma_f32_16x16x32_bf16 v[48:51], v[12:15], a[96:99], v[48:51]
    v_mfma_f32_16x16x32_bf16 v[52:55], v[12:15], a[100:103], v[52:55]
    ds_read_b128 v[32:35], v5 offset:15360
    ds_read_b128 v[36:39], v5 offset:31744
    s_waitcnt lgkmcnt(4)
    v_mfma_f32_16x16x32_bf16 v[40:43], v[16:19], a[104:107], v[40:43]
    v_mfma_f32_16x16x32_bf16 v[44:47], v[16:19], a[108:111], v[44:47]
    v_mfma_f32_16x16x32_bf16 v[48:51], v[20:23], a[104:107], v[48:51]
    v_mfma_f32_16x16x32_bf16 v[52:55], v[20:23], a[108:111], v[52:55]
    s_waitcnt lgkmcnt(2)
    v_mfma_f32_16x16x32_bf16 v[40:43], v[24:27], a[112:115], v[40:43]
    v_mfma_f32_16x16x32_bf16 v[44:47], v[24:27], a[116:119], v[44:47]
    v_mfma_f32_16x16x32_bf16 v[48:51], v[28:31], a[112:115], v[48:51]
    v_mfma_f32_16x16x32_bf16 v[52:55], v[28:31], a[116:119], v[52:55]
    s_waitcnt lgkmcnt(0)
    v_mfma_f32_16x16x32_bf16 v[40:43], v[32:35], a[120:123], v[40:43]
    v_mfma_f32_16x16x32_bf16 v[44:47], v[32:35], a[124:127], v[44:47]
    v_mfma_f32_16x16x32_bf16 v[48:51], v[36:39], a[120:123], v[48:51]
    v_mfma_f32_16x16x32_bf16 v[52:55], v[36:39], a[124:127], v[52:55]
    v_cvt_pk_bf16_f32 v56, v40, v41
    v_cvt_pk_bf16_f32 v57, v42, v43
    s_nop 2
    v_cvt_pk_bf16_f32 v58, v48, v49
    v_cvt_pk_bf16_f32 v59, v50, v51
    v_cvt_pk_bf16_f32 v60, v44, v45
    v_cvt_pk_bf16_f32 v61, v46, v47
    v_cvt_pk_bf16_f32 v62, v52, v53
    v_cvt_pk_bf16_f32 v63, v54, v55
    buffer_store_dwordx4 v[56:59], v1, s[4:7], s46 offen sc1
    buffer_store_dwordx4 v[60:63], v1, s[4:7], s46 offen offset:1024 sc1
    s_add_u32 s46, s46, 0x80000
    s_add_u32 s44, s44, 1
    s_cmp_lt_u32 s44, 32
    s_cbranch_scc1 L_qkv_v
L_qkv_end:
    s_waitcnt vmcnt(0)
    s_barrier
    s_cmp_lg_u32 s28, 0
    s_cbranch_scc1 L_qf_36
    v_mov_b32 v4, 32
    s_mov_b64 exec, 1
    buffer_store_dword v4, v3, s[4:7], s47 offen sc1
    s_mov_b64 exec, -1
L_qf_36:
    s_waitcnt vmcnt(0)
    s_barrier
    s_cmp_lg_u32 s28, 0
    s_cbranch_scc1 L_arr_37
    v_mov_b32 v250, 1
    v_mov_b32 v251, 20
    s_mov_b64 exec, 1
    buffer_atomic_add v250, v251, s[8:11], 0 offen sc0
    s_mov_b64 exec, -1
    s_waitcnt vmcnt(0)
    v_readfirstlane_b32 s30, v250
    s_add_u32 s30, s30, 1
    s_and_b32 s57, s30, 0xffff
    s_cmp_lg_u32 s57, 192
    s_cbranch_scc1 L_ae_38
    v_mov_b32 v250, s30
    v_mov_b32 v251, 148
    s_mov_b64 exec, 1
    buffer_store_dword v250, v251, s[8:11], 0 offen sc1
    s_mov_b64 exec, -1
L_ae_38:
L_arr_37:
    s_cmp_ge_u32 s31, 160
    s_cbranch_scc1 L_att
    s_cmp_ge_u32 s31, 112
    s_cbranch_scc1 L_no_b1
    s_mov_b32 s39, s31
    s_mov_b32 s12, s80
    s_mov_b32 s13, s81
    s_mov_b32 s14, 0x700000
    s_mov_b32 s15, 0x20000
    s_mov_b32 s16, s82
    s_mov_b32 s17, s83
    s_mov_b32 s18, 0xe00
    s_mov_b32 s19, 0x20000
    s_mul_hi_u32 s41, s39, 0x924924a
    s_mul_i32 s40, s41, 28
    s_sub_u32 s40, s39, s40
    v_and_b32 v1, 15, v255
    v_lshrrev_b32 v2, 4, v255
    v_mul_u32_u24 v3, 28672, v2
    v_lshl_add_u32 v3, v1, 3, v3
    s_mul_i32 s36, s28, 1835008
    s_lshl_b32 s37, s40, 7
    s_add_u32 s36, s36, s37
    v_add_u32 v3, s36, v3
    v_lshlrev_b32 v4, 13, v2
    v_lshl_add_u32 v4, v1, 4, v4
    s_mul_i32 s36, s28, 524288
    s_lshl_b32 s37, s41, 11
    s_add_u32 s36, s36, s37
    s_add_u32 s36, s36, 0x200000
    v_add_u32 v4, s36, v4
    s_lshl_b32 s36, s40, 7
    v_lshlrev_b32 v5, 5, v2
    buffer_load_dwordx4 v[8:11], v5, s[16:19], s36 offen
    buffer_load_dwordx4 v[12:15], v5, s[16:19], s36 offen offset:16
    s_mov_b32 s36, 0x0
    buffer_load_dwordx2 v[16:17], v3, s[12:15], s36 offen
    s_mov_b32 s36, 0xe00
    buffer_load_dwordx2 v[18:19], v3, s[12:15], s36 offen
    s_mov_b32 s36, 0x1c00
    buffer_load_dwordx2 v[20:21], v3, s[12:15], s36 offen
    s_mov_b32 s36, 0x2a00
    buffer_load_dwordx2 v[22:23], v3, s[12:15], s36 offen
    s_mov_b32 s36, 0x3800
    buffer_load_dwordx2 v[24:25], v3, s[12:15], s36 offen
    s_mov_b32 s36, 0x4600
    buffer_load_dwordx2 v[26:27], v3, s[12:15], s36 offen
    s_mov_b32 s36, 0x5400
    buffer_load_dwordx2 v[28:29], v3, s[12:15], s36 offen
    s_mov_b32 s36, 0x6200
    buffer_load_dwordx2 v[30:31], v3, s[12:15], s36 offen
    s_mov_b32 s36, 0x0
    buffer_load_dwordx4 v[64:67], v4, s[4:7], s36 offen offset:0 sc1
    buffer_load_dwordx4 v[68:71], v4, s[4:7], s36 offen offset:256 sc1
    buffer_load_dwordx4 v[72:75], v4, s[4:7], s36 offen offset:512 sc1
    buffer_load_dwordx4 v[76:79], v4, s[4:7], s36 offen offset:768 sc1
    buffer_load_dwordx4 v[80:83], v4, s[4:7], s36 offen offset:1024 sc1
    buffer_load_dwordx4 v[84:87], v4, s[4:7], s36 offen offset:1280 sc1
    buffer_load_dwordx4 v[88:91], v4, s[4:7], s36 offen offset:1536 sc1
    buffer_load_dwordx4 v[92:95], v4, s[4:7], s36 offen offset:1792 sc1
    s_mov_b32 s36, 0x1c000
    buffer_load_dwordx2 v[32:33], v3, s[12:15], s36 offen
    s_mov_b32 s36, 0x1ce00
    buffer_load_dwordx2 v[34:35], v3, s[12:15], s36 offen
    s_mov_b32 s36, 0x1dc00
    buffer_load_dwordx2 v[36:37], v3, s[12:15], s36 offen
    s_mov_b32 s36, 0x1ea00
    buffer_load_dwordx2 v[38:39], v3, s[12:15], s36 offen
    s_mov_b32 s36, 0x1f800
    buffer_load_dwordx2 v[40:41], v3, s[12:15], s36 offen
    s_mov_b32 s36, 0x20600
    buffer_load_dwordx2 v[42:43], v3, s[12:15], s36 offen
    s_mov_b32 s36, 0x21400
    buffer_load_dwordx2 v[44:45], v3, s[12:15], s36 offen
    s_mov_b32 s36, 0x22200
    buffer_load_dwordx2 v[46:47], v3, s[12:15], s36 offen
    s_mov_b32 s36, 0x8000
    buffer_load_dwordx4 v[96:99], v4, s[4:7], s36 offen offset:0 sc1
    buffer_load_dwordx4 v[100:103], v4, s[4:7], s36 offen offset:256 sc1
    buffer_load_dwordx4 v[104:107], v4, s[4:7], s36 offen offset:512 sc1
    buffer_load_dwordx4 v[108:111], v4, s[4:7], s36 offen offset:768 sc1
    buffer_load_dwordx4 v[112:115], v4, s[4:7], s36 offen offset:1024 sc1
    buffer_load_dwordx4 v[116:119], v4, s[4:7], s36 offen offset:1280 sc1
    buffer_load_dwordx4 v[120:123], v4, s[4:7], s36 offen offset:1536 sc1
    buffer_load_dwordx4 v[124:127], v4, s[4:7], s36 offen offset:1792 sc1
    s_mov_b32 s36, 0x38000
    buffer_load_dwordx2 v[48:49], v3, s[12:15], s36 offen
    s_mov_b32 s36, 0x38e00
    buffer_load_dwordx2 v[50:51], v3, s[12:15], s36 offen
    s_mov_b32 s36, 0x39c00
    buffer_load_dwordx2 v[52:53], v3, s[12:15], s36 offen
    s_mov_b32 s36, 0x3aa00
    buffer_load_dwordx2 v[54:55], v3, s[12:15], s36 offen
    s_mov_b32 s36, 0x3b800
    buffer_load_dwordx2 v[56:57], v3, s[12:15], s36 offen
    s_mov_b32 s36, 0x3c600
    buffer_load_dwordx2 v[58:59], v3, s[12:15], s36 offen
    s_mov_b32 s36, 0x3d400
    buffer_load_dwordx2 v[60:61], v3, s[12:15], s36 offen
    s_mov_b32 s36, 0x3e200
    buffer_load_dwordx2 v[62:63], v3, s[12:15], s36 offen
    s_mov_b32 s36, 0x10000
    buffer_load_dwordx4 v[128:131], v4, s[4:7], s36 offen offset:0 sc1
    buffer_load_dwordx4 v[132:135], v4, s[4:7], s36 offen offset:256 sc1
    buffer_load_dwordx4 v[136:139], v4, s[4:7], s36 offen offset:512 sc1
    buffer_load_dwordx4 v[140:143], v4, s[4:7], s36 offen offset:768 sc1
    buffer_load_dwordx4 v[144:147], v4, s[4:7], s36 offen offset:1024 sc1
    buffer_load_dwordx4 v[148:151], v4, s[4:7], s36 offen offset:1280 sc1
    buffer_load_dwordx4 v[152:155], v4, s[4:7], s36 offen offset:1536 sc1
    buffer_load_dwordx4 v[156:159], v4, s[4:7], s36 offen offset:1792 sc1
    s_waitcnt vmcnt(40)
    v_perm_b32 v160, v18, v16, s60
    v_perm_b32 v161, v22, v20, s60
    v_perm_b32 v162, v26, v24, s60
    v_perm_b32 v163, v30, v28, s60
    v_perm_b32 v164, v18, v16, s61
    v_perm_b32 v165, v22, v20, s61
    v_perm_b32 v166, v26, v24, s61
    v_perm_b32 v167, v30, v28, s61
    v_perm_b32 v168, v19, v17, s60
    v_perm_b32 v169, v23, v21, s60
    v_perm_b32 v170, v27, v25, s60
    v_perm_b32 v171, v31, v29, s60
    v_perm_b32 v172, v19, v17, s61
    v_perm_b32 v173, v23, v21, s61
    v_perm_b32 v174, v27, v25, s61
    v_perm_b32 v175, v31, v29, s61
    s_waitcnt vmcnt(39)
    v_mfma_f32_16x16x32_bf16 a[0:3], v[160:163], v[64:67], 0
    v_mfma_f32_16x16x32_bf16 a[4:7], v[164:167], v[64:67], 0
    v_mfma_f32_16x16x32_bf16 a[8:11], v[168:171], v[64:67], 0
    v_mfma_f32_16x16x32_bf16 a[12:15], v[172:175], v[64:67], 0
    s_waitcnt vmcnt(38)
    v_mfma_f32_16x16x32_bf16 a[16:19], v[160:163], v[68:71], 0
    v_mfma_f32_16x16x32_bf16 a[20:23], v[164:167], v[68:71], 0
    v_mfma_f32_16x16x32_bf16 a[24:27], v[168:171], v[68:71], 0
    v_mfma_f32_16x16x32_bf16 a[28:31], v[172:175], v[68:71], 0
    s_waitcnt vmcnt(37)
    v_mfma_f32_16x16x32_bf16 a[32:35], v[160:163], v[72:75], 0
    v_mfma_f32_16x16x32_bf16 a[36:39], v[164:167], v[72:75], 0
    v_mfma_f32_16x16x32_bf16 a[40:43], v[168:171], v[72:75], 0
    v_mfma_f32_16x16x32_bf16 a[44:47], v[172:175], v[72:75], 0
    s_waitcnt vmcnt(36)
    v_mfma_f32_16x16x32_bf16 a[48:51], v[160:163], v[76:79], 0
    v_mfma_f32_16x16x32_bf16 a[52:55], v[164:167], v[76:79], 0
    v_mfma_f32_16x16x32_bf16 a[56:59], v[168:171], v[76:79], 0
    v_mfma_f32_16x16x32_bf16 a[60:63], v[172:175], v[76:79], 0
    s_waitcnt vmcnt(35)
    v_mfma_f32_16x16x32_bf16 a[64:67], v[160:163], v[80:83], 0
    v_mfma_f32_16x16x32_bf16 a[68:71], v[164:167], v[80:83], 0
    v_mfma_f32_16x16x32_bf16 a[72:75], v[168:171], v[80:83], 0
    v_mfma_f32_16x16x32_bf16 a[76:79], v[172:175], v[80:83], 0
    s_waitcnt vmcnt(34)
    v_mfma_f32_16x16x32_bf16 a[80:83], v[160:163], v[84:87], 0
    v_mfma_f32_16x16x32_bf16 a[84:87], v[164:167], v[84:87], 0
    v_mfma_f32_16x16x32_bf16 a[88:91], v[168:171], v[84:87], 0
    v_mfma_f32_16x16x32_bf16 a[92:95], v[172:175], v[84:87], 0
    s_waitcnt vmcnt(33)
    v_mfma_f32_16x16x32_bf16 a[96:99], v[160:163], v[88:91], 0
    v_mfma_f32_16x16x32_bf16 a[100:103], v[164:167], v[88:91], 0
    v_mfma_f32_16x16x32_bf16 a[104:107], v[168:171], v[88:91], 0
    v_mfma_f32_16x16x32_bf16 a[108:111], v[172:175], v[88:91], 0
    s_waitcnt vmcnt(32)
    v_mfma_f32_16x16x32_bf16 a[112:115], v[160:163], v[92:95], 0
    v_mfma_f32_16x16x32_bf16 a[116:119], v[164:167], v[92:95], 0
    v_mfma_f32_16x16x32_bf16 a[120:123], v[168:171], v[92:95], 0
    v_mfma_f32_16x16x32_bf16 a[124:127], v[172:175], v[92:95], 0
    s_mov_b32 s36, 0x54000
    buffer_load_dwordx2 v[16:17], v3, s[12:15], s36 offen
    s_mov_b32 s36, 0x54e00
    buffer_load_dwordx2 v[18:19], v3, s[12:15], s36 offen
    s_mov_b32 s36, 0x55c00
    buffer_load_dwordx2 v[20:21], v3, s[12:15], s36 offen
    s_mov_b32 s36, 0x56a00
    buffer_load_dwordx2 v[22:23], v3, s[12:15], s36 offen
    s_mov_b32 s36, 0x57800
    buffer_load_dwordx2 v[24:25], v3, s[12:15], s36 offen
    s_mov_b32 s36, 0x58600
    buffer_load_dwordx2 v[26:27], v3, s[12:15], s36 offen
    s_mov_b32 s36, 0x59400
    buffer_load_dwordx2 v[28:29], v3, s[12:15], s36 offen
    s_mov_b32 s36, 0x5a200
    buffer_load_dwordx2 v[30:31], v3, s[12:15], s36 offen
    s_mov_b32 s36, 0x18000
    buffer_load_dwordx4 v[64:67], v4, s[4:7], s36 offen offset:0 sc1
    buffer_load_dwordx4 v[68:71], v4, s[4:7], s36 offen offset:256 sc1
    buffer_load_dwordx4 v[72:75], v4, s[4:7], s36 offen offset:512 sc1
    buffer_load_dwordx4 v[76:79], v4, s[4:7], s36 offen offset:768 sc1
    buffer_load_dwordx4 v[80:83], v4, s[4:7], s36 offen offset:1024 sc1
    buffer_load_dwordx4 v[84:87], v4, s[4:7], s36 offen offset:1280 sc1
    buffer_load_dwordx4 v[88:91], v4, s[4:7], s36 offen offset:1536 sc1
    buffer_load_dwordx4 v[92:95], v4, s[4:7], s36 offen offset:1792 sc1
    s_waitcnt vmcnt(40)
    v_perm_b32 v160, v34, v32, s60
    v_perm_b32 v161, v38, v36, s60
    v_perm_b32 v162, v42, v40, s60
    v_perm_b32 v163, v46, v44, s60
    v_perm_b32 v164, v34, v32, s61
    v_perm_b32 v165, v38, v36, s61
    v_perm_b32 v166, v42, v40, s61
    v_perm_b32 v167, v46, v44, s61
    v_perm_b32 v168, v35, v33, s60
    v_perm_b32 v169, v39, v37, s60
    v_perm_b32 v170, v43, v41, s60
    v_perm_b32 v171, v47, v45, s60
    v_perm_b32 v172, v35, v33, s61
    v_perm_b32 v173, v39, v37, s61
    v_perm_b32 v174, v43, v41, s61
    v_perm_b32 v175, v47, v45, s61
    s_waitcnt vmcnt(39)
    v_mfma_f32_16x16x32_bf16 a[0:3], v[160:163], v[96:99], a[0:3]
    v_mfma_f32_16x16x32_bf16 a[4:7], v[164:167], v[96:99], a[4:7]
    v_mfma_f32_16x16x32_bf16 a[8:11], v[168:171], v[96:99], a[8:11]
    v_mfma_f32_16x16x32_bf16 a[12:15], v[172:175], v[96:99], a[12:15]
    s_waitcnt vmcnt(38)
    v_mfma_f32_16x16x32_bf16 a[16:19], v[160:163], v[100:103], a[16:19]
    v_mfma_f32_16x16x32_bf16 a[20:23], v[164:167], v[100:103], a[20:23]
    v_mfma_f32_16x16x32_bf16 a[24:27], v[168:171], v[100:103], a[24:27]
    v_mfma_f32_16x16x32_bf16 a[28:31], v[172:175], v[100:103], a[28:31]
    s_waitcnt vmcnt(37)
    v_mfma_f32_16x16x32_bf16 a[32:35], v[160:163], v[104:107], a[32:35]
    v_mfma_f32_16x16x32_bf16 a[36:39], v[164:167], v[104:107], a[36:39]
    v_mfma_f32_16x16x32_bf16 a[40:43], v[168:171], v[104:107], a[40:43]
    v_mfma_f32_16x16x32_bf16 a[44:47], v[172:175], v[104:107], a[44:47]
    s_waitcnt vmcnt(36)
    v_mfma_f32_16x16x32_bf16 a[48:51], v[160:163], v[108:111], a[48:51]
    v_mfma_f32_16x16x32_bf16 a[52:55], v[164:167], v[108:111], a[52:55]
    v_mfma_f32_16x16x32_bf16 a[56:59], v[168:171], v[108:111], a[56:59]
    v_mfma_f32_16x16x32_bf16 a[60:63], v[172:175], v[108:111], a[60:63]
    s_waitcnt vmcnt(35)
    v_mfma_f32_16x16x32_bf16 a[64:67], v[160:163], v[112:115], a[64:67]
    v_mfma_f32_16x16x32_bf16 a[68:71], v[164:167], v[112:115], a[68:71]
    v_mfma_f32_16x16x32_bf16 a[72:75], v[168:171], v[112:115], a[72:75]
    v_mfma_f32_16x16x32_bf16 a[76:79], v[172:175], v[112:115], a[76:79]
    s_waitcnt vmcnt(34)
    v_mfma_f32_16x16x32_bf16 a[80:83], v[160:163], v[116:119], a[80:83]
    v_mfma_f32_16x16x32_bf16 a[84:87], v[164:167], v[116:119], a[84:87]
    v_mfma_f32_16x16x32_bf16 a[88:91], v[168:171], v[116:119], a[88:91]
    v_mfma_f32_16x16x32_bf16 a[92:95], v[172:175], v[116:119], a[92:95]
    s_waitcnt vmcnt(33)
    v_mfma_f32_16x16x32_bf16 a[96:99], v[160:163], v[120:123], a[96:99]
    v_mfma_f32_16x16x32_bf16 a[100:103], v[164:167], v[120:123], a[100:103]
    v_mfma_f32_16x16x32_bf16 a[104:107], v[168:171], v[120:123], a[104:107]
    v_mfma_f32_16x16x32_bf16 a[108:111], v[172:175], v[120:123], a[108:111]
    s_waitcnt vmcnt(32)
    v_mfma_f32_16x16x32_bf16 a[112:115], v[160:163], v[124:127], a[112:115]
    v_mfma_f32_16x16x32_bf16 a[116:119], v[164:167], v[124:127], a[116:119]
    v_mfma_f32_16x16x32_bf16 a[120:123], v[168:171], v[124:127], a[120:123]
    v_mfma_f32_16x16x32_bf16 a[124:127], v[172:175], v[124:127], a[124:127]
    s_mov_b32 s36, 0x70000
    buffer_load_dwordx2 v[32:33], v3, s[12:15], s36 offen
    s_mov_b32 s36, 0x70e00
    buffer_load_dwordx2 v[34:35], v3, s[12:15], s36 offen
    s_mov_b32 s36, 0x71c00
    buffer_load_dwordx2 v[36:37], v3, s[12:15], s36 offen
    s_mov_b32 s36, 0x72a00
    buffer_load_dwordx2 v[38:39], v3, s[12:15], s36 offen
    s_mov_b32 s36, 0x73800
    buffer_load_dwordx2 v[40:41], v3, s[12:15], s36 offen
    s_mov_b32 s36, 0x74600
    buffer_load_dwordx2 v[42:43], v3, s[12:15], s36 offen
    s_mov_b32 s36, 0x75400
    buffer_load_dwordx2 v[44:45], v3, s[12:15], s36 offen
    s_mov_b32 s36, 0x76200
    buffer_load_dwordx2 v[46:47], v3, s[12:15], s36 offen
    s_mov_b32 s36, 0x20000
    buffer_load_dwordx4 v[96:99], v4, s[4:7], s36 offen offset:0 sc1
    buffer_load_dwordx4 v[100:103], v4, s[4:7], s36 offen offset:256 sc1
    buffer_load_dwordx4 v[104:107], v4, s[4:7], s36 offen offset:512 sc1
    buffer_load_dwordx4 v[108:111], v4, s[4:7], s36 offen offset:768 sc1
    buffer_load_dwordx4 v[112:115], v4, s[4:7], s36 offen offset:1024 sc1
    buffer_load_dwordx4 v[116:119], v4, s[4:7], s36 offen offset:1280 sc1
    buffer_load_dwordx4 v[120:123], v4, s[4:7], s36 offen offset:1536 sc1
    buffer_load_dwordx4 v[124:127], v4, s[4:7], s36 offen offset:1792 sc1
    s_waitcnt vmcnt(40)
    v_perm_b32 v160, v50, v48, s60
    v_perm_b32 v161, v54, v52, s60
    v_perm_b32 v162, v58, v56, s60
    v_perm_b32 v163, v62, v60, s60
    v_perm_b32 v164, v50, v48, s61
    v_perm_b32 v165, v54, v52, s61
    v_perm_b32 v166, v58, v56, s61
    v_perm_b32 v167, v62, v60, s61
    v_perm_b32 v168, v51, v49, s60
    v_perm_b32 v169, v55, v53, s60
    v_perm_b32 v170, v59, v57, s60
    v_perm_b32 v171, v63, v61, s60
    v_perm_b32 v172, v51, v49, s61
    v_perm_b32 v173, v55, v53, s61
    v_perm_b32 v174, v59, v57, s61
    v_perm_b32 v175, v63, v61, s61
    s_waitcnt vmcnt(39)
    v_mfma_f32_16x16x32_bf16 a[0:3], v[160:163], v[128:131], a[0:3]
    v_mfma_f32_16x16x32_bf16 a[4:7], v[164:167], v[128:131], a[4:7]
    v_mfma_f32_16x16x32_bf16 a[8:11], v[168:171], v[128:131], a[8:11]
    v_mfma_f32_16x16x32_bf16 a[12:15], v[172:175], v[128:131], a[12:15]
    s_waitcnt vmcnt(38)
    v_mfma_f32_16x16x32_bf16 a[16:19], v[160:163], v[132:135], a[16:19]
    v_mfma_f32_16x16x32_bf16 a[20:23], v[164:167], v[132:135], a[20:23]
    v_mfma_f32_16x16x32_bf16 a[24:27], v[168:171], v[132:135], a[24:27]
    v_mfma_f32_16x16x32_bf16 a[28:31], v[172:175], v[132:135], a[28:31]
    s_waitcnt vmcnt(37)
    v_mfma_f32_16x16x32_bf16 a[32:35], v[160:163], v[136:139], a[32:35]
    v_mfma_f32_16x16x32_bf16 a[36:39], v[164:167], v[136:139], a[36:39]
    v_mfma_f32_16x16x32_bf16 a[40:43], v[168:171], v[136:139], a[40:43]
    v_mfma_f32_16x16x32_bf16 a[44:47], v[172:175], v[136:139], a[44:47]
    s_waitcnt vmcnt(36)
    v_mfma_f32_16x16x32_bf16 a[48:51], v[160:163], v[140:143], a[48:51]
    v_mfma_f32_16x16x32_bf16 a[52:55], v[164:167], v[140:143], a[52:55]
    v_mfma_f32_16x16x32_bf16 a[56:59], v[168:171], v[140:143], a[56:59]
    v_mfma_f32_16x16x32_bf16 a[60:63], v[172:175], v[140:143], a[60:63]
    s_waitcnt vmcnt(35)
    v_mfma_f32_16x16x32_bf16 a[64:67], v[160:163], v[144:147], a[64:67]
    v_mfma_f32_16x16x32_bf16 a[68:71], v[164:167], v[144:147], a[68:71]
    v_mfma_f32_16x16x32_bf16 a[72:75], v[168:171], v[144:147], a[72:75]
    v_mfma_f32_16x16x32_bf16 a[76:79], v[172:175], v[144:147], a[76:79]
    s_waitcnt vmcnt(34)
    v_mfma_f32_16x16x32_bf16 a[80:83], v[160:163], v[148:151], a[80:83]
    v_mfma_f32_16x16x32_bf16 a[84:87], v[164:167], v[148:151], a[84:87]
    v_mfma_f32_16x16x32_bf16 a[88:91], v[168:171], v[148:151], a[88:91]
    v_mfma_f32_16x16x32_bf16 a[92:95], v[172:175], v[148:151], a[92:95]
    s_waitcnt vmcnt(33)
    v_mfma_f32_16x16x32_bf16 a[96:99], v[160:163], v[152:155], a[96:99]
    v_mfma_f32_16x16x32_bf16 a[100:103], v[164:167], v[152:155], a[100:103]
    v_mfma_f32_16x16x32_bf16 a[104:107], v[168:171], v[152:155], a[104:107]
    v_mfma_f32_16x16x32_bf16 a[108:111], v[172:175], v[152:155], a[108:111]
    s_waitcnt vmcnt(32)
    v_mfma_f32_16x16x32_bf16 a[112:115], v[160:163], v[156:159], a[112:115]
    v_mfma_f32_16x16x32_bf16 a[116:119], v[164:167], v[156:159], a[116:119]
    v_mfma_f32_16x16x32_bf16 a[120:123], v[168:171], v[156:159], a[120:123]
    v_mfma_f32_16x16x32_bf16 a[124:127], v[172:175], v[156:159], a[124:127]
    s_mov_b32 s36, 0x8c000
    buffer_load_dwordx2 v[48:49], v3, s[12:15], s36 offen
    s_mov_b32 s36, 0x8ce00
    buffer_load_dwordx2 v[50:51], v3, s[12:15], s36 offen
    s_mov_b32 s36, 0x8dc00
    buffer_load_dwordx2 v[52:53], v3, s[12:15], s36 offen
    s_mov_b32 s36, 0x8ea00
    buffer_load_dwordx2 v[54:55], v3, s[12:15], s36 offen
    s_mov_b32 s36, 0x8f800
    buffer_load_dwordx2 v[56:57], v3, s[12:15], s36 offen
    s_mov_b32 s36, 0x90600
    buffer_load_dwordx2 v[58:59], v3, s[12:15], s36 offen
    s_mov_b32 s36, 0x91400
    buffer_load_dwordx2 v[60:61], v3, s[12:15], s36 offen
    s_mov_b32 s36, 0x92200
    buffer_load_dwordx2 v[62:63], v3, s[12:15], s36 offen
    s_mov_b32 s36, 0x28000
    buffer_load_dwordx4 v[128:131], v4, s[4:7], s36 offen offset:0 sc1
    buffer_load_dwordx4 v[132:135], v4, s[4:7], s36 offen offset:256 sc1
    buffer_load_dwordx4 v[136:139], v4, s[4:7], s36 offen offset:512 sc1
    buffer_load_dwordx4 v[140:143], v4, s[4:7], s36 offen offset:768 sc1
    buffer_load_dwordx4 v[144:147], v4, s[4:7], s36 offen offset:1024 sc1
    buffer_load_dwordx4 v[148:151], v4, s[4:7], s36 offen offset:1280 sc1
    buffer_load_dwordx4 v[152:155], v4, s[4:7], s36 offen offset:1536 sc1
    buffer_load_dwordx4 v[156:159], v4, s[4:7], s36 offen offset:1792 sc1
    s_waitcnt vmcnt(40)
    v_perm_b32 v160, v18, v16, s60
    v_perm_b32 v161, v22, v20, s60
    v_perm_b32 v162, v26, v24, s60
    v_perm_b32 v163, v30, v28, s60
    v_perm_b32 v164, v18, v16, s61
    v_perm_b32 v165, v22, v20, s61
    v_perm_b32 v166, v26, v24, s61
    v_perm_b32 v167, v30, v28, s61
    v_perm_b32 v168, v19, v17, s60
    v_perm_b32 v169, v23, v21, s60
    v_perm_b32 v170, v27, v25, s60
    v_perm_b32 v171, v31, v29, s60
    v_perm_b32 v172, v19, v17, s61
    v_perm_b32 v173, v23, v21, s61
    v_perm_b32 v174, v27, v25, s61
    v_perm_b32 v175, v31, v29, s61
    s_waitcnt vmcnt(39)
    v_mfma_f32_16x16x32_bf16 a[0:3], v[160:163], v[64:67], a[0:3]
    v_mfma_f32_16x16x32_bf16 a[4:7], v[164:167], v[64:67], a[4:7]
    v_mfma_f32_16x16x32_bf16 a[8:11], v[168:171], v[64:67], a[8:11]
    v_mfma_f32_16x16x32_bf16 a[12:15], v[172:175], v[64:67], a[12:15]
    s_waitcnt vmcnt(38)
    v_mfma_f32_16x16x32_bf16 a[16:19], v[160:163], v[68:71], a[16:19]
    v_mfma_f32_16x16x32_bf16 a[20:23], v[164:167], v[68:71], a[20:23]
    v_mfma_f32_16x16x32_bf16 a[24:27], v[168:171], v[68:71], a[24:27]
    v_mfma_f32_16x16x32_bf16 a[28:31], v[172:175], v[68:71], a[28:31]
    s_waitcnt vmcnt(37)
    v_mfma_f32_16x16x32_bf16 a[32:35], v[160:163], v[72:75], a[32:35]
    v_mfma_f32_16x16x32_bf16 a[36:39], v[164:167], v[72:75], a[36:39]
    v_mfma_f32_16x16x32_bf16 a[40:43], v[168:171], v[72:75], a[40:43]
    v_mfma_f32_16x16x32_bf16 a[44:47], v[172:175], v[72:75], a[44:47]
    s_waitcnt vmcnt(36)
    v_mfma_f32_16x16x32_bf16 a[48:51], v[160:163], v[76:79], a[48:51]
    v_mfma_f32_16x16x32_bf16 a[52:55], v[164:167], v[76:79], a[52:55]
    v_mfma_f32_16x16x32_bf16 a[56:59], v[168:171], v[76:79], a[56:59]
    v_mfma_f32_16x16x32_bf16 a[60:63], v[172:175], v[76:79], a[60:63]
    s_waitcnt vmcnt(35)
    v_mfma_f32_16x16x32_bf16 a[64:67], v[160:163], v[80:83], a[64:67]
    v_mfma_f32_16x16x32_bf16 a[68:71], v[164:167], v[80:83], a[68:71]
    v_mfma_f32_16x16x32_bf16 a[72:75], v[168:171], v[80:83], a[72:75]
    v_mfma_f32_16x16x32_bf16 a[76:79], v[172:175], v[80:83], a[76:79]
    s_waitcnt vmcnt(34)
    v_mfma_f32_16x16x32_bf16 a[80:83], v[160:163], v[84:87], a[80:83]
    v_mfma_f32_16x16x32_bf16 a[84:87], v[164:167], v[84:87], a[84:87]
    v_mfma_f32_16x16x32_bf16 a[88:91], v[168:171], v[84:87], a[88:91]
    v_mfma_f32_16x16x32_bf16 a[92:95], v[172:175], v[84:87], a[92:95]
    s_waitcnt vmcnt(33)
    v_mfma_f32_16x16x32_bf16 a[96:99], v[160:163], v[88:91], a[96:99]
    v_mfma_f32_16x16x32_bf16 a[100:103], v[164:167], v[88:91], a[100:103]
    v_mfma_f32_16x16x32_bf16 a[104:107], v[168:171], v[88:91], a[104:107]
    v_mfma_f32_16x16x32_bf16 a[108:111], v[172:175], v[88:91], a[108:111]
    s_waitcnt vmcnt(32)
    v_mfma_f32_16x16x32_bf16 a[112:115], v[160:163], v[92:95], a[112:115]
    v_mfma_f32_16x16x32_bf16 a[116:119], v[164:167], v[92:95], a[116:119]
    v_mfma_f32_16x16x32_bf16 a[120:123], v[168:171], v[92:95], a[120:123]
    v_mfma_f32_16x16x32_bf16 a[124:127], v[172:175], v[92:95], a[124:127]
    s_mov_b32 s36, 0xa8000
    buffer_load_dwordx2 v[16:17], v3, s[12:15], s36 offen
    s_mov_b32 s36, 0xa8e00
    buffer_load_dwordx2 v[18:19], v3, s[12:15], s36 offen
    s_mov_b32 s36, 0xa9c00
    buffer_load_dwordx2 v[20:21], v3, s[12:15], s36 offen
    s_mov_b32 s36, 0xaaa00
    buffer_load_dwordx2 v[22:23], v3, s[12:15], s36 offen
    s_mov_b32 s36, 0xab800
    buffer_load_dwordx2 v[24:25], v3, s[12:15], s36 offen
    s_mov_b32 s36, 0xac600
    buffer_load_dwordx2 v[26:27], v3, s[12:15], s36 offen
    s_mov_b32 s36, 0xad400
    buffer_load_dwordx2 v[28:29], v3, s[12:15], s36 offen
    s_mov_b32 s36, 0xae200
    buffer_load_dwordx2 v[30:31], v3, s[12:15], s36 offen
    s_mov_b32 s36, 0x30000
    buffer_load_dwordx4 v[64:67], v4, s[4:7], s36 offen offset:0 sc1
    buffer_load_dwordx4 v[68:71], v4, s[4:7], s36 offen offset:256 sc1
    buffer_load_dwordx4 v[72:75], v4, s[4:7], s36 offen offset:512 sc1
    buffer_load_dwordx4 v[76:79], v4, s[4:7], s36 offen offset:768 sc1
    buffer_load_dwordx4 v[80:83], v4, s[4:7], s36 offen offset:1024 sc1
    buffer_load_dwordx4 v[84:87], v4, s[4:7], s36 offen offset:1280 sc1
    buffer_load_dwordx4 v[88:91], v4, s[4:7], s36 offen offset:1536 sc1
    buffer_load_dwordx4 v[92:95], v4, s[4:7], s36 offen offset:1792 sc1
    s_waitcnt vmcnt(40)
    v_perm_b32 v160, v34, v32, s60
    v_perm_b32 v161, v38, v36, s60
    v_perm_b32 v162, v42, v40, s60
    v_perm_b32 v163, v46, v44, s60
    v_perm_b32 v164, v34, v32, s61
    v_perm_b32 v165, v38, v36, s61
    v_perm_b32 v166, v42, v40, s61
    v_perm_b32 v167, v46, v44, s61
    v_perm_b32 v168, v35, v33, s60
    v_perm_b32 v169, v39, v37, s60
    v_perm_b32 v170, v43, v41, s60
    v_perm_b32 v171, v47, v45, s60
    v_perm_b32 v172, v35, v33, s61
    v_perm_b32 v173, v39, v37, s61
    v_perm_b32 v174, v43, v41, s61
    v_perm_b32 v175, v47, v45, s61
    s_waitcnt vmcnt(39)
    v_mfma_f32_16x16x32_bf16 a[0:3], v[160:163], v[96:99], a[0:3]
    v_mfma_f32_16x16x32_bf16 a[4:7], v[164:167], v[96:99], a[4:7]
    v_mfma_f32_16x16x32_bf16 a[8:11], v[168:171], v[96:99], a[8:11]
    v_mfma_f32_16x16x32_bf16 a[12:15], v[172:175], v[96:99], a[12:15]
    s_waitcnt vmcnt(38)
    v_mfma_f32_16x16x32_bf16 a[16:19], v[160:163], v[100:103], a[16:19]
    v_mfma_f32_16x16x32_bf16 a[20:23], v[164:167], v[100:103], a[20:23]
    v_mfma_f32_16x16x32_bf16 a[24:27], v[168:171], v[100:103], a[24:27]
    v_mfma_f32_16x16x32_bf16 a[28:31], v[172:175], v[100:103], a[28:31]
    s_waitcnt vmcnt(37)
    v_mfma_f32_16x16x32_bf16 a[32:35], v[160:163], v[104:107], a[32:35]
    v_mfma_f32_16x16x32_bf16 a[36:39], v[164:167], v[104:107], a[36:39]
    v_mfma_f32_16x16x32_bf16 a[40:43], v[168:171], v[104:107], a[40:43]
    v_mfma_f32_16x16x32_bf16 a[44:47], v[172:175], v[104:107], a[44:47]
    s_waitcnt vmcnt(36)
    v_mfma_f32_16x16x32_bf16 a[48:51], v[160:163], v[108:111], a[48:51]
    v_mfma_f32_16x16x32_bf16 a[52:55], v[164:167], v[108:111], a[52:55]
    v_mfma_f32_16x16x32_bf16 a[56:59], v[168:171], v[108:111], a[56:59]
    v_mfma_f32_16x16x32_bf16 a[60:63], v[172:175], v[108:111], a[60:63]
    s_waitcnt vmcnt(35)
    v_mfma_f32_16x16x32_bf16 a[64:67], v[160:163], v[112:115], a[64:67]
    v_mfma_f32_16x16x32_bf16 a[68:71], v[164:167], v[112:115], a[68:71]
    v_mfma_f32_16x16x32_bf16 a[72:75], v[168:171], v[112:115], a[72:75]
    v_mfma_f32_16x16x32_bf16 a[76:79], v[172:175], v[112:115], a[76:79]
    s_waitcnt vmcnt(34)
    v_mfma_f32_16x16x32_bf16 a[80:83], v[160:163], v[116:119], a[80:83]
    v_mfma_f32_16x16x32_bf16 a[84:87], v[164:167], v[116:119], a[84:87]
    v_mfma_f32_16x16x32_bf16 a[88:91], v[168:171], v[116:119], a[88:91]
    v_mfma_f32_16x16x32_bf16 a[92:95], v[172:175], v[116:119], a[92:95]
    s_waitcnt vmcnt(33)
    v_mfma_f32_16x16x32_bf16 a[96:99], v[160:163], v[120:123], a[96:99]
    v_mfma_f32_16x16x32_bf16 a[100:103], v[164:167], v[120:123], a[100:103]
    v_mfma_f32_16x16x32_bf16 a[104:107], v[168:171], v[120:123], a[104:107]
    v_mfma_f32_16x16x32_bf16 a[108:111], v[172:175], v[120:123], a[108:111]
    s_waitcnt vmcnt(32)
    v_mfma_f32_16x16x32_bf16 a[112:115], v[160:163], v[124:127], a[112:115]
    v_mfma_f32_16x16x32_bf16 a[116:119], v[164:167], v[124:127], a[116:119]
    v_mfma_f32_16x16x32_bf16 a[120:123], v[168:171], v[124:127], a[120:123]
    v_mfma_f32_16x16x32_bf16 a[124:127], v[172:175], v[124:127], a[124:127]
    s_mov_b32 s36, 0xc4000
    buffer_load_dwordx2 v[32:33], v3, s[12:15], s36 offen
    s_mov_b32 s36, 0xc4e00
    buffer_load_dwordx2 v[34:35], v3, s[12:15], s36 offen
    s_mov_b32 s36, 0xc5c00
    buffer_load_dwordx2 v[36:37], v3, s[12:15], s36 offen
    s_mov_b32 s36, 0xc6a00
    buffer_load_dwordx2 v[38:39], v3, s[12:15], s36 offen
    s_mov_b32 s36, 0xc7800
    buffer_load_dwordx2 v[40:41], v3, s[12:15], s36 offen
    s_mov_b32 s36, 0xc8600
    buffer_load_dwordx2 v[42:43], v3, s[12:15], s36 offen
    s_mov_b32 s36, 0xc9400
    buffer_load_dwordx2 v[44:45], v3, s[12:15], s36 offen
    s_mov_b32 s36, 0xca200
    buffer_load_dwordx2 v[46:47], v3, s[12:15], s36 offen
    s_mov_b32 s36, 0x38000
    buffer_load_dwordx4 v[96:99], v4, s[4:7], s36 offen offset:0 sc1
    buffer_load_dwordx4 v[100:103], v4, s[4:7], s36 offen offset:256 sc1
    buffer_load_dwordx4 v[104:107], v4, s[4:7], s36 offen offset:512 sc1
    buffer_load_dwordx4 v[108:111], v4, s[4:7], s36 offen offset:768 sc1
    buffer_load_dwordx4 v[112:115], v4, s[4:7], s36 offen offset:1024 sc1
    buffer_load_dwordx4 v[116:119], v4, s[4:7], s36 offen offset:1280 sc1
    buffer_load_dwordx4 v[120:123], v4, s[4:7], s36 offen offset:1536 sc1
    buffer_load_dwordx4 v[124:127], v4, s[4:7], s36 offen offset:1792 sc1
    s_waitcnt vmcnt(40)
    v_perm_b32 v160, v50, v48, s60
    v_perm_b32 v161, v54, v52, s60
    v_perm_b32 v162, v58, v56, s60
    v_perm_b32 v163, v62, v60, s60
    v_perm_b32 v164, v50, v48, s61
    v_perm_b32 v165, v54, v52, s61
    v_perm_b32 v166, v58, v56, s61
    v_perm_b32 v167, v62, v60, s61
    v_perm_b32 v168, v51, v49, s60
    v_perm_b32 v169, v55, v53, s60
    v_perm_b32 v170, v59, v57, s60
    v_perm_b32 v171, v63, v61, s60
    v_perm_b32 v172, v51, v49, s61
    v_perm_b32 v173, v55, v53, s61
    v_perm_b32 v174, v59, v57, s61
    v_perm_b32 v175, v63, v61, s61
    s_waitcnt vmcnt(39)
    v_mfma_f32_16x16x32_bf16 a[0:3], v[160:163], v[128:131], a[0:3]
    v_mfma_f32_16x16x32_bf16 a[4:7], v[164:167], v[128:131], a[4:7]
    v_mfma_f32_16x16x32_bf16 a[8:11], v[168:171], v[128:131], a[8:11]
    v_mfma_f32_16x16x32_bf16 a[12:15], v[172:175], v[128:131], a[12:15]
    s_waitcnt vmcnt(38)
    v_mfma_f32_16x16x32_bf16 a[16:19], v[160:163], v[132:135], a[16:19]
    v_mfma_f32_16x16x32_bf16 a[20:23], v[164:167], v[132:135], a[20:23]
    v_mfma_f32_16x16x32_bf16 a[24:27], v[168:171], v[132:135], a[24:27]
    v_mfma_f32_16x16x32_bf16 a[28:31], v[172:175], v[132:135], a[28:31]
    s_waitcnt vmcnt(37)
    v_mfma_f32_16x16x32_bf16 a[32:35], v[160:163], v[136:139], a[32:35]
    v_mfma_f32_16x16x32_bf16 a[36:39], v[164:167], v[136:139], a[36:39]
    v_mfma_f32_16x16x32_bf16 a[40:43], v[168:171], v[136:139], a[40:43]
    v_mfma_f32_16x16x32_bf16 a[44:47], v[172:175], v[136:139], a[44:47]
    s_waitcnt vmcnt(36)
    v_mfma_f32_16x16x32_bf16 a[48:51], v[160:163], v[140:143], a[48:51]
    v_mfma_f32_16x16x32_bf16 a[52:55], v[164:167], v[140:143], a[52:55]
    v_mfma_f32_16x16x32_bf16 a[56:59], v[168:171], v[140:143], a[56:59]
    v_mfma_f32_16x16x32_bf16 a[60:63], v[172:175], v[140:143], a[60:63]
    s_waitcnt vmcnt(35)
    v_mfma_f32_16x16x32_bf16 a[64:67], v[160:163], v[144:147], a[64:67]
    v_mfma_f32_16x16x32_bf16 a[68:71], v[164:167], v[144:147], a[68:71]
    v_mfma_f32_16x16x32_bf16 a[72:75], v[168:171], v[144:147], a[72:75]
    v_mfma_f32_16x16x32_bf16 a[76:79], v[172:175], v[144:147], a[76:79]
    s_waitcnt vmcnt(34)
    v_mfma_f32_16x16x32_bf16 a[80:83], v[160:163], v[148:151], a[80:83]
    v_mfma_f32_16x16x32_bf16 a[84:87], v[164:167], v[148:151], a[84:87]
    v_mfma_f32_16x16x32_bf16 a[88:91], v[168:171], v[148:151], a[88:91]
    v_mfma_f32_16x16x32_bf16 a[92:95], v[172:175], v[148:151], a[92:95]
    s_waitcnt vmcnt(33)
    v_mfma_f32_16x16x32_bf16 a[96:99], v[160:163], v[152:155], a[96:99]
    v_mfma_f32_16x16x32_bf16 a[100:103], v[164:167], v[152:155], a[100:103]
    v_mfma_f32_16x16x32_bf16 a[104:107], v[168:171], v[152:155], a[104:107]
    v_mfma_f32_16x16x32_bf16 a[108:111], v[172:175], v[152:155], a[108:111]
    s_waitcnt vmcnt(32)
    v_mfma_f32_16x16x32_bf16 a[112:115], v[160:163], v[156:159], a[112:115]
    v_mfma_f32_16x16x32_bf16 a[116:119], v[164:167], v[156:159], a[116:119]
    v_mfma_f32_16x16x32_bf16 a[120:123], v[168:171], v[156:159], a[120:123]
    v_mfma_f32_16x16x32_bf16 a[124:127], v[172:175], v[156:159], a[124:127]
    s_mov_b32 s36, 0xe0000
    buffer_load_dwordx2 v[48:49], v3, s[12:15], s36 offen
    s_mov_b32 s36, 0xe0e00
    buffer_load_dwordx2 v[50:51], v3, s[12:15], s36 offen
    s_mov_b32 s36, 0xe1c00
    buffer_load_dwordx2 v[52:53], v3, s[12:15], s36 offen
    s_mov_b32 s36, 0xe2a00
    buffer_load_dwordx2 v[54:55], v3, s[12:15], s36 offen
    s_mov_b32 s36, 0xe3800
    buffer_load_dwordx2 v[56:57], v3, s[12:15], s36 offen
    s_mov_b32 s36, 0xe4600
    buffer_load_dwordx2 v[58:59], v3, s[12:15], s36 offen
    s_mov_b32 s36, 0xe5400
    buffer_load_dwordx2 v[60:61], v3, s[12:15], s36 offen
    s_mov_b32 s36, 0xe6200
    buffer_load_dwordx2 v[62:63], v3, s[12:15], s36 offen
    s_mov_b32 s36, 0x40000
    buffer_load_dwordx4 v[128:131], v4, s[4:7], s36 offen offset:0 sc1
    buffer_load_dwordx4 v[132:135], v4, s[4:7], s36 offen offset:256 sc1
    buffer_load_dwordx4 v[136:139], v4, s[4:7], s36 offen offset:512 sc1
    buffer_load_dwordx4 v[140:143], v4, s[4:7], s36 offen offset:768 sc1
    buffer_load_dwordx4 v[144:147], v4, s[4:7], s36 offen offset:1024 sc1
    buffer_load_dwordx4 v[148:151], v4, s[4:7], s36 offen offset:1280 sc1
    buffer_load_dwordx4 v[152:155], v4, s[4:7], s36 offen offset:1536 sc1
    buffer_load_dwordx4 v[156:159], v4, s[4:7], s36 offen offset:1792 sc1
    s_waitcnt vmcnt(40)
    v_perm_b32 v160, v18, v16, s60
    v_perm_b32 v161, v22, v20, s60
    v_perm_b32 v162, v26, v24, s60
    v_perm_b32 v163, v30, v28, s60
    v_perm_b32 v164, v18, v16, s61
    v_perm_b32 v165, v22, v20, s61
    v_perm_b32 v166, v26, v24, s61
    v_perm_b32 v167, v30, v28, s61
    v_perm_b32 v168, v19, v17, s60
    v_perm_b32 v169, v23, v21, s60
    v_perm_b32 v170, v27, v25, s60
    v_perm_b32 v171, v31, v29, s60
    v_perm_b32 v172, v19, v17, s61
    v_perm_b32 v173, v23, v21, s61
    v_perm_b32 v174, v27, v25, s61
    v_perm_b32 v175, v31, v29, s61
    s_waitcnt vmcnt(39)
    v_mfma_f32_16x16x32_bf16 a[0:3], v[160:163], v[64:67], a[0:3]
    v_mfma_f32_16x16x32_bf16 a[4:7], v[164:167], v[64:67], a[4:7]
    v_mfma_f32_16x16x32_bf16 a[8:11], v[168:171], v[64:67], a[8:11]
    v_mfma_f32_16x16x32_bf16 a[12:15], v[172:175], v[64:67], a[12:15]
    s_waitcnt vmcnt(38)
    v_mfma_f32_16x16x32_bf16 a[16:19], v[160:163], v[68:71], a[16:19]
    v_mfma_f32_16x16x32_bf16 a[20:23], v[164:167], v[68:71], a[20:23]
    v_mfma_f32_16x16x32_bf16 a[24:27], v[168:171], v[68:71], a[24:27]
    v_mfma_f32_16x16x32_bf16 a[28:31], v[172:175], v[68:71], a[28:31]
    s_waitcnt vmcnt(37)
    v_mfma_f32_16x16x32_bf16 a[32:35], v[160:163], v[72:75], a[32:35]
    v_mfma_f32_16x16x32_bf16 a[36:39], v[164:167], v[72:75], a[36:39]
    v_mfma_f32_16x16x32_bf16 a[40:43], v[168:171], v[72:75], a[40:43]
    v_mfma_f32_16x16x32_bf16 a[44:47], v[172:175], v[72:75], a[44:47]
    s_waitcnt vmcnt(36)
    v_mfma_f32_16x16x32_bf16 a[48:51], v[160:163], v[76:79], a[48:51]
    v_mfma_f32_16x16x32_bf16 a[52:55], v[164:167], v[76:79], a[52:55]
    v_mfma_f32_16x16x32_bf16 a[56:59], v[168:171], v[76:79], a[56:59]
    v_mfma_f32_16x16x32_bf16 a[60:63], v[172:175], v[76:79], a[60:63]
    s_waitcnt vmcnt(35)
    v_mfma_f32_16x16x32_bf16 a[64:67], v[160:163], v[80:83], a[64:67]
    v_mfma_f32_16x16x32_bf16 a[68:71], v[164:167], v[80:83], a[68:71]
    v_mfma_f32_16x16x32_bf16 a[72:75], v[168:171], v[80:83], a[72:75]
    v_mfma_f32_16x16x32_bf16 a[76:79], v[172:175], v[80:83], a[76:79]
    s_waitcnt vmcnt(34)
    v_mfma_f32_16x16x32_bf16 a[80:83], v[160:163], v[84:87], a[80:83]
    v_mfma_f32_16x16x32_bf16 a[84:87], v[164:167], v[84:87], a[84:87]
    v_mfma_f32_16x16x32_bf16 a[88:91], v[168:171], v[84:87], a[88:91]
    v_mfma_f32_16x16x32_bf16 a[92:95], v[172:175], v[84:87], a[92:95]
    s_waitcnt vmcnt(33)
    v_mfma_f32_16x16x32_bf16 a[96:99], v[160:163], v[88:91], a[96:99]
    v_mfma_f32_16x16x32_bf16 a[100:103], v[164:167], v[88:91], a[100:103]
    v_mfma_f32_16x16x32_bf16 a[104:107], v[168:171], v[88:91], a[104:107]
    v_mfma_f32_16x16x32_bf16 a[108:111], v[172:175], v[88:91], a[108:111]
    s_waitcnt vmcnt(32)
    v_mfma_f32_16x16x32_bf16 a[112:115], v[160:163], v[92:95], a[112:115]
    v_mfma_f32_16x16x32_bf16 a[116:119], v[164:167], v[92:95], a[116:119]
    v_mfma_f32_16x16x32_bf16 a[120:123], v[168:171], v[92:95], a[120:123]
    v_mfma_f32_16x16x32_bf16 a[124:127], v[172:175], v[92:95], a[124:127]
    s_mov_b32 s36, 0xfc000
    buffer_load_dwordx2 v[16:17], v3, s[12:15], s36 offen
    s_mov_b32 s36, 0xfce00
    buffer_load_dwordx2 v[18:19], v3, s[12:15], s36 offen
    s_mov_b32 s36, 0xfdc00
    buffer_load_dwordx2 v[20:21], v3, s[12:15], s36 offen
    s_mov_b32 s36, 0xfea00
    buffer_load_dwordx2 v[22:23], v3, s[12:15], s36 offen
    s_mov_b32 s36, 0xff800
    buffer_load_dwordx2 v[24:25], v3, s[12:15], s36 offen
    s_mov_b32 s36, 0x100600
    buffer_load_dwordx2 v[26:27], v3, s[12:15], s36 offen
    s_mov_b32 s36, 0x101400
    buffer_load_dwordx2 v[28:29], v3, s[12:15], s36 offen
    s_mov_b32 s36, 0x102200
    buffer_load_dwordx2 v[30:31], v3, s[12:15], s36 offen
    s_mov_b32 s36, 0x48000
    buffer_load_dwordx4 v[64:67], v4, s[4:7], s36 offen offset:0 sc1
    buffer_load_dwordx4 v[68:71], v4, s[4:7], s36 offen offset:256 sc1
    buffer_load_dwordx4 v[72:75], v4, s[4:7], s36 offen offset:512 sc1
    buffer_load_dwordx4 v[76:79], v4, s[4:7], s36 offen offset:768 sc1
    buffer_load_dwordx4 v[80:83], v4, s[4:7], s36 offen offset:1024 sc1
    buffer_load_dwordx4 v[84:87], v4, s[4:7], s36 offen offset:1280 sc1
    buffer_load_dwordx4 v[88:91], v4, s[4:7], s36 offen offset:1536 sc1
    buffer_load_dwordx4 v[92:95], v4, s[4:7], s36 offen offset:1792 sc1
    s_waitcnt vmcnt(40)
    v_perm_b32 v160, v34, v32, s60
    v_perm_b32 v161, v38, v36, s60
    v_perm_b32 v162, v42, v40, s60
    v_perm_b32 v163, v46, v44, s60
    v_perm_b32 v164, v34, v32, s61
    v_perm_b32 v165, v38, v36, s61
    v_perm_b32 v166, v42, v40, s61
    v_perm_b32 v167, v46, v44, s61
    v_perm_b32 v168, v35, v33, s60
    v_perm_b32 v169, v39, v37, s60
    v_perm_b32 v170, v43, v41, s60
    v_perm_b32 v171, v47, v45, s60
    v_perm_b32 v172, v35, v33, s61
    v_perm_b32 v173, v39, v37, s61
    v_perm_b32 v174, v43, v41, s61
    v_perm_b32 v175, v47, v45, s61
    s_waitcnt vmcnt(39)
    v_mfma_f32_16x16x32_bf16 a[0:3], v[160:163], v[96:99], a[0:3]
    v_mfma_f32_16x16x32_bf16 a[4:7], v[164:167], v[96:99], a[4:7]
    v_mfma_f32_16x16x32_bf16 a[8:11], v[168:171], v[96:99], a[8:11]
    v_mfma_f32_16x16x32_bf16 a[12:15], v[172:175], v[96:99], a[12:15]
    s_waitcnt vmcnt(38)
    v_mfma_f32_16x16x32_bf16 a[16:19], v[160:163], v[100:103], a[16:19]
    v_mfma_f32_16x16x32_bf16 a[20:23], v[164:167], v[100:103], a[20:23]
    v_mfma_f32_16x16x32_bf16 a[24:27], v[168:171], v[100:103], a[24:27]
    v_mfma_f32_16x16x32_bf16 a[28:31], v[172:175], v[100:103], a[28:31]
    s_waitcnt vmcnt(37)
    v_mfma_f32_16x16x32_bf16 a[32:35], v[160:163], v[104:107], a[32:35]
    v_mfma_f32_16x16x32_bf16 a[36:39], v[164:167], v[104:107], a[36:39]
    v_mfma_f32_16x16x32_bf16 a[40:43], v[168:171], v[104:107], a[40:43]
    v_mfma_f32_16x16x32_bf16 a[44:47], v[172:175], v[104:107], a[44:47]
    s_waitcnt vmcnt(36)
    v_mfma_f32_16x16x32_bf16 a[48:51], v[160:163], v[108:111], a[48:51]
    v_mfma_f32_16x16x32_bf16 a[52:55], v[164:167], v[108:111], a[52:55]
    v_mfma_f32_16x16x32_bf16 a[56:59], v[168:171], v[108:111], a[56:59]
    v_mfma_f32_16x16x32_bf16 a[60:63], v[172:175], v[108:111], a[60:63]
    s_waitcnt vmcnt(35)
    v_mfma_f32_16x16x32_bf16 a[64:67], v[160:163], v[112:115], a[64:67]
    v_mfma_f32_16x16x32_bf16 a[68:71], v[164:167], v[112:115], a[68:71]
    v_mfma_f32_16x16x32_bf16 a[72:75], v[168:171], v[112:115], a[72:75]
    v_mfma_f32_16x16x32_bf16 a[76:79], v[172:175], v[112:115], a[76:79]
    s_waitcnt vmcnt(34)
    v_mfma_f32_16x16x32_bf16 a[80:83], v[160:163], v[116:119], a[80:83]
    v_mfma_f32_16x16x32_bf16 a[84:87], v[164:167], v[116:119], a[84:87]
    v_mfma_f32_16x16x32_bf16 a[88:91], v[168:171], v[116:119], a[88:91]
    v_mfma_f32_16x16x32_bf16 a[92:95], v[172:175], v[116:119], a[92:95]
    s_waitcnt vmcnt(33)
    v_mfma_f32_16x16x32_bf16 a[96:99], v[160:163], v[120:123], a[96:99]
    v_mfma_f32_16x16x32_bf16 a[100:103], v[164:167], v[120:123], a[100:103]
    v_mfma_f32_16x16x32_bf16 a[104:107], v[168:171], v[120:123], a[104:107]
    v_mfma_f32_16x16x32_bf16 a[108:111], v[172:175], v[120:123], a[108:111]
    s_waitcnt vmcnt(32)
    v_mfma_f32_16x16x32_bf16 a[112:115], v[160:163], v[124:127], a[112:115]
    v_mfma_f32_16x16x32_bf16 a[116:119], v[164:167], v[124:127], a[116:119]
    v_mfma_f32_16x16x32_bf16 a[120:123], v[168:171], v[124:127], a[120:123]
    v_mfma_f32_16x16x32_bf16 a[124:127], v[172:175], v[124:127], a[124:127]
    s_mov_b32 s36, 0x118000
    buffer_load_dwordx2 v[32:33], v3, s[12:15], s36 offen
    s_mov_b32 s36, 0x118e00
    buffer_load_dwordx2 v[34:35], v3, s[12:15], s36 offen
    s_mov_b32 s36, 0x119c00
    buffer_load_dwordx2 v[36:37], v3, s[12:15], s36 offen
    s_mov_b32 s36, 0x11aa00
    buffer_load_dwordx2 v[38:39], v3, s[12:15], s36 offen
    s_mov_b32 s36, 0x11b800
    buffer_load_dwordx2 v[40:41], v3, s[12:15], s36 offen
    s_mov_b32 s36, 0x11c600
    buffer_load_dwordx2 v[42:43], v3, s[12:15], s36 offen
    s_mov_b32 s36, 0x11d400
    buffer_load_dwordx2 v[44:45], v3, s[12:15], s36 offen
    s_mov_b32 s36, 0x11e200
    buffer_load_dwordx2 v[46:47], v3, s[12:15], s36 offen
    s_mov_b32 s36, 0x50000
    buffer_load_dwordx4 v[96:99], v4, s[4:7], s36 offen offset:0 sc1
    buffer_load_dwordx4 v[100:103], v4, s[4:7], s36 offen offset:256 sc1
    buffer_load_dwordx4 v[104:107], v4, s[4:7], s36 offen offset:512 sc1
    buffer_load_dwordx4 v[108:111], v4, s[4:7], s36 offen offset:768 sc1
    buffer_load_dwordx4 v[112:115], v4, s[4:7], s36 offen offset:1024 sc1
    buffer_load_dwordx4 v[116:119], v4, s[4:7], s36 offen offset:1280 sc1
    buffer_load_dwordx4 v[120:123], v4, s[4:7], s36 offen offset:1536 sc1
    buffer_load_dwordx4 v[124:127], v4, s[4:7], s36 offen offset:1792 sc1
    s_waitcnt vmcnt(40)
    v_perm_b32 v160, v50, v48, s60
    v_perm_b32 v161, v54, v52, s60
    v_perm_b32 v162, v58, v56, s60
    v_perm_b32 v163, v62, v60, s60
    v_perm_b32 v164, v50, v48, s61
    v_perm_b32 v165, v54, v52, s61
    v_perm_b32 v166, v58, v56, s61
    v_perm_b32 v167, v62, v60, s61
    v_perm_b32 v168, v51, v49, s60
    v_perm_b32 v169, v55, v53, s60
    v_perm_b32 v170, v59, v57, s60
    v_perm_b32 v171, v63, v61, s60
    v_perm_b32 v172, v51, v49, s61
    v_perm_b32 v173, v55, v53, s61
    v_perm_b32 v174, v59, v57, s61
    v_perm_b32 v175, v63, v61, s61
    s_waitcnt vmcnt(39)
    v_mfma_f32_16x16x32_bf16 a[0:3], v[160:163], v[128:131], a[0:3]
    v_mfma_f32_16x16x32_bf16 a[4:7], v[164:167], v[128:131], a[4:7]
    v_mfma_f32_16x16x32_bf16 a[8:11], v[168:171], v[128:131], a[8:11]
    v_mfma_f32_16x16x32_bf16 a[12:15], v[172:175], v[128:131], a[12:15]
    s_waitcnt vmcnt(38)
    v_mfma_f32_16x16x32_bf16 a[16:19], v[160:163], v[132:135], a[16:19]
    v_mfma_f32_16x16x32_bf16 a[20:23], v[164:167], v[132:135], a[20:23]
    v_mfma_f32_16x16x32_bf16 a[24:27], v[168:171], v[132:135], a[24:27]
    v_mfma_f32_16x16x32_bf16 a[28:31], v[172:175], v[132:135], a[28:31]
    s_waitcnt vmcnt(37)
    v_mfma_f32_16x16x32_bf16 a[32:35], v[160:163], v[136:139], a[32:35]
    v_mfma_f32_16x16x32_bf16 a[36:39], v[164:167], v[136:139], a[36:39]
    v_mfma_f32_16x16x32_bf16 a[40:43], v[168:171], v[136:139], a[40:43]
    v_mfma_f32_16x16x32_bf16 a[44:47], v[172:175], v[136:139], a[44:47]
    s_waitcnt vmcnt(36)
    v_mfma_f32_16x16x32_bf16 a[48:51], v[160:163], v[140:143], a[48:51]
    v_mfma_f32_16x16x32_bf16 a[52:55], v[164:167], v[140:143], a[52:55]
    v_mfma_f32_16x16x32_bf16 a[56:59], v[168:171], v[140:143], a[56:59]
    v_mfma_f32_16x16x32_bf16 a[60:63], v[172:175], v[140:143], a[60:63]
    s_waitcnt vmcnt(35)
    v_mfma_f32_16x16x32_bf16 a[64:67], v[160:163], v[144:147], a[64:67]
    v_mfma_f32_16x16x32_bf16 a[68:71], v[164:167], v[144:147], a[68:71]
    v_mfma_f32_16x16x32_bf16 a[72:75], v[168:171], v[144:147], a[72:75]
    v_mfma_f32_16x16x32_bf16 a[76:79], v[172:175], v[144:147], a[76:79]
    s_waitcnt vmcnt(34)
    v_mfma_f32_16x16x32_bf16 a[80:83], v[160:163], v[148:151], a[80:83]
    v_mfma_f32_16x16x32_bf16 a[84:87], v[164:167], v[148:151], a[84:87]
    v_mfma_f32_16x16x32_bf16 a[88:91], v[168:171], v[148:151], a[88:91]
    v_mfma_f32_16x16x32_bf16 a[92:95], v[172:175], v[148:151], a[92:95]
    s_waitcnt vmcnt(33)
    v_mfma_f32_16x16x32_bf16 a[96:99], v[160:163], v[152:155], a[96:99]
    v_mfma_f32_16x16x32_bf16 a[100:103], v[164:167], v[152:155], a[100:103]
    v_mfma_f32_16x16x32_bf16 a[104:107], v[168:171], v[152:155], a[104:107]
    v_mfma_f32_16x16x32_bf16 a[108:111], v[172:175], v[152:155], a[108:111]
    s_waitcnt vmcnt(32)
    v_mfma_f32_16x16x32_bf16 a[112:115], v[160:163], v[156:159], a[112:115]
    v_mfma_f32_16x16x32_bf16 a[116:119], v[164:167], v[156:159], a[116:119]
    v_mfma_f32_16x16x32_bf16 a[120:123], v[168:171], v[156:159], a[120:123]
    v_mfma_f32_16x16x32_bf16 a[124:127], v[172:175], v[156:159], a[124:127]
    s_mov_b32 s36, 0x134000
    buffer_load_dwordx2 v[48:49], v3, s[12:15], s36 offen
    s_mov_b32 s36, 0x134e00
    buffer_load_dwordx2 v[50:51], v3, s[12:15], s36 offen
    s_mov_b32 s36, 0x135c00
    buffer_load_dwordx2 v[52:53], v3, s[12:15], s36 offen
    s_mov_b32 s36, 0x136a00
    buffer_load_dwordx2 v[54:55], v3, s[12:15], s36 offen
    s_mov_b32 s36, 0x137800
    buffer_load_dwordx2 v[56:57], v3, s[12:15], s36 offen
    s_mov_b32 s36, 0x138600
    buffer_load_dwordx2 v[58:59], v3, s[12:15], s36 offen
    s_mov_b32 s36, 0x139400
    buffer_load_dwordx2 v[60:61], v3, s[12:15], s36 offen
    s_mov_b32 s36, 0x13a200
    buffer_load_dwordx2 v[62:63], v3, s[12:15], s36 offen
    s_mov_b32 s36, 0x58000
    buffer_load_dwordx4 v[128:131], v4, s[4:7], s36 offen offset:0 sc1
    buffer_load_dwordx4 v[132:135], v4, s[4:7], s36 offen offset:256 sc1
    buffer_load_dwordx4 v[136:139], v4, s[4:7], s36 offen offset:512 sc1
    buffer_load_dwordx4 v[140:143], v4, s[4:7], s36 offen offset:768 sc1
    buffer_load_dwordx4 v[144:147], v4, s[4:7], s36 offen offset:1024 sc1
    buffer_load_dwordx4 v[148:151], v4, s[4:7], s36 offen offset:1280 sc1
    buffer_load_dwordx4 v[152:155], v4, s[4:7], s36 offen offset:1536 sc1
    buffer_load_dwordx4 v[156:159], v4, s[4:7], s36 offen offset:1792 sc1
    s_waitcnt vmcnt(40)
    v_perm_b32 v160, v18, v16, s60
    v_perm_b32 v161, v22, v20, s60
    v_perm_b32 v162, v26, v24, s60
    v_perm_b32 v163, v30, v28, s60
    v_perm_b32 v164, v18, v16, s61
    v_perm_b32 v165, v22, v20, s61
    v_perm_b32 v166, v26, v24, s61
    v_perm_b32 v167, v30, v28, s61
    v_perm_b32 v168, v19, v17, s60
    v_perm_b32 v169, v23, v21, s60
    v_perm_b32 v170, v27, v25, s60
    v_perm_b32 v171, v31, v29, s60
    v_perm_b32 v172, v19, v17, s61
    v_perm_b32 v173, v23, v21, s61
    v_perm_b32 v174, v27, v25, s61
    v_perm_b32 v175, v31, v29, s61
    s_waitcnt vmcnt(39)
    v_mfma_f32_16x16x32_bf16 a[0:3], v[160:163], v[64:67], a[0:3]
    v_mfma_f32_16x16x32_bf16 a[4:7], v[164:167], v[64:67], a[4:7]
    v_mfma_f32_16x16x32_bf16 a[8:11], v[168:171], v[64:67], a[8:11]
    v_mfma_f32_16x16x32_bf16 a[12:15], v[172:175], v[64:67], a[12:15]
    s_waitcnt vmcnt(38)
    v_mfma_f32_16x16x32_bf16 a[16:19], v[160:163], v[68:71], a[16:19]
    v_mfma_f32_16x16x32_bf16 a[20:23], v[164:167], v[68:71], a[20:23]
    v_mfma_f32_16x16x32_bf16 a[24:27], v[168:171], v[68:71], a[24:27]
    v_mfma_f32_16x16x32_bf16 a[28:31], v[172:175], v[68:71], a[28:31]
    s_waitcnt vmcnt(37)
    v_mfma_f32_16x16x32_bf16 a[32:35], v[160:163], v[72:75], a[32:35]
    v_mfma_f32_16x16x32_bf16 a[36:39], v[164:167], v[72:75], a[36:39]
    v_mfma_f32_16x16x32_bf16 a[40:43], v[168:171], v[72:75], a[40:43]
    v_mfma_f32_16x16x32_bf16 a[44:47], v[172:175], v[72:75], a[44:47]
    s_waitcnt vmcnt(36)
    v_mfma_f32_16x16x32_bf16 a[48:51], v[160:163], v[76:79], a[48:51]
    v_mfma_f32_16x16x32_bf16 a[52:55], v[164:167], v[76:79], a[52:55]
    v_mfma_f32_16x16x32_bf16 a[56:59], v[168:171], v[76:79], a[56:59]
    v_mfma_f32_16x16x32_bf16 a[60:63], v[172:175], v[76:79], a[60:63]
    s_waitcnt vmcnt(35)
    v_mfma_f32_16x16x32_bf16 a[64:67], v[160:163], v[80:83], a[64:67]
    v_mfma_f32_16x16x32_bf16 a[68:71], v[164:167], v[80:83], a[68:71]
    v_mfma_f32_16x16x32_bf16 a[72:75], v[168:171], v[80:83], a[72:75]
    v_mfma_f32_16x16x32_bf16 a[76:79], v[172:175], v[80:83], a[76:79]
    s_waitcnt vmcnt(34)
    v_mfma_f32_16x16x32_bf16 a[80:83], v[160:163], v[84:87], a[80:83]
    v_mfma_f32_16x16x32_bf16 a[84:87], v[164:167], v[84:87], a[84:87]
    v_mfma_f32_16x16x32_bf16 a[88:91], v[168:171], v[84:87], a[88:91]
    v_mfma_f32_16x16x32_bf16 a[92:95], v[172:175], v[84:87], a[92:95]
    s_waitcnt vmcnt(33)
    v_mfma_f32_16x16x32_bf16 a[96:99], v[160:163], v[88:91], a[96:99]
    v_mfma_f32_16x16x32_bf16 a[100:103], v[164:167], v[88:91], a[100:103]
    v_mfma_f32_16x16x32_bf16 a[104:107], v[168:171], v[88:91], a[104:107]
    v_mfma_f32_16x16x32_bf16 a[108:111], v[172:175], v[88:91], a[108:111]
    s_waitcnt vmcnt(32)
    v_mfma_f32_16x16x32_bf16 a[112:115], v[160:163], v[92:95], a[112:115]
    v_mfma_f32_16x16x32_bf16 a[116:119], v[164:167], v[92:95], a[116:119]
    v_mfma_f32_16x16x32_bf16 a[120:123], v[168:171], v[92:95], a[120:123]
    v_mfma_f32_16x16x32_bf16 a[124:127], v[172:175], v[92:95], a[124:127]
    s_mov_b32 s36, 0x150000
    buffer_load_dwordx2 v[16:17], v3, s[12:15], s36 offen
    s_mov_b32 s36, 0x150e00
    buffer_load_dwordx2 v[18:19], v3, s[12:15], s36 offen
    s_mov_b32 s36, 0x151c00
    buffer_load_dwordx2 v[20:21], v3, s[12:15], s36 offen
    s_mov_b32 s36, 0x152a00
    buffer_load_dwordx2 v[22:23], v3, s[12:15], s36 offen
    s_mov_b32 s36, 0x153800
    buffer_load_dwordx2 v[24:25], v3, s[12:15], s36 offen
    s_mov_b32 s36, 0x154600
    buffer_load_dwordx2 v[26:27], v3, s[12:15], s36 offen
    s_mov_b32 s36, 0x155400
    buffer_load_dwordx2 v[28:29], v3, s[12:15], s36 offen
    s_mov_b32 s36, 0x156200
    buffer_load_dwordx2 v[30:31], v3, s[12:15], s36 offen
    s_mov_b32 s36, 0x60000
    buffer_load_dwordx4 v[64:67], v4, s[4:7], s36 offen offset:0 sc1
    buffer_load_dwordx4 v[68:71], v4, s[4:7], s36 offen offset:256 sc1
    buffer_load_dwordx4 v[72:75], v4, s[4:7], s36 offen offset:512 sc1
    buffer_load_dwordx4 v[76:79], v4, s[4:7], s36 offen offset:768 sc1
    buffer_load_dwordx4 v[80:83], v4, s[4:7], s36 offen offset:1024 sc1
    buffer_load_dwordx4 v[84:87], v4, s[4:7], s36 offen offset:1280 sc1
    buffer_load_dwordx4 v[88:91], v4, s[4:7], s36 offen offset:1536 sc1
    buffer_load_dwordx4 v[92:95], v4, s[4:7], s36 offen offset:1792 sc1
    s_waitcnt vmcnt(40)
    v_perm_b32 v160, v34, v32, s60
    v_perm_b32 v161, v38, v36, s60
    v_perm_b32 v162, v42, v40, s60
    v_perm_b32 v163, v46, v44, s60
    v_perm_b32 v164, v34, v32, s61
    v_perm_b32 v165, v38, v36, s61
    v_perm_b32 v166, v42, v40, s61
    v_perm_b32 v167, v46, v44, s61
    v_perm_b32 v168, v35, v33, s60
    v_perm_b32 v169, v39, v37, s60
    v_perm_b32 v170, v43, v41, s60
    v_perm_b32 v171, v47, v45, s60
    v_perm_b32 v172, v35, v33, s61
    v_perm_b32 v173, v39, v37, s61
    v_perm_b32 v174, v43, v41, s61
    v_perm_b32 v175, v47, v45, s61
    s_waitcnt vmcnt(39)
    v_mfma_f32_16x16x32_bf16 a[0:3], v[160:163], v[96:99], a[0:3]
    v_mfma_f32_16x16x32_bf16 a[4:7], v[164:167], v[96:99], a[4:7]
    v_mfma_f32_16x16x32_bf16 a[8:11], v[168:171], v[96:99], a[8:11]
    v_mfma_f32_16x16x32_bf16 a[12:15], v[172:175], v[96:99], a[12:15]
    s_waitcnt vmcnt(38)
    v_mfma_f32_16x16x32_bf16 a[16:19], v[160:163], v[100:103], a[16:19]
    v_mfma_f32_16x16x32_bf16 a[20:23], v[164:167], v[100:103], a[20:23]
    v_mfma_f32_16x16x32_bf16 a[24:27], v[168:171], v[100:103], a[24:27]
    v_mfma_f32_16x16x32_bf16 a[28:31], v[172:175], v[100:103], a[28:31]
    s_waitcnt vmcnt(37)
    v_mfma_f32_16x16x32_bf16 a[32:35], v[160:163], v[104:107], a[32:35]
    v_mfma_f32_16x16x32_bf16 a[36:39], v[164:167], v[104:107], a[36:39]
    v_mfma_f32_16x16x32_bf16 a[40:43], v[168:171], v[104:107], a[40:43]
    v_mfma_f32_16x16x32_bf16 a[44:47], v[172:175], v[104:107], a[44:47]
    s_waitcnt vmcnt(36)
    v_mfma_f32_16x16x32_bf16 a[48:51], v[160:163], v[108:111], a[48:51]
    v_mfma_f32_16x16x32_bf16 a[52:55], v[164:167], v[108:111], a[52:55]
    v_mfma_f32_16x16x32_bf16 a[56:59], v[168:171], v[108:111], a[56:59]
    v_mfma_f32_16x16x32_bf16 a[60:63], v[172:175], v[108:111], a[60:63]
    s_waitcnt vmcnt(35)
    v_mfma_f32_16x16x32_bf16 a[64:67], v[160:163], v[112:115], a[64:67]
    v_mfma_f32_16x16x32_bf16 a[68:71], v[164:167], v[112:115], a[68:71]
    v_mfma_f32_16x16x32_bf16 a[72:75], v[168:171], v[112:115], a[72:75]
    v_mfma_f32_16x16x32_bf16 a[76:79], v[172:175], v[112:115], a[76:79]
    s_waitcnt vmcnt(34)
    v_mfma_f32_16x16x32_bf16 a[80:83], v[160:163], v[116:119], a[80:83]
    v_mfma_f32_16x16x32_bf16 a[84:87], v[164:167], v[116:119], a[84:87]
    v_mfma_f32_16x16x32_bf16 a[88:91], v[168:171], v[116:119], a[88:91]
    v_mfma_f32_16x16x32_bf16 a[92:95], v[172:175], v[116:119], a[92:95]
    s_waitcnt vmcnt(33)
    v_mfma_f32_16x16x32_bf16 a[96:99], v[160:163], v[120:123], a[96:99]
    v_mfma_f32_16x16x32_bf16 a[100:103], v[164:167], v[120:123], a[100:103]
    v_mfma_f32_16x16x32_bf16 a[104:107], v[168:171], v[120:123], a[104:107]
    v_mfma_f32_16x16x32_bf16 a[108:111], v[172:175], v[120:123], a[108:111]
    s_waitcnt vmcnt(32)
    v_mfma_f32_16x16x32_bf16 a[112:115], v[160:163], v[124:127], a[112:115]
    v_mfma_f32_16x16x32_bf16 a[116:119], v[164:167], v[124:127], a[116:119]
    v_mfma_f32_16x16x32_bf16 a[120:123], v[168:171], v[124:127], a[120:123]
    v_mfma_f32_16x16x32_bf16 a[124:127], v[172:175], v[124:127], a[124:127]
    s_mov_b32 s36, 0x16c000
    buffer_load_dwordx2 v[32:33], v3, s[12:15], s36 offen
    s_mov_b32 s36, 0x16ce00
    buffer_load_dwordx2 v[34:35], v3, s[12:15], s36 offen
    s_mov_b32 s36, 0x16dc00
    buffer_load_dwordx2 v[36:37], v3, s[12:15], s36 offen
    s_mov_b32 s36, 0x16ea00
    buffer_load_dwordx2 v[38:39], v3, s[12:15], s36 offen
    s_mov_b32 s36, 0x16f800
    buffer_load_dwordx2 v[40:41], v3, s[12:15], s36 offen
    s_mov_b32 s36, 0x170600
    buffer_load_dwordx2 v[42:43], v3, s[12:15], s36 offen
    s_mov_b32 s36, 0x171400
    buffer_load_dwordx2 v[44:45], v3, s[12:15], s36 offen
    s_mov_b32 s36, 0x172200
    buffer_load_dwordx2 v[46:47], v3, s[12:15], s36 offen
    s_mov_b32 s36, 0x68000
    buffer_load_dwordx4 v[96:99], v4, s[4:7], s36 offen offset:0 sc1
    buffer_load_dwordx4 v[100:103], v4, s[4:7], s36 offen offset:256 sc1
    buffer_load_dwordx4 v[104:107], v4, s[4:7], s36 offen offset:512 sc1
    buffer_load_dwordx4 v[108:111], v4, s[4:7], s36 offen offset:768 sc1
    buffer_load_dwordx4 v[112:115], v4, s[4:7], s36 offen offset:1024 sc1
    buffer_load_dwordx4 v[116:119], v4, s[4:7], s36 offen offset:1280 sc1
    buffer_load_dwordx4 v[120:123], v4, s[4:7], s36 offen offset:1536 sc1
    buffer_load_dwordx4 v[124:127], v4, s[4:7], s36 offen offset:1792 sc1
    s_waitcnt vmcnt(40)
    v_perm_b32 v160, v50, v48, s60
    v_perm_b32 v161, v54, v52, s60
    v_perm_b32 v162, v58, v56, s60
    v_perm_b32 v163, v62, v60, s60
    v_perm_b32 v164, v50, v48, s61
    v_perm_b32 v165, v54, v52, s61
    v_perm_b32 v166, v58, v56, s61
    v_perm_b32 v167, v62, v60, s61
    v_perm_b32 v168, v51, v49, s60
    v_perm_b32 v169, v55, v53, s60
    v_perm_b32 v170, v59, v57, s60
    v_perm_b32 v171, v63, v61, s60
    v_perm_b32 v172, v51, v49, s61
    v_perm_b32 v173, v55, v53, s61
    v_perm_b32 v174, v59, v57, s61
    v_perm_b32 v175, v63, v61, s61
    s_waitcnt vmcnt(39)
    v_mfma_f32_16x16x32_bf16 a[0:3], v[160:163], v[128:131], a[0:3]
    v_mfma_f32_16x16x32_bf16 a[4:7], v[164:167], v[128:131], a[4:7]
    v_mfma_f32_16x16x32_bf16 a[8:11], v[168:171], v[128:131], a[8:11]
    v_mfma_f32_16x16x32_bf16 a[12:15], v[172:175], v[128:131], a[12:15]
    s_waitcnt vmcnt(38)
    v_mfma_f32_16x16x32_bf16 a[16:19], v[160:163], v[132:135], a[16:19]
    v_mfma_f32_16x16x32_bf16 a[20:23], v[164:167], v[132:135], a[20:23]
    v_mfma_f32_16x16x32_bf16 a[24:27], v[168:171], v[132:135], a[24:27]
    v_mfma_f32_16x16x32_bf16 a[28:31], v[172:175], v[132:135], a[28:31]
    s_waitcnt vmcnt(37)
    v_mfma_f32_16x16x32_bf16 a[32:35], v[160:163], v[136:139], a[32:35]
    v_mfma_f32_16x16x32_bf16 a[36:39], v[164:167], v[136:139], a[36:39]
    v_mfma_f32_16x16x32_bf16 a[40:43], v[168:171], v[136:139], a[40:43]
    v_mfma_f32_16x16x32_bf16 a[44:47], v[172:175], v[136:139], a[44:47]
    s_waitcnt vmcnt(36)
    v_mfma_f32_16x16x32_bf16 a[48:51], v[160:163], v[140:143], a[48:51]
    v_mfma_f32_16x16x32_bf16 a[52:55], v[164:167], v[140:143], a[52:55]
    v_mfma_f32_16x16x32_bf16 a[56:59], v[168:171], v[140:143], a[56:59]
    v_mfma_f32_16x16x32_bf16 a[60:63], v[172:175], v[140:143], a[60:63]
    s_waitcnt vmcnt(35)
    v_mfma_f32_16x16x32_bf16 a[64:67], v[160:163], v[144:147], a[64:67]
    v_mfma_f32_16x16x32_bf16 a[68:71], v[164:167], v[144:147], a[68:71]
    v_mfma_f32_16x16x32_bf16 a[72:75], v[168:171], v[144:147], a[72:75]
    v_mfma_f32_16x16x32_bf16 a[76:79], v[172:175], v[144:147], a[76:79]
    s_waitcnt vmcnt(34)
    v_mfma_f32_16x16x32_bf16 a[80:83], v[160:163], v[148:151], a[80:83]
    v_mfma_f32_16x16x32_bf16 a[84:87], v[164:167], v[148:151], a[84:87]
    v_mfma_f32_16x16x32_bf16 a[88:91], v[168:171], v[148:151], a[88:91]
    v_mfma_f32_16x16x32_bf16 a[92:95], v[172:175], v[148:151], a[92:95]
    s_waitcnt vmcnt(33)
    v_mfma_f32_16x16x32_bf16 a[96:99], v[160:163], v[152:155], a[96:99]
    v_mfma_f32_16x16x32_bf16 a[100:103], v[164:167], v[152:155], a[100:103]
    v_mfma_f32_16x16x32_bf16 a[104:107], v[168:171], v[152:155], a[104:107]
    v_mfma_f32_16x16x32_bf16 a[108:111], v[172:175], v[152:155], a[108:111]
    s_waitcnt vmcnt(32)
    v_mfma_f32_16x16x32_bf16 a[112:115], v[160:163], v[156:159], a[112:115]
    v_mfma_f32_16x16x32_bf16 a[116:119], v[164:167], v[156:159], a[116:119]
    v_mfma_f32_16x16x32_bf16 a[120:123], v[168:171], v[156:159], a[120:123]
    v_mfma_f32_16x16x32_bf16 a[124:127], v[172:175], v[156:159], a[124:127]
    s_mov_b32 s36, 0x188000
    buffer_load_dwordx2 v[48:49], v3, s[12:15], s36 offen
    s_mov_b32 s36, 0x188e00
    buffer_load_dwordx2 v[50:51], v3, s[12:15], s36 offen
    s_mov_b32 s36, 0x189c00
    buffer_load_dwordx2 v[52:53], v3, s[12:15], s36 offen
    s_mov_b32 s36, 0x18aa00
    buffer_load_dwordx2 v[54:55], v3, s[12:15], s36 offen
    s_mov_b32 s36, 0x18b800
    buffer_load_dwordx2 v[56:57], v3, s[12:15], s36 offen
    s_mov_b32 s36, 0x18c600
    buffer_load_dwordx2 v[58:59], v3, s[12:15], s36 offen
    s_mov_b32 s36, 0x18d400
    buffer_load_dwordx2 v[60:61], v3, s[12:15], s36 offen
    s_mov_b32 s36, 0x18e200
    buffer_load_dwordx2 v[62:63], v3, s[12:15], s36 offen
    s_mov_b32 s36, 0x70000
    buffer_load_dwordx4 v[128:131], v4, s[4:7], s36 offen offset:0 sc1
    buffer_load_dwordx4 v[132:135], v4, s[4:7], s36 offen offset:256 sc1
    buffer_load_dwordx4 v[136:139], v4, s[4:7], s36 offen offset:512 sc1
    buffer_load_dwordx4 v[140:143], v4, s[4:7], s36 offen offset:768 sc1
    buffer_load_dwordx4 v[144:147], v4, s[4:7], s36 offen offset:1024 sc1
    buffer_load_dwordx4 v[148:151], v4, s[4:7], s36 offen offset:1280 sc1
    buffer_load_dwordx4 v[152:155], v4, s[4:7], s36 offen offset:1536 sc1
    buffer_load_dwordx4 v[156:159], v4, s[4:7], s36 offen offset:1792 sc1
    s_waitcnt vmcnt(40)
    v_perm_b32 v160, v18, v16, s60
    v_perm_b32 v161, v22, v20, s60
    v_perm_b32 v162, v26, v24, s60
    v_perm_b32 v163, v30, v28, s60
    v_perm_b32 v164, v18, v16, s61
    v_perm_b32 v165, v22, v20, s61
    v_perm_b32 v166, v26, v24, s61
    v_perm_b32 v167, v30, v28, s61
    v_perm_b32 v168, v19, v17, s60
    v_perm_b32 v169, v23, v21, s60
    v_perm_b32 v170, v27, v25, s60
    v_perm_b32 v171, v31, v29, s60
    v_perm_b32 v172, v19, v17, s61
    v_perm_b32 v173, v23, v21, s61
    v_perm_b32 v174, v27, v25, s61
    v_perm_b32 v175, v31, v29, s61
    s_waitcnt vmcnt(39)
    v_mfma_f32_16x16x32_bf16 a[0:3], v[160:163], v[64:67], a[0:3]
    v_mfma_f32_16x16x32_bf16 a[4:7], v[164:167], v[64:67], a[4:7]
    v_mfma_f32_16x16x32_bf16 a[8:11], v[168:171], v[64:67], a[8:11]
    v_mfma_f32_16x16x32_bf16 a[12:15], v[172:175], v[64:67], a[12:15]
    s_waitcnt vmcnt(38)
    v_mfma_f32_16x16x32_bf16 a[16:19], v[160:163], v[68:71], a[16:19]
    v_mfma_f32_16x16x32_bf16 a[20:23], v[164:167], v[68:71], a[20:23]
    v_mfma_f32_16x16x32_bf16 a[24:27], v[168:171], v[68:71], a[24:27]
    v_mfma_f32_16x16x32_bf16 a[28:31], v[172:175], v[68:71], a[28:31]
    s_waitcnt vmcnt(37)
    v_mfma_f32_16x16x32_bf16 a[32:35], v[160:163], v[72:75], a[32:35]
    v_mfma_f32_16x16x32_bf16 a[36:39], v[164:167], v[72:75], a[36:39]
    v_mfma_f32_16x16x32_bf16 a[40:43], v[168:171], v[72:75], a[40:43]
    v_mfma_f32_16x16x32_bf16 a[44:47], v[172:175], v[72:75], a[44:47]
    s_waitcnt vmcnt(36)
    v_mfma_f32_16x16x32_bf16 a[48:51], v[160:163], v[76:79], a[48:51]
    v_mfma_f32_16x16x32_bf16 a[52:55], v[164:167], v[76:79], a[52:55]
    v_mfma_f32_16x16x32_bf16 a[56:59], v[168:171], v[76:79], a[56:59]
    v_mfma_f32_16x16x32_bf16 a[60:63], v[172:175], v[76:79], a[60:63]
    s_waitcnt vmcnt(35)
    v_mfma_f32_16x16x32_bf16 a[64:67], v[160:163], v[80:83], a[64:67]
    v_mfma_f32_16x16x32_bf16 a[68:71], v[164:167], v[80:83], a[68:71]
    v_mfma_f32_16x16x32_bf16 a[72:75], v[168:171], v[80:83], a[72:75]
    v_mfma_f32_16x16x32_bf16 a[76:79], v[172:175], v[80:83], a[76:79]
    s_waitcnt vmcnt(34)
    v_mfma_f32_16x16x32_bf16 a[80:83], v[160:163], v[84:87], a[80:83]
    v_mfma_f32_16x16x32_bf16 a[84:87], v[164:167], v[84:87], a[84:87]
    v_mfma_f32_16x16x32_bf16 a[88:91], v[168:171], v[84:87], a[88:91]
    v_mfma_f32_16x16x32_bf16 a[92:95], v[172:175], v[84:87], a[92:95]
    s_waitcnt vmcnt(33)
    v_mfma_f32_16x16x32_bf16 a[96:99], v[160:163], v[88:91], a[96:99]
    v_mfma_f32_16x16x32_bf16 a[100:103], v[164:167], v[88:91], a[100:103]
    v_mfma_f32_16x16x32_bf16 a[104:107], v[168:171], v[88:91], a[104:107]
    v_mfma_f32_16x16x32_bf16 a[108:111], v[172:175], v[88:91], a[108:111]
    s_waitcnt vmcnt(32)
    v_mfma_f32_16x16x32_bf16 a[112:115], v[160:163], v[92:95], a[112:115]
    v_mfma_f32_16x16x32_bf16 a[116:119], v[164:167], v[92:95], a[116:119]
    v_mfma_f32_16x16x32_bf16 a[120:123], v[168:171], v[92:95], a[120:123]
    v_mfma_f32_16x16x32_bf16 a[124:127], v[172:175], v[92:95], a[124:127]
    s_mov_b32 s36, 0x1a4000
    buffer_load_dwordx2 v[16:17], v3, s[12:15], s36 offen
    s_mov_b32 s36, 0x1a4e00
    buffer_load_dwordx2 v[18:19], v3, s[12:15], s36 offen
    s_mov_b32 s36, 0x1a5c00
    buffer_load_dwordx2 v[20:21], v3, s[12:15], s36 offen
    s_mov_b32 s36, 0x1a6a00
    buffer_load_dwordx2 v[22:23], v3, s[12:15], s36 offen
    s_mov_b32 s36, 0x1a7800
    buffer_load_dwordx2 v[24:25], v3, s[12:15], s36 offen
    s_mov_b32 s36, 0x1a8600
    buffer_load_dwordx2 v[26:27], v3, s[12:15], s36 offen
    s_mov_b32 s36, 0x1a9400
    buffer_load_dwordx2 v[28:29], v3, s[12:15], s36 offen
    s_mov_b32 s36, 0x1aa200
    buffer_load_dwordx2 v[30:31], v3, s[12:15], s36 offen
    s_mov_b32 s36, 0x78000
    buffer_load_dwordx4 v[64:67], v4, s[4:7], s36 offen offset:0 sc1
    buffer_load_dwordx4 v[68:71], v4, s[4:7], s36 offen offset:256 sc1
    buffer_load_dwordx4 v[72:75], v4, s[4:7], s36 offen offset:512 sc1
    buffer_load_dwordx4 v[76:79], v4, s[4:7], s36 offen offset:768 sc1
    buffer_load_dwordx4 v[80:83], v4, s[4:7], s36 offen offset:1024 sc1
    buffer_load_dwordx4 v[84:87], v4, s[4:7], s36 offen offset:1280 sc1
    buffer_load_dwordx4 v[88:91], v4, s[4:7], s36 offen offset:1536 sc1
    buffer_load_dwordx4 v[92:95], v4, s[4:7], s36 offen offset:1792 sc1
    s_waitcnt vmcnt(40)
    v_perm_b32 v160, v34, v32, s60
    v_perm_b32 v161, v38, v36, s60
    v_perm_b32 v162, v42, v40, s60
    v_perm_b32 v163, v46, v44, s60
    v_perm_b32 v164, v34, v32, s61
    v_perm_b32 v165, v38, v36, s61
    v_perm_b32 v166, v42, v40, s61
    v_perm_b32 v167, v46, v44, s61
    v_perm_b32 v168, v35, v33, s60
    v_perm_b32 v169, v39, v37, s60
    v_perm_b32 v170, v43, v41, s60
    v_perm_b32 v171, v47, v45, s60
    v_perm_b32 v172, v35, v33, s61
    v_perm_b32 v173, v39, v37, s61
    v_perm_b32 v174, v43, v41, s61
    v_perm_b32 v175, v47, v45, s61
    s_waitcnt vmcnt(39)
    v_mfma_f32_16x16x32_bf16 a[0:3], v[160:163], v[96:99], a[0:3]
    v_mfma_f32_16x16x32_bf16 a[4:7], v[164:167], v[96:99], a[4:7]
    v_mfma_f32_16x16x32_bf16 a[8:11], v[168:171], v[96:99], a[8:11]
    v_mfma_f32_16x16x32_bf16 a[12:15], v[172:175], v[96:99], a[12:15]
    s_waitcnt vmcnt(38)
    v_mfma_f32_16x16x32_bf16 a[16:19], v[160:163], v[100:103], a[16:19]
    v_mfma_f32_16x16x32_bf16 a[20:23], v[164:167], v[100:103], a[20:23]
    v_mfma_f32_16x16x32_bf16 a[24:27], v[168:171], v[100:103], a[24:27]
    v_mfma_f32_16x16x32_bf16 a[28:31], v[172:175], v[100:103], a[28:31]
    s_waitcnt vmcnt(37)
    v_mfma_f32_16x16x32_bf16 a[32:35], v[160:163], v[104:107], a[32:35]
    v_mfma_f32_16x16x32_bf16 a[36:39], v[164:167], v[104:107], a[36:39]
    v_mfma_f32_16x16x32_bf16 a[40:43], v[168:171], v[104:107], a[40:43]
    v_mfma_f32_16x16x32_bf16 a[44:47], v[172:175], v[104:107], a[44:47]
    s_waitcnt vmcnt(36)
    v_mfma_f32_16x16x32_bf16 a[48:51], v[160:163], v[108:111], a[48:51]
    v_mfma_f32_16x16x32_bf16 a[52:55], v[164:167], v[108:111], a[52:55]
    v_mfma_f32_16x16x32_bf16 a[56:59], v[168:171], v[108:111], a[56:59]
    v_mfma_f32_16x16x32_bf16 a[60:63], v[172:175], v[108:111], a[60:63]
    s_waitcnt vmcnt(35)
    v_mfma_f32_16x16x32_bf16 a[64:67], v[160:163], v[112:115], a[64:67]
    v_mfma_f32_16x16x32_bf16 a[68:71], v[164:167], v[112:115], a[68:71]
    v_mfma_f32_16x16x32_bf16 a[72:75], v[168:171], v[112:115], a[72:75]
    v_mfma_f32_16x16x32_bf16 a[76:79], v[172:175], v[112:115], a[76:79]
    s_waitcnt vmcnt(34)
    v_mfma_f32_16x16x32_bf16 a[80:83], v[160:163], v[116:119], a[80:83]
    v_mfma_f32_16x16x32_bf16 a[84:87], v[164:167], v[116:119], a[84:87]
    v_mfma_f32_16x16x32_bf16 a[88:91], v[168:171], v[116:119], a[88:91]
    v_mfma_f32_16x16x32_bf16 a[92:95], v[172:175], v[116:119], a[92:95]
    s_waitcnt vmcnt(33)
    v_mfma_f32_16x16x32_bf16 a[96:99], v[160:163], v[120:123], a[96:99]
    v_mfma_f32_16x16x32_bf16 a[100:103], v[164:167], v[120:123], a[100:103]
    v_mfma_f32_16x16x32_bf16 a[104:107], v[168:171], v[120:123], a[104:107]
    v_mfma_f32_16x16x32_bf16 a[108:111], v[172:175], v[120:123], a[108:111]
    s_waitcnt vmcnt(32)
    v_mfma_f32_16x16x32_bf16 a[112:115], v[160:163], v[124:127], a[112:115]
    v_mfma_f32_16x16x32_bf16 a[116:119], v[164:167], v[124:127], a[116:119]
    v_mfma_f32_16x16x32_bf16 a[120:123], v[168:171], v[124:127], a[120:123]
    v_mfma_f32_16x16x32_bf16 a[124:127], v[172:175], v[124:127], a[124:127]
    s_waitcnt vmcnt(24)
    v_perm_b32 v160, v50, v48, s60
    v_perm_b32 v161, v54, v52, s60
    v_perm_b32 v162, v58, v56, s60
    v_perm_b32 v163, v62, v60, s60
    v_perm_b32 v164, v50, v48, s61
    v_perm_b32 v165, v54, v52, s61
    v_perm_b32 v166, v58, v56, s61
    v_perm_b32 v167, v62, v60, s61
    v_perm_b32 v168, v51, v49, s60
    v_perm_b32 v169, v55, v53, s60
    v_perm_b32 v170, v59, v57, s60
    v_perm_b32 v171, v63, v61, s60
    v_perm_b32 v172, v51, v49, s61
    v_perm_b32 v173, v55, v53, s61
    v_perm_b32 v174, v59, v57, s61
    v_perm_b32 v175, v63, v61, s61
    s_waitcnt vmcnt(23)
    v_mfma_f32_16x16x32_bf16 a[0:3], v[160:163], v[128:131], a[0:3]
    v_mfma_f32_16x16x32_bf16 a[4:7], v[164:167], v[128:131], a[4:7]
    v_mfma_f32_16x16x32_bf16 a[8:11], v[168:171], v[128:131], a[8:11]
    v_mfma_f32_16x16x32_bf16 a[12:15], v[172:175], v[128:131], a[12:15]
    s_waitcnt vmcnt(22)
    v_mfma_f32_16x16x32_bf16 a[16:19], v[160:163], v[132:135], a[16:19]
    v_mfma_f32_16x16x32_bf16 a[20:23], v[164:167], v[132:135], a[20:23]
    v_mfma_f32_16x16x32_bf16 a[24:27], v[168:171], v[132:135], a[24:27]
    v_mfma_f32_16x16x32_bf16 a[28:31], v[172:175], v[132:135], a[28:31]
    s_waitcnt vmcnt(21)
    v_mfma_f32_16x16x32_bf16 a[32:35], v[160:163], v[136:139], a[32:35]
    v_mfma_f32_16x16x32_bf16 a[36:39], v[164:167], v[136:139], a[36:39]
    v_mfma_f32_16x16x32_bf16 a[40:43], v[168:171], v[136:139], a[40:43]
    v_mfma_f32_16x16x32_bf16 a[44:47], v[172:175], v[136:139], a[44:47]
    s_waitcnt vmcnt(20)
    v_mfma_f32_16x16x32_bf16 a[48:51], v[160:163], v[140:143], a[48:51]
    v_mfma_f32_16x16x32_bf16 a[52:55], v[164:167], v[140:143], a[52:55]
    v_mfma_f32_16x16x32_bf16 a[56:59], v[168:171], v[140:143], a[56:59]
    v_mfma_f32_16x16x32_bf16 a[60:63], v[172:175], v[140:143], a[60:63]
    s_waitcnt vmcnt(19)
    v_mfma_f32_16x16x32_bf16 a[64:67], v[160:163], v[144:147], a[64:67]
    v_mfma_f32_16x16x32_bf16 a[68:71], v[164:167], v[144:147], a[68:71]
    v_mfma_f32_16x16x32_bf16 a[72:75], v[168:171], v[144:147], a[72:75]
    v_mfma_f32_16x16x32_bf16 a[76:79], v[172:175], v[144:147], a[76:79]
    s_waitcnt vmcnt(18)
    v_mfma_f32_16x16x32_bf16 a[80:83], v[160:163], v[148:151], a[80:83]
    v_mfma_f32_16x16x32_bf16 a[84:87], v[164:167], v[148:151], a[84:87]
    v_mfma_f32_16x16x32_bf16 a[88:91], v[168:171], v[148:151], a[88:91]
    v_mfma_f32_16x16x32_bf16 a[92:95], v[172:175], v[148:151], a[92:95]
    s_waitcnt vmcnt(17)
    v_mfma_f32_16x16x32_bf16 a[96:99], v[160:163], v[152:155], a[96:99]
    v_mfma_f32_16x16x32_bf16 a[100:103], v[164:167], v[152:155], a[100:103]
    v_mfma_f32_16x16x32_bf16 a[104:107], v[168:171], v[152:155], a[104:107]
    v_mfma_f32_16x16x32_bf16 a[108:111], v[172:175], v[152:155], a[108:111]
    s_waitcnt vmcnt(16)
    v_mfma_f32_16x16x32_bf16 a[112:115], v[160:163], v[156:159], a[112:115]
    v_mfma_f32_16x16x32_bf16 a[116:119], v[164:167], v[156:159], a[116:119]
    v_mfma_f32_16x16x32_bf16 a[120:123], v[168:171], v[156:159], a[120:123]
    v_mfma_f32_16x16x32_bf16 a[124:127], v[172:175], v[156:159], a[124:127]
    s_waitcnt vmcnt(8)
    v_perm_b32 v160, v18, v16, s60
    v_perm_b32 v161, v22, v20, s60
    v_perm_b32 v162, v26, v24, s60
    v_perm_b32 v163, v30, v28, s60
    v_perm_b32 v164, v18, v16, s61
    v_perm_b32 v165, v22, v20, s61
    v_perm_b32 v166, v26, v24, s61
    v_perm_b32 v167, v30, v28, s61
    v_perm_b32 v168, v19, v17, s60
    v_perm_b32 v169, v23, v21, s60
    v_perm_b32 v170, v27, v25, s60
    v_perm_b32 v171, v31, v29, s60
    v_perm_b32 v172, v19, v17, s61
    v_perm_b32 v173, v23, v21, s61
    v_perm_b32 v174, v27, v25, s61
    v_perm_b32 v175, v31, v29, s61
    s_waitcnt vmcnt(7)
    v_mfma_f32_16x16x32_bf16 a[0:3], v[160:163], v[64:67], a[0:3]
    v_mfma_f32_16x16x32_bf16 a[4:7], v[164:167], v[64:67], a[4:7]
    v_mfma_f32_16x16x32_bf16 a[8:11], v[168:171], v[64:67], a[8:11]
    v_mfma_f32_16x16x32_bf16 a[12:15], v[172:175], v[64:67], a[12:15]
    s_waitcnt vmcnt(6)
    v_mfma_f32_16x16x32_bf16 a[16:19], v[160:163], v[68:71], a[16:19]
    v_mfma_f32_16x16x32_bf16 a[20:23], v[164:167], v[68:71], a[20:23]
    v_mfma_f32_16x16x32_bf16 a[24:27], v[168:171], v[68:71], a[24:27]
    v_mfma_f32_16x16x32_bf16 a[28:31], v[172:175], v[68:71], a[28:31]
    s_waitcnt vmcnt(5)
    v_mfma_f32_16x16x32_bf16 a[32:35], v[160:163], v[72:75], a[32:35]
    v_mfma_f32_16x16x32_bf16 a[36:39], v[164:167], v[72:75], a[36:39]
    v_mfma_f32_16x16x32_bf16 a[40:43], v[168:171], v[72:75], a[40:43]
    v_mfma_f32_16x16x32_bf16 a[44:47], v[172:175], v[72:75], a[44:47]
    s_waitcnt vmcnt(4)
    v_mfma_f32_16x16x32_bf16 a[48:51], v[160:163], v[76:79], a[48:51]
    v_mfma_f32_16x16x32_bf16 a[52:55], v[164:167], v[76:79], a[52:55]
    v_mfma_f32_16x16x32_bf16 a[56:59], v[168:171], v[76:79], a[56:59]
    v_mfma_f32_16x16x32_bf16 a[60:63], v[172:175], v[76:79], a[60:63]
    s_waitcnt vmcnt(3)
    v_mfma_f32_16x16x32_bf16 a[64:67], v[160:163], v[80:83], a[64:67]
    v_mfma_f32_16x16x32_bf16 a[68:71], v[164:167], v[80:83], a[68:71]
    v_mfma_f32_16x16x32_bf16 a[72:75], v[168:171], v[80:83], a[72:75]
    v_mfma_f32_16x16x32_bf16 a[76:79], v[172:175], v[80:83], a[76:79]
    s_waitcnt vmcnt(2)
    v_mfma_f32_16x16x32_bf16 a[80:83], v[160:163], v[84:87], a[80:83]
    v_mfma_f32_16x16x32_bf16 a[84:87], v[164:167], v[84:87], a[84:87]
    v_mfma_f32_16x16x32_bf16 a[88:91], v[168:171], v[84:87], a[88:91]
    v_mfma_f32_16x16x32_bf16 a[92:95], v[172:175], v[84:87], a[92:95]
    s_waitcnt vmcnt(1)
    v_mfma_f32_16x16x32_bf16 a[96:99], v[160:163], v[88:91], a[96:99]
    v_mfma_f32_16x16x32_bf16 a[100:103], v[164:167], v[88:91], a[100:103]
    v_mfma_f32_16x16x32_bf16 a[104:107], v[168:171], v[88:91], a[104:107]
    v_mfma_f32_16x16x32_bf16 a[108:111], v[172:175], v[88:91], a[108:111]
    s_waitcnt vmcnt(0)
    v_mfma_f32_16x16x32_bf16 a[112:115], v[160:163], v[92:95], a[112:115]
    v_mfma_f32_16x16x32_bf16 a[116:119], v[164:167], v[92:95], a[116:119]
    v_mfma_f32_16x16x32_bf16 a[120:123], v[168:171], v[92:95], a[120:123]
    v_mfma_f32_16x16x32_bf16 a[124:127], v[172:175], v[92:95], a[124:127]
    v_lshlrev_b32 v6, 4, v255
    s_nop 7
    s_cmp_lg_u32 s28, 0
    s_cbranch_scc1 L_gw_39
    v_accvgpr_read_b32 v16, a0
    v_accvgpr_read_b32 v17, a1
    v_accvgpr_read_b32 v18, a2
    v_accvgpr_read_b32 v19, a3
    v_accvgpr_read_b32 v20, a4
    v_accvgpr_read_b32 v21, a5
    v_accvgpr_read_b32 v22, a6
    v_accvgpr_read_b32 v23, a7
    v_accvgpr_read_b32 v24, a8
    v_accvgpr_read_b32 v25, a9
    v_accvgpr_read_b32 v26, a10
    v_accvgpr_read_b32 v27, a11
    v_accvgpr_read_b32 v28, a12
    v_accvgpr_read_b32 v29, a13
    v_accvgpr_read_b32 v30, a14
    v_accvgpr_read_b32 v31, a15
    v_accvgpr_read_b32 v32, a16
    v_accvgpr_read_b32 v33, a17
    v_accvgpr_read_b32 v34, a18
    v_accvgpr_read_b32 v35, a19
    v_accvgpr_read_b32 v36, a20
    v_accvgpr_read_b32 v37, a21
    v_accvgpr_read_b32 v38, a22
    v_accvgpr_read_b32 v39, a23
    v_accvgpr_read_b32 v40, a24
    v_accvgpr_read_b32 v41, a25
    v_accvgpr_read_b32 v42, a26
    v_accvgpr_read_b32 v43, a27
    v_accvgpr_read_b32 v44, a28
    v_accvgpr_read_b32 v45, a29
    v_accvgpr_read_b32 v46, a30
    v_accvgpr_read_b32 v47, a31
    v_add_u32 v7, 24576, v6
    ds_write_b128 v7, a[32:35] offset:0
    ds_write_b128 v7, a[36:39] offset:1024
    ds_write_b128 v7, a[40:43] offset:2048
    ds_write_b128 v7, a[44:47] offset:3072
    ds_write_b128 v7, a[48:51] offset:4096
    ds_write_b128 v7, a[52:55] offset:5120
    ds_write_b128 v7, a[56:59] offset:6144
    ds_write_b128 v7, a[60:63] offset:7168
    v_add_u32 v7, 57344, v6
    ds_write_b128 v7, a[64:67] offset:0
    ds_write_b128 v7, a[68:71] offset:1024
    ds_write_b128 v7, a[72:75] offset:2048
    ds_write_b128 v7, a[76:79] offset:3072
    ds_write_b128 v7, a[80:83] offset:4096
    ds_write_b128 v7, a[84:87] offset:5120
    ds_write_b128 v7, a[88:91] offset:6144
    ds_write_b128 v7, a[92:95] offset:7168
    v_add_u32 v7, 90112, v6
    ds_write_b128 v7, a[96:99] offset:0
    ds_write_b128 v7, a[100:103] offset:1024
    ds_write_b128 v7, a[104:107] offset:2048
    ds_write_b128 v7, a[108:111] offset:3072
    ds_write_b128 v7, a[112:115] offset:4096
    ds_write_b128 v7, a[116:119] offset:5120
    ds_write_b128 v7, a[120:123] offset:6144
    ds_write_b128 v7, a[124:127] offset:7168
L_gw_39:
    s_cmp_lg_u32 s28, 1
    s_cbranch_scc1 L_gw_40
    v_add_u32 v7, 0, v6
    ds_write_b128 v7, a[0:3] offset:0
    ds_write_b128 v7, a[4:7] offset:1024
    ds_write_b128 v7, a[8:11] offset:2048
    ds_write_b128 v7, a[12:15] offset:3072
    ds_write_b128 v7, a[16:19] offset:4096
    ds_write_b128 v7, a[20:23] offset:5120
    ds_write_b128 v7, a[24:27] offset:6144
    ds_write_b128 v7, a[28:31] offset:7168
    v_accvgpr_read_b32 v16, a32
    v_accvgpr_read_b32 v17, a33
    v_accvgpr_read_b32 v18, a34
    v_accvgpr_read_b32 v19, a35
    v_accvgpr_read_b32 v20, a36
    v_accvgpr_read_b32 v21, a37
    v_accvgpr_read_b32 v22, a38
    v_accvgpr_read_b32 v23, a39
    v_accvgpr_read_b32 v24, a40
    v_accvgpr_read_b32 v25, a41
    v_accvgpr_read_b32 v26, a42
    v_accvgpr_read_b32 v27, a43
    v_accvgpr_read_b32 v28, a44
    v_accvgpr_read_b32 v29, a45
    v_accvgpr_read_b32 v30, a46
    v_accvgpr_read_b32 v31, a47
    v_accvgpr_read_b32 v32, a48
    v_accvgpr_read_b32 v33, a49
    v_accvgpr_read_b32 v34, a50
    v_accvgpr_read_b32 v35, a51
    v_accvgpr_read_b32 v36, a52
    v_accvgpr_read_b32 v37, a53
    v_accvgpr_read_b32 v38, a54
    v_accvgpr_read_b32 v39, a55
    v_accvgpr_read_b32 v40, a56
    v_accvgpr_read_b32 v41, a57
    v_accvgpr_read_b32 v42, a58
    v_accvgpr_read_b32 v43, a59
    v_accvgpr_read_b32 v44, a60
    v_accvgpr_read_b32 v45, a61
    v_accvgpr_read_b32 v46, a62
    v_accvgpr_read_b32 v47, a63
    v_add_u32 v7, 65536, v6
    ds_write_b128 v7, a[64:67] offset:0
    ds_write_b128 v7, a[68:71] offset:1024
    ds_write_b128 v7, a[72:75] offset:2048
    ds_write_b128 v7, a[76:79] offset:3072
    ds_write_b128 v7, a[80:83] offset:4096
    ds_write_b128 v7, a[84:87] offset:5120
    ds_write_b128 v7, a[88:91] offset:6144
    ds_write_b128 v7, a[92:95] offset:7168
    v_add_u32 v7, 81920, v6
    ds_write_b128 v7, a[96:99] offset:0
    ds_write_b128 v7, a[100:103] offset:1024
    ds_write_b128 v7, a[104:107] offset:2048
    ds_write_b128 v7, a[108:111] offset:3072
    ds_write_b128 v7, a[112:115] offset:4096
    ds_write_b128 v7, a[116:119] offset:5120
    ds_write_b128 v7, a[120:123] offset:6144
    ds_write_b128 v7, a[124:127] offset:7168
L_gw_40:
    s_cmp_lg_u32 s28, 2
    s_cbranch_scc1 L_gw_41
    v_add_u32 v7, 8192, v6
    ds_write_b128 v7, a[0:3] offset:0
    ds_write_b128 v7, a[4:7] offset:1024
    ds_write_b128 v7, a[8:11] offset:2048
    ds_write_b128 v7, a[12:15] offset:3072
    ds_write_b128 v7, a[16:19] offset:4096
    ds_write_b128 v7, a[20:23] offset:5120
    ds_write_b128 v7, a[24:27] offset:6144
    ds_write_b128 v7, a[28:31] offset:7168
    v_add_u32 v7, 40960, v6
    ds_write_b128 v7, a[32:35] offset:0
    ds_write_b128 v7, a[36:39] offset:1024
    ds_write_b128 v7, a[40:43] offset:2048
    ds_write_b128 v7, a[44:47] offset:3072
    ds_write_b128 v7, a[48:51] offset:4096
    ds_write_b128 v7, a[52:55] offset:5120
    ds_write_b128 v7, a[56:59] offset:6144
    ds_write_b128 v7, a[60:63] offset:7168
    v_accvgpr_read_b32 v16, a64
    v_accvgpr_read_b32 v17, a65
    v_accvgpr_read_b32 v18, a66
    v_accvgpr_read_b32 v19, a67
    v_accvgpr_read_b32 v20, a68
    v_accvgpr_read_b32 v21, a69
    v_accvgpr_read_b32 v22, a70
    v_accvgpr_read_b32 v23, a71
    v_accvgpr_read_b32 v24, a72
    v_accvgpr_read_b32 v25, a73
    v_accvgpr_read_b32 v26, a74
    v_accvgpr_read_b32 v27, a75
    v_accvgpr_read_b32 v28, a76
    v_accvgpr_read_b32 v29, a77
    v_accvgpr_read_b32 v30, a78
    v_accvgpr_read_b32 v31, a79
    v_accvgpr_read_b32 v32, a80
    v_accvgpr_read_b32 v33, a81
    v_accvgpr_read_b32 v34, a82
    v_accvgpr_read_b32 v35, a83
    v_accvgpr_read_b32 v36, a84
    v_accvgpr_read_b32 v37, a85
    v_accvgpr_read_b32 v38, a86
    v_accvgpr_read_b32 v39, a87
    v_accvgpr_read_b32 v40, a88
    v_accvgpr_read_b32 v41, a89
    v_accvgpr_read_b32 v42, a90
    v_accvgpr_read_b32 v43, a91
    v_accvgpr_read_b32 v44, a92
    v_accvgpr_read_b32 v45, a93
    v_accvgpr_read_b32 v46, a94
    v_accvgpr_read_b32 v47, a95
    v_add_u32 v7, 73728, v6
    ds_write_b128 v7, a[96:99] offset:0
    ds_write_b128 v7, a[100:103] offset:1024
    ds_write_b128 v7, a[104:107] offset:2048
    ds_write_b128 v7, a[108:111] offset:3072
    ds_write_b128 v7, a[112:115] offset:4096
    ds_write_b128 v7, a[116:119] offset:5120
    ds_write_b128 v7, a[120:123] offset:6144
    ds_write_b128 v7, a[124:127] offset:7168
L_gw_41:
    s_cmp_lg_u32 s28, 3
    s_cbranch_scc1 L_gw_42
    v_add_u32 v7, 16384, v6
    ds_write_b128 v7, a[0:3] offset:0
    ds_write_b128 v7, a[4:7] offset:1024
    ds_write_b128 v7, a[8:11] offset:2048
    ds_write_b128 v7, a[12:15] offset:3072
    ds_write_b128 v7, a[16:19] offset:4096
    ds_write_b128 v7, a[20:23] offset:5120
    ds_write_b128 v7, a[24:27] offset:6144
    ds_write_b128 v7, a[28:31] offset:7168
    v_add_u32 v7, 32768, v6
    ds_write_b128 v7, a[32:35] offset:0
    ds_write_b128 v7, a[36:39] offset:1024
    ds_write_b128 v7, a[40:43] offset:2048
    ds_write_b128 v7, a[44:47] offset:3072
    ds_write_b128 v7, a[48:51] offset:4096
    ds_write_b128 v7, a[52:55] offset:5120
    ds_write_b128 v7, a[56:59] offset:6144
    ds_write_b128 v7, a[60:63] offset:7168
    v_add_u32 v7, 49152, v6
    ds_write_b128 v7, a[64:67] offset:0
    ds_write_b128 v7, a[68:71] offset:1024
    ds_write_b128 v7, a[72:75] offset:2048
    ds_write_b128 v7, a[76:79] offset:3072
    ds_write_b128 v7, a[80:83] offset:4096
    ds_write_b128 v7, a[84:87] offset:5120
    ds_write_b128 v7, a[88:91] offset:6144
    ds_write_b128 v7, a[92:95] offset:7168
    v_accvgpr_read_b32 v16, a96
    v_accvgpr_read_b32 v17, a97
    v_accvgpr_read_b32 v18, a98
    v_accvgpr_read_b32 v19, a99
    v_accvgpr_read_b32 v20, a100
    v_accvgpr_read_b32 v21, a101
    v_accvgpr_read_b32 v22, a102
    v_accvgpr_read_b32 v23, a103
    v_accvgpr_read_b32 v24, a104
    v_accvgpr_read_b32 v25, a105
    v_accvgpr_read_b32 v26, a106
    v_accvgpr_read_b32 v27, a107
    v_accvgpr_read_b32 v28, a108
    v_accvgpr_read_b32 v29, a109
    v_accvgpr_read_b32 v30, a110
    v_accvgpr_read_b32 v31, a111
    v_accvgpr_read_b32 v32, a112
    v_accvgpr_read_b32 v33, a113
    v_accvgpr_read_b32 v34, a114
    v_accvgpr_read_b32 v35, a115
    v_accvgpr_read_b32 v36, a116
    v_accvgpr_read_b32 v37, a117
    v_accvgpr_read_b32 v38, a118
    v_accvgpr_read_b32 v39, a119
    v_accvgpr_read_b32 v40, a120
    v_accvgpr_read_b32 v41, a121
    v_accvgpr_read_b32 v42, a122
    v_accvgpr_read_b32 v43, a123
    v_accvgpr_read_b32 v44, a124
    v_accvgpr_read_b32 v45, a125
    v_accvgpr_read_b32 v46, a126
    v_accvgpr_read_b32 v47, a127
L_gw_42:
    s_mul_i32 s36, s28, 24576
    v_add_u32 v7, s36, v6
    s_waitcnt lgkmcnt(0)
    s_barrier
    ds_read_b128 v[48:51], v7 offset:0
    ds_read_b128 v[52:55], v7 offset:1024
    ds_read_b128 v[56:59], v7 offset:2048
    ds_read_b128 v[60:63], v7 offset:3072
    ds_read_b128 v[64:67], v7 offset:4096
    ds_read_b128 v[68:71], v7 offset:5120
    ds_read_b128 v[72:75], v7 offset:6144
    ds_read_b128 v[76:79], v7 offset:7168
    ds_read_b128 v[80:83], v7 offset:8192
    ds_read_b128 v[84:87], v7 offset:9216
    ds_read_b128 v[88:91], v7 offset:10240
    ds_read_b128 v[92:95], v7 offset:11264
    ds_read_b128 v[96:99], v7 offset:12288
    ds_read_b128 v[100:103], v7 offset:13312
    ds_read_b128 v[104:107], v7 offset:14336
    ds_read_b128 v[108:111], v7 offset:15360
    s_waitcnt lgkmcnt(8)
    v_add_f32 v16, v16, v48
    v_add_f32 v17, v17, v49
    v_add_f32 v18, v18, v50
    v_add_f32 v19, v19, v51
    v_add_f32 v20, v20, v52
    v_add_f32 v21, v21, v53
    v_add_f32 v22, v22, v54
    v_add_f32 v23, v23, v55
    v_add_f32 v24, v24, v56
    v_add_f32 v25, v25, v57
    v_add_f32 v26, v26, v58
    v_add_f32 v27, v27, v59
    v_add_f32 v28, v28, v60
    v_add_f32 v29, v29, v61
    v_add_f32 v30, v30, v62
    v_add_f32 v31, v31, v63
    v_add_f32 v32, v32, v64
    v_add_f32 v33, v33, v65
    v_add_f32 v34, v34, v66
    v_add_f32 v35, v35, v67
    v_add_f32 v36, v36, v68
    v_add_f32 v37, v37, v69
    v_add_f32 v38, v38, v70
    v_add_f32 v39, v39, v71
    v_add_f32 v40, v40, v72
    v_add_f32 v41, v41, v73
    v_add_f32 v42, v42, v74
    v_add_f32 v43, v43, v75
    v_add_f32 v44, v44, v76
    v_add_f32 v45, v45, v77
    v_add_f32 v46, v46, v78
    v_add_f32 v47, v47, v79
    ds_read_b128 v[112:115], v7 offset:16384
    ds_read_b128 v[116:119], v7 offset:17408
    ds_read_b128 v[120:123], v7 offset:18432
    ds_read_b128 v[124:127], v7 offset:19456
    ds_read_b128 v[128:131], v7 offset:20480
    ds_read_b128 v[132:135], v7 offset:21504
    ds_read_b128 v[136:139], v7 offset:22528
    ds_read_b128 v[140:143], v7 offset:23552
    s_waitcnt lgkmcnt(8)
    v_add_f32 v16, v16, v80
    v_add_f32 v17, v17, v81
    v_add_f32 v18, v18, v82
    v_add_f32 v19, v19, v83
    v_add_f32 v20, v20, v84
    v_add_f32 v21, v21, v85
    v_add_f32 v22, v22, v86
    v_add_f32 v23, v23, v87
    v_add_f32 v24, v24, v88
    v_add_f32 v25, v25, v89
    v_add_f32 v26, v26, v90
    v_add_f32 v27, v27, v91
    v_add_f32 v28, v28, v92
    v_add_f32 v29, v29, v93
    v_add_f32 v30, v30, v94
    v_add_f32 v31, v31, v95
    v_add_f32 v32, v32, v96
    v_add_f32 v33, v33, v97
    v_add_f32 v34, v34, v98
    v_add_f32 v35, v35, v99
    v_add_f32 v36, v36, v100
    v_add_f32 v37, v37, v101
    v_add_f32 v38, v38, v102
    v_add_f32 v39, v39, v103
    v_add_f32 v40, v40, v104
    v_add_f32 v41, v41, v105
    v_add_f32 v42, v42, v106
    v_add_f32 v43, v43, v107
    v_add_f32 v44, v44, v108
    v_add_f32 v45, v45, v109
    v_add_f32 v46, v46, v110
    v_add_f32 v47, v47, v111
    s_waitcnt lgkmcnt(0)
    v_add_f32 v16, v16, v112
    v_add_f32 v17, v17, v113
    v_add_f32 v18, v18, v114
    v_add_f32 v19, v19, v115
    v_add_f32 v20, v20, v116
    v_add_f32 v21, v21, v117
    v_add_f32 v22, v22, v118
    v_add_f32 v23, v23, v119
    v_add_f32 v24, v24, v120
    v_add_f32 v25, v25, v121
    v_add_f32 v26, v26, v122
    v_add_f32 v27, v27, v123
    v_add_f32 v28, v28, v124
    v_add_f32 v29, v29, v125
    v_add_f32 v30, v30, v126
    v_add_f32 v31, v31, v127
    v_add_f32 v32, v32, v128
    v_add_f32 v33, v33, v129
    v_add_f32 v34, v34, v130
    v_add_f32 v35, v35, v131
    v_add_f32 v36, v36, v132
    v_add_f32 v37, v37, v133
    v_add_f32 v38, v38, v134
    v_add_f32 v39, v39, v135
    v_add_f32 v40, v40, v136
    v_add_f32 v41, v41, v137
    v_add_f32 v42, v42, v138
    v_add_f32 v43, v43, v139
    v_add_f32 v44, v44, v140
    v_add_f32 v45, v45, v141
    v_add_f32 v46, v46, v142
    v_add_f32 v47, v47, v143
    v_lshlrev_b32 v48, 16, v8
    v_and_b32 v49, s62, v8
    v_lshlrev_b32 v50, 16, v9
    v_and_b32 v51, s62, v9
    v_lshlrev_b32 v52, 16, v10
    v_and_b32 v53, s62, v10
    v_lshlrev_b32 v54, 16, v11
    v_and_b32 v55, s62, v11
    v_lshlrev_b32 v56, 16, v12
    v_and_b32 v57, s62, v12
    v_lshlrev_b32 v58, 16, v13
    v_and_b32 v59, s62, v13
    v_lshlrev_b32 v60, 16, v14
    v_and_b32 v61, s62, v14
    v_lshlrev_b32 v62, 16, v15
    v_and_b32 v63, s62, v15
    s_mov_b32 s36, 0xc0135761
    s_mov_b32 s37, 0xbdd2d3e8
    v_mov_b32 v64, s36
    v_cvt_pk_bf16_f32 v16, v16, v16
    v_and_b32 v16, s62, v16
    v_add_f32 v16, v16, v48
    v_cvt_pk_bf16_f32 v16, v16, v16
    v_and_b32 v16, s62, v16
    v_mul_f32 v65, v16, v16
    v_fma_f32 v65, v65, s37, v64
    v_mul_f32 v65, v65, v16
    v_exp_f32 v65, v65
    s_nop 0
    v_add_f32 v65, 1.0, v65
    v_rcp_f32 v65, v65
    s_nop 0
    v_mul_f32 v16, v16, v65
    v_cvt_pk_bf16_f32 v17, v17, v17
    v_and_b32 v17, s62, v17
    v_add_f32 v17, v17, v52
    v_cvt_pk_bf16_f32 v17, v17, v17
    v_and_b32 v17, s62, v17
    v_mul_f32 v65, v17, v17
    v_fma_f32 v65, v65, s37, v64
    v_mul_f32 v65, v65, v17
    v_exp_f32 v65, v65
    s_nop 0
    v_add_f32 v65, 1.0, v65
    v_rcp_f32 v65, v65
    s_nop 0
    v_mul_f32 v17, v17, v65
    v_cvt_pk_bf16_f32 v18, v18, v18
    v_and_b32 v18, s62, v18
    v_add_f32 v18, v18, v56
    v_cvt_pk_bf16_f32 v18, v18, v18
    v_and_b32 v18, s62, v18
    v_mul_f32 v65, v18, v18
    v_fma_f32 v65, v65, s37, v64
    v_mul_f32 v65, v65, v18
    v_exp_f32 v65, v65
    s_nop 0
    v_add_f32 v65, 1.0, v65
    v_rcp_f32 v65, v65
    s_nop 0
    v_mul_f32 v18, v18, v65
    v_cvt_pk_bf16_f32 v19, v19, v19
    v_and_b32 v19, s62, v19
    v_add_f32 v19, v19, v60
    v_cvt_pk_bf16_f32 v19, v19, v19
    v_and_b32 v19, s62, v19
    v_mul_f32 v65, v19, v19
    v_fma_f32 v65, v65, s37, v64
    v_mul_f32 v65, v65, v19
    v_exp_f32 v65, v65
    s_nop 0
    v_add_f32 v65, 1.0, v65
    v_rcp_f32 v65, v65
    s_nop 0
    v_mul_f32 v19, v19, v65
    v_cvt_pk_bf16_f32 v20, v20, v20
    v_and_b32 v20, s62, v20
    v_add_f32 v20, v20, v49
    v_cvt_pk_bf16_f32 v20, v20, v20
    v_and_b32 v20, s62, v20
    v_mul_f32 v65, v20, v20
    v_fma_f32 v65, v65, s37, v64
    v_mul_f32 v65, v65, v20
    v_exp_f32 v65, v65
    s_nop 0
    v_add_f32 v65, 1.0, v65
    v_rcp_f32 v65, v65
    s_nop 0
    v_mul_f32 v20, v20, v65
    v_cvt_pk_bf16_f32 v21, v21, v21
    v_and_b32 v21, s62, v21
    v_add_f32 v21, v21, v53
    v_cvt_pk_bf16_f32 v21, v21, v21
    v_and_b32 v21, s62, v21
    v_mul_f32 v65, v21, v21
    v_fma_f32 v65, v65, s37, v64
    v_mul_f32 v65, v65, v21
    v_exp_f32 v65, v65
    s_nop 0
    v_add_f32 v65, 1.0, v65
    v_rcp_f32 v65, v65
    s_nop 0
    v_mul_f32 v21, v21, v65
    v_cvt_pk_bf16_f32 v22, v22, v22
    v_and_b32 v22, s62, v22
    v_add_f32 v22, v22, v57
    v_cvt_pk_bf16_f32 v22, v22, v22
    v_and_b32 v22, s62, v22
    v_mul_f32 v65, v22, v22
    v_fma_f32 v65, v65, s37, v64
    v_mul_f32 v65, v65, v22
    v_exp_f32 v65, v65
    s_nop 0
    v_add_f32 v65, 1.0, v65
    v_rcp_f32 v65, v65
    s_nop 0
    v_mul_f32 v22, v22, v65
    v_cvt_pk_bf16_f32 v23, v23, v23
    v_and_b32 v23, s62, v23
    v_add_f32 v23, v23, v61
    v_cvt_pk_bf16_f32 v23, v23, v23
    v_and_b32 v23, s62, v23
    v_mul_f32 v65, v23, v23
    v_fma_f32 v65, v65, s37, v64
    v_mul_f32 v65, v65, v23
    v_exp_f32 v65, v65
    s_nop 0
    v_add_f32 v65, 1.0, v65
    v_rcp_f32 v65, v65
    s_nop 0
    v_mul_f32 v23, v23, v65
    v_cvt_pk_bf16_f32 v24, v24, v24
    v_and_b32 v24, s62, v24
    v_add_f32 v24, v24, v50
    v_cvt_pk_bf16_f32 v24, v24, v24
    v_and_b32 v24, s62, v24
    v_mul_f32 v65, v24, v24
    v_fma_f32 v65, v65, s37, v64
    v_mul_f32 v65, v65, v24
    v_exp_f32 v65, v65
    s_nop 0
    v_add_f32 v65, 1.0, v65
    v_rcp_f32 v65, v65
    s_nop 0
    v_mul_f32 v24, v24, v65
    v_cvt_pk_bf16_f32 v25, v25, v25
    v_and_b32 v25, s62, v25
    v_add_f32 v25, v25, v54
    v_cvt_pk_bf16_f32 v25, v25, v25
    v_and_b32 v25, s62, v25
    v_mul_f32 v65, v25, v25
    v_fma_f32 v65, v65, s37, v64
    v_mul_f32 v65, v65, v25
    v_exp_f32 v65, v65
    s_nop 0
    v_add_f32 v65, 1.0, v65
    v_rcp_f32 v65, v65
    s_nop 0
    v_mul_f32 v25, v25, v65
    v_cvt_pk_bf16_f32 v26, v26, v26
    v_and_b32 v26, s62, v26
    v_add_f32 v26, v26, v58
    v_cvt_pk_bf16_f32 v26, v26, v26
    v_and_b32 v26, s62, v26
    v_mul_f32 v65, v26, v26
    v_fma_f32 v65, v65, s37, v64
    v_mul_f32 v65, v65, v26
    v_exp_f32 v65, v65
    s_nop 0
    v_add_f32 v65, 1.0, v65
    v_rcp_f32 v65, v65
    s_nop 0
    v_mul_f32 v26, v26, v65
    v_cvt_pk_bf16_f32 v27, v27, v27
    v_and_b32 v27, s62, v27
    v_add_f32 v27, v27, v62
    v_cvt_pk_bf16_f32 v27, v27, v27
    v_and_b32 v27, s62, v27
    v_mul_f32 v65, v27, v27
    v_fma_f32 v65, v65, s37, v64
    v_mul_f32 v65, v65, v27
    v_exp_f32 v65, v65
    s_nop 0
    v_add_f32 v65, 1.0, v65
    v_rcp_f32 v65, v65
    s_nop 0
    v_mul_f32 v27, v27, v65
    v_cvt_pk_bf16_f32 v28, v28, v28
    v_and_b32 v28, s62, v28
    v_add_f32 v28, v28, v51
    v_cvt_pk_bf16_f32 v28, v28, v28
    v_and_b32 v28, s62, v28
    v_mul_f32 v65, v28, v28
    v_fma_f32 v65, v65, s37, v64
    v_mul_f32 v65, v65, v28
    v_exp_f32 v65, v65
    s_nop 0
    v_add_f32 v65, 1.0, v65
    v_rcp_f32 v65, v65
    s_nop 0
    v_mul_f32 v28, v28, v65
    v_cvt_pk_bf16_f32 v29, v29, v29
    v_and_b32 v29, s62, v29
    v_add_f32 v29, v29, v55
    v_cvt_pk_bf16_f32 v29, v29, v29
    v_and_b32 v29, s62, v29
    v_mul_f32 v65, v29, v29
    v_fma_f32 v65, v65, s37, v64
    v_mul_f32 v65, v65, v29
    v_exp_f32 v65, v65
    s_nop 0
    v_add_f32 v65, 1.0, v65
    v_rcp_f32 v65, v65
    s_nop 0
    v_mul_f32 v29, v29, v65
    v_cvt_pk_bf16_f32 v30, v30, v30
    v_and_b32 v30, s62, v30
    v_add_f32 v30, v30, v59
    v_cvt_pk_bf16_f32 v30, v30, v30
    v_and_b32 v30, s62, v30
    v_mul_f32 v65, v30, v30
    v_fma_f32 v65, v65, s37, v64
    v_mul_f32 v65, v65, v30
    v_exp_f32 v65, v65
    s_nop 0
    v_add_f32 v65, 1.0, v65
    v_rcp_f32 v65, v65
    s_nop 0
    v_mul_f32 v30, v30, v65
    v_cvt_pk_bf16_f32 v31, v31, v31
    v_and_b32 v31, s62, v31
    v_add_f32 v31, v31, v63
    v_cvt_pk_bf16_f32 v31, v31, v31
    v_and_b32 v31, s62, v31
    v_mul_f32 v65, v31, v31
    v_fma_f32 v65, v65, s37, v64
    v_mul_f32 v65, v65, v31
    v_exp_f32 v65, v65
    s_nop 0
    v_add_f32 v65, 1.0, v65
    v_rcp_f32 v65, v65
    s_nop 0
    v_mul_f32 v31, v31, v65
    v_cvt_pk_bf16_f32 v32, v32, v32
    v_and_b32 v32, s62, v32
    v_add_f32 v32, v32, v48
    v_cvt_pk_bf16_f32 v32, v32, v32
    v_and_b32 v32, s62, v32
    v_mul_f32 v65, v32, v32
    v_fma_f32 v65, v65, s37, v64
    v_mul_f32 v65, v65, v32
    v_exp_f32 v65, v65
    s_nop 0
    v_add_f32 v65, 1.0, v65
    v_rcp_f32 v65, v65
    s_nop 0
    v_mul_f32 v32, v32, v65
    v_cvt_pk_bf16_f32 v33, v33, v33
    v_and_b32 v33, s62, v33
    v_add_f32 v33, v33, v52
    v_cvt_pk_bf16_f32 v33, v33, v33
    v_and_b32 v33, s62, v33
    v_mul_f32 v65, v33, v33
    v_fma_f32 v65, v65, s37, v64
    v_mul_f32 v65, v65, v33
    v_exp_f32 v65, v65
    s_nop 0
    v_add_f32 v65, 1.0, v65
    v_rcp_f32 v65, v65
    s_nop 0
    v_mul_f32 v33, v33, v65
    v_cvt_pk_bf16_f32 v34, v34, v34
    v_and_b32 v34, s62, v34
    v_add_f32 v34, v34, v56
    v_cvt_pk_bf16_f32 v34, v34, v34
    v_and_b32 v34, s62, v34
    v_mul_f32 v65, v34, v34
    v_fma_f32 v65, v65, s37, v64
    v_mul_f32 v65, v65, v34
    v_exp_f32 v65, v65
    s_nop 0
    v_add_f32 v65, 1.0, v65
    v_rcp_f32 v65, v65
    s_nop 0
    v_mul_f32 v34, v34, v65
    v_cvt_pk_bf16_f32 v35, v35, v35
    v_and_b32 v35, s62, v35
    v_add_f32 v35, v35, v60
    v_cvt_pk_bf16_f32 v35, v35, v35
    v_and_b32 v35, s62, v35
    v_mul_f32 v65, v35, v35
    v_fma_f32 v65, v65, s37, v64
    v_mul_f32 v65, v65, v35
    v_exp_f32 v65, v65
    s_nop 0
    v_add_f32 v65, 1.0, v65
    v_rcp_f32 v65, v65
    s_nop 0
    v_mul_f32 v35, v35, v65
    v_cvt_pk_bf16_f32 v36, v36, v36
    v_and_b32 v36, s62, v36
    v_add_f32 v36, v36, v49
    v_cvt_pk_bf16_f32 v36, v36, v36
    v_and_b32 v36, s62, v36
    v_mul_f32 v65, v36, v36
    v_fma_f32 v65, v65, s37, v64
    v_mul_f32 v65, v65, v36
    v_exp_f32 v65, v65
    s_nop 0
    v_add_f32 v65, 1.0, v65
    v_rcp_f32 v65, v65
    s_nop 0
    v_mul_f32 v36, v36, v65
    v_cvt_pk_bf16_f32 v37, v37, v37
    v_and_b32 v37, s62, v37
    v_add_f32 v37, v37, v53
    v_cvt_pk_bf16_f32 v37, v37, v37
    v_and_b32 v37, s62, v37
    v_mul_f32 v65, v37, v37
    v_fma_f32 v65, v65, s37, v64
    v_mul_f32 v65, v65, v37
    v_exp_f32 v65, v65
    s_nop 0
    v_add_f32 v65, 1.0, v65
    v_rcp_f32 v65, v65
    s_nop 0
    v_mul_f32 v37, v37, v65
    v_cvt_pk_bf16_f32 v38, v38, v38
    v_and_b32 v38, s62, v38
    v_add_f32 v38, v38, v57
    v_cvt_pk_bf16_f32 v38, v38, v38
    v_and_b32 v38, s62, v38
    v_mul_f32 v65, v38, v38
    v_fma_f32 v65, v65, s37, v64
    v_mul_f32 v65, v65, v38
    v_exp_f32 v65, v65
    s_nop 0
    v_add_f32 v65, 1.0, v65
    v_rcp_f32 v65, v65
    s_nop 0
    v_mul_f32 v38, v38, v65
    v_cvt_pk_bf16_f32 v39, v39, v39
    v_and_b32 v39, s62, v39
    v_add_f32 v39, v39, v61
    v_cvt_pk_bf16_f32 v39, v39, v39
    v_and_b32 v39, s62, v39
    v_mul_f32 v65, v39, v39
    v_fma_f32 v65, v65, s37, v64
    v_mul_f32 v65, v65, v39
    v_exp_f32 v65, v65
    s_nop 0
    v_add_f32 v65, 1.0, v65
    v_rcp_f32 v65, v65
    s_nop 0
    v_mul_f32 v39, v39, v65
    v_cvt_pk_bf16_f32 v40, v40, v40
    v_and_b32 v40, s62, v40
    v_add_f32 v40, v40, v50
    v_cvt_pk_bf16_f32 v40, v40, v40
    v_and_b32 v40, s62, v40
    v_mul_f32 v65, v40, v40
    v_fma_f32 v65, v65, s37, v64
    v_mul_f32 v65, v65, v40
    v_exp_f32 v65, v65
    s_nop 0
    v_add_f32 v65, 1.0, v65
    v_rcp_f32 v65, v65
    s_nop 0
    v_mul_f32 v40, v40, v65
    v_cvt_pk_bf16_f32 v41, v41, v41
    v_and_b32 v41, s62, v41
    v_add_f32 v41, v41, v54
    v_cvt_pk_bf16_f32 v41, v41, v41
    v_and_b32 v41, s62, v41
    v_mul_f32 v65, v41, v41
    v_fma_f32 v65, v65, s37, v64
    v_mul_f32 v65, v65, v41
    v_exp_f32 v65, v65
    s_nop 0
    v_add_f32 v65, 1.0, v65
    v_rcp_f32 v65, v65
    s_nop 0
    v_mul_f32 v41, v41, v65
    v_cvt_pk_bf16_f32 v42, v42, v42
    v_and_b32 v42, s62, v42
    v_add_f32 v42, v42, v58
    v_cvt_pk_bf16_f32 v42, v42, v42
    v_and_b32 v42, s62, v42
    v_mul_f32 v65, v42, v42
    v_fma_f32 v65, v65, s37, v64
    v_mul_f32 v65, v65, v42
    v_exp_f32 v65, v65
    s_nop 0
    v_add_f32 v65, 1.0, v65
    v_rcp_f32 v65, v65
    s_nop 0
    v_mul_f32 v42, v42, v65
    v_cvt_pk_bf16_f32 v43, v43, v43
    v_and_b32 v43, s62, v43
    v_add_f32 v43, v43, v62
    v_cvt_pk_bf16_f32 v43, v43, v43
    v_and_b32 v43, s62, v43
    v_mul_f32 v65, v43, v43
    v_fma_f32 v65, v65, s37, v64
    v_mul_f32 v65, v65, v43
    v_exp_f32 v65, v65
    s_nop 0
    v_add_f32 v65, 1.0, v65
    v_rcp_f32 v65, v65
    s_nop 0
    v_mul_f32 v43, v43, v65
    v_cvt_pk_bf16_f32 v44, v44, v44
    v_and_b32 v44, s62, v44
    v_add_f32 v44, v44, v51
    v_cvt_pk_bf16_f32 v44, v44, v44
    v_and_b32 v44, s62, v44
    v_mul_f32 v65, v44, v44
    v_fma_f32 v65, v65, s37, v64
    v_mul_f32 v65, v65, v44
    v_exp_f32 v65, v65
    s_nop 0
    v_add_f32 v65, 1.0, v65
    v_rcp_f32 v65, v65
    s_nop 0
    v_mul_f32 v44, v44, v65
    v_cvt_pk_bf16_f32 v45, v45, v45
    v_and_b32 v45, s62, v45
    v_add_f32 v45, v45, v55
    v_cvt_pk_bf16_f32 v45, v45, v45
    v_and_b32 v45, s62, v45
    v_mul_f32 v65, v45, v45
    v_fma_f32 v65, v65, s37, v64
    v_mul_f32 v65, v65, v45
    v_exp_f32 v65, v65
    s_nop 0
    v_add_f32 v65, 1.0, v65
    v_rcp_f32 v65, v65
    s_nop 0
    v_mul_f32 v45, v45, v65
    v_cvt_pk_bf16_f32 v46, v46, v46
    v_and_b32 v46, s62, v46
    v_add_f32 v46, v46, v59
    v_cvt_pk_bf16_f32 v46, v46, v46
    v_and_b32 v46, s62, v46
    v_mul_f32 v65, v46, v46
    v_fma_f32 v65, v65, s37, v64
    v_mul_f32 v65, v65, v46
    v_exp_f32 v65, v65
    s_nop 0
    v_add_f32 v65, 1.0, v65
    v_rcp_f32 v65, v65
    s_nop 0
    v_mul_f32 v46, v46, v65
    v_cvt_pk_bf16_f32 v47, v47, v47
    v_and_b32 v47, s62, v47
    v_add_f32 v47, v47, v63
    v_cvt_pk_bf16_f32 v47, v47, v47
    v_and_b32 v47, s62, v47
    v_mul_f32 v65, v47, v47
    v_fma_f32 v65, v65, s37, v64
    v_mul_f32 v65, v65, v47
    v_exp_f32 v65, v65
    s_nop 0
    v_add_f32 v65, 1.0, v65
    v_rcp_f32 v65, v65
    s_nop 0
    v_mul_f32 v47, v47, v65
    v_lshlrev_b32 v5, 14, v2
    v_lshl_add_u32 v5, v1, 4, v5
    s_lshl_b32 s36, s40, 16
    s_lshl_b32 s37, s41, 11
    s_add_u32 s36, s36, s37
    s_lshl_b32 s37, s28, 9
    s_add_u32 s36, s36, s37
    s_add_u32 s36, s36, 0x400000
    s_add_u32 s37, s36, 8192
    v_cvt_pk_bf16_f32 v68, v16, v20
    v_cvt_pk_bf16_f32 v69, v24, v28
    v_cvt_pk_bf16_f32 v70, v17, v21
    v_cvt_pk_bf16_f32 v71, v25, v29
    buffer_store_dwordx4 v[68:71], v5, s[4:7], s36 offen offset:0 sc1
    v_cvt_pk_bf16_f32 v72, v18, v22
    v_cvt_pk_bf16_f32 v73, v26, v30
    v_cvt_pk_bf16_f32 v74, v19, v23
    v_cvt_pk_bf16_f32 v75, v27, v31
    buffer_store_dwordx4 v[72:75], v5, s[4:7], s37 offen offset:0 sc1
    v_cvt_pk_bf16_f32 v76, v32, v36
    v_cvt_pk_bf16_f32 v77, v40, v44
    v_cvt_pk_bf16_f32 v78, v33, v37
    v_cvt_pk_bf16_f32 v79, v41, v45
    buffer_store_dwordx4 v[76:79], v5, s[4:7], s36 offen offset:256 sc1
    v_cvt_pk_bf16_f32 v80, v34, v38
    v_cvt_pk_bf16_f32 v81, v42, v46
    v_cvt_pk_bf16_f32 v82, v35, v39
    v_cvt_pk_bf16_f32 v83, v43, v47
    buffer_store_dwordx4 v[80:83], v5, s[4:7], s37 offen offset:256 sc1
    s_waitcnt vmcnt(0)
    s_barrier
    s_cmp_lg_u32 s28, 0
    s_cbranch_scc1 L_arr_43
    v_mov_b32 v250, 1
    v_mov_b32 v251, 12
    s_mov_b64 exec, 1
    buffer_atomic_add v250, v251, s[8:11], 0 offen sc0
    s_mov_b64 exec, -1
    s_waitcnt vmcnt(0)
    v_readfirstlane_b32 s30, v250
    s_add_u32 s30, s30, 1
    s_and_b32 s57, s30, 0xffff
    s_cmp_lg_u32 s57, 112
    s_cbranch_scc1 L_ae_44
    v_mov_b32 v250, s30
    v_mov_b32 v251, 140
    s_mov_b64 exec, 1
    buffer_store_dword v250, v251, s[8:11], 0 offen sc1
    s_mov_b64 exec, -1
L_ae_44:
L_arr_43:
L_no_b1:
    s_cmp_lt_u32 s31, 32
    s_cbranch_scc1 L_no_b2
    s_sub_u32 s39, s31, 32
    s_cmp_lg_u32 s28, 0
    s_cbranch_scc1 L_wgw_45
    v_mov_b32 v251, 140
L_pd_46:
    buffer_load_dword v250, v251, s[8:11], 0 offen sc1
    s_waitcnt vmcnt(0)
    v_readfirstlane_b32 s30, v250
    s_and_b32 s57, s30, 0xffff
    s_cmp_ge_u32 s57, 112
    s_cbranch_scc1 L_pdd_47
    s_sleep 4
    s_add_u32 s100, s100, 1
    s_bitcmp1_b32 s100, 15
    s_cbranch_scc1 L_exit
    s_branch L_pd_46
L_pdd_47:
L_wgw_45:
    s_barrier
    s_mov_b32 s12, s84
    s_mov_b32 s13, s85
    s_mov_b32 s14, 0x700000
    s_mov_b32 s15, 0x20000
    s_mov_b32 s16, s86
    s_mov_b32 s17, s87
    s_mov_b32 s18, 0x1000
    s_mov_b32 s19, 0x20000
    s_lshr_b32 s41, s39, 5
    s_and_b32 s40, s39, 31
    v_and_b32 v1, 15, v255
    v_lshrrev_b32 v2, 4, v255
    v_mul_u32_u24 v3, 32768, v2
    v_lshl_add_u32 v3, v1, 3, v3
    s_mul_i32 s36, s28, 1835008
    s_lshl_b32 s37, s40, 7
    s_add_u32 s36, s36, s37
    v_add_u32 v3, s36, v3
    v_lshlrev_b32 v4, 13, v2
    v_lshrrev_b32 v5, 2, v1
    v_lshl_add_u32 v4, v5, 7, v4
    v_and_b32 v5, 3, v1
    v_lshl_add_u32 v4, v5, 4, v4
    s_mul_i32 s36, s28, 458752
    s_lshl_b32 s37, s41, 11
    s_add_u32 s36, s36, s37
    s_add_u32 s36, s36, 0x400000
    v_add_u32 v4, s36, v4
    s_lshl_b32 s36, s40, 7
    v_lshlrev_b32 v5, 3, v1
    buffer_load_dwordx2 v[8:9], v5, s[16:19], s36 offen
    s_mov_b32 s36, 0x0
    buffer_load_dwordx2 v[16:17], v3, s[12:15], s36 offen
    s_mov_b32 s36, 0x1000
    buffer_load_dwordx2 v[18:19], v3, s[12:15], s36 offen
    s_mov_b32 s36, 0x2000
    buffer_load_dwordx2 v[20:21], v3, s[12:15], s36 offen
    s_mov_b32 s36, 0x3000
    buffer_load_dwordx2 v[22:23], v3, s[12:15], s36 offen
    s_mov_b32 s36, 0x4000
    buffer_load_dwordx2 v[24:25], v3, s[12:15], s36 offen
    s_mov_b32 s36, 0x5000
    buffer_load_dwordx2 v[26:27], v3, s[12:15], s36 offen
    s_mov_b32 s36, 0x6000
    buffer_load_dwordx2 v[28:29], v3, s[12:15], s36 offen
    s_mov_b32 s36, 0x7000
    buffer_load_dwordx2 v[30:31], v3, s[12:15], s36 offen
    s_mov_b32 s36, 0x0
    buffer_load_dwordx4 v[64:67], v4, s[4:7], s36 offen offset:0 sc1
    buffer_load_dwordx4 v[68:71], v4, s[4:7], s36 offen offset:64 sc1
    buffer_load_dwordx4 v[72:75], v4, s[4:7], s36 offen offset:512 sc1
    buffer_load_dwordx4 v[76:79], v4, s[4:7], s36 offen offset:576 sc1
    buffer_load_dwordx4 v[80:83], v4, s[4:7], s36 offen offset:1024 sc1
    buffer_load_dwordx4 v[84:87], v4, s[4:7], s36 offen offset:1088 sc1
    buffer_load_dwordx4 v[88:91], v4, s[4:7], s36 offen offset:1536 sc1
    buffer_load_dwordx4 v[92:95], v4, s[4:7], s36 offen offset:1600 sc1
    s_mov_b32 s36, 0x20000
    buffer_load_dwordx2 v[32:33], v3, s[12:15], s36 offen
    s_mov_b32 s36, 0x21000
    buffer_load_dwordx2 v[34:35], v3, s[12:15], s36 offen
    s_mov_b32 s36, 0x22000
    buffer_load_dwordx2 v[36:37], v3, s[12:15], s36 offen
    s_mov_b32 s36, 0x23000
    buffer_load_dwordx2 v[38:39], v3, s[12:15], s36 offen
    s_mov_b32 s36, 0x24000
    buffer_load_dwordx2 v[40:41], v3, s[12:15], s36 offen
    s_mov_b32 s36, 0x25000
    buffer_load_dwordx2 v[42:43], v3, s[12:15], s36 offen
    s_mov_b32 s36, 0x26000
    buffer_load_dwordx2 v[44:45], v3, s[12:15], s36 offen
    s_mov_b32 s36, 0x27000
    buffer_load_dwordx2 v[46:47], v3, s[12:15], s36 offen
    s_mov_b32 s36, 0x8000
    buffer_load_dwordx4 v[96:99], v4, s[4:7], s36 offen offset:0 sc1
    buffer_load_dwordx4 v[100:103], v4, s[4:7], s36 offen offset:64 sc1
    buffer_load_dwordx4 v[104:107], v4, s[4:7], s36 offen offset:512 sc1
    buffer_load_dwordx4 v[108:111], v4, s[4:7], s36 offen offset:576 sc1
    buffer_load_dwordx4 v[112:115], v4, s[4:7], s36 offen offset:1024 sc1
    buffer_load_dwordx4 v[116:119], v4, s[4:7], s36 offen offset:1088 sc1
    buffer_load_dwordx4 v[120:123], v4, s[4:7], s36 offen offset:1536 sc1
    buffer_load_dwordx4 v[124:127], v4, s[4:7], s36 offen offset:1600 sc1
    s_mov_b32 s36, 0x40000
    buffer_load_dwordx2 v[48:49], v3, s[12:15], s36 offen
    s_mov_b32 s36, 0x41000
    buffer_load_dwordx2 v[50:51], v3, s[12:15], s36 offen
    s_mov_b32 s36, 0x42000
    buffer_load_dwordx2 v[52:53], v3, s[12:15], s36 offen
    s_mov_b32 s36, 0x43000
    buffer_load_dwordx2 v[54:55], v3, s[12:15], s36 offen
    s_mov_b32 s36, 0x44000
    buffer_load_dwordx2 v[56:57], v3, s[12:15], s36 offen
    s_mov_b32 s36, 0x45000
    buffer_load_dwordx2 v[58:59], v3, s[12:15], s36 offen
    s_mov_b32 s36, 0x46000
    buffer_load_dwordx2 v[60:61], v3, s[12:15], s36 offen
    s_mov_b32 s36, 0x47000
    buffer_load_dwordx2 v[62:63], v3, s[12:15], s36 offen
    s_mov_b32 s36, 0x10000
    buffer_load_dwordx4 v[128:131], v4, s[4:7], s36 offen offset:0 sc1
    buffer_load_dwordx4 v[132:135], v4, s[4:7], s36 offen offset:64 sc1
    buffer_load_dwordx4 v[136:139], v4, s[4:7], s36 offen offset:512 sc1
    buffer_load_dwordx4 v[140:143], v4, s[4:7], s36 offen offset:576 sc1
    buffer_load_dwordx4 v[144:147], v4, s[4:7], s36 offen offset:1024 sc1
    buffer_load_dwordx4 v[148:151], v4, s[4:7], s36 offen offset:1088 sc1
    buffer_load_dwordx4 v[152:155], v4, s[4:7], s36 offen offset:1536 sc1
    buffer_load_dwordx4 v[156:159], v4, s[4:7], s36 offen offset:1600 sc1
    s_waitcnt vmcnt(40)
    v_perm_b32 v160, v18, v16, s60
    v_perm_b32 v161, v22, v20, s60
    v_perm_b32 v162, v26, v24, s60
    v_perm_b32 v163, v30, v28, s60
    v_perm_b32 v164, v18, v16, s61
    v_perm_b32 v165, v22, v20, s61
    v_perm_b32 v166, v26, v24, s61
    v_perm_b32 v167, v30, v28, s61
    v_perm_b32 v168, v19, v17, s60
    v_perm_b32 v169, v23, v21, s60
    v_perm_b32 v170, v27, v25, s60
    v_perm_b32 v171, v31, v29, s60
    v_perm_b32 v172, v19, v17, s61
    v_perm_b32 v173, v23, v21, s61
    v_perm_b32 v174, v27, v25, s61
    v_perm_b32 v175, v31, v29, s61
    s_waitcnt vmcnt(39)
    v_mfma_f32_16x16x32_bf16 a[0:3], v[64:67], v[160:163], 0
    v_mfma_f32_16x16x32_bf16 a[4:7], v[64:67], v[164:167], 0
    v_mfma_f32_16x16x32_bf16 a[8:11], v[64:67], v[168:171], 0
    v_mfma_f32_16x16x32_bf16 a[12:15], v[64:67], v[172:175], 0
    s_waitcnt vmcnt(38)
    v_mfma_f32_16x16x32_bf16 a[16:19], v[68:71], v[160:163], 0
    v_mfma_f32_16x16x32_bf16 a[20:23], v[68:71], v[164:167], 0
    v_mfma_f32_16x16x32_bf16 a[24:27], v[68:71], v[168:171], 0
    v_mfma_f32_16x16x32_bf16 a[28:31], v[68:71], v[172:175], 0
    s_waitcnt vmcnt(37)
    v_mfma_f32_16x16x32_bf16 a[32:35], v[72:75], v[160:163], 0
    v_mfma_f32_16x16x32_bf16 a[36:39], v[72:75], v[164:167], 0
    v_mfma_f32_16x16x32_bf16 a[40:43], v[72:75], v[168:171], 0
    v_mfma_f32_16x16x32_bf16 a[44:47], v[72:75], v[172:175], 0
    s_waitcnt vmcnt(36)
    v_mfma_f32_16x16x32_bf16 a[48:51], v[76:79], v[160:163], 0
    v_mfma_f32_16x16x32_bf16 a[52:55], v[76:79], v[164:167], 0
    v_mfma_f32_16x16x32_bf16 a[56:59], v[76:79], v[168:171], 0
    v_mfma_f32_16x16x32_bf16 a[60:63], v[76:79], v[172:175], 0
    s_waitcnt vmcnt(35)
    v_mfma_f32_16x16x32_bf16 a[64:67], v[80:83], v[160:163], 0
    v_mfma_f32_16x16x32_bf16 a[68:71], v[80:83], v[164:167], 0
    v_mfma_f32_16x16x32_bf16 a[72:75], v[80:83], v[168:171], 0
    v_mfma_f32_16x16x32_bf16 a[76:79], v[80:83], v[172:175], 0
    s_waitcnt vmcnt(34)
    v_mfma_f32_16x16x32_bf16 a[80:83], v[84:87], v[160:163], 0
    v_mfma_f32_16x16x32_bf16 a[84:87], v[84:87], v[164:167], 0
    v_mfma_f32_16x16x32_bf16 a[88:91], v[84:87], v[168:171], 0
    v_mfma_f32_16x16x32_bf16 a[92:95], v[84:87], v[172:175], 0
    s_waitcnt vmcnt(33)
    v_mfma_f32_16x16x32_bf16 a[96:99], v[88:91], v[160:163], 0
    v_mfma_f32_16x16x32_bf16 a[100:103], v[88:91], v[164:167], 0
    v_mfma_f32_16x16x32_bf16 a[104:107], v[88:91], v[168:171], 0
    v_mfma_f32_16x16x32_bf16 a[108:111], v[88:91], v[172:175], 0
    s_waitcnt vmcnt(32)
    v_mfma_f32_16x16x32_bf16 a[112:115], v[92:95], v[160:163], 0
    v_mfma_f32_16x16x32_bf16 a[116:119], v[92:95], v[164:167], 0
    v_mfma_f32_16x16x32_bf16 a[120:123], v[92:95], v[168:171], 0
    v_mfma_f32_16x16x32_bf16 a[124:127], v[92:95], v[172:175], 0
    s_mov_b32 s36, 0x60000
    buffer_load_dwordx2 v[16:17], v3, s[12:15], s36 offen
    s_mov_b32 s36, 0x61000
    buffer_load_dwordx2 v[18:19], v3, s[12:15], s36 offen
    s_mov_b32 s36, 0x62000
    buffer_load_dwordx2 v[20:21], v3, s[12:15], s36 offen
    s_mov_b32 s36, 0x63000
    buffer_load_dwordx2 v[22:23], v3, s[12:15], s36 offen
    s_mov_b32 s36, 0x64000
    buffer_load_dwordx2 v[24:25], v3, s[12:15], s36 offen
    s_mov_b32 s36, 0x65000
    buffer_load_dwordx2 v[26:27], v3, s[12:15], s36 offen
    s_mov_b32 s36, 0x66000
    buffer_load_dwordx2 v[28:29], v3, s[12:15], s36 offen
    s_mov_b32 s36, 0x67000
    buffer_load_dwordx2 v[30:31], v3, s[12:15], s36 offen
    s_mov_b32 s36, 0x18000
    buffer_load_dwordx4 v[64:67], v4, s[4:7], s36 offen offset:0 sc1
    buffer_load_dwordx4 v[68:71], v4, s[4:7], s36 offen offset:64 sc1
    buffer_load_dwordx4 v[72:75], v4, s[4:7], s36 offen offset:512 sc1
    buffer_load_dwordx4 v[76:79], v4, s[4:7], s36 offen offset:576 sc1
    buffer_load_dwordx4 v[80:83], v4, s[4:7], s36 offen offset:1024 sc1
    buffer_load_dwordx4 v[84:87], v4, s[4:7], s36 offen offset:1088 sc1
    buffer_load_dwordx4 v[88:91], v4, s[4:7], s36 offen offset:1536 sc1
    buffer_load_dwordx4 v[92:95], v4, s[4:7], s36 offen offset:1600 sc1
    s_waitcnt vmcnt(40)
    v_perm_b32 v160, v34, v32, s60
    v_perm_b32 v161, v38, v36, s60
    v_perm_b32 v162, v42, v40, s60
    v_perm_b32 v163, v46, v44, s60
    v_perm_b32 v164, v34, v32, s61
    v_perm_b32 v165, v38, v36, s61
    v_perm_b32 v166, v42, v40, s61
    v_perm_b32 v167, v46, v44, s61
    v_perm_b32 v168, v35, v33, s60
    v_perm_b32 v169, v39, v37, s60
    v_perm_b32 v170, v43, v41, s60
    v_perm_b32 v171, v47, v45, s60
    v_perm_b32 v172, v35, v33, s61
    v_perm_b32 v173, v39, v37, s61
    v_perm_b32 v174, v43, v41, s61
    v_perm_b32 v175, v47, v45, s61
    s_waitcnt vmcnt(39)
    v_mfma_f32_16x16x32_bf16 a[0:3], v[96:99], v[160:163], a[0:3]
    v_mfma_f32_16x16x32_bf16 a[4:7], v[96:99], v[164:167], a[4:7]
    v_mfma_f32_16x16x32_bf16 a[8:11], v[96:99], v[168:171], a[8:11]
    v_mfma_f32_16x16x32_bf16 a[12:15], v[96:99], v[172:175], a[12:15]
    s_waitcnt vmcnt(38)
    v_mfma_f32_16x16x32_bf16 a[16:19], v[100:103], v[160:163], a[16:19]
    v_mfma_f32_16x16x32_bf16 a[20:23], v[100:103], v[164:167], a[20:23]
    v_mfma_f32_16x16x32_bf16 a[24:27], v[100:103], v[168:171], a[24:27]
    v_mfma_f32_16x16x32_bf16 a[28:31], v[100:103], v[172:175], a[28:31]
    s_waitcnt vmcnt(37)
    v_mfma_f32_16x16x32_bf16 a[32:35], v[104:107], v[160:163], a[32:35]
    v_mfma_f32_16x16x32_bf16 a[36:39], v[104:107], v[164:167], a[36:39]
    v_mfma_f32_16x16x32_bf16 a[40:43], v[104:107], v[168:171], a[40:43]
    v_mfma_f32_16x16x32_bf16 a[44:47], v[104:107], v[172:175], a[44:47]
    s_waitcnt vmcnt(36)
    v_mfma_f32_16x16x32_bf16 a[48:51], v[108:111], v[160:163], a[48:51]
    v_mfma_f32_16x16x32_bf16 a[52:55], v[108:111], v[164:167], a[52:55]
    v_mfma_f32_16x16x32_bf16 a[56:59], v[108:111], v[168:171], a[56:59]
    v_mfma_f32_16x16x32_bf16 a[60:63], v[108:111], v[172:175], a[60:63]
    s_waitcnt vmcnt(35)
    v_mfma_f32_16x16x32_bf16 a[64:67], v[112:115], v[160:163], a[64:67]
    v_mfma_f32_16x16x32_bf16 a[68:71], v[112:115], v[164:167], a[68:71]
    v_mfma_f32_16x16x32_bf16 a[72:75], v[112:115], v[168:171], a[72:75]
    v_mfma_f32_16x16x32_bf16 a[76:79], v[112:115], v[172:175], a[76:79]
    s_waitcnt vmcnt(34)
    v_mfma_f32_16x16x32_bf16 a[80:83], v[116:119], v[160:163], a[80:83]
    v_mfma_f32_16x16x32_bf16 a[84:87], v[116:119], v[164:167], a[84:87]
    v_mfma_f32_16x16x32_bf16 a[88:91], v[116:119], v[168:171], a[88:91]
    v_mfma_f32_16x16x32_bf16 a[92:95], v[116:119], v[172:175], a[92:95]
    s_waitcnt vmcnt(33)
    v_mfma_f32_16x16x32_bf16 a[96:99], v[120:123], v[160:163], a[96:99]
    v_mfma_f32_16x16x32_bf16 a[100:103], v[120:123], v[164:167], a[100:103]
    v_mfma_f32_16x16x32_bf16 a[104:107], v[120:123], v[168:171], a[104:107]
    v_mfma_f32_16x16x32_bf16 a[108:111], v[120:123], v[172:175], a[108:111]
    s_waitcnt vmcnt(32)
    v_mfma_f32_16x16x32_bf16 a[112:115], v[124:127], v[160:163], a[112:115]
    v_mfma_f32_16x16x32_bf16 a[116:119], v[124:127], v[164:167], a[116:119]
    v_mfma_f32_16x16x32_bf16 a[120:123], v[124:127], v[168:171], a[120:123]
    v_mfma_f32_16x16x32_bf16 a[124:127], v[124:127], v[172:175], a[124:127]
    s_mov_b32 s36, 0x80000
    buffer_load_dwordx2 v[32:33], v3, s[12:15], s36 offen
    s_mov_b32 s36, 0x81000
    buffer_load_dwordx2 v[34:35], v3, s[12:15], s36 offen
    s_mov_b32 s36, 0x82000
    buffer_load_dwordx2 v[36:37], v3, s[12:15], s36 offen
    s_mov_b32 s36, 0x83000
    buffer_load_dwordx2 v[38:39], v3, s[12:15], s36 offen
    s_mov_b32 s36, 0x84000
    buffer_load_dwordx2 v[40:41], v3, s[12:15], s36 offen
    s_mov_b32 s36, 0x85000
    buffer_load_dwordx2 v[42:43], v3, s[12:15], s36 offen
    s_mov_b32 s36, 0x86000
    buffer_load_dwordx2 v[44:45], v3, s[12:15], s36 offen
    s_mov_b32 s36, 0x87000
    buffer_load_dwordx2 v[46:47], v3, s[12:15], s36 offen
    s_mov_b32 s36, 0x20000
    buffer_load_dwordx4 v[96:99], v4, s[4:7], s36 offen offset:0 sc1
    buffer_load_dwordx4 v[100:103], v4, s[4:7], s36 offen offset:64 sc1
    buffer_load_dwordx4 v[104:107], v4, s[4:7], s36 offen offset:512 sc1
    buffer_load_dwordx4 v[108:111], v4, s[4:7], s36 offen offset:576 sc1
    buffer_load_dwordx4 v[112:115], v4, s[4:7], s36 offen offset:1024 sc1
    buffer_load_dwordx4 v[116:119], v4, s[4:7], s36 offen offset:1088 sc1
    buffer_load_dwordx4 v[120:123], v4, s[4:7], s36 offen offset:1536 sc1
    buffer_load_dwordx4 v[124:127], v4, s[4:7], s36 offen offset:1600 sc1
    s_waitcnt vmcnt(40)
    v_perm_b32 v160, v50, v48, s60
    v_perm_b32 v161, v54, v52, s60
    v_perm_b32 v162, v58, v56, s60
    v_perm_b32 v163, v62, v60, s60
    v_perm_b32 v164, v50, v48, s61
    v_perm_b32 v165, v54, v52, s61
    v_perm_b32 v166, v58, v56, s61
    v_perm_b32 v167, v62, v60, s61
    v_perm_b32 v168, v51, v49, s60
    v_perm_b32 v169, v55, v53, s60
    v_perm_b32 v170, v59, v57, s60
    v_perm_b32 v171, v63, v61, s60
    v_perm_b32 v172, v51, v49, s61
    v_perm_b32 v173, v55, v53, s61
    v_perm_b32 v174, v59, v57, s61
    v_perm_b32 v175, v63, v61, s61
    s_waitcnt vmcnt(39)
    v_mfma_f32_16x16x32_bf16 a[0:3], v[128:131], v[160:163], a[0:3]
    v_mfma_f32_16x16x32_bf16 a[4:7], v[128:131], v[164:167], a[4:7]
    v_mfma_f32_16x16x32_bf16 a[8:11], v[128:131], v[168:171], a[8:11]
    v_mfma_f32_16x16x32_bf16 a[12:15], v[128:131], v[172:175], a[12:15]
    s_waitcnt vmcnt(38)
    v_mfma_f32_16x16x32_bf16 a[16:19], v[132:135], v[160:163], a[16:19]
    v_mfma_f32_16x16x32_bf16 a[20:23], v[132:135], v[164:167], a[20:23]
    v_mfma_f32_16x16x32_bf16 a[24:27], v[132:135], v[168:171], a[24:27]
    v_mfma_f32_16x16x32_bf16 a[28:31], v[132:135], v[172:175], a[28:31]
    s_waitcnt vmcnt(37)
    v_mfma_f32_16x16x32_bf16 a[32:35], v[136:139], v[160:163], a[32:35]
    v_mfma_f32_16x16x32_bf16 a[36:39], v[136:139], v[164:167], a[36:39]
    v_mfma_f32_16x16x32_bf16 a[40:43], v[136:139], v[168:171], a[40:43]
    v_mfma_f32_16x16x32_bf16 a[44:47], v[136:139], v[172:175], a[44:47]
    s_waitcnt vmcnt(36)
    v_mfma_f32_16x16x32_bf16 a[48:51], v[140:143], v[160:163], a[48:51]
    v_mfma_f32_16x16x32_bf16 a[52:55], v[140:143], v[164:167], a[52:55]
    v_mfma_f32_16x16x32_bf16 a[56:59], v[140:143], v[168:171], a[56:59]
    v_mfma_f32_16x16x32_bf16 a[60:63], v[140:143], v[172:175], a[60:63]
    s_waitcnt vmcnt(35)
    v_mfma_f32_16x16x32_bf16 a[64:67], v[144:147], v[160:163], a[64:67]
    v_mfma_f32_16x16x32_bf16 a[68:71], v[144:147], v[164:167], a[68:71]
    v_mfma_f32_16x16x32_bf16 a[72:75], v[144:147], v[168:171], a[72:75]
    v_mfma_f32_16x16x32_bf16 a[76:79], v[144:147], v[172:175], a[76:79]
    s_waitcnt vmcnt(34)
    v_mfma_f32_16x16x32_bf16 a[80:83], v[148:151], v[160:163], a[80:83]
    v_mfma_f32_16x16x32_bf16 a[84:87], v[148:151], v[164:167], a[84:87]
    v_mfma_f32_16x16x32_bf16 a[88:91], v[148:151], v[168:171], a[88:91]
    v_mfma_f32_16x16x32_bf16 a[92:95], v[148:151], v[172:175], a[92:95]
    s_waitcnt vmcnt(33)
    v_mfma_f32_16x16x32_bf16 a[96:99], v[152:155], v[160:163], a[96:99]
    v_mfma_f32_16x16x32_bf16 a[100:103], v[152:155], v[164:167], a[100:103]
    v_mfma_f32_16x16x32_bf16 a[104:107], v[152:155], v[168:171], a[104:107]
    v_mfma_f32_16x16x32_bf16 a[108:111], v[152:155], v[172:175], a[108:111]
    s_waitcnt vmcnt(32)
    v_mfma_f32_16x16x32_bf16 a[112:115], v[156:159], v[160:163], a[112:115]
    v_mfma_f32_16x16x32_bf16 a[116:119], v[156:159], v[164:167], a[116:119]
    v_mfma_f32_16x16x32_bf16 a[120:123], v[156:159], v[168:171], a[120:123]
    v_mfma_f32_16x16x32_bf16 a[124:127], v[156:159], v[172:175], a[124:127]
    s_mov_b32 s36, 0xa0000
    buffer_load_dwordx2 v[48:49], v3, s[12:15], s36 offen
    s_mov_b32 s36, 0xa1000
    buffer_load_dwordx2 v[50:51], v3, s[12:15], s36 offen
    s_mov_b32 s36, 0xa2000
    buffer_load_dwordx2 v[52:53], v3, s[12:15], s36 offen
    s_mov_b32 s36, 0xa3000
    buffer_load_dwordx2 v[54:55], v3, s[12:15], s36 offen
    s_mov_b32 s36, 0xa4000
    buffer_load_dwordx2 v[56:57], v3, s[12:15], s36 offen
    s_mov_b32 s36, 0xa5000
    buffer_load_dwordx2 v[58:59], v3, s[12:15], s36 offen
    s_mov_b32 s36, 0xa6000
    buffer_load_dwordx2 v[60:61], v3, s[12:15], s36 offen
    s_mov_b32 s36, 0xa7000
    buffer_load_dwordx2 v[62:63], v3, s[12:15], s36 offen
    s_mov_b32 s36, 0x28000
    buffer_load_dwordx4 v[128:131], v4, s[4:7], s36 offen offset:0 sc1
    buffer_load_dwordx4 v[132:135], v4, s[4:7], s36 offen offset:64 sc1
    buffer_load_dwordx4 v[136:139], v4, s[4:7], s36 offen offset:512 sc1
    buffer_load_dwordx4 v[140:143], v4, s[4:7], s36 offen offset:576 sc1
    buffer_load_dwordx4 v[144:147], v4, s[4:7], s36 offen offset:1024 sc1
    buffer_load_dwordx4 v[148:151], v4, s[4:7], s36 offen offset:1088 sc1
    buffer_load_dwordx4 v[152:155], v4, s[4:7], s36 offen offset:1536 sc1
    buffer_load_dwordx4 v[156:159], v4, s[4:7], s36 offen offset:1600 sc1
    s_waitcnt vmcnt(40)
    v_perm_b32 v160, v18, v16, s60
    v_perm_b32 v161, v22, v20, s60
    v_perm_b32 v162, v26, v24, s60
    v_perm_b32 v163, v30, v28, s60
    v_perm_b32 v164, v18, v16, s61
    v_perm_b32 v165, v22, v20, s61
    v_perm_b32 v166, v26, v24, s61
    v_perm_b32 v167, v30, v28, s61
    v_perm_b32 v168, v19, v17, s60
    v_perm_b32 v169, v23, v21, s60
    v_perm_b32 v170, v27, v25, s60
    v_perm_b32 v171, v31, v29, s60
    v_perm_b32 v172, v19, v17, s61
    v_perm_b32 v173, v23, v21, s61
    v_perm_b32 v174, v27, v25, s61
    v_perm_b32 v175, v31, v29, s61
    s_waitcnt vmcnt(39)
    v_mfma_f32_16x16x32_bf16 a[0:3], v[64:67], v[160:163], a[0:3]
    v_mfma_f32_16x16x32_bf16 a[4:7], v[64:67], v[164:167], a[4:7]
    v_mfma_f32_16x16x32_bf16 a[8:11], v[64:67], v[168:171], a[8:11]
    v_mfma_f32_16x16x32_bf16 a[12:15], v[64:67], v[172:175], a[12:15]
    s_waitcnt vmcnt(38)
    v_mfma_f32_16x16x32_bf16 a[16:19], v[68:71], v[160:163], a[16:19]
    v_mfma_f32_16x16x32_bf16 a[20:23], v[68:71], v[164:167], a[20:23]
    v_mfma_f32_16x16x32_bf16 a[24:27], v[68:71], v[168:171], a[24:27]
    v_mfma_f32_16x16x32_bf16 a[28:31], v[68:71], v[172:175], a[28:31]
    s_waitcnt vmcnt(37)
    v_mfma_f32_16x16x32_bf16 a[32:35], v[72:75], v[160:163], a[32:35]
    v_mfma_f32_16x16x32_bf16 a[36:39], v[72:75], v[164:167], a[36:39]
    v_mfma_f32_16x16x32_bf16 a[40:43], v[72:75], v[168:171], a[40:43]
    v_mfma_f32_16x16x32_bf16 a[44:47], v[72:75], v[172:175], a[44:47]
    s_waitcnt vmcnt(36)
    v_mfma_f32_16x16x32_bf16 a[48:51], v[76:79], v[160:163], a[48:51]
    v_mfma_f32_16x16x32_bf16 a[52:55], v[76:79], v[164:167], a[52:55]
    v_mfma_f32_16x16x32_bf16 a[56:59], v[76:79], v[168:171], a[56:59]
    v_mfma_f32_16x16x32_bf16 a[60:63], v[76:79], v[172:175], a[60:63]
    s_waitcnt vmcnt(35)
    v_mfma_f32_16x16x32_bf16 a[64:67], v[80:83], v[160:163], a[64:67]
    v_mfma_f32_16x16x32_bf16 a[68:71], v[80:83], v[164:167], a[68:71]
    v_mfma_f32_16x16x32_bf16 a[72:75], v[80:83], v[168:171], a[72:75]
    v_mfma_f32_16x16x32_bf16 a[76:79], v[80:83], v[172:175], a[76:79]
    s_waitcnt vmcnt(34)
    v_mfma_f32_16x16x32_bf16 a[80:83], v[84:87], v[160:163], a[80:83]
    v_mfma_f32_16x16x32_bf16 a[84:87], v[84:87], v[164:167], a[84:87]
    v_mfma_f32_16x16x32_bf16 a[88:91], v[84:87], v[168:171], a[88:91]
    v_mfma_f32_16x16x32_bf16 a[92:95], v[84:87], v[172:175], a[92:95]
    s_waitcnt vmcnt(33)
    v_mfma_f32_16x16x32_bf16 a[96:99], v[88:91], v[160:163], a[96:99]
    v_mfma_f32_16x16x32_bf16 a[100:103], v[88:91], v[164:167], a[100:103]
    v_mfma_f32_16x16x32_bf16 a[104:107], v[88:91], v[168:171], a[104:107]
    v_mfma_f32_16x16x32_bf16 a[108:111], v[88:91], v[172:175], a[108:111]
    s_waitcnt vmcnt(32)
    v_mfma_f32_16x16x32_bf16 a[112:115], v[92:95], v[160:163], a[112:115]
    v_mfma_f32_16x16x32_bf16 a[116:119], v[92:95], v[164:167], a[116:119]
    v_mfma_f32_16x16x32_bf16 a[120:123], v[92:95], v[168:171], a[120:123]
    v_mfma_f32_16x16x32_bf16 a[124:127], v[92:95], v[172:175], a[124:127]
    s_mov_b32 s36, 0xc0000
    buffer_load_dwordx2 v[16:17], v3, s[12:15], s36 offen
    s_mov_b32 s36, 0xc1000
    buffer_load_dwordx2 v[18:19], v3, s[12:15], s36 offen
    s_mov_b32 s36, 0xc2000
    buffer_load_dwordx2 v[20:21], v3, s[12:15], s36 offen
    s_mov_b32 s36, 0xc3000
    buffer_load_dwordx2 v[22:23], v3, s[12:15], s36 offen
    s_mov_b32 s36, 0xc4000
    buffer_load_dwordx2 v[24:25], v3, s[12:15], s36 offen
    s_mov_b32 s36, 0xc5000
    buffer_load_dwordx2 v[26:27], v3, s[12:15], s36 offen
    s_mov_b32 s36, 0xc6000
    buffer_load_dwordx2 v[28:29], v3, s[12:15], s36 offen
    s_mov_b32 s36, 0xc7000
    buffer_load_dwordx2 v[30:31], v3, s[12:15], s36 offen
    s_mov_b32 s36, 0x30000
    buffer_load_dwordx4 v[64:67], v4, s[4:7], s36 offen offset:0 sc1
    buffer_load_dwordx4 v[68:71], v4, s[4:7], s36 offen offset:64 sc1
    buffer_load_dwordx4 v[72:75], v4, s[4:7], s36 offen offset:512 sc1
    buffer_load_dwordx4 v[76:79], v4, s[4:7], s36 offen offset:576 sc1
    buffer_load_dwordx4 v[80:83], v4, s[4:7], s36 offen offset:1024 sc1
    buffer_load_dwordx4 v[84:87], v4, s[4:7], s36 offen offset:1088 sc1
    buffer_load_dwordx4 v[88:91], v4, s[4:7], s36 offen offset:1536 sc1
    buffer_load_dwordx4 v[92:95], v4, s[4:7], s36 offen offset:1600 sc1
    s_waitcnt vmcnt(40)
    v_perm_b32 v160, v34, v32, s60
    v_perm_b32 v161, v38, v36, s60
    v_perm_b32 v162, v42, v40, s60
    v_perm_b32 v163, v46, v44, s60
    v_perm_b32 v164, v34, v32, s61
    v_perm_b32 v165, v38, v36, s61
    v_perm_b32 v166, v42, v40, s61
    v_perm_b32 v167, v46, v44, s61
    v_perm_b32 v168, v35, v33, s60
    v_perm_b32 v169, v39, v37, s60
    v_perm_b32 v170, v43, v41, s60
    v_perm_b32 v171, v47, v45, s60
    v_perm_b32 v172, v35, v33, s61
    v_perm_b32 v173, v39, v37, s61
    v_perm_b32 v174, v43, v41, s61
    v_perm_b32 v175, v47, v45, s61
    s_waitcnt vmcnt(39)
    v_mfma_f32_16x16x32_bf16 a[0:3], v[96:99], v[160:163], a[0:3]
    v_mfma_f32_16x16x32_bf16 a[4:7], v[96:99], v[164:167], a[4:7]
    v_mfma_f32_16x16x32_bf16 a[8:11], v[96:99], v[168:171], a[8:11]
    v_mfma_f32_16x16x32_bf16 a[12:15], v[96:99], v[172:175], a[12:15]
    s_waitcnt vmcnt(38)
    v_mfma_f32_16x16x32_bf16 a[16:19], v[100:103], v[160:163], a[16:19]
    v_mfma_f32_16x16x32_bf16 a[20:23], v[100:103], v[164:167], a[20:23]
    v_mfma_f32_16x16x32_bf16 a[24:27], v[100:103], v[168:171], a[24:27]
    v_mfma_f32_16x16x32_bf16 a[28:31], v[100:103], v[172:175], a[28:31]
    s_waitcnt vmcnt(37)
    v_mfma_f32_16x16x32_bf16 a[32:35], v[104:107], v[160:163], a[32:35]
    v_mfma_f32_16x16x32_bf16 a[36:39], v[104:107], v[164:167], a[36:39]
    v_mfma_f32_16x16x32_bf16 a[40:43], v[104:107], v[168:171], a[40:43]
    v_mfma_f32_16x16x32_bf16 a[44:47], v[104:107], v[172:175], a[44:47]
    s_waitcnt vmcnt(36)
    v_mfma_f32_16x16x32_bf16 a[48:51], v[108:111], v[160:163], a[48:51]
    v_mfma_f32_16x16x32_bf16 a[52:55], v[108:111], v[164:167], a[52:55]
    v_mfma_f32_16x16x32_bf16 a[56:59], v[108:111], v[168:171], a[56:59]
    v_mfma_f32_16x16x32_bf16 a[60:63], v[108:111], v[172:175], a[60:63]
    s_waitcnt vmcnt(35)
    v_mfma_f32_16x16x32_bf16 a[64:67], v[112:115], v[160:163], a[64:67]
    v_mfma_f32_16x16x32_bf16 a[68:71], v[112:115], v[164:167], a[68:71]
    v_mfma_f32_16x16x32_bf16 a[72:75], v[112:115], v[168:171], a[72:75]
    v_mfma_f32_16x16x32_bf16 a[76:79], v[112:115], v[172:175], a[76:79]
    s_waitcnt vmcnt(34)
    v_mfma_f32_16x16x32_bf16 a[80:83], v[116:119], v[160:163], a[80:83]
    v_mfma_f32_16x16x32_bf16 a[84:87], v[116:119], v[164:167], a[84:87]
    v_mfma_f32_16x16x32_bf16 a[88:91], v[116:119], v[168:171], a[88:91]
    v_mfma_f32_16x16x32_bf16 a[92:95], v[116:119], v[172:175], a[92:95]
    s_waitcnt vmcnt(33)
    v_mfma_f32_16x16x32_bf16 a[96:99], v[120:123], v[160:163], a[96:99]
    v_mfma_f32_16x16x32_bf16 a[100:103], v[120:123], v[164:167], a[100:103]
    v_mfma_f32_16x16x32_bf16 a[104:107], v[120:123], v[168:171], a[104:107]
    v_mfma_f32_16x16x32_bf16 a[108:111], v[120:123], v[172:175], a[108:111]
    s_waitcnt vmcnt(32)
    v_mfma_f32_16x16x32_bf16 a[112:115], v[124:127], v[160:163], a[112:115]
    v_mfma_f32_16x16x32_bf16 a[116:119], v[124:127], v[164:167], a[116:119]
    v_mfma_f32_16x16x32_bf16 a[120:123], v[124:127], v[168:171], a[120:123]
    v_mfma_f32_16x16x32_bf16 a[124:127], v[124:127], v[172:175], a[124:127]
    s_mov_b32 s36, 0xe0000
    buffer_load_dwordx2 v[32:33], v3, s[12:15], s36 offen
    s_mov_b32 s36, 0xe1000
    buffer_load_dwordx2 v[34:35], v3, s[12:15], s36 offen
    s_mov_b32 s36, 0xe2000
    buffer_load_dwordx2 v[36:37], v3, s[12:15], s36 offen
    s_mov_b32 s36, 0xe3000
    buffer_load_dwordx2 v[38:39], v3, s[12:15], s36 offen
    s_mov_b32 s36, 0xe4000
    buffer_load_dwordx2 v[40:41], v3, s[12:15], s36 offen
    s_mov_b32 s36, 0xe5000
    buffer_load_dwordx2 v[42:43], v3, s[12:15], s36 offen
    s_mov_b32 s36, 0xe6000
    buffer_load_dwordx2 v[44:45], v3, s[12:15], s36 offen
    s_mov_b32 s36, 0xe7000
    buffer_load_dwordx2 v[46:47], v3, s[12:15], s36 offen
    s_mov_b32 s36, 0x38000
    buffer_load_dwordx4 v[96:99], v4, s[4:7], s36 offen offset:0 sc1
    buffer_load_dwordx4 v[100:103], v4, s[4:7], s36 offen offset:64 sc1
    buffer_load_dwordx4 v[104:107], v4, s[4:7], s36 offen offset:512 sc1
    buffer_load_dwordx4 v[108:111], v4, s[4:7], s36 offen offset:576 sc1
    buffer_load_dwordx4 v[112:115], v4, s[4:7], s36 offen offset:1024 sc1
    buffer_load_dwordx4 v[116:119], v4, s[4:7], s36 offen offset:1088 sc1
    buffer_load_dwordx4 v[120:123], v4, s[4:7], s36 offen offset:1536 sc1
    buffer_load_dwordx4 v[124:127], v4, s[4:7], s36 offen offset:1600 sc1
    s_waitcnt vmcnt(40)
    v_perm_b32 v160, v50, v48, s60
    v_perm_b32 v161, v54, v52, s60
    v_perm_b32 v162, v58, v56, s60
    v_perm_b32 v163, v62, v60, s60
    v_perm_b32 v164, v50, v48, s61
    v_perm_b32 v165, v54, v52, s61
    v_perm_b32 v166, v58, v56, s61
    v_perm_b32 v167, v62, v60, s61
    v_perm_b32 v168, v51, v49, s60
    v_perm_b32 v169, v55, v53, s60
    v_perm_b32 v170, v59, v57, s60
    v_perm_b32 v171, v63, v61, s60
    v_perm_b32 v172, v51, v49, s61
    v_perm_b32 v173, v55, v53, s61
    v_perm_b32 v174, v59, v57, s61
    v_perm_b32 v175, v63, v61, s61
    s_waitcnt vmcnt(39)
    v_mfma_f32_16x16x32_bf16 a[0:3], v[128:131], v[160:163], a[0:3]
    v_mfma_f32_16x16x32_bf16 a[4:7], v[128:131], v[164:167], a[4:7]
    v_mfma_f32_16x16x32_bf16 a[8:11], v[128:131], v[168:171], a[8:11]
    v_mfma_f32_16x16x32_bf16 a[12:15], v[128:131], v[172:175], a[12:15]
    s_waitcnt vmcnt(38)
    v_mfma_f32_16x16x32_bf16 a[16:19], v[132:135], v[160:163], a[16:19]
    v_mfma_f32_16x16x32_bf16 a[20:23], v[132:135], v[164:167], a[20:23]
    v_mfma_f32_16x16x32_bf16 a[24:27], v[132:135], v[168:171], a[24:27]
    v_mfma_f32_16x16x32_bf16 a[28:31], v[132:135], v[172:175], a[28:31]
    s_waitcnt vmcnt(37)
    v_mfma_f32_16x16x32_bf16 a[32:35], v[136:139], v[160:163], a[32:35]
    v_mfma_f32_16x16x32_bf16 a[36:39], v[136:139], v[164:167], a[36:39]
    v_mfma_f32_16x16x32_bf16 a[40:43], v[136:139], v[168:171], a[40:43]
    v_mfma_f32_16x16x32_bf16 a[44:47], v[136:139], v[172:175], a[44:47]
    s_waitcnt vmcnt(36)
    v_mfma_f32_16x16x32_bf16 a[48:51], v[140:143], v[160:163], a[48:51]
    v_mfma_f32_16x16x32_bf16 a[52:55], v[140:143], v[164:167], a[52:55]
    v_mfma_f32_16x16x32_bf16 a[56:59], v[140:143], v[168:171], a[56:59]
    v_mfma_f32_16x16x32_bf16 a[60:63], v[140:143], v[172:175], a[60:63]
    s_waitcnt vmcnt(35)
    v_mfma_f32_16x16x32_bf16 a[64:67], v[144:147], v[160:163], a[64:67]
    v_mfma_f32_16x16x32_bf16 a[68:71], v[144:147], v[164:167], a[68:71]
    v_mfma_f32_16x16x32_bf16 a[72:75], v[144:147], v[168:171], a[72:75]
    v_mfma_f32_16x16x32_bf16 a[76:79], v[144:147], v[172:175], a[76:79]
    s_waitcnt vmcnt(34)
    v_mfma_f32_16x16x32_bf16 a[80:83], v[148:151], v[160:163], a[80:83]
    v_mfma_f32_16x16x32_bf16 a[84:87], v[148:151], v[164:167], a[84:87]
    v_mfma_f32_16x16x32_bf16 a[88:91], v[148:151], v[168:171], a[88:91]
    v_mfma_f32_16x16x32_bf16 a[92:95], v[148:151], v[172:175], a[92:95]
    s_waitcnt vmcnt(33)
    v_mfma_f32_16x16x32_bf16 a[96:99], v[152:155], v[160:163], a[96:99]
    v_mfma_f32_16x16x32_bf16 a[100:103], v[152:155], v[164:167], a[100:103]
    v_mfma_f32_16x16x32_bf16 a[104:107], v[152:155], v[168:171], a[104:107]
    v_mfma_f32_16x16x32_bf16 a[108:111], v[152:155], v[172:175], a[108:111]
    s_waitcnt vmcnt(32)
    v_mfma_f32_16x16x32_bf16 a[112:115], v[156:159], v[160:163], a[112:115]
    v_mfma_f32_16x16x32_bf16 a[116:119], v[156:159], v[164:167], a[116:119]
    v_mfma_f32_16x16x32_bf16 a[120:123], v[156:159], v[168:171], a[120:123]
    v_mfma_f32_16x16x32_bf16 a[124:127], v[156:159], v[172:175], a[124:127]
    s_mov_b32 s36, 0x100000
    buffer_load_dwordx2 v[48:49], v3, s[12:15], s36 offen
    s_mov_b32 s36, 0x101000
    buffer_load_dwordx2 v[50:51], v3, s[12:15], s36 offen
    s_mov_b32 s36, 0x102000
    buffer_load_dwordx2 v[52:53], v3, s[12:15], s36 offen
    s_mov_b32 s36, 0x103000
    buffer_load_dwordx2 v[54:55], v3, s[12:15], s36 offen
    s_mov_b32 s36, 0x104000
    buffer_load_dwordx2 v[56:57], v3, s[12:15], s36 offen
    s_mov_b32 s36, 0x105000
    buffer_load_dwordx2 v[58:59], v3, s[12:15], s36 offen
    s_mov_b32 s36, 0x106000
    buffer_load_dwordx2 v[60:61], v3, s[12:15], s36 offen
    s_mov_b32 s36, 0x107000
    buffer_load_dwordx2 v[62:63], v3, s[12:15], s36 offen
    s_mov_b32 s36, 0x40000
    buffer_load_dwordx4 v[128:131], v4, s[4:7], s36 offen offset:0 sc1
    buffer_load_dwordx4 v[132:135], v4, s[4:7], s36 offen offset:64 sc1
    buffer_load_dwordx4 v[136:139], v4, s[4:7], s36 offen offset:512 sc1
    buffer_load_dwordx4 v[140:143], v4, s[4:7], s36 offen offset:576 sc1
    buffer_load_dwordx4 v[144:147], v4, s[4:7], s36 offen offset:1024 sc1
    buffer_load_dwordx4 v[148:151], v4, s[4:7], s36 offen offset:1088 sc1
    buffer_load_dwordx4 v[152:155], v4, s[4:7], s36 offen offset:1536 sc1
    buffer_load_dwordx4 v[156:159], v4, s[4:7], s36 offen offset:1600 sc1
    s_waitcnt vmcnt(40)
    v_perm_b32 v160, v18, v16, s60
    v_perm_b32 v161, v22, v20, s60
    v_perm_b32 v162, v26, v24, s60
    v_perm_b32 v163, v30, v28, s60
    v_perm_b32 v164, v18, v16, s61
    v_perm_b32 v165, v22, v20, s61
    v_perm_b32 v166, v26, v24, s61
    v_perm_b32 v167, v30, v28, s61
    v_perm_b32 v168, v19, v17, s60
    v_perm_b32 v169, v23, v21, s60
    v_perm_b32 v170, v27, v25, s60
    v_perm_b32 v171, v31, v29, s60
    v_perm_b32 v172, v19, v17, s61
    v_perm_b32 v173, v23, v21, s61
    v_perm_b32 v174, v27, v25, s61
    v_perm_b32 v175, v31, v29, s61
    s_waitcnt vmcnt(39)
    v_mfma_f32_16x16x32_bf16 a[0:3], v[64:67], v[160:163], a[0:3]
    v_mfma_f32_16x16x32_bf16 a[4:7], v[64:67], v[164:167], a[4:7]
    v_mfma_f32_16x16x32_bf16 a[8:11], v[64:67], v[168:171], a[8:11]
    v_mfma_f32_16x16x32_bf16 a[12:15], v[64:67], v[172:175], a[12:15]
    s_waitcnt vmcnt(38)
    v_mfma_f32_16x16x32_bf16 a[16:19], v[68:71], v[160:163], a[16:19]
    v_mfma_f32_16x16x32_bf16 a[20:23], v[68:71], v[164:167], a[20:23]
    v_mfma_f32_16x16x32_bf16 a[24:27], v[68:71], v[168:171], a[24:27]
    v_mfma_f32_16x16x32_bf16 a[28:31], v[68:71], v[172:175], a[28:31]
    s_waitcnt vmcnt(37)
    v_mfma_f32_16x16x32_bf16 a[32:35], v[72:75], v[160:163], a[32:35]
    v_mfma_f32_16x16x32_bf16 a[36:39], v[72:75], v[164:167], a[36:39]
    v_mfma_f32_16x16x32_bf16 a[40:43], v[72:75], v[168:171], a[40:43]
    v_mfma_f32_16x16x32_bf16 a[44:47], v[72:75], v[172:175], a[44:47]
    s_waitcnt vmcnt(36)
    v_mfma_f32_16x16x32_bf16 a[48:51], v[76:79], v[160:163], a[48:51]
    v_mfma_f32_16x16x32_bf16 a[52:55], v[76:79], v[164:167], a[52:55]
    v_mfma_f32_16x16x32_bf16 a[56:59], v[76:79], v[168:171], a[56:59]
    v_mfma_f32_16x16x32_bf16 a[60:63], v[76:79], v[172:175], a[60:63]
    s_waitcnt vmcnt(35)
    v_mfma_f32_16x16x32_bf16 a[64:67], v[80:83], v[160:163], a[64:67]
    v_mfma_f32_16x16x32_bf16 a[68:71], v[80:83], v[164:167], a[68:71]
    v_mfma_f32_16x16x32_bf16 a[72:75], v[80:83], v[168:171], a[72:75]
    v_mfma_f32_16x16x32_bf16 a[76:79], v[80:83], v[172:175], a[76:79]
    s_waitcnt vmcnt(34)
    v_mfma_f32_16x16x32_bf16 a[80:83], v[84:87], v[160:163], a[80:83]
    v_mfma_f32_16x16x32_bf16 a[84:87], v[84:87], v[164:167], a[84:87]
    v_mfma_f32_16x16x32_bf16 a[88:91], v[84:87], v[168:171], a[88:91]
    v_mfma_f32_16x16x32_bf16 a[92:95], v[84:87], v[172:175], a[92:95]
    s_waitcnt vmcnt(33)
    v_mfma_f32_16x16x32_bf16 a[96:99], v[88:91], v[160:163], a[96:99]
    v_mfma_f32_16x16x32_bf16 a[100:103], v[88:91], v[164:167], a[100:103]
    v_mfma_f32_16x16x32_bf16 a[104:107], v[88:91], v[168:171], a[104:107]
    v_mfma_f32_16x16x32_bf16 a[108:111], v[88:91], v[172:175], a[108:111]
    s_waitcnt vmcnt(32)
    v_mfma_f32_16x16x32_bf16 a[112:115], v[92:95], v[160:163], a[112:115]
    v_mfma_f32_16x16x32_bf16 a[116:119], v[92:95], v[164:167], a[116:119]
    v_mfma_f32_16x16x32_bf16 a[120:123], v[92:95], v[168:171], a[120:123]
    v_mfma_f32_16x16x32_bf16 a[124:127], v[92:95], v[172:175], a[124:127]
    s_mov_b32 s36, 0x120000
    buffer_load_dwordx2 v[16:17], v3, s[12:15], s36 offen
    s_mov_b32 s36, 0x121000
    buffer_load_dwordx2 v[18:19], v3, s[12:15], s36 offen
    s_mov_b32 s36, 0x122000
    buffer_load_dwordx2 v[20:21], v3, s[12:15], s36 offen
    s_mov_b32 s36, 0x123000
    buffer_load_dwordx2 v[22:23], v3, s[12:15], s36 offen
    s_mov_b32 s36, 0x124000
    buffer_load_dwordx2 v[24:25], v3, s[12:15], s36 offen
    s_mov_b32 s36, 0x125000
    buffer_load_dwordx2 v[26:27], v3, s[12:15], s36 offen
    s_mov_b32 s36, 0x126000
    buffer_load_dwordx2 v[28:29], v3, s[12:15], s36 offen
    s_mov_b32 s36, 0x127000
    buffer_load_dwordx2 v[30:31], v3, s[12:15], s36 offen
    s_mov_b32 s36, 0x48000
    buffer_load_dwordx4 v[64:67], v4, s[4:7], s36 offen offset:0 sc1
    buffer_load_dwordx4 v[68:71], v4, s[4:7], s36 offen offset:64 sc1
    buffer_load_dwordx4 v[72:75], v4, s[4:7], s36 offen offset:512 sc1
    buffer_load_dwordx4 v[76:79], v4, s[4:7], s36 offen offset:576 sc1
    buffer_load_dwordx4 v[80:83], v4, s[4:7], s36 offen offset:1024 sc1
    buffer_load_dwordx4 v[84:87], v4, s[4:7], s36 offen offset:1088 sc1
    buffer_load_dwordx4 v[88:91], v4, s[4:7], s36 offen offset:1536 sc1
    buffer_load_dwordx4 v[92:95], v4, s[4:7], s36 offen offset:1600 sc1
    s_waitcnt vmcnt(40)
    v_perm_b32 v160, v34, v32, s60
    v_perm_b32 v161, v38, v36, s60
    v_perm_b32 v162, v42, v40, s60
    v_perm_b32 v163, v46, v44, s60
    v_perm_b32 v164, v34, v32, s61
    v_perm_b32 v165, v38, v36, s61
    v_perm_b32 v166, v42, v40, s61
    v_perm_b32 v167, v46, v44, s61
    v_perm_b32 v168, v35, v33, s60
    v_perm_b32 v169, v39, v37, s60
    v_perm_b32 v170, v43, v41, s60
    v_perm_b32 v171, v47, v45, s60
    v_perm_b32 v172, v35, v33, s61
    v_perm_b32 v173, v39, v37, s61
    v_perm_b32 v174, v43, v41, s61
    v_perm_b32 v175, v47, v45, s61
    s_waitcnt vmcnt(39)
    v_mfma_f32_16x16x32_bf16 a[0:3], v[96:99], v[160:163], a[0:3]
    v_mfma_f32_16x16x32_bf16 a[4:7], v[96:99], v[164:167], a[4:7]
    v_mfma_f32_16x16x32_bf16 a[8:11], v[96:99], v[168:171], a[8:11]
    v_mfma_f32_16x16x32_bf16 a[12:15], v[96:99], v[172:175], a[12:15]
    s_waitcnt vmcnt(38)
    v_mfma_f32_16x16x32_bf16 a[16:19], v[100:103], v[160:163], a[16:19]
    v_mfma_f32_16x16x32_bf16 a[20:23], v[100:103], v[164:167], a[20:23]
    v_mfma_f32_16x16x32_bf16 a[24:27], v[100:103], v[168:171], a[24:27]
    v_mfma_f32_16x16x32_bf16 a[28:31], v[100:103], v[172:175], a[28:31]
    s_waitcnt vmcnt(37)
    v_mfma_f32_16x16x32_bf16 a[32:35], v[104:107], v[160:163], a[32:35]
    v_mfma_f32_16x16x32_bf16 a[36:39], v[104:107], v[164:167], a[36:39]
    v_mfma_f32_16x16x32_bf16 a[40:43], v[104:107], v[168:171], a[40:43]
    v_mfma_f32_16x16x32_bf16 a[44:47], v[104:107], v[172:175], a[44:47]
    s_waitcnt vmcnt(36)
    v_mfma_f32_16x16x32_bf16 a[48:51], v[108:111], v[160:163], a[48:51]
    v_mfma_f32_16x16x32_bf16 a[52:55], v[108:111], v[164:167], a[52:55]
    v_mfma_f32_16x16x32_bf16 a[56:59], v[108:111], v[168:171], a[56:59]
    v_mfma_f32_16x16x32_bf16 a[60:63], v[108:111], v[172:175], a[60:63]
    s_waitcnt vmcnt(35)
    v_mfma_f32_16x16x32_bf16 a[64:67], v[112:115], v[160:163], a[64:67]
    v_mfma_f32_16x16x32_bf16 a[68:71], v[112:115], v[164:167], a[68:71]
    v_mfma_f32_16x16x32_bf16 a[72:75], v[112:115], v[168:171], a[72:75]
    v_mfma_f32_16x16x32_bf16 a[76:79], v[112:115], v[172:175], a[76:79]
    s_waitcnt vmcnt(34)
    v_mfma_f32_16x16x32_bf16 a[80:83], v[116:119], v[160:163], a[80:83]
    v_mfma_f32_16x16x32_bf16 a[84:87], v[116:119], v[164:167], a[84:87]
    v_mfma_f32_16x16x32_bf16 a[88:91], v[116:119], v[168:171], a[88:91]
    v_mfma_f32_16x16x32_bf16 a[92:95], v[116:119], v[172:175], a[92:95]
    s_waitcnt vmcnt(33)
    v_mfma_f32_16x16x32_bf16 a[96:99], v[120:123], v[160:163], a[96:99]
    v_mfma_f32_16x16x32_bf16 a[100:103], v[120:123], v[164:167], a[100:103]
    v_mfma_f32_16x16x32_bf16 a[104:107], v[120:123], v[168:171], a[104:107]
    v_mfma_f32_16x16x32_bf16 a[108:111], v[120:123], v[172:175], a[108:111]
    s_waitcnt vmcnt(32)
    v_mfma_f32_16x16x32_bf16 a[112:115], v[124:127], v[160:163], a[112:115]
    v_mfma_f32_16x16x32_bf16 a[116:119], v[124:127], v[164:167], a[116:119]
    v_mfma_f32_16x16x32_bf16 a[120:123], v[124:127], v[168:171], a[120:123]
    v_mfma_f32_16x16x32_bf16 a[124:127], v[124:127], v[172:175], a[124:127]
    s_mov_b32 s36, 0x140000
    buffer_load_dwordx2 v[32:33], v3, s[12:15], s36 offen
    s_mov_b32 s36, 0x141000
    buffer_load_dwordx2 v[34:35], v3, s[12:15], s36 offen
    s_mov_b32 s36, 0x142000
    buffer_load_dwordx2 v[36:37], v3, s[12:15], s36 offen
    s_mov_b32 s36, 0x143000
    buffer_load_dwordx2 v[38:39], v3, s[12:15], s36 offen
    s_mov_b32 s36, 0x144000
    buffer_load_dwordx2 v[40:41], v3, s[12:15], s36 offen
    s_mov_b32 s36, 0x145000
    buffer_load_dwordx2 v[42:43], v3, s[12:15], s36 offen
    s_mov_b32 s36, 0x146000
    buffer_load_dwordx2 v[44:45], v3, s[12:15], s36 offen
    s_mov_b32 s36, 0x147000
    buffer_load_dwordx2 v[46:47], v3, s[12:15], s36 offen
    s_mov_b32 s36, 0x50000
    buffer_load_dwordx4 v[96:99], v4, s[4:7], s36 offen offset:0 sc1
    buffer_load_dwordx4 v[100:103], v4, s[4:7], s36 offen offset:64 sc1
    buffer_load_dwordx4 v[104:107], v4, s[4:7], s36 offen offset:512 sc1
    buffer_load_dwordx4 v[108:111], v4, s[4:7], s36 offen offset:576 sc1
    buffer_load_dwordx4 v[112:115], v4, s[4:7], s36 offen offset:1024 sc1
    buffer_load_dwordx4 v[116:119], v4, s[4:7], s36 offen offset:1088 sc1
    buffer_load_dwordx4 v[120:123], v4, s[4:7], s36 offen offset:1536 sc1
    buffer_load_dwordx4 v[124:127], v4, s[4:7], s36 offen offset:1600 sc1
    s_waitcnt vmcnt(40)
    v_perm_b32 v160, v50, v48, s60
    v_perm_b32 v161, v54, v52, s60
    v_perm_b32 v162, v58, v56, s60
    v_perm_b32 v163, v62, v60, s60
    v_perm_b32 v164, v50, v48, s61
    v_perm_b32 v165, v54, v52, s61
    v_perm_b32 v166, v58, v56, s61
    v_perm_b32 v167, v62, v60, s61
    v_perm_b32 v168, v51, v49, s60
    v_perm_b32 v169, v55, v53, s60
    v_perm_b32 v170, v59, v57, s60
    v_perm_b32 v171, v63, v61, s60
    v_perm_b32 v172, v51, v49, s61
    v_perm_b32 v173, v55, v53, s61
    v_perm_b32 v174, v59, v57, s61
    v_perm_b32 v175, v63, v61, s61
    s_waitcnt vmcnt(39)
    v_mfma_f32_16x16x32_bf16 a[0:3], v[128:131], v[160:163], a[0:3]
    v_mfma_f32_16x16x32_bf16 a[4:7], v[128:131], v[164:167], a[4:7]
    v_mfma_f32_16x16x32_bf16 a[8:11], v[128:131], v[168:171], a[8:11]
    v_mfma_f32_16x16x32_bf16 a[12:15], v[128:131], v[172:175], a[12:15]
    s_waitcnt vmcnt(38)
    v_mfma_f32_16x16x32_bf16 a[16:19], v[132:135], v[160:163], a[16:19]
    v_mfma_f32_16x16x32_bf16 a[20:23], v[132:135], v[164:167], a[20:23]
    v_mfma_f32_16x16x32_bf16 a[24:27], v[132:135], v[168:171], a[24:27]
    v_mfma_f32_16x16x32_bf16 a[28:31], v[132:135], v[172:175], a[28:31]
    s_waitcnt vmcnt(37)
    v_mfma_f32_16x16x32_bf16 a[32:35], v[136:139], v[160:163], a[32:35]
    v_mfma_f32_16x16x32_bf16 a[36:39], v[136:139], v[164:167], a[36:39]
    v_mfma_f32_16x16x32_bf16 a[40:43], v[136:139], v[168:171], a[40:43]
    v_mfma_f32_16x16x32_bf16 a[44:47], v[136:139], v[172:175], a[44:47]
    s_waitcnt vmcnt(36)
    v_mfma_f32_16x16x32_bf16 a[48:51], v[140:143], v[160:163], a[48:51]
    v_mfma_f32_16x16x32_bf16 a[52:55], v[140:143], v[164:167], a[52:55]
    v_mfma_f32_16x16x32_bf16 a[56:59], v[140:143], v[168:171], a[56:59]
    v_mfma_f32_16x16x32_bf16 a[60:63], v[140:143], v[172:175], a[60:63]
    s_waitcnt vmcnt(35)
    v_mfma_f32_16x16x32_bf16 a[64:67], v[144:147], v[160:163], a[64:67]
    v_mfma_f32_16x16x32_bf16 a[68:71], v[144:147], v[164:167], a[68:71]
    v_mfma_f32_16x16x32_bf16 a[72:75], v[144:147], v[168:171], a[72:75]
    v_mfma_f32_16x16x32_bf16 a[76:79], v[144:147], v[172:175], a[76:79]
    s_waitcnt vmcnt(34)
    v_mfma_f32_16x16x32_bf16 a[80:83], v[148:151], v[160:163], a[80:83]
    v_mfma_f32_16x16x32_bf16 a[84:87], v[148:151], v[164:167], a[84:87]
    v_mfma_f32_16x16x32_bf16 a[88:91], v[148:151], v[168:171], a[88:91]
    v_mfma_f32_16x16x32_bf16 a[92:95], v[148:151], v[172:175], a[92:95]
    s_waitcnt vmcnt(33)
    v_mfma_f32_16x16x32_bf16 a[96:99], v[152:155], v[160:163], a[96:99]
    v_mfma_f32_16x16x32_bf16 a[100:103], v[152:155], v[164:167], a[100:103]
    v_mfma_f32_16x16x32_bf16 a[104:107], v[152:155], v[168:171], a[104:107]
    v_mfma_f32_16x16x32_bf16 a[108:111], v[152:155], v[172:175], a[108:111]
    s_waitcnt vmcnt(32)
    v_mfma_f32_16x16x32_bf16 a[112:115], v[156:159], v[160:163], a[112:115]
    v_mfma_f32_16x16x32_bf16 a[116:119], v[156:159], v[164:167], a[116:119]
    v_mfma_f32_16x16x32_bf16 a[120:123], v[156:159], v[168:171], a[120:123]
    v_mfma_f32_16x16x32_bf16 a[124:127], v[156:159], v[172:175], a[124:127]
    s_mov_b32 s36, 0x160000
    buffer_load_dwordx2 v[48:49], v3, s[12:15], s36 offen
    s_mov_b32 s36, 0x161000
    buffer_load_dwordx2 v[50:51], v3, s[12:15], s36 offen
    s_mov_b32 s36, 0x162000
    buffer_load_dwordx2 v[52:53], v3, s[12:15], s36 offen
    s_mov_b32 s36, 0x163000
    buffer_load_dwordx2 v[54:55], v3, s[12:15], s36 offen
    s_mov_b32 s36, 0x164000
    buffer_load_dwordx2 v[56:57], v3, s[12:15], s36 offen
    s_mov_b32 s36, 0x165000
    buffer_load_dwordx2 v[58:59], v3, s[12:15], s36 offen
    s_mov_b32 s36, 0x166000
    buffer_load_dwordx2 v[60:61], v3, s[12:15], s36 offen
    s_mov_b32 s36, 0x167000
    buffer_load_dwordx2 v[62:63], v3, s[12:15], s36 offen
    s_mov_b32 s36, 0x58000
    buffer_load_dwordx4 v[128:131], v4, s[4:7], s36 offen offset:0 sc1
    buffer_load_dwordx4 v[132:135], v4, s[4:7], s36 offen offset:64 sc1
    buffer_load_dwordx4 v[136:139], v4, s[4:7], s36 offen offset:512 sc1
    buffer_load_dwordx4 v[140:143], v4, s[4:7], s36 offen offset:576 sc1
    buffer_load_dwordx4 v[144:147], v4, s[4:7], s36 offen offset:1024 sc1
    buffer_load_dwordx4 v[148:151], v4, s[4:7], s36 offen offset:1088 sc1
    buffer_load_dwordx4 v[152:155], v4, s[4:7], s36 offen offset:1536 sc1
    buffer_load_dwordx4 v[156:159], v4, s[4:7], s36 offen offset:1600 sc1
    s_waitcnt vmcnt(40)
    v_perm_b32 v160, v18, v16, s60
    v_perm_b32 v161, v22, v20, s60
    v_perm_b32 v162, v26, v24, s60
    v_perm_b32 v163, v30, v28, s60
    v_perm_b32 v164, v18, v16, s61
    v_perm_b32 v165, v22, v20, s61
    v_perm_b32 v166, v26, v24, s61
    v_perm_b32 v167, v30, v28, s61
    v_perm_b32 v168, v19, v17, s60
    v_perm_b32 v169, v23, v21, s60
    v_perm_b32 v170, v27, v25, s60
    v_perm_b32 v171, v31, v29, s60
    v_perm_b32 v172, v19, v17, s61
    v_perm_b32 v173, v23, v21, s61
    v_perm_b32 v174, v27, v25, s61
    v_perm_b32 v175, v31, v29, s61
    s_waitcnt vmcnt(39)
    v_mfma_f32_16x16x32_bf16 a[0:3], v[64:67], v[160:163], a[0:3]
    v_mfma_f32_16x16x32_bf16 a[4:7], v[64:67], v[164:167], a[4:7]
    v_mfma_f32_16x16x32_bf16 a[8:11], v[64:67], v[168:171], a[8:11]
    v_mfma_f32_16x16x32_bf16 a[12:15], v[64:67], v[172:175], a[12:15]
    s_waitcnt vmcnt(38)
    v_mfma_f32_16x16x32_bf16 a[16:19], v[68:71], v[160:163], a[16:19]
    v_mfma_f32_16x16x32_bf16 a[20:23], v[68:71], v[164:167], a[20:23]
    v_mfma_f32_16x16x32_bf16 a[24:27], v[68:71], v[168:171], a[24:27]
    v_mfma_f32_16x16x32_bf16 a[28:31], v[68:71], v[172:175], a[28:31]
    s_waitcnt vmcnt(37)
    v_mfma_f32_16x16x32_bf16 a[32:35], v[72:75], v[160:163], a[32:35]
    v_mfma_f32_16x16x32_bf16 a[36:39], v[72:75], v[164:167], a[36:39]
    v_mfma_f32_16x16x32_bf16 a[40:43], v[72:75], v[168:171], a[40:43]
    v_mfma_f32_16x16x32_bf16 a[44:47], v[72:75], v[172:175], a[44:47]
    s_waitcnt vmcnt(36)
    v_mfma_f32_16x16x32_bf16 a[48:51], v[76:79], v[160:163], a[48:51]
    v_mfma_f32_16x16x32_bf16 a[52:55], v[76:79], v[164:167], a[52:55]
    v_mfma_f32_16x16x32_bf16 a[56:59], v[76:79], v[168:171], a[56:59]
    v_mfma_f32_16x16x32_bf16 a[60:63], v[76:79], v[172:175], a[60:63]
    s_waitcnt vmcnt(35)
    v_mfma_f32_16x16x32_bf16 a[64:67], v[80:83], v[160:163], a[64:67]
    v_mfma_f32_16x16x32_bf16 a[68:71], v[80:83], v[164:167], a[68:71]
    v_mfma_f32_16x16x32_bf16 a[72:75], v[80:83], v[168:171], a[72:75]
    v_mfma_f32_16x16x32_bf16 a[76:79], v[80:83], v[172:175], a[76:79]
    s_waitcnt vmcnt(34)
    v_mfma_f32_16x16x32_bf16 a[80:83], v[84:87], v[160:163], a[80:83]
    v_mfma_f32_16x16x32_bf16 a[84:87], v[84:87], v[164:167], a[84:87]
    v_mfma_f32_16x16x32_bf16 a[88:91], v[84:87], v[168:171], a[88:91]
    v_mfma_f32_16x16x32_bf16 a[92:95], v[84:87], v[172:175], a[92:95]
    s_waitcnt vmcnt(33)
    v_mfma_f32_16x16x32_bf16 a[96:99], v[88:91], v[160:163], a[96:99]
    v_mfma_f32_16x16x32_bf16 a[100:103], v[88:91], v[164:167], a[100:103]
    v_mfma_f32_16x16x32_bf16 a[104:107], v[88:91], v[168:171], a[104:107]
    v_mfma_f32_16x16x32_bf16 a[108:111], v[88:91], v[172:175], a[108:111]
    s_waitcnt vmcnt(32)
    v_mfma_f32_16x16x32_bf16 a[112:115], v[92:95], v[160:163], a[112:115]
    v_mfma_f32_16x16x32_bf16 a[116:119], v[92:95], v[164:167], a[116:119]
    v_mfma_f32_16x16x32_bf16 a[120:123], v[92:95], v[168:171], a[120:123]
    v_mfma_f32_16x16x32_bf16 a[124:127], v[92:95], v[172:175], a[124:127]
    s_mov_b32 s36, 0x180000
    buffer_load_dwordx2 v[16:17], v3, s[12:15], s36 offen
    s_mov_b32 s36, 0x181000
    buffer_load_dwordx2 v[18:19], v3, s[12:15], s36 offen
    s_mov_b32 s36, 0x182000
    buffer_load_dwordx2 v[20:21], v3, s[12:15], s36 offen
    s_mov_b32 s36, 0x183000
    buffer_load_dwordx2 v[22:23], v3, s[12:15], s36 offen
    s_mov_b32 s36, 0x184000
    buffer_load_dwordx2 v[24:25], v3, s[12:15], s36 offen
    s_mov_b32 s36, 0x185000
    buffer_load_dwordx2 v[26:27], v3, s[12:15], s36 offen
    s_mov_b32 s36, 0x186000
    buffer_load_dwordx2 v[28:29], v3, s[12:15], s36 offen
    s_mov_b32 s36, 0x187000
    buffer_load_dwordx2 v[30:31], v3, s[12:15], s36 offen
    s_mov_b32 s36, 0x60000
    buffer_load_dwordx4 v[64:67], v4, s[4:7], s36 offen offset:0 sc1
    buffer_load_dwordx4 v[68:71], v4, s[4:7], s36 offen offset:64 sc1
    buffer_load_dwordx4 v[72:75], v4, s[4:7], s36 offen offset:512 sc1
    buffer_load_dwordx4 v[76:79], v4, s[4:7], s36 offen offset:576 sc1
    buffer_load_dwordx4 v[80:83], v4, s[4:7], s36 offen offset:1024 sc1
    buffer_load_dwordx4 v[84:87], v4, s[4:7], s36 offen offset:1088 sc1
    buffer_load_dwordx4 v[88:91], v4, s[4:7], s36 offen offset:1536 sc1
    buffer_load_dwordx4 v[92:95], v4, s[4:7], s36 offen offset:1600 sc1
    s_waitcnt vmcnt(40)
    v_perm_b32 v160, v34, v32, s60
    v_perm_b32 v161, v38, v36, s60
    v_perm_b32 v162, v42, v40, s60
    v_perm_b32 v163, v46, v44, s60
    v_perm_b32 v164, v34, v32, s61
    v_perm_b32 v165, v38, v36, s61
    v_perm_b32 v166, v42, v40, s61
    v_perm_b32 v167, v46, v44, s61
    v_perm_b32 v168, v35, v33, s60
    v_perm_b32 v169, v39, v37, s60
    v_perm_b32 v170, v43, v41, s60
    v_perm_b32 v171, v47, v45, s60
    v_perm_b32 v172, v35, v33, s61
    v_perm_b32 v173, v39, v37, s61
    v_perm_b32 v174, v43, v41, s61
    v_perm_b32 v175, v47, v45, s61
    s_waitcnt vmcnt(39)
    v_mfma_f32_16x16x32_bf16 a[0:3], v[96:99], v[160:163], a[0:3]
    v_mfma_f32_16x16x32_bf16 a[4:7], v[96:99], v[164:167], a[4:7]
    v_mfma_f32_16x16x32_bf16 a[8:11], v[96:99], v[168:171], a[8:11]
    v_mfma_f32_16x16x32_bf16 a[12:15], v[96:99], v[172:175], a[12:15]
    s_waitcnt vmcnt(38)
    v_mfma_f32_16x16x32_bf16 a[16:19], v[100:103], v[160:163], a[16:19]
    v_mfma_f32_16x16x32_bf16 a[20:23], v[100:103], v[164:167], a[20:23]
    v_mfma_f32_16x16x32_bf16 a[24:27], v[100:103], v[168:171], a[24:27]
    v_mfma_f32_16x16x32_bf16 a[28:31], v[100:103], v[172:175], a[28:31]
    s_waitcnt vmcnt(37)
    v_mfma_f32_16x16x32_bf16 a[32:35], v[104:107], v[160:163], a[32:35]
    v_mfma_f32_16x16x32_bf16 a[36:39], v[104:107], v[164:167], a[36:39]
    v_mfma_f32_16x16x32_bf16 a[40:43], v[104:107], v[168:171], a[40:43]
    v_mfma_f32_16x16x32_bf16 a[44:47], v[104:107], v[172:175], a[44:47]
    s_waitcnt vmcnt(36)
    v_mfma_f32_16x16x32_bf16 a[48:51], v[108:111], v[160:163], a[48:51]
    v_mfma_f32_16x16x32_bf16 a[52:55], v[108:111], v[164:167], a[52:55]
    v_mfma_f32_16x16x32_bf16 a[56:59], v[108:111], v[168:171], a[56:59]
    v_mfma_f32_16x16x32_bf16 a[60:63], v[108:111], v[172:175], a[60:63]
    s_waitcnt vmcnt(35)
    v_mfma_f32_16x16x32_bf16 a[64:67], v[112:115], v[160:163], a[64:67]
    v_mfma_f32_16x16x32_bf16 a[68:71], v[112:115], v[164:167], a[68:71]
    v_mfma_f32_16x16x32_bf16 a[72:75], v[112:115], v[168:171], a[72:75]
    v_mfma_f32_16x16x32_bf16 a[76:79], v[112:115], v[172:175], a[76:79]
    s_waitcnt vmcnt(34)
    v_mfma_f32_16x16x32_bf16 a[80:83], v[116:119], v[160:163], a[80:83]
    v_mfma_f32_16x16x32_bf16 a[84:87], v[116:119], v[164:167], a[84:87]
    v_mfma_f32_16x16x32_bf16 a[88:91], v[116:119], v[168:171], a[88:91]
    v_mfma_f32_16x16x32_bf16 a[92:95], v[116:119], v[172:175], a[92:95]
    s_waitcnt vmcnt(33)
    v_mfma_f32_16x16x32_bf16 a[96:99], v[120:123], v[160:163], a[96:99]
    v_mfma_f32_16x16x32_bf16 a[100:103], v[120:123], v[164:167], a[100:103]
    v_mfma_f32_16x16x32_bf16 a[104:107], v[120:123], v[168:171], a[104:107]
    v_mfma_f32_16x16x32_bf16 a[108:111], v[120:123], v[172:175], a[108:111]
    s_waitcnt vmcnt(32)
    v_mfma_f32_16x16x32_bf16 a[112:115], v[124:127], v[160:163], a[112:115]
    v_mfma_f32_16x16x32_bf16 a[116:119], v[124:127], v[164:167], a[116:119]
    v_mfma_f32_16x16x32_bf16 a[120:123], v[124:127], v[168:171], a[120:123]
    v_mfma_f32_16x16x32_bf16 a[124:127], v[124:127], v[172:175], a[124:127]
    s_mov_b32 s36, 0x1a0000
    buffer_load_dwordx2 v[32:33], v3, s[12:15], s36 offen
    s_mov_b32 s36, 0x1a1000
    buffer_load_dwordx2 v[34:35], v3, s[12:15], s36 offen
    s_mov_b32 s36, 0x1a2000
    buffer_load_dwordx2 v[36:37], v3, s[12:15], s36 offen
    s_mov_b32 s36, 0x1a3000
    buffer_load_dwordx2 v[38:39], v3, s[12:15], s36 offen
    s_mov_b32 s36, 0x1a4000
    buffer_load_dwordx2 v[40:41], v3, s[12:15], s36 offen
    s_mov_b32 s36, 0x1a5000
    buffer_load_dwordx2 v[42:43], v3, s[12:15], s36 offen
    s_mov_b32 s36, 0x1a6000
    buffer_load_dwordx2 v[44:45], v3, s[12:15], s36 offen
    s_mov_b32 s36, 0x1a7000
    buffer_load_dwordx2 v[46:47], v3, s[12:15], s36 offen
    s_mov_b32 s36, 0x68000
    buffer_load_dwordx4 v[96:99], v4, s[4:7], s36 offen offset:0 sc1
    buffer_load_dwordx4 v[100:103], v4, s[4:7], s36 offen offset:64 sc1
    buffer_load_dwordx4 v[104:107], v4, s[4:7], s36 offen offset:512 sc1
    buffer_load_dwordx4 v[108:111], v4, s[4:7], s36 offen offset:576 sc1
    buffer_load_dwordx4 v[112:115], v4, s[4:7], s36 offen offset:1024 sc1
    buffer_load_dwordx4 v[116:119], v4, s[4:7], s36 offen offset:1088 sc1
    buffer_load_dwordx4 v[120:123], v4, s[4:7], s36 offen offset:1536 sc1
    buffer_load_dwordx4 v[124:127], v4, s[4:7], s36 offen offset:1600 sc1
    s_waitcnt vmcnt(40)
    v_perm_b32 v160, v50, v48, s60
    v_perm_b32 v161, v54, v52, s60
    v_perm_b32 v162, v58, v56, s60
    v_perm_b32 v163, v62, v60, s60
    v_perm_b32 v164, v50, v48, s61
    v_perm_b32 v165, v54, v52, s61
    v_perm_b32 v166, v58, v56, s61
    v_perm_b32 v167, v62, v60, s61
    v_perm_b32 v168, v51, v49, s60
    v_perm_b32 v169, v55, v53, s60
    v_perm_b32 v170, v59, v57, s60
    v_perm_b32 v171, v63, v61, s60
    v_perm_b32 v172, v51, v49, s61
    v_perm_b32 v173, v55, v53, s61
    v_perm_b32 v174, v59, v57, s61
    v_perm_b32 v175, v63, v61, s61
    s_waitcnt vmcnt(39)
    v_mfma_f32_16x16x32_bf16 a[0:3], v[128:131], v[160:163], a[0:3]
    v_mfma_f32_16x16x32_bf16 a[4:7], v[128:131], v[164:167], a[4:7]
    v_mfma_f32_16x16x32_bf16 a[8:11], v[128:131], v[168:171], a[8:11]
    v_mfma_f32_16x16x32_bf16 a[12:15], v[128:131], v[172:175], a[12:15]
    s_waitcnt vmcnt(38)
    v_mfma_f32_16x16x32_bf16 a[16:19], v[132:135], v[160:163], a[16:19]
    v_mfma_f32_16x16x32_bf16 a[20:23], v[132:135], v[164:167], a[20:23]
    v_mfma_f32_16x16x32_bf16 a[24:27], v[132:135], v[168:171], a[24:27]
    v_mfma_f32_16x16x32_bf16 a[28:31], v[132:135], v[172:175], a[28:31]
    s_waitcnt vmcnt(37)
    v_mfma_f32_16x16x32_bf16 a[32:35], v[136:139], v[160:163], a[32:35]
    v_mfma_f32_16x16x32_bf16 a[36:39], v[136:139], v[164:167], a[36:39]
    v_mfma_f32_16x16x32_bf16 a[40:43], v[136:139], v[168:171], a[40:43]
    v_mfma_f32_16x16x32_bf16 a[44:47], v[136:139], v[172:175], a[44:47]
    s_waitcnt vmcnt(36)
    v_mfma_f32_16x16x32_bf16 a[48:51], v[140:143], v[160:163], a[48:51]
    v_mfma_f32_16x16x32_bf16 a[52:55], v[140:143], v[164:167], a[52:55]
    v_mfma_f32_16x16x32_bf16 a[56:59], v[140:143], v[168:171], a[56:59]
    v_mfma_f32_16x16x32_bf16 a[60:63], v[140:143], v[172:175], a[60:63]
    s_waitcnt vmcnt(35)
    v_mfma_f32_16x16x32_bf16 a[64:67], v[144:147], v[160:163], a[64:67]
    v_mfma_f32_16x16x32_bf16 a[68:71], v[144:147], v[164:167], a[68:71]
    v_mfma_f32_16x16x32_bf16 a[72:75], v[144:147], v[168:171], a[72:75]
    v_mfma_f32_16x16x32_bf16 a[76:79], v[144:147], v[172:175], a[76:79]
    s_waitcnt vmcnt(34)
    v_mfma_f32_16x16x32_bf16 a[80:83], v[148:151], v[160:163], a[80:83]
    v_mfma_f32_16x16x32_bf16 a[84:87], v[148:151], v[164:167], a[84:87]
    v_mfma_f32_16x16x32_bf16 a[88:91], v[148:151], v[168:171], a[88:91]
    v_mfma_f32_16x16x32_bf16 a[92:95], v[148:151], v[172:175], a[92:95]
    s_waitcnt vmcnt(33)
    v_mfma_f32_16x16x32_bf16 a[96:99], v[152:155], v[160:163], a[96:99]
    v_mfma_f32_16x16x32_bf16 a[100:103], v[152:155], v[164:167], a[100:103]
    v_mfma_f32_16x16x32_bf16 a[104:107], v[152:155], v[168:171], a[104:107]
    v_mfma_f32_16x16x32_bf16 a[108:111], v[152:155], v[172:175], a[108:111]
    s_waitcnt vmcnt(32)
    v_mfma_f32_16x16x32_bf16 a[112:115], v[156:159], v[160:163], a[112:115]
    v_mfma_f32_16x16x32_bf16 a[116:119], v[156:159], v[164:167], a[116:119]
    v_mfma_f32_16x16x32_bf16 a[120:123], v[156:159], v[168:171], a[120:123]
    v_mfma_f32_16x16x32_bf16 a[124:127], v[156:159], v[172:175], a[124:127]
    s_waitcnt vmcnt(24)
    v_perm_b32 v160, v18, v16, s60
    v_perm_b32 v161, v22, v20, s60
    v_perm_b32 v162, v26, v24, s60
    v_perm_b32 v163, v30, v28, s60
    v_perm_b32 v164, v18, v16, s61
    v_perm_b32 v165, v22, v20, s61
    v_perm_b32 v166, v26, v24, s61
    v_perm_b32 v167, v30, v28, s61
    v_perm_b32 v168, v19, v17, s60
    v_perm_b32 v169, v23, v21, s60
    v_perm_b32 v170, v27, v25, s60
    v_perm_b32 v171, v31, v29, s60
    v_perm_b32 v172, v19, v17, s61
    v_perm_b32 v173, v23, v21, s61
    v_perm_b32 v174, v27, v25, s61
    v_perm_b32 v175, v31, v29, s61
    s_waitcnt vmcnt(23)
    v_mfma_f32_16x16x32_bf16 a[0:3], v[64:67], v[160:163], a[0:3]
    v_mfma_f32_16x16x32_bf16 a[4:7], v[64:67], v[164:167], a[4:7]
    v_mfma_f32_16x16x32_bf16 a[8:11], v[64:67], v[168:171], a[8:11]
    v_mfma_f32_16x16x32_bf16 a[12:15], v[64:67], v[172:175], a[12:15]
    s_waitcnt vmcnt(22)
    v_mfma_f32_16x16x32_bf16 a[16:19], v[68:71], v[160:163], a[16:19]
    v_mfma_f32_16x16x32_bf16 a[20:23], v[68:71], v[164:167], a[20:23]
    v_mfma_f32_16x16x32_bf16 a[24:27], v[68:71], v[168:171], a[24:27]
    v_mfma_f32_16x16x32_bf16 a[28:31], v[68:71], v[172:175], a[28:31]
    s_waitcnt vmcnt(21)
    v_mfma_f32_16x16x32_bf16 a[32:35], v[72:75], v[160:163], a[32:35]
    v_mfma_f32_16x16x32_bf16 a[36:39], v[72:75], v[164:167], a[36:39]
    v_mfma_f32_16x16x32_bf16 a[40:43], v[72:75], v[168:171], a[40:43]
    v_mfma_f32_16x16x32_bf16 a[44:47], v[72:75], v[172:175], a[44:47]
    s_waitcnt vmcnt(20)
    v_mfma_f32_16x16x32_bf16 a[48:51], v[76:79], v[160:163], a[48:51]
    v_mfma_f32_16x16x32_bf16 a[52:55], v[76:79], v[164:167], a[52:55]
    v_mfma_f32_16x16x32_bf16 a[56:59], v[76:79], v[168:171], a[56:59]
    v_mfma_f32_16x16x32_bf16 a[60:63], v[76:79], v[172:175], a[60:63]
    s_waitcnt vmcnt(19)
    v_mfma_f32_16x16x32_bf16 a[64:67], v[80:83], v[160:163], a[64:67]
    v_mfma_f32_16x16x32_bf16 a[68:71], v[80:83], v[164:167], a[68:71]
    v_mfma_f32_16x16x32_bf16 a[72:75], v[80:83], v[168:171], a[72:75]
    v_mfma_f32_16x16x32_bf16 a[76:79], v[80:83], v[172:175], a[76:79]
    s_waitcnt vmcnt(18)
    v_mfma_f32_16x16x32_bf16 a[80:83], v[84:87], v[160:163], a[80:83]
    v_mfma_f32_16x16x32_bf16 a[84:87], v[84:87], v[164:167], a[84:87]
    v_mfma_f32_16x16x32_bf16 a[88:91], v[84:87], v[168:171], a[88:91]
    v_mfma_f32_16x16x32_bf16 a[92:95], v[84:87], v[172:175], a[92:95]
    s_waitcnt vmcnt(17)
    v_mfma_f32_16x16x32_bf16 a[96:99], v[88:91], v[160:163], a[96:99]
    v_mfma_f32_16x16x32_bf16 a[100:103], v[88:91], v[164:167], a[100:103]
    v_mfma_f32_16x16x32_bf16 a[104:107], v[88:91], v[168:171], a[104:107]
    v_mfma_f32_16x16x32_bf16 a[108:111], v[88:91], v[172:175], a[108:111]
    s_waitcnt vmcnt(16)
    v_mfma_f32_16x16x32_bf16 a[112:115], v[92:95], v[160:163], a[112:115]
    v_mfma_f32_16x16x32_bf16 a[116:119], v[92:95], v[164:167], a[116:119]
    v_mfma_f32_16x16x32_bf16 a[120:123], v[92:95], v[168:171], a[120:123]
    v_mfma_f32_16x16x32_bf16 a[124:127], v[92:95], v[172:175], a[124:127]
    s_waitcnt vmcnt(8)
    v_perm_b32 v160, v34, v32, s60
    v_perm_b32 v161, v38, v36, s60
    v_perm_b32 v162, v42, v40, s60
    v_perm_b32 v163, v46, v44, s60
    v_perm_b32 v164, v34, v32, s61
    v_perm_b32 v165, v38, v36, s61
    v_perm_b32 v166, v42, v40, s61
    v_perm_b32 v167, v46, v44, s61
    v_perm_b32 v168, v35, v33, s60
    v_perm_b32 v169, v39, v37, s60
    v_perm_b32 v170, v43, v41, s60
    v_perm_b32 v171, v47, v45, s60
    v_perm_b32 v172, v35, v33, s61
    v_perm_b32 v173, v39, v37, s61
    v_perm_b32 v174, v43, v41, s61
    v_perm_b32 v175, v47, v45, s61
    s_waitcnt vmcnt(7)
    v_mfma_f32_16x16x32_bf16 a[0:3], v[96:99], v[160:163], a[0:3]
    v_mfma_f32_16x16x32_bf16 a[4:7], v[96:99], v[164:167], a[4:7]
    v_mfma_f32_16x16x32_bf16 a[8:11], v[96:99], v[168:171], a[8:11]
    v_mfma_f32_16x16x32_bf16 a[12:15], v[96:99], v[172:175], a[12:15]
    s_waitcnt vmcnt(6)
    v_mfma_f32_16x16x32_bf16 a[16:19], v[100:103], v[160:163], a[16:19]
    v_mfma_f32_16x16x32_bf16 a[20:23], v[100:103], v[164:167], a[20:23]
    v_mfma_f32_16x16x32_bf16 a[24:27], v[100:103], v[168:171], a[24:27]
    v_mfma_f32_16x16x32_bf16 a[28:31], v[100:103], v[172:175], a[28:31]
    s_waitcnt vmcnt(5)
    v_mfma_f32_16x16x32_bf16 a[32:35], v[104:107], v[160:163], a[32:35]
    v_mfma_f32_16x16x32_bf16 a[36:39], v[104:107], v[164:167], a[36:39]
    v_mfma_f32_16x16x32_bf16 a[40:43], v[104:107], v[168:171], a[40:43]
    v_mfma_f32_16x16x32_bf16 a[44:47], v[104:107], v[172:175], a[44:47]
    s_waitcnt vmcnt(4)
    v_mfma_f32_16x16x32_bf16 a[48:51], v[108:111], v[160:163], a[48:51]
    v_mfma_f32_16x16x32_bf16 a[52:55], v[108:111], v[164:167], a[52:55]
    v_mfma_f32_16x16x32_bf16 a[56:59], v[108:111], v[168:171], a[56:59]
    v_mfma_f32_16x16x32_bf16 a[60:63], v[108:111], v[172:175], a[60:63]
    s_waitcnt vmcnt(3)
    v_mfma_f32_16x16x32_bf16 a[64:67], v[112:115], v[160:163], a[64:67]
    v_mfma_f32_16x16x32_bf16 a[68:71], v[112:115], v[164:167], a[68:71]
    v_mfma_f32_16x16x32_bf16 a[72:75], v[112:115], v[168:171], a[72:75]
    v_mfma_f32_16x16x32_bf16 a[76:79], v[112:115], v[172:175], a[76:79]
    s_waitcnt vmcnt(2)
    v_mfma_f32_16x16x32_bf16 a[80:83], v[116:119], v[160:163], a[80:83]
    v_mfma_f32_16x16x32_bf16 a[84:87], v[116:119], v[164:167], a[84:87]
    v_mfma_f32_16x16x32_bf16 a[88:91], v[116:119], v[168:171], a[88:91]
    v_mfma_f32_16x16x32_bf16 a[92:95], v[116:119], v[172:175], a[92:95]
    s_waitcnt vmcnt(1)
    v_mfma_f32_16x16x32_bf16 a[96:99], v[120:123], v[160:163], a[96:99]
    v_mfma_f32_16x16x32_bf16 a[100:103], v[120:123], v[164:167], a[100:103]
    v_mfma_f32_16x16x32_bf16 a[104:107], v[120:123], v[168:171], a[104:107]
    v_mfma_f32_16x16x32_bf16 a[108:111], v[120:123], v[172:175], a[108:111]
    s_waitcnt vmcnt(0)
    v_mfma_f32_16x16x32_bf16 a[112:115], v[124:127], v[160:163], a[112:115]
    v_mfma_f32_16x16x32_bf16 a[116:119], v[124:127], v[164:167], a[116:119]
    v_mfma_f32_16x16x32_bf16 a[120:123], v[124:127], v[168:171], a[120:123]
    v_mfma_f32_16x16x32_bf16 a[124:127], v[124:127], v[172:175], a[124:127]
    v_lshlrev_b32 v6, 4, v255
    s_nop 7
    s_cmp_lg_u32 s28, 0
    s_cbranch_scc1 L_gw_48
    v_accvgpr_read_b32 v16, a0
    v_accvgpr_read_b32 v17, a1
    v_accvgpr_read_b32 v18, a2
    v_accvgpr_read_b32 v19, a3
    v_accvgpr_read_b32 v20, a4
    v_accvgpr_read_b32 v21, a5
    v_accvgpr_read_b32 v22, a6
    v_accvgpr_read_b32 v23, a7
    v_accvgpr_read_b32 v24, a8
    v_accvgpr_read_b32 v25, a9
    v_accvgpr_read_b32 v26, a10
    v_accvgpr_read_b32 v27, a11
    v_accvgpr_read_b32 v28, a12
    v_accvgpr_read_b32 v29, a13
    v_accvgpr_read_b32 v30, a14
    v_accvgpr_read_b32 v31, a15
    v_accvgpr_read_b32 v32, a16
    v_accvgpr_read_b32 v33, a17
    v_accvgpr_read_b32 v34, a18
    v_accvgpr_read_b32 v35, a19
    v_accvgpr_read_b32 v36, a20
    v_accvgpr_read_b32 v37, a21
    v_accvgpr_read_b32 v38, a22
    v_accvgpr_read_b32 v39, a23
    v_accvgpr_read_b32 v40, a24
    v_accvgpr_read_b32 v41, a25
    v_accvgpr_read_b32 v42, a26
    v_accvgpr_read_b32 v43, a27
    v_accvgpr_read_b32 v44, a28
    v_accvgpr_read_b32 v45, a29
    v_accvgpr_read_b32 v46, a30
    v_accvgpr_read_b32 v47, a31
    v_add_u32 v7, 24576, v6
    ds_write_b128 v7, a[32:35] offset:0
    ds_write_b128 v7, a[36:39] offset:1024
    ds_write_b128 v7, a[40:43] offset:2048
    ds_write_b128 v7, a[44:47] offset:3072
    ds_write_b128 v7, a[48:51] offset:4096
    ds_write_b128 v7, a[52:55] offset:5120
    ds_write_b128 v7, a[56:59] offset:6144
    ds_write_b128 v7, a[60:63] offset:7168
    v_add_u32 v7, 57344, v6
    ds_write_b128 v7, a[64:67] offset:0
    ds_write_b128 v7, a[68:71] offset:1024
    ds_write_b128 v7, a[72:75] offset:2048
    ds_write_b128 v7, a[76:79] offset:3072
    ds_write_b128 v7, a[80:83] offset:4096
    ds_write_b128 v7, a[84:87] offset:5120
    ds_write_b128 v7, a[88:91] offset:6144
    ds_write_b128 v7, a[92:95] offset:7168
    v_add_u32 v7, 90112, v6
    ds_write_b128 v7, a[96:99] offset:0
    ds_write_b128 v7, a[100:103] offset:1024
    ds_write_b128 v7, a[104:107] offset:2048
    ds_write_b128 v7, a[108:111] offset:3072
    ds_write_b128 v7, a[112:115] offset:4096
    ds_write_b128 v7, a[116:119] offset:5120
    ds_write_b128 v7, a[120:123] offset:6144
    ds_write_b128 v7, a[124:127] offset:7168
L_gw_48:
    s_cmp_lg_u32 s28, 1
    s_cbranch_scc1 L_gw_49
    v_add_u32 v7, 0, v6
    ds_write_b128 v7, a[0:3] offset:0
    ds_write_b128 v7, a[4:7] offset:1024
    ds_write_b128 v7, a[8:11] offset:2048
    ds_write_b128 v7, a[12:15] offset:3072
    ds_write_b128 v7, a[16:19] offset:4096
    ds_write_b128 v7, a[20:23] offset:5120
    ds_write_b128 v7, a[24:27] offset:6144
    ds_write_b128 v7, a[28:31] offset:7168
    v_accvgpr_read_b32 v16, a32
    v_accvgpr_read_b32 v17, a33
    v_accvgpr_read_b32 v18, a34
    v_accvgpr_read_b32 v19, a35
    v_accvgpr_read_b32 v20, a36
    v_accvgpr_read_b32 v21, a37
    v_accvgpr_read_b32 v22, a38
    v_accvgpr_read_b32 v23, a39
    v_accvgpr_read_b32 v24, a40
    v_accvgpr_read_b32 v25, a41
    v_accvgpr_read_b32 v26, a42
    v_accvgpr_read_b32 v27, a43
    v_accvgpr_read_b32 v28, a44
    v_accvgpr_read_b32 v29, a45
    v_accvgpr_read_b32 v30, a46
    v_accvgpr_read_b32 v31, a47
    v_accvgpr_read_b32 v32, a48
    v_accvgpr_read_b32 v33, a49
    v_accvgpr_read_b32 v34, a50
    v_accvgpr_read_b32 v35, a51
    v_accvgpr_read_b32 v36, a52
    v_accvgpr_read_b32 v37, a53
    v_accvgpr_read_b32 v38, a54
    v_accvgpr_read_b32 v39, a55
    v_accvgpr_read_b32 v40, a56
    v_accvgpr_read_b32 v41, a57
    v_accvgpr_read_b32 v42, a58
    v_accvgpr_read_b32 v43, a59
    v_accvgpr_read_b32 v44, a60
    v_accvgpr_read_b32 v45, a61
    v_accvgpr_read_b32 v46, a62
    v_accvgpr_read_b32 v47, a63
    v_add_u32 v7, 65536, v6
    ds_write_b128 v7, a[64:67] offset:0
    ds_write_b128 v7, a[68:71] offset:1024
    ds_write_b128 v7, a[72:75] offset:2048
    ds_write_b128 v7, a[76:79] offset:3072
    ds_write_b128 v7, a[80:83] offset:4096
    ds_write_b128 v7, a[84:87] offset:5120
    ds_write_b128 v7, a[88:91] offset:6144
    ds_write_b128 v7, a[92:95] offset:7168
    v_add_u32 v7, 81920, v6
    ds_write_b128 v7, a[96:99] offset:0
    ds_write_b128 v7, a[100:103] offset:1024
    ds_write_b128 v7, a[104:107] offset:2048
    ds_write_b128 v7, a[108:111] offset:3072
    ds_write_b128 v7, a[112:115] offset:4096
    ds_write_b128 v7, a[116:119] offset:5120
    ds_write_b128 v7, a[120:123] offset:6144
    ds_write_b128 v7, a[124:127] offset:7168
L_gw_49:
    s_cmp_lg_u32 s28, 2
    s_cbranch_scc1 L_gw_50
    v_add_u32 v7, 8192, v6
    ds_write_b128 v7, a[0:3] offset:0
    ds_write_b128 v7, a[4:7] offset:1024
    ds_write_b128 v7, a[8:11] offset:2048
    ds_write_b128 v7, a[12:15] offset:3072
    ds_write_b128 v7, a[16:19] offset:4096
    ds_write_b128 v7, a[20:23] offset:5120
    ds_write_b128 v7, a[24:27] offset:6144
    ds_write_b128 v7, a[28:31] offset:7168
    v_add_u32 v7, 40960, v6
    ds_write_b128 v7, a[32:35] offset:0
    ds_write_b128 v7, a[36:39] offset:1024
    ds_write_b128 v7, a[40:43] offset:2048
    ds_write_b128 v7, a[44:47] offset:3072
    ds_write_b128 v7, a[48:51] offset:4096
    ds_write_b128 v7, a[52:55] offset:5120
    ds_write_b128 v7, a[56:59] offset:6144
    ds_write_b128 v7, a[60:63] offset:7168
    v_accvgpr_read_b32 v16, a64
    v_accvgpr_read_b32 v17, a65
    v_accvgpr_read_b32 v18, a66
    v_accvgpr_read_b32 v19, a67
    v_accvgpr_read_b32 v20, a68
    v_accvgpr_read_b32 v21, a69
    v_accvgpr_read_b32 v22, a70
    v_accvgpr_read_b32 v23, a71
    v_accvgpr_read_b32 v24, a72
    v_accvgpr_read_b32 v25, a73
    v_accvgpr_read_b32 v26, a74
    v_accvgpr_read_b32 v27, a75
    v_accvgpr_read_b32 v28, a76
    v_accvgpr_read_b32 v29, a77
    v_accvgpr_read_b32 v30, a78
    v_accvgpr_read_b32 v31, a79
    v_accvgpr_read_b32 v32, a80
    v_accvgpr_read_b32 v33, a81
    v_accvgpr_read_b32 v34, a82
    v_accvgpr_read_b32 v35, a83
    v_accvgpr_read_b32 v36, a84
    v_accvgpr_read_b32 v37, a85
    v_accvgpr_read_b32 v38, a86
    v_accvgpr_read_b32 v39, a87
    v_accvgpr_read_b32 v40, a88
    v_accvgpr_read_b32 v41, a89
    v_accvgpr_read_b32 v42, a90
    v_accvgpr_read_b32 v43, a91
    v_accvgpr_read_b32 v44, a92
    v_accvgpr_read_b32 v45, a93
    v_accvgpr_read_b32 v46, a94
    v_accvgpr_read_b32 v47, a95
    v_add_u32 v7, 73728, v6
    ds_write_b128 v7, a[96:99] offset:0
    ds_write_b128 v7, a[100:103] offset:1024
    ds_write_b128 v7, a[104:107] offset:2048
    ds_write_b128 v7, a[108:111] offset:3072
    ds_write_b128 v7, a[112:115] offset:4096
    ds_write_b128 v7, a[116:119] offset:5120
    ds_write_b128 v7, a[120:123] offset:6144
    ds_write_b128 v7, a[124:127] offset:7168
L_gw_50:
    s_cmp_lg_u32 s28, 3
    s_cbranch_scc1 L_gw_51
    v_add_u32 v7, 16384, v6
    ds_write_b128 v7, a[0:3] offset:0
    ds_write_b128 v7, a[4:7] offset:1024
    ds_write_b128 v7, a[8:11] offset:2048
    ds_write_b128 v7, a[12:15] offset:3072
    ds_write_b128 v7, a[16:19] offset:4096
    ds_write_b128 v7, a[20:23] offset:5120
    ds_write_b128 v7, a[24:27] offset:6144
    ds_write_b128 v7, a[28:31] offset:7168
    v_add_u32 v7, 32768, v6
    ds_write_b128 v7, a[32:35] offset:0
    ds_write_b128 v7, a[36:39] offset:1024
    ds_write_b128 v7, a[40:43] offset:2048
    ds_write_b128 v7, a[44:47] offset:3072
    ds_write_b128 v7, a[48:51] offset:4096
    ds_write_b128 v7, a[52:55] offset:5120
    ds_write_b128 v7, a[56:59] offset:6144
    ds_write_b128 v7, a[60:63] offset:7168
    v_add_u32 v7, 49152, v6
    ds_write_b128 v7, a[64:67] offset:0
    ds_write_b128 v7, a[68:71] offset:1024
    ds_write_b128 v7, a[72:75] offset:2048
    ds_write_b128 v7, a[76:79] offset:3072
    ds_write_b128 v7, a[80:83] offset:4096
    ds_write_b128 v7, a[84:87] offset:5120
    ds_write_b128 v7, a[88:91] offset:6144
    ds_write_b128 v7, a[92:95] offset:7168
    v_accvgpr_read_b32 v16, a96
    v_accvgpr_read_b32 v17, a97
    v_accvgpr_read_b32 v18, a98
    v_accvgpr_read_b32 v19, a99
    v_accvgpr_read_b32 v20, a100
    v_accvgpr_read_b32 v21, a101
    v_accvgpr_read_b32 v22, a102
    v_accvgpr_read_b32 v23, a103
    v_accvgpr_read_b32 v24, a104
    v_accvgpr_read_b32 v25, a105
    v_accvgpr_read_b32 v26, a106
    v_accvgpr_read_b32 v27, a107
    v_accvgpr_read_b32 v28, a108
    v_accvgpr_read_b32 v29, a109
    v_accvgpr_read_b32 v30, a110
    v_accvgpr_read_b32 v31, a111
    v_accvgpr_read_b32 v32, a112
    v_accvgpr_read_b32 v33, a113
    v_accvgpr_read_b32 v34, a114
    v_accvgpr_read_b32 v35, a115
    v_accvgpr_read_b32 v36, a116
    v_accvgpr_read_b32 v37, a117
    v_accvgpr_read_b32 v38, a118
    v_accvgpr_read_b32 v39, a119
    v_accvgpr_read_b32 v40, a120
    v_accvgpr_read_b32 v41, a121
    v_accvgpr_read_b32 v42, a122
    v_accvgpr_read_b32 v43, a123
    v_accvgpr_read_b32 v44, a124
    v_accvgpr_read_b32 v45, a125
    v_accvgpr_read_b32 v46, a126
    v_accvgpr_read_b32 v47, a127
L_gw_51:
    s_mul_i32 s36, s28, 24576
    v_add_u32 v7, s36, v6
    s_waitcnt lgkmcnt(0)
    s_barrier
    ds_read_b128 v[48:51], v7 offset:0
    ds_read_b128 v[52:55], v7 offset:1024
    ds_read_b128 v[56:59], v7 offset:2048
    ds_read_b128 v[60:63], v7 offset:3072
    ds_read_b128 v[64:67], v7 offset:4096
    ds_read_b128 v[68:71], v7 offset:5120
    ds_read_b128 v[72:75], v7 offset:6144
    ds_read_b128 v[76:79], v7 offset:7168
    ds_read_b128 v[80:83], v7 offset:8192
    ds_read_b128 v[84:87], v7 offset:9216
    ds_read_b128 v[88:91], v7 offset:10240
    ds_read_b128 v[92:95], v7 offset:11264
    ds_read_b128 v[96:99], v7 offset:12288
    ds_read_b128 v[100:103], v7 offset:13312
    ds_read_b128 v[104:107], v7 offset:14336
    ds_read_b128 v[108:111], v7 offset:15360
    s_waitcnt lgkmcnt(8)
    v_add_f32 v16, v16, v48
    v_add_f32 v17, v17, v49
    v_add_f32 v18, v18, v50
    v_add_f32 v19, v19, v51
    v_add_f32 v20, v20, v52
    v_add_f32 v21, v21, v53
    v_add_f32 v22, v22, v54
    v_add_f32 v23, v23, v55
    v_add_f32 v24, v24, v56
    v_add_f32 v25, v25, v57
    v_add_f32 v26, v26, v58
    v_add_f32 v27, v27, v59
    v_add_f32 v28, v28, v60
    v_add_f32 v29, v29, v61
    v_add_f32 v30, v30, v62
    v_add_f32 v31, v31, v63
    v_add_f32 v32, v32, v64
    v_add_f32 v33, v33, v65
    v_add_f32 v34, v34, v66
    v_add_f32 v35, v35, v67
    v_add_f32 v36, v36, v68
    v_add_f32 v37, v37, v69
    v_add_f32 v38, v38, v70
    v_add_f32 v39, v39, v71
    v_add_f32 v40, v40, v72
    v_add_f32 v41, v41, v73
    v_add_f32 v42, v42, v74
    v_add_f32 v43, v43, v75
    v_add_f32 v44, v44, v76
    v_add_f32 v45, v45, v77
    v_add_f32 v46, v46, v78
    v_add_f32 v47, v47, v79
    ds_read_b128 v[112:115], v7 offset:16384
    ds_read_b128 v[116:119], v7 offset:17408
    ds_read_b128 v[120:123], v7 offset:18432
    ds_read_b128 v[124:127], v7 offset:19456
    ds_read_b128 v[128:131], v7 offset:20480
    ds_read_b128 v[132:135], v7 offset:21504
    ds_read_b128 v[136:139], v7 offset:22528
    ds_read_b128 v[140:143], v7 offset:23552
    s_waitcnt lgkmcnt(8)
    v_add_f32 v16, v16, v80
    v_add_f32 v17, v17, v81
    v_add_f32 v18, v18, v82
    v_add_f32 v19, v19, v83
    v_add_f32 v20, v20, v84
    v_add_f32 v21, v21, v85
    v_add_f32 v22, v22, v86
    v_add_f32 v23, v23, v87
    v_add_f32 v24, v24, v88
    v_add_f32 v25, v25, v89
    v_add_f32 v26, v26, v90
    v_add_f32 v27, v27, v91
    v_add_f32 v28, v28, v92
    v_add_f32 v29, v29, v93
    v_add_f32 v30, v30, v94
    v_add_f32 v31, v31, v95
    v_add_f32 v32, v32, v96
    v_add_f32 v33, v33, v97
    v_add_f32 v34, v34, v98
    v_add_f32 v35, v35, v99
    v_add_f32 v36, v36, v100
    v_add_f32 v37, v37, v101
    v_add_f32 v38, v38, v102
    v_add_f32 v39, v39, v103
    v_add_f32 v40, v40, v104
    v_add_f32 v41, v41, v105
    v_add_f32 v42, v42, v106
    v_add_f32 v43, v43, v107
    v_add_f32 v44, v44, v108
    v_add_f32 v45, v45, v109
    v_add_f32 v46, v46, v110
    v_add_f32 v47, v47, v111
    s_waitcnt lgkmcnt(0)
    v_add_f32 v16, v16, v112
    v_add_f32 v17, v17, v113
    v_add_f32 v18, v18, v114
    v_add_f32 v19, v19, v115
    v_add_f32 v20, v20, v116
    v_add_f32 v21, v21, v117
    v_add_f32 v22, v22, v118
    v_add_f32 v23, v23, v119
    v_add_f32 v24, v24, v120
    v_add_f32 v25, v25, v121
    v_add_f32 v26, v26, v122
    v_add_f32 v27, v27, v123
    v_add_f32 v28, v28, v124
    v_add_f32 v29, v29, v125
    v_add_f32 v30, v30, v126
    v_add_f32 v31, v31, v127
    v_add_f32 v32, v32, v128
    v_add_f32 v33, v33, v129
    v_add_f32 v34, v34, v130
    v_add_f32 v35, v35, v131
    v_add_f32 v36, v36, v132
    v_add_f32 v37, v37, v133
    v_add_f32 v38, v38, v134
    v_add_f32 v39, v39, v135
    v_add_f32 v40, v40, v136
    v_add_f32 v41, v41, v137
    v_add_f32 v42, v42, v138
    v_add_f32 v43, v43, v139
    v_add_f32 v44, v44, v140
    v_add_f32 v45, v45, v141
    v_add_f32 v46, v46, v142
    v_add_f32 v47, v47, v143
    v_lshlrev_b32 v48, 16, v8
    v_and_b32 v49, s62, v8
    v_lshlrev_b32 v50, 16, v9
    v_and_b32 v51, s62, v9
    v_lshlrev_b32 v5, 12, v1
    v_lshl_add_u32 v5, v2, 4, v5
    s_lshl_b32 s36, s40, 16
    s_lshl_b32 s37, s41, 8
    s_add_u32 s36, s36, s37
    s_lshl_b32 s37, s28, 6
    s_add_u32 s36, s36, s37
    s_add_u32 s36, s36, 0x600000
    v_cvt_pk_bf16_f32 v16, v16, v16
    v_and_b32 v16, s62, v16
    v_add_f32 v16, v16, v48
    v_cvt_pk_bf16_f32 v17, v17, v17
    v_and_b32 v17, s62, v17
    v_add_f32 v17, v17, v48
    v_cvt_pk_bf16_f32 v18, v18, v18
    v_and_b32 v18, s62, v18
    v_add_f32 v18, v18, v48
    v_cvt_pk_bf16_f32 v19, v19, v19
    v_and_b32 v19, s62, v19
    v_add_f32 v19, v19, v48
    v_cvt_pk_bf16_f32 v68, v16, v17
    v_cvt_pk_bf16_f32 v69, v18, v19
    v_cvt_pk_bf16_f32 v32, v32, v32
    v_and_b32 v32, s62, v32
    v_add_f32 v32, v32, v48
    v_cvt_pk_bf16_f32 v33, v33, v33
    v_and_b32 v33, s62, v33
    v_add_f32 v33, v33, v48
    v_cvt_pk_bf16_f32 v34, v34, v34
    v_and_b32 v34, s62, v34
    v_add_f32 v34, v34, v48
    v_cvt_pk_bf16_f32 v35, v35, v35
    v_and_b32 v35, s62, v35
    v_add_f32 v35, v35, v48
    v_cvt_pk_bf16_f32 v70, v32, v33
    v_cvt_pk_bf16_f32 v71, v34, v35
    buffer_store_dwordx4 v[68:71], v5, s[4:7], s36 offen offset:0 sc1
    v_cvt_pk_bf16_f32 v20, v20, v20
    v_and_b32 v20, s62, v20
    v_add_f32 v20, v20, v49
    v_cvt_pk_bf16_f32 v21, v21, v21
    v_and_b32 v21, s62, v21
    v_add_f32 v21, v21, v49
    v_cvt_pk_bf16_f32 v22, v22, v22
    v_and_b32 v22, s62, v22
    v_add_f32 v22, v22, v49
    v_cvt_pk_bf16_f32 v23, v23, v23
    v_and_b32 v23, s62, v23
    v_add_f32 v23, v23, v49
    v_cvt_pk_bf16_f32 v72, v20, v21
    v_cvt_pk_bf16_f32 v73, v22, v23
    v_cvt_pk_bf16_f32 v36, v36, v36
    v_and_b32 v36, s62, v36
    v_add_f32 v36, v36, v49
    v_cvt_pk_bf16_f32 v37, v37, v37
    v_and_b32 v37, s62, v37
    v_add_f32 v37, v37, v49
    v_cvt_pk_bf16_f32 v38, v38, v38
    v_and_b32 v38, s62, v38
    v_add_f32 v38, v38, v49
    v_cvt_pk_bf16_f32 v39, v39, v39
    v_and_b32 v39, s62, v39
    v_add_f32 v39, v39, v49
    v_cvt_pk_bf16_f32 v74, v36, v37
    v_cvt_pk_bf16_f32 v75, v38, v39
    buffer_store_dwordx4 v[72:75], v5, s[4:7], s36 offen offset:1024 sc1
    v_cvt_pk_bf16_f32 v24, v24, v24
    v_and_b32 v24, s62, v24
    v_add_f32 v24, v24, v50
    v_cvt_pk_bf16_f32 v25, v25, v25
    v_and_b32 v25, s62, v25
    v_add_f32 v25, v25, v50
    v_cvt_pk_bf16_f32 v26, v26, v26
    v_and_b32 v26, s62, v26
    v_add_f32 v26, v26, v50
    v_cvt_pk_bf16_f32 v27, v27, v27
    v_and_b32 v27, s62, v27
    v_add_f32 v27, v27, v50
    v_cvt_pk_bf16_f32 v76, v24, v25
    v_cvt_pk_bf16_f32 v77, v26, v27
    v_cvt_pk_bf16_f32 v40, v40, v40
    v_and_b32 v40, s62, v40
    v_add_f32 v40, v40, v50
    v_cvt_pk_bf16_f32 v41, v41, v41
    v_and_b32 v41, s62, v41
    v_add_f32 v41, v41, v50
    v_cvt_pk_bf16_f32 v42, v42, v42
    v_and_b32 v42, s62, v42
    v_add_f32 v42, v42, v50
    v_cvt_pk_bf16_f32 v43, v43, v43
    v_and_b32 v43, s62, v43
    v_add_f32 v43, v43, v50
    v_cvt_pk_bf16_f32 v78, v40, v41
    v_cvt_pk_bf16_f32 v79, v42, v43
    buffer_store_dwordx4 v[76:79], v5, s[4:7], s36 offen offset:2048 sc1
    v_cvt_pk_bf16_f32 v28, v28, v28
    v_and_b32 v28, s62, v28
    v_add_f32 v28, v28, v51
    v_cvt_pk_bf16_f32 v29, v29, v29
    v_and_b32 v29, s62, v29
    v_add_f32 v29, v29, v51
    v_cvt_pk_bf16_f32 v30, v30, v30
    v_and_b32 v30, s62, v30
    v_add_f32 v30, v30, v51
    v_cvt_pk_bf16_f32 v31, v31, v31
    v_and_b32 v31, s62, v31
    v_add_f32 v31, v31, v51
    v_cvt_pk_bf16_f32 v80, v28, v29
    v_cvt_pk_bf16_f32 v81, v30, v31
    v_cvt_pk_bf16_f32 v44, v44, v44
    v_and_b32 v44, s62, v44
    v_add_f32 v44, v44, v51
    v_cvt_pk_bf16_f32 v45, v45, v45
    v_and_b32 v45, s62, v45
    v_add_f32 v45, v45, v51
    v_cvt_pk_bf16_f32 v46, v46, v46
    v_and_b32 v46, s62, v46
    v_add_f32 v46, v46, v51
    v_cvt_pk_bf16_f32 v47, v47, v47
    v_and_b32 v47, s62, v47
    v_add_f32 v47, v47, v51
    v_cvt_pk_bf16_f32 v82, v44, v45
    v_cvt_pk_bf16_f32 v83, v46, v47
    buffer_store_dwordx4 v[80:83], v5, s[4:7], s36 offen offset:3072 sc1
    s_waitcnt vmcnt(0)
    s_barrier
    s_cmp_lg_u32 s28, 0
    s_cbranch_scc1 L_arr_52
    v_mov_b32 v250, 1
    v_mov_b32 v251, 16
    s_mov_b64 exec, 1
    buffer_atomic_add v250, v251, s[8:11], 0 offen sc0
    s_mov_b64 exec, -1
    s_waitcnt vmcnt(0)
    v_readfirstlane_b32 s30, v250
    s_add_u32 s30, s30, 1
    s_and_b32 s57, s30, 0xffff
    s_cmp_lg_u32 s57, 128
    s_cbranch_scc1 L_ae_53
    v_mov_b32 v250, s30
    v_mov_b32 v251, 144
    s_mov_b64 exec, 1
    buffer_store_dword v250, v251, s[8:11], 0 offen sc1
    s_mov_b64 exec, -1
L_ae_53:
L_arr_52:
L_no_b2:
    s_mov_b32 s12, s74
    s_mov_b32 s13, s75
    s_mov_b32 s14, 0x400000
    s_mov_b32 s15, 0x20000
    s_mov_b32 s16, s64
    s_mov_b32 s17, s65
    s_mov_b32 s18, 0x200000
    s_mov_b32 s19, 0x20000
    s_mov_b32 s20, s88
    s_mov_b32 s21, s89
    s_mov_b32 s22, 0x200000
    s_mov_b32 s23, 0x20000
    s_and_b32 s40, s31, 15
    s_lshr_b32 s41, s31, 4
    v_and_b32 v1, 15, v255
    v_lshrrev_b32 v2, 4, v255
    v_lshlrev_b32 v3, 13, v2
    v_lshl_add_u32 v3, v1, 2, v3
    s_lshl_b32 s36, s28, 20
    s_lshl_b32 s37, s40, 6
    s_add_u32 s36, s36, s37
    v_add_u32 v3, s36, v3
    s_mov_b32 s36, 0x0
    buffer_load_dword v64, v3, s[12:15], s36 offen offset:0
    buffer_load_dword v65, v3, s[12:15], s36 offen offset:2048
    s_mov_b32 s36, 0x1000
    buffer_load_dword v66, v3, s[12:15], s36 offen offset:0
    buffer_load_dword v67, v3, s[12:15], s36 offen offset:2048
    s_mov_b32 s36, 0x0
    buffer_load_dword v68, v3, s[12:15], s36 offen offset:1024
    buffer_load_dword v69, v3, s[12:15], s36 offen offset:3072
    s_mov_b32 s36, 0x1000
    buffer_load_dword v70, v3, s[12:15], s36 offen offset:1024
    buffer_load_dword v71, v3, s[12:15], s36 offen offset:3072
    s_mov_b32 s36, 0x8000
    buffer_load_dword v72, v3, s[12:15], s36 offen offset:0
    buffer_load_dword v73, v3, s[12:15], s36 offen offset:2048
    s_mov_b32 s36, 0x9000
    buffer_load_dword v74, v3, s[12:15], s36 offen offset:0
    buffer_load_dword v75, v3, s[12:15], s36 offen offset:2048
    s_mov_b32 s36, 0x8000
    buffer_load_dword v76, v3, s[12:15], s36 offen offset:1024
    buffer_load_dword v77, v3, s[12:15], s36 offen offset:3072
    s_mov_b32 s36, 0x9000
    buffer_load_dword v78, v3, s[12:15], s36 offen offset:1024
    buffer_load_dword v79, v3, s[12:15], s36 offen offset:3072
    s_mov_b32 s36, 0x10000
    buffer_load_dword v80, v3, s[12:15], s36 offen offset:0
    buffer_load_dword v81, v3, s[12:15], s36 offen offset:2048
    s_mov_b32 s36, 0x11000
    buffer_load_dword v82, v3, s[12:15], s36 offen offset:0
    buffer_load_dword v83, v3, s[12:15], s36 offen offset:2048
    s_mov_b32 s36, 0x10000
    buffer_load_dword v84, v3, s[12:15], s36 offen offset:1024
    buffer_load_dword v85, v3, s[12:15], s36 offen offset:3072
    s_mov_b32 s36, 0x11000
    buffer_load_dword v86, v3, s[12:15], s36 offen offset:1024
    buffer_load_dword v87, v3, s[12:15], s36 offen offset:3072
    s_mov_b32 s36, 0x18000
    buffer_load_dword v88, v3, s[12:15], s36 offen offset:0
    buffer_load_dword v89, v3, s[12:15], s36 offen offset:2048
    s_mov_b32 s36, 0x19000
    buffer_load_dword v90, v3, s[12:15], s36 offen offset:0
    buffer_load_dword v91, v3, s[12:15], s36 offen offset:2048
    s_mov_b32 s36, 0x18000
    buffer_load_dword v92, v3, s[12:15], s36 offen offset:1024
    buffer_load_dword v93, v3, s[12:15], s36 offen offset:3072
    s_mov_b32 s36, 0x19000
    buffer_load_dword v94, v3, s[12:15], s36 offen offset:1024
    buffer_load_dword v95, v3, s[12:15], s36 offen offset:3072
    s_mov_b32 s36, 0x20000
    buffer_load_dword v96, v3, s[12:15], s36 offen offset:0
    buffer_load_dword v97, v3, s[12:15], s36 offen offset:2048
    s_mov_b32 s36, 0x21000
    buffer_load_dword v98, v3, s[12:15], s36 offen offset:0
    buffer_load_dword v99, v3, s[12:15], s36 offen offset:2048
    s_mov_b32 s36, 0x20000
    buffer_load_dword v100, v3, s[12:15], s36 offen offset:1024
    buffer_load_dword v101, v3, s[12:15], s36 offen offset:3072
    s_mov_b32 s36, 0x21000
    buffer_load_dword v102, v3, s[12:15], s36 offen offset:1024
    buffer_load_dword v103, v3, s[12:15], s36 offen offset:3072
    s_mov_b32 s36, 0x28000
    buffer_load_dword v104, v3, s[12:15], s36 offen offset:0
    buffer_load_dword v105, v3, s[12:15], s36 offen offset:2048
    s_mov_b32 s36, 0x29000
    buffer_load_dword v106, v3, s[12:15], s36 offen offset:0
    buffer_load_dword v107, v3, s[12:15], s36 offen offset:2048
    s_mov_b32 s36, 0x28000
    buffer_load_dword v108, v3, s[12:15], s36 offen offset:1024
    buffer_load_dword v109, v3, s[12:15], s36 offen offset:3072
    s_mov_b32 s36, 0x29000
    buffer_load_dword v110, v3, s[12:15], s36 offen offset:1024
    buffer_load_dword v111, v3, s[12:15], s36 offen offset:3072
    s_mov_b32 s36, 0x30000
    buffer_load_dword v112, v3, s[12:15], s36 offen offset:0
    buffer_load_dword v113, v3, s[12:15], s36 offen offset:2048
    s_mov_b32 s36, 0x31000
    buffer_load_dword v114, v3, s[12:15], s36 offen offset:0
    buffer_load_dword v115, v3, s[12:15], s36 offen offset:2048
    s_mov_b32 s36, 0x30000
    buffer_load_dword v116, v3, s[12:15], s36 offen offset:1024
    buffer_load_dword v117, v3, s[12:15], s36 offen offset:3072
    s_mov_b32 s36, 0x31000
    buffer_load_dword v118, v3, s[12:15], s36 offen offset:1024
    buffer_load_dword v119, v3, s[12:15], s36 offen offset:3072
    s_waitcnt vmcnt(54)
    v_perm_b32 v62, v65, v64, s60
    v_accvgpr_write_b32 a0, v62
    v_perm_b32 v63, v65, v64, s61
    v_accvgpr_write_b32 a4, v63
    s_mov_b32 s36, 0x38000
    buffer_load_dword v64, v3, s[12:15], s36 offen offset:0
    buffer_load_dword v65, v3, s[12:15], s36 offen offset:2048
    s_waitcnt vmcnt(54)
    v_perm_b32 v62, v67, v66, s60
    v_accvgpr_write_b32 a1, v62
    v_perm_b32 v63, v67, v66, s61
    v_accvgpr_write_b32 a5, v63
    s_mov_b32 s36, 0x39000
    buffer_load_dword v66, v3, s[12:15], s36 offen offset:0
    buffer_load_dword v67, v3, s[12:15], s36 offen offset:2048
    s_waitcnt vmcnt(54)
    v_perm_b32 v62, v69, v68, s60
    v_accvgpr_write_b32 a2, v62
    v_perm_b32 v63, v69, v68, s61
    v_accvgpr_write_b32 a6, v63
    s_mov_b32 s36, 0x38000
    buffer_load_dword v68, v3, s[12:15], s36 offen offset:1024
    buffer_load_dword v69, v3, s[12:15], s36 offen offset:3072
    s_waitcnt vmcnt(54)
    v_perm_b32 v62, v71, v70, s60
    v_accvgpr_write_b32 a3, v62
    v_perm_b32 v63, v71, v70, s61
    v_accvgpr_write_b32 a7, v63
    s_mov_b32 s36, 0x39000
    buffer_load_dword v70, v3, s[12:15], s36 offen offset:1024
    buffer_load_dword v71, v3, s[12:15], s36 offen offset:3072
    s_waitcnt vmcnt(54)
    v_perm_b32 v62, v73, v72, s60
    v_accvgpr_write_b32 a8, v62
    v_perm_b32 v63, v73, v72, s61
    v_accvgpr_write_b32 a12, v63
    s_mov_b32 s36, 0x40000
    buffer_load_dword v72, v3, s[12:15], s36 offen offset:0
    buffer_load_dword v73, v3, s[12:15], s36 offen offset:2048
    s_waitcnt vmcnt(54)
    v_perm_b32 v62, v75, v74, s60
    v_accvgpr_write_b32 a9, v62
    v_perm_b32 v63, v75, v74, s61
    v_accvgpr_write_b32 a13, v63
    s_mov_b32 s36, 0x41000
    buffer_load_dword v74, v3, s[12:15], s36 offen offset:0
    buffer_load_dword v75, v3, s[12:15], s36 offen offset:2048
    s_waitcnt vmcnt(54)
    v_perm_b32 v62, v77, v76, s60
    v_accvgpr_write_b32 a10, v62
    v_perm_b32 v63, v77, v76, s61
    v_accvgpr_write_b32 a14, v63
    s_mov_b32 s36, 0x40000
    buffer_load_dword v76, v3, s[12:15], s36 offen offset:1024
    buffer_load_dword v77, v3, s[12:15], s36 offen offset:3072
    s_waitcnt vmcnt(54)
    v_perm_b32 v62, v79, v78, s60
    v_accvgpr_write_b32 a11, v62
    v_perm_b32 v63, v79, v78, s61
    v_accvgpr_write_b32 a15, v63
    s_mov_b32 s36, 0x41000
    buffer_load_dword v78, v3, s[12:15], s36 offen offset:1024
    buffer_load_dword v79, v3, s[12:15], s36 offen offset:3072
    s_waitcnt vmcnt(54)
    v_perm_b32 v62, v81, v80, s60
    v_accvgpr_write_b32 a16, v62
    v_perm_b32 v63, v81, v80, s61
    v_accvgpr_write_b32 a20, v63
    s_mov_b32 s36, 0x48000
    buffer_load_dword v80, v3, s[12:15], s36 offen offset:0
    buffer_load_dword v81, v3, s[12:15], s36 offen offset:2048
    s_waitcnt vmcnt(54)
    v_perm_b32 v62, v83, v82, s60
    v_accvgpr_write_b32 a17, v62
    v_perm_b32 v63, v83, v82, s61
    v_accvgpr_write_b32 a21, v63
    s_mov_b32 s36, 0x49000
    buffer_load_dword v82, v3, s[12:15], s36 offen offset:0
    buffer_load_dword v83, v3, s[12:15], s36 offen offset:2048
    s_waitcnt vmcnt(54)
    v_perm_b32 v62, v85, v84, s60
    v_accvgpr_write_b32 a18, v62
    v_perm_b32 v63, v85, v84, s61
    v_accvgpr_write_b32 a22, v63
    s_mov_b32 s36, 0x48000
    buffer_load_dword v84, v3, s[12:15], s36 offen offset:1024
    buffer_load_dword v85, v3, s[12:15], s36 offen offset:3072
    s_waitcnt vmcnt(54)
    v_perm_b32 v62, v87, v86, s60
    v_accvgpr_write_b32 a19, v62
    v_perm_b32 v63, v87, v86, s61
    v_accvgpr_write_b32 a23, v63
    s_mov_b32 s36, 0x49000
    buffer_load_dword v86, v3, s[12:15], s36 offen offset:1024
    buffer_load_dword v87, v3, s[12:15], s36 offen offset:3072
    s_waitcnt vmcnt(54)
    v_perm_b32 v62, v89, v88, s60
    v_accvgpr_write_b32 a24, v62
    v_perm_b32 v63, v89, v88, s61
    v_accvgpr_write_b32 a28, v63
    s_mov_b32 s36, 0x50000
    buffer_load_dword v88, v3, s[12:15], s36 offen offset:0
    buffer_load_dword v89, v3, s[12:15], s36 offen offset:2048
    s_waitcnt vmcnt(54)
    v_perm_b32 v62, v91, v90, s60
    v_accvgpr_write_b32 a25, v62
    v_perm_b32 v63, v91, v90, s61
    v_accvgpr_write_b32 a29, v63
    s_mov_b32 s36, 0x51000
    buffer_load_dword v90, v3, s[12:15], s36 offen offset:0
    buffer_load_dword v91, v3, s[12:15], s36 offen offset:2048
    s_waitcnt vmcnt(54)
    v_perm_b32 v62, v93, v92, s60
    v_accvgpr_write_b32 a26, v62
    v_perm_b32 v63, v93, v92, s61
    v_accvgpr_write_b32 a30, v63
    s_mov_b32 s36, 0x50000
    buffer_load_dword v92, v3, s[12:15], s36 offen offset:1024
    buffer_load_dword v93, v3, s[12:15], s36 offen offset:3072
    s_waitcnt vmcnt(54)
    v_perm_b32 v62, v95, v94, s60
    v_accvgpr_write_b32 a27, v62
    v_perm_b32 v63, v95, v94, s61
    v_accvgpr_write_b32 a31, v63
    s_mov_b32 s36, 0x51000
    buffer_load_dword v94, v3, s[12:15], s36 offen offset:1024
    buffer_load_dword v95, v3, s[12:15], s36 offen offset:3072
    s_waitcnt vmcnt(54)
    v_perm_b32 v62, v97, v96, s60
    v_accvgpr_write_b32 a32, v62
    v_perm_b32 v63, v97, v96, s61
    v_accvgpr_write_b32 a36, v63
    s_mov_b32 s36, 0x58000
    buffer_load_dword v96, v3, s[12:15], s36 offen offset:0
    buffer_load_dword v97, v3, s[12:15], s36 offen offset:2048
    s_waitcnt vmcnt(54)
    v_perm_b32 v62, v99, v98, s60
    v_accvgpr_write_b32 a33, v62
    v_perm_b32 v63, v99, v98, s61
    v_accvgpr_write_b32 a37, v63
    s_mov_b32 s36, 0x59000
    buffer_load_dword v98, v3, s[12:15], s36 offen offset:0
    buffer_load_dword v99, v3, s[12:15], s36 offen offset:2048
    s_waitcnt vmcnt(54)
    v_perm_b32 v62, v101, v100, s60
    v_accvgpr_write_b32 a34, v62
    v_perm_b32 v63, v101, v100, s61
    v_accvgpr_write_b32 a38, v63
    s_mov_b32 s36, 0x58000
    buffer_load_dword v100, v3, s[12:15], s36 offen offset:1024
    buffer_load_dword v101, v3, s[12:15], s36 offen offset:3072
    s_waitcnt vmcnt(54)
    v_perm_b32 v62, v103, v102, s60
    v_accvgpr_write_b32 a35, v62
    v_perm_b32 v63, v103, v102, s61
    v_accvgpr_write_b32 a39, v63
    s_mov_b32 s36, 0x59000
    buffer_load_dword v102, v3, s[12:15], s36 offen offset:1024
    buffer_load_dword v103, v3, s[12:15], s36 offen offset:3072
    s_waitcnt vmcnt(54)
    v_perm_b32 v62, v105, v104, s60
    v_accvgpr_write_b32 a40, v62
    v_perm_b32 v63, v105, v104, s61
    v_accvgpr_write_b32 a44, v63
    s_mov_b32 s36, 0x60000
    buffer_load_dword v104, v3, s[12:15], s36 offen offset:0
    buffer_load_dword v105, v3, s[12:15], s36 offen offset:2048
    s_waitcnt vmcnt(54)
    v_perm_b32 v62, v107, v106, s60
    v_accvgpr_write_b32 a41, v62
    v_perm_b32 v63, v107, v106, s61
    v_accvgpr_write_b32 a45, v63
    s_mov_b32 s36, 0x61000
    buffer_load_dword v106, v3, s[12:15], s36 offen offset:0
    buffer_load_dword v107, v3, s[12:15], s36 offen offset:2048
    s_waitcnt vmcnt(54)
    v_perm_b32 v62, v109, v108, s60
    v_accvgpr_write_b32 a42, v62
    v_perm_b32 v63, v109, v108, s61
    v_accvgpr_write_b32 a46, v63
    s_mov_b32 s36, 0x60000
    buffer_load_dword v108, v3, s[12:15], s36 offen offset:1024
    buffer_load_dword v109, v3, s[12:15], s36 offen offset:3072
    s_waitcnt vmcnt(54)
    v_perm_b32 v62, v111, v110, s60
    v_accvgpr_write_b32 a43, v62
    v_perm_b32 v63, v111, v110, s61
    v_accvgpr_write_b32 a47, v63
    s_mov_b32 s36, 0x61000
    buffer_load_dword v110, v3, s[12:15], s36 offen offset:1024
    buffer_load_dword v111, v3, s[12:15], s36 offen offset:3072
    s_waitcnt vmcnt(54)
    v_perm_b32 v62, v113, v112, s60
    v_accvgpr_write_b32 a48, v62
    v_perm_b32 v63, v113, v112, s61
    v_accvgpr_write_b32 a52, v63
    s_mov_b32 s36, 0x68000
    buffer_load_dword v112, v3, s[12:15], s36 offen offset:0
    buffer_load_dword v113, v3, s[12:15], s36 offen offset:2048
    s_waitcnt vmcnt(54)
    v_perm_b32 v62, v115, v114, s60
    v_accvgpr_write_b32 a49, v62
    v_perm_b32 v63, v115, v114, s61
    v_accvgpr_write_b32 a53, v63
    s_mov_b32 s36, 0x69000
    buffer_load_dword v114, v3, s[12:15], s36 offen offset:0
    buffer_load_dword v115, v3, s[12:15], s36 offen offset:2048
    s_waitcnt vmcnt(54)
    v_perm_b32 v62, v117, v116, s60
    v_accvgpr_write_b32 a50, v62
    v_perm_b32 v63, v117, v116, s61
    v_accvgpr_write_b32 a54, v63
    s_mov_b32 s36, 0x68000
    buffer_load_dword v116, v3, s[12:15], s36 offen offset:1024
    buffer_load_dword v117, v3, s[12:15], s36 offen offset:3072
    s_waitcnt vmcnt(54)
    v_perm_b32 v62, v119, v118, s60
    v_accvgpr_write_b32 a51, v62
    v_perm_b32 v63, v119, v118, s61
    v_accvgpr_write_b32 a55, v63
    s_mov_b32 s36, 0x69000
    buffer_load_dword v118, v3, s[12:15], s36 offen offset:1024
    buffer_load_dword v119, v3, s[12:15], s36 offen offset:3072
    s_waitcnt vmcnt(54)
    v_perm_b32 v62, v65, v64, s60
    v_accvgpr_write_b32 a56, v62
    v_perm_b32 v63, v65, v64, s61
    v_accvgpr_write_b32 a60, v63
    s_mov_b32 s36, 0x70000
    buffer_load_dword v64, v3, s[12:15], s36 offen offset:0
    buffer_load_dword v65, v3, s[12:15], s36 offen offset:2048
    s_waitcnt vmcnt(54)
    v_perm_b32 v62, v67, v66, s60
    v_accvgpr_write_b32 a57, v62
    v_perm_b32 v63, v67, v66, s61
    v_accvgpr_write_b32 a61, v63
    s_mov_b32 s36, 0x71000
    buffer_load_dword v66, v3, s[12:15], s36 offen offset:0
    buffer_load_dword v67, v3, s[12:15], s36 offen offset:2048
    s_waitcnt vmcnt(54)
    v_perm_b32 v62, v69, v68, s60
    v_accvgpr_write_b32 a58, v62
    v_perm_b32 v63, v69, v68, s61
    v_accvgpr_write_b32 a62, v63
    s_mov_b32 s36, 0x70000
    buffer_load_dword v68, v3, s[12:15], s36 offen offset:1024
    buffer_load_dword v69, v3, s[12:15], s36 offen offset:3072
    s_waitcnt vmcnt(54)
    v_perm_b32 v62, v71, v70, s60
    v_accvgpr_write_b32 a59, v62
    v_perm_b32 v63, v71, v70, s61
    v_accvgpr_write_b32 a63, v63
    s_mov_b32 s36, 0x71000
    buffer_load_dword v70, v3, s[12:15], s36 offen offset:1024
    buffer_load_dword v71, v3, s[12:15], s36 offen offset:3072
    s_waitcnt vmcnt(54)
    v_perm_b32 v62, v73, v72, s60
    v_accvgpr_write_b32 a64, v62
    v_perm_b32 v63, v73, v72, s61
    v_accvgpr_write_b32 a68, v63
    s_mov_b32 s36, 0x78000
    buffer_load_dword v72, v3, s[12:15], s36 offen offset:0
    buffer_load_dword v73, v3, s[12:15], s36 offen offset:2048
    s_waitcnt vmcnt(54)
    v_perm_b32 v62, v75, v74, s60
    v_accvgpr_write_b32 a65, v62
    v_perm_b32 v63, v75, v74, s61
    v_accvgpr_write_b32 a69, v63
    s_mov_b32 s36, 0x79000
    buffer_load_dword v74, v3, s[12:15], s36 offen offset:0
    buffer_load_dword v75, v3, s[12:15], s36 offen offset:2048
    s_waitcnt vmcnt(54)
    v_perm_b32 v62, v77, v76, s60
    v_accvgpr_write_b32 a66, v62
    v_perm_b32 v63, v77, v76, s61
    v_accvgpr_write_b32 a70, v63
    s_mov_b32 s36, 0x78000
    buffer_load_dword v76, v3, s[12:15], s36 offen offset:1024
    buffer_load_dword v77, v3, s[12:15], s36 offen offset:3072
    s_waitcnt vmcnt(54)
    v_perm_b32 v62, v79, v78, s60
    v_accvgpr_write_b32 a67, v62
    v_perm_b32 v63, v79, v78, s61
    v_accvgpr_write_b32 a71, v63
    s_mov_b32 s36, 0x79000
    buffer_load_dword v78, v3, s[12:15], s36 offen offset:1024
    buffer_load_dword v79, v3, s[12:15], s36 offen offset:3072
    s_waitcnt vmcnt(54)
    v_perm_b32 v62, v81, v80, s60
    v_accvgpr_write_b32 a72, v62
    v_perm_b32 v63, v81, v80, s61
    v_accvgpr_write_b32 a76, v63
    s_mov_b32 s36, 0x80000
    buffer_load_dword v80, v3, s[12:15], s36 offen offset:0
    buffer_load_dword v81, v3, s[12:15], s36 offen offset:2048
    s_waitcnt vmcnt(54)
    v_perm_b32 v62, v83, v82, s60
    v_accvgpr_write_b32 a73, v62
    v_perm_b32 v63, v83, v82, s61
    v_accvgpr_write_b32 a77, v63
    s_mov_b32 s36, 0x81000
    buffer_load_dword v82, v3, s[12:15], s36 offen offset:0
    buffer_load_dword v83, v3, s[12:15], s36 offen offset:2048
    s_waitcnt vmcnt(54)
    v_perm_b32 v62, v85, v84, s60
    v_accvgpr_write_b32 a74, v62
    v_perm_b32 v63, v85, v84, s61
    v_accvgpr_write_b32 a78, v63
    s_mov_b32 s36, 0x80000
    buffer_load_dword v84, v3, s[12:15], s36 offen offset:1024
    buffer_load_dword v85, v3, s[12:15], s36 offen offset:3072
    s_waitcnt vmcnt(54)
    v_perm_b32 v62, v87, v86, s60
    v_accvgpr_write_b32 a75, v62
    v_perm_b32 v63, v87, v86, s61
    v_accvgpr_write_b32 a79, v63
    s_mov_b32 s36, 0x81000
    buffer_load_dword v86, v3, s[12:15], s36 offen offset:1024
    buffer_load_dword v87, v3, s[12:15], s36 offen offset:3072
    s_waitcnt vmcnt(54)
    v_perm_b32 v62, v89, v88, s60
    v_accvgpr_write_b32 a80, v62
    v_perm_b32 v63, v89, v88, s61
    v_accvgpr_write_b32 a84, v63
    s_mov_b32 s36, 0x88000
    buffer_load_dword v88, v3, s[12:15], s36 offen offset:0
    buffer_load_dword v89, v3, s[12:15], s36 offen offset:2048
    s_waitcnt vmcnt(54)
    v_perm_b32 v62, v91, v90, s60
    v_accvgpr_write_b32 a81, v62
    v_perm_b32 v63, v91, v90, s61
    v_accvgpr_write_b32 a85, v63
    s_mov_b32 s36, 0x89000
    buffer_load_dword v90, v3, s[12:15], s36 offen offset:0
    buffer_load_dword v91, v3, s[12:15], s36 offen offset:2048
    s_waitcnt vmcnt(54)
    v_perm_b32 v62, v93, v92, s60
    v_accvgpr_write_b32 a82, v62
    v_perm_b32 v63, v93, v92, s61
    v_accvgpr_write_b32 a86, v63
    s_mov_b32 s36, 0x88000
    buffer_load_dword v92, v3, s[12:15], s36 offen offset:1024
    buffer_load_dword v93, v3, s[12:15], s36 offen offset:3072
    s_waitcnt vmcnt(54)
    v_perm_b32 v62, v95, v94, s60
    v_accvgpr_write_b32 a83, v62
    v_perm_b32 v63, v95, v94, s61
    v_accvgpr_write_b32 a87, v63
    s_mov_b32 s36, 0x89000
    buffer_load_dword v94, v3, s[12:15], s36 offen offset:1024
    buffer_load_dword v95, v3, s[12:15], s36 offen offset:3072
    s_waitcnt vmcnt(54)
    v_perm_b32 v62, v97, v96, s60
    v_accvgpr_write_b32 a88, v62
    v_perm_b32 v63, v97, v96, s61
    v_accvgpr_write_b32 a92, v63
    s_mov_b32 s36, 0x90000
    buffer_load_dword v96, v3, s[12:15], s36 offen offset:0
    buffer_load_dword v97, v3, s[12:15], s36 offen offset:2048
    s_waitcnt vmcnt(54)
    v_perm_b32 v62, v99, v98, s60
    v_accvgpr_write_b32 a89, v62
    v_perm_b32 v63, v99, v98, s61
    v_accvgpr_write_b32 a93, v63
    s_mov_b32 s36, 0x91000
    buffer_load_dword v98, v3, s[12:15], s36 offen offset:0
    buffer_load_dword v99, v3, s[12:15], s36 offen offset:2048
    s_waitcnt vmcnt(54)
    v_perm_b32 v62, v101, v100, s60
    v_accvgpr_write_b32 a90, v62
    v_perm_b32 v63, v101, v100, s61
    v_accvgpr_write_b32 a94, v63
    s_mov_b32 s36, 0x90000
    buffer_load_dword v100, v3, s[12:15], s36 offen offset:1024
    buffer_load_dword v101, v3, s[12:15], s36 offen offset:3072
    s_waitcnt vmcnt(54)
    v_perm_b32 v62, v103, v102, s60
    v_accvgpr_write_b32 a91, v62
    v_perm_b32 v63, v103, v102, s61
    v_accvgpr_write_b32 a95, v63
    s_mov_b32 s36, 0x91000
    buffer_load_dword v102, v3, s[12:15], s36 offen offset:1024
    buffer_load_dword v103, v3, s[12:15], s36 offen offset:3072
    s_waitcnt vmcnt(54)
    v_perm_b32 v62, v105, v104, s60
    v_accvgpr_write_b32 a96, v62
    v_perm_b32 v63, v105, v104, s61
    v_accvgpr_write_b32 a100, v63
    s_mov_b32 s36, 0x98000
    buffer_load_dword v104, v3, s[12:15], s36 offen offset:0
    buffer_load_dword v105, v3, s[12:15], s36 offen offset:2048
    s_waitcnt vmcnt(54)
    v_perm_b32 v62, v107, v106, s60
    v_accvgpr_write_b32 a97, v62
    v_perm_b32 v63, v107, v106, s61
    v_accvgpr_write_b32 a101, v63
    s_mov_b32 s36, 0x99000
    buffer_load_dword v106, v3, s[12:15], s36 offen offset:0
    buffer_load_dword v107, v3, s[12:15], s36 offen offset:2048
    s_waitcnt vmcnt(54)
    v_perm_b32 v62, v109, v108, s60
    v_accvgpr_write_b32 a98, v62
    v_perm_b32 v63, v109, v108, s61
    v_accvgpr_write_b32 a102, v63
    s_mov_b32 s36, 0x98000
    buffer_load_dword v108, v3, s[12:15], s36 offen offset:1024
    buffer_load_dword v109, v3, s[12:15], s36 offen offset:3072
    s_waitcnt vmcnt(54)
    v_perm_b32 v62, v111, v110, s60
    v_accvgpr_write_b32 a99, v62
    v_perm_b32 v63, v111, v110, s61
    v_accvgpr_write_b32 a103, v63
    s_mov_b32 s36, 0x99000
    buffer_load_dword v110, v3, s[12:15], s36 offen offset:1024
    buffer_load_dword v111, v3, s[12:15], s36 offen offset:3072
    s_waitcnt vmcnt(54)
    v_perm_b32 v62, v113, v112, s60
    v_accvgpr_write_b32 a104, v62
    v_perm_b32 v63, v113, v112, s61
    v_accvgpr_write_b32 a108, v63
    s_mov_b32 s36, 0xa0000
    buffer_load_dword v112, v3, s[12:15], s36 offen offset:0
    buffer_load_dword v113, v3, s[12:15], s36 offen offset:2048
    s_waitcnt vmcnt(54)
    v_perm_b32 v62, v115, v114, s60
    v_accvgpr_write_b32 a105, v62
    v_perm_b32 v63, v115, v114, s61
    v_accvgpr_write_b32 a109, v63
    s_mov_b32 s36, 0xa1000
    buffer_load_dword v114, v3, s[12:15], s36 offen offset:0
    buffer_load_dword v115, v3, s[12:15], s36 offen offset:2048
    s_waitcnt vmcnt(54)
    v_perm_b32 v62, v117, v116, s60
    v_accvgpr_write_b32 a106, v62
    v_perm_b32 v63, v117, v116, s61
    v_accvgpr_write_b32 a110, v63
    s_mov_b32 s36, 0xa0000
    buffer_load_dword v116, v3, s[12:15], s36 offen offset:1024
    buffer_load_dword v117, v3, s[12:15], s36 offen offset:3072
    s_waitcnt vmcnt(54)
    v_perm_b32 v62, v119, v118, s60
    v_accvgpr_write_b32 a107, v62
    v_perm_b32 v63, v119, v118, s61
    v_accvgpr_write_b32 a111, v63
    s_mov_b32 s36, 0xa1000
    buffer_load_dword v118, v3, s[12:15], s36 offen offset:1024
    buffer_load_dword v119, v3, s[12:15], s36 offen offset:3072
    s_waitcnt vmcnt(54)
    v_perm_b32 v62, v65, v64, s60
    v_accvgpr_write_b32 a112, v62
    v_perm_b32 v63, v65, v64, s61
    v_accvgpr_write_b32 a116, v63
    s_mov_b32 s36, 0xa8000
    buffer_load_dword v64, v3, s[12:15], s36 offen offset:0
    buffer_load_dword v65, v3, s[12:15], s36 offen offset:2048
    s_waitcnt vmcnt(54)
    v_perm_b32 v62, v67, v66, s60
    v_accvgpr_write_b32 a113, v62
    v_perm_b32 v63, v67, v66, s61
    v_accvgpr_write_b32 a117, v63
    s_mov_b32 s36, 0xa9000
    buffer_load_dword v66, v3, s[12:15], s36 offen offset:0
    buffer_load_dword v67, v3, s[12:15], s36 offen offset:2048
    s_waitcnt vmcnt(54)
    v_perm_b32 v62, v69, v68, s60
    v_accvgpr_write_b32 a114, v62
    v_perm_b32 v63, v69, v68, s61
    v_accvgpr_write_b32 a118, v63
    s_mov_b32 s36, 0xa8000
    buffer_load_dword v68, v3, s[12:15], s36 offen offset:1024
    buffer_load_dword v69, v3, s[12:15], s36 offen offset:3072
    s_waitcnt vmcnt(54)
    v_perm_b32 v62, v71, v70, s60
    v_accvgpr_write_b32 a115, v62
    v_perm_b32 v63, v71, v70, s61
    v_accvgpr_write_b32 a119, v63
    s_mov_b32 s36, 0xa9000
    buffer_load_dword v70, v3, s[12:15], s36 offen offset:1024
    buffer_load_dword v71, v3, s[12:15], s36 offen offset:3072
    s_waitcnt vmcnt(54)
    v_perm_b32 v62, v73, v72, s60
    v_accvgpr_write_b32 a120, v62
    v_perm_b32 v63, v73, v72, s61
    v_accvgpr_write_b32 a124, v63
    s_mov_b32 s36, 0xb0000
    buffer_load_dword v72, v3, s[12:15], s36 offen offset:0
    buffer_load_dword v73, v3, s[12:15], s36 offen offset:2048
    s_waitcnt vmcnt(54)
    v_perm_b32 v62, v75, v74, s60
    v_accvgpr_write_b32 a121, v62
    v_perm_b32 v63, v75, v74, s61
    v_accvgpr_write_b32 a125, v63
    s_mov_b32 s36, 0xb1000
    buffer_load_dword v74, v3, s[12:15], s36 offen offset:0
    buffer_load_dword v75, v3, s[12:15], s36 offen offset:2048
    s_waitcnt vmcnt(54)
    v_perm_b32 v62, v77, v76, s60
    v_accvgpr_write_b32 a122, v62
    v_perm_b32 v63, v77, v76, s61
    v_accvgpr_write_b32 a126, v63
    s_mov_b32 s36, 0xb0000
    buffer_load_dword v76, v3, s[12:15], s36 offen offset:1024
    buffer_load_dword v77, v3, s[12:15], s36 offen offset:3072
    s_waitcnt vmcnt(54)
    v_perm_b32 v62, v79, v78, s60
    v_accvgpr_write_b32 a123, v62
    v_perm_b32 v63, v79, v78, s61
    v_accvgpr_write_b32 a127, v63
    s_mov_b32 s36, 0xb1000
    buffer_load_dword v78, v3, s[12:15], s36 offen offset:1024
    buffer_load_dword v79, v3, s[12:15], s36 offen offset:3072
    s_waitcnt vmcnt(54)
    v_perm_b32 v62, v81, v80, s60
    v_accvgpr_write_b32 a128, v62
    v_perm_b32 v63, v81, v80, s61
    v_accvgpr_write_b32 a132, v63
    s_mov_b32 s36, 0xb8000
    buffer_load_dword v80, v3, s[12:15], s36 offen offset:0
    buffer_load_dword v81, v3, s[12:15], s36 offen offset:2048
    s_waitcnt vmcnt(54)
    v_perm_b32 v62, v83, v82, s60
    v_accvgpr_write_b32 a129, v62
    v_perm_b32 v63, v83, v82, s61
    v_accvgpr_write_b32 a133, v63
    s_mov_b32 s36, 0xb9000
    buffer_load_dword v82, v3, s[12:15], s36 offen offset:0
    buffer_load_dword v83, v3, s[12:15], s36 offen offset:2048
    s_waitcnt vmcnt(54)
    v_perm_b32 v62, v85, v84, s60
    v_accvgpr_write_b32 a130, v62
    v_perm_b32 v63, v85, v84, s61
    v_accvgpr_write_b32 a134, v63
    s_mov_b32 s36, 0xb8000
    buffer_load_dword v84, v3, s[12:15], s36 offen offset:1024
    buffer_load_dword v85, v3, s[12:15], s36 offen offset:3072
    s_waitcnt vmcnt(54)
    v_perm_b32 v62, v87, v86, s60
    v_accvgpr_write_b32 a131, v62
    v_perm_b32 v63, v87, v86, s61
    v_accvgpr_write_b32 a135, v63
    s_mov_b32 s36, 0xb9000
    buffer_load_dword v86, v3, s[12:15], s36 offen offset:1024
    buffer_load_dword v87, v3, s[12:15], s36 offen offset:3072
    s_waitcnt vmcnt(54)
    v_perm_b32 v62, v89, v88, s60
    v_accvgpr_write_b32 a136, v62
    v_perm_b32 v63, v89, v88, s61
    v_accvgpr_write_b32 a140, v63
    s_mov_b32 s36, 0xc0000
    buffer_load_dword v88, v3, s[12:15], s36 offen offset:0
    buffer_load_dword v89, v3, s[12:15], s36 offen offset:2048
    s_waitcnt vmcnt(54)
    v_perm_b32 v62, v91, v90, s60
    v_accvgpr_write_b32 a137, v62
    v_perm_b32 v63, v91, v90, s61
    v_accvgpr_write_b32 a141, v63
    s_mov_b32 s36, 0xc1000
    buffer_load_dword v90, v3, s[12:15], s36 offen offset:0
    buffer_load_dword v91, v3, s[12:15], s36 offen offset:2048
    s_waitcnt vmcnt(54)
    v_perm_b32 v62, v93, v92, s60
    v_accvgpr_write_b32 a138, v62
    v_perm_b32 v63, v93, v92, s61
    v_accvgpr_write_b32 a142, v63
    s_mov_b32 s36, 0xc0000
    buffer_load_dword v92, v3, s[12:15], s36 offen offset:1024
    buffer_load_dword v93, v3, s[12:15], s36 offen offset:3072
    s_waitcnt vmcnt(54)
    v_perm_b32 v62, v95, v94, s60
    v_accvgpr_write_b32 a139, v62
    v_perm_b32 v63, v95, v94, s61
    v_accvgpr_write_b32 a143, v63
    s_mov_b32 s36, 0xc1000
    buffer_load_dword v94, v3, s[12:15], s36 offen offset:1024
    buffer_load_dword v95, v3, s[12:15], s36 offen offset:3072
    s_waitcnt vmcnt(54)
    v_perm_b32 v62, v97, v96, s60
    v_accvgpr_write_b32 a144, v62
    v_perm_b32 v63, v97, v96, s61
    v_accvgpr_write_b32 a148, v63
    s_mov_b32 s36, 0xc8000
    buffer_load_dword v96, v3, s[12:15], s36 offen offset:0
    buffer_load_dword v97, v3, s[12:15], s36 offen offset:2048
    s_waitcnt vmcnt(54)
    v_perm_b32 v62, v99, v98, s60
    v_accvgpr_write_b32 a145, v62
    v_perm_b32 v63, v99, v98, s61
    v_accvgpr_write_b32 a149, v63
    s_mov_b32 s36, 0xc9000
    buffer_load_dword v98, v3, s[12:15], s36 offen offset:0
    buffer_load_dword v99, v3, s[12:15], s36 offen offset:2048
    s_waitcnt vmcnt(54)
    v_perm_b32 v62, v101, v100, s60
    v_accvgpr_write_b32 a146, v62
    v_perm_b32 v63, v101, v100, s61
    v_accvgpr_write_b32 a150, v63
    s_mov_b32 s36, 0xc8000
    buffer_load_dword v100, v3, s[12:15], s36 offen offset:1024
    buffer_load_dword v101, v3, s[12:15], s36 offen offset:3072
    s_waitcnt vmcnt(54)
    v_perm_b32 v62, v103, v102, s60
    v_accvgpr_write_b32 a147, v62
    v_perm_b32 v63, v103, v102, s61
    v_accvgpr_write_b32 a151, v63
    s_mov_b32 s36, 0xc9000
    buffer_load_dword v102, v3, s[12:15], s36 offen offset:1024
    buffer_load_dword v103, v3, s[12:15], s36 offen offset:3072
    s_waitcnt vmcnt(54)
    v_perm_b32 v62, v105, v104, s60
    v_accvgpr_write_b32 a152, v62
    v_perm_b32 v63, v105, v104, s61
    v_accvgpr_write_b32 a156, v63
    s_mov_b32 s36, 0xd0000
    buffer_load_dword v104, v3, s[12:15], s36 offen offset:0
    buffer_load_dword v105, v3, s[12:15], s36 offen offset:2048
    s_waitcnt vmcnt(54)
    v_perm_b32 v62, v107, v106, s60
    v_accvgpr_write_b32 a153, v62
    v_perm_b32 v63, v107, v106, s61
    v_accvgpr_write_b32 a157, v63
    s_mov_b32 s36, 0xd1000
    buffer_load_dword v106, v3, s[12:15], s36 offen offset:0
    buffer_load_dword v107, v3, s[12:15], s36 offen offset:2048
    s_waitcnt vmcnt(54)
    v_perm_b32 v62, v109, v108, s60
    v_accvgpr_write_b32 a154, v62
    v_perm_b32 v63, v109, v108, s61
    v_accvgpr_write_b32 a158, v63
    s_mov_b32 s36, 0xd0000
    buffer_load_dword v108, v3, s[12:15], s36 offen offset:1024
    buffer_load_dword v109, v3, s[12:15], s36 offen offset:3072
    s_waitcnt vmcnt(54)
    v_perm_b32 v62, v111, v110, s60
    v_accvgpr_write_b32 a155, v62
    v_perm_b32 v63, v111, v110, s61
    v_accvgpr_write_b32 a159, v63
    s_mov_b32 s36, 0xd1000
    buffer_load_dword v110, v3, s[12:15], s36 offen offset:1024
    buffer_load_dword v111, v3, s[12:15], s36 offen offset:3072
    s_waitcnt vmcnt(54)
    v_perm_b32 v62, v113, v112, s60
    v_accvgpr_write_b32 a160, v62
    v_perm_b32 v63, v113, v112, s61
    v_accvgpr_write_b32 a164, v63
    s_mov_b32 s36, 0xd8000
    buffer_load_dword v112, v3, s[12:15], s36 offen offset:0
    buffer_load_dword v113, v3, s[12:15], s36 offen offset:2048
    s_waitcnt vmcnt(54)
    v_perm_b32 v62, v115, v114, s60
    v_accvgpr_write_b32 a161, v62
    v_perm_b32 v63, v115, v114, s61
    v_accvgpr_write_b32 a165, v63
    s_mov_b32 s36, 0xd9000
    buffer_load_dword v114, v3, s[12:15], s36 offen offset:0
    buffer_load_dword v115, v3, s[12:15], s36 offen offset:2048
    s_waitcnt vmcnt(54)
    v_perm_b32 v62, v117, v116, s60
    v_accvgpr_write_b32 a162, v62
    v_perm_b32 v63, v117, v116, s61
    v_accvgpr_write_b32 a166, v63
    s_mov_b32 s36, 0xd8000
    buffer_load_dword v116, v3, s[12:15], s36 offen offset:1024
    buffer_load_dword v117, v3, s[12:15], s36 offen offset:3072
    s_waitcnt vmcnt(54)
    v_perm_b32 v62, v119, v118, s60
    v_accvgpr_write_b32 a163, v62
    v_perm_b32 v63, v119, v118, s61
    v_accvgpr_write_b32 a167, v63
    s_mov_b32 s36, 0xd9000
    buffer_load_dword v118, v3, s[12:15], s36 offen offset:1024
    buffer_load_dword v119, v3, s[12:15], s36 offen offset:3072
    s_waitcnt vmcnt(54)
    v_perm_b32 v62, v65, v64, s60
    v_accvgpr_write_b32 a168, v62
    v_perm_b32 v63, v65, v64, s61
    v_accvgpr_write_b32 a172, v63
    s_mov_b32 s36, 0xe0000
    buffer_load_dword v64, v3, s[12:15], s36 offen offset:0
    buffer_load_dword v65, v3, s[12:15], s36 offen offset:2048
    s_waitcnt vmcnt(54)
    v_perm_b32 v62, v67, v66, s60
    v_accvgpr_write_b32 a169, v62
    v_perm_b32 v63, v67, v66, s61
    v_accvgpr_write_b32 a173, v63
    s_mov_b32 s36, 0xe1000
    buffer_load_dword v66, v3, s[12:15], s36 offen offset:0
    buffer_load_dword v67, v3, s[12:15], s36 offen offset:2048
    s_waitcnt vmcnt(54)
    v_perm_b32 v62, v69, v68, s60
    v_accvgpr_write_b32 a170, v62
    v_perm_b32 v63, v69, v68, s61
    v_accvgpr_write_b32 a174, v63
    s_mov_b32 s36, 0xe0000
    buffer_load_dword v68, v3, s[12:15], s36 offen offset:1024
    buffer_load_dword v69, v3, s[12:15], s36 offen offset:3072
    s_waitcnt vmcnt(54)
    v_perm_b32 v62, v71, v70, s60
    v_accvgpr_write_b32 a171, v62
    v_perm_b32 v63, v71, v70, s61
    v_accvgpr_write_b32 a175, v63
    s_mov_b32 s36, 0xe1000
    buffer_load_dword v70, v3, s[12:15], s36 offen offset:1024
    buffer_load_dword v71, v3, s[12:15], s36 offen offset:3072
    s_waitcnt vmcnt(54)
    v_perm_b32 v62, v73, v72, s60
    v_accvgpr_write_b32 a176, v62
    v_perm_b32 v63, v73, v72, s61
    v_accvgpr_write_b32 a180, v63
    s_mov_b32 s36, 0xe8000
    buffer_load_dword v72, v3, s[12:15], s36 offen offset:0
    buffer_load_dword v73, v3, s[12:15], s36 offen offset:2048
    s_waitcnt vmcnt(54)
    v_perm_b32 v62, v75, v74, s60
    v_accvgpr_write_b32 a177, v62
    v_perm_b32 v63, v75, v74, s61
    v_accvgpr_write_b32 a181, v63
    s_mov_b32 s36, 0xe9000
    buffer_load_dword v74, v3, s[12:15], s36 offen offset:0
    buffer_load_dword v75, v3, s[12:15], s36 offen offset:2048
    s_waitcnt vmcnt(54)
    v_perm_b32 v62, v77, v76, s60
    v_accvgpr_write_b32 a178, v62
    v_perm_b32 v63, v77, v76, s61
    v_accvgpr_write_b32 a182, v63
    s_mov_b32 s36, 0xe8000
    buffer_load_dword v76, v3, s[12:15], s36 offen offset:1024
    buffer_load_dword v77, v3, s[12:15], s36 offen offset:3072
    s_waitcnt vmcnt(54)
    v_perm_b32 v62, v79, v78, s60
    v_accvgpr_write_b32 a179, v62
    v_perm_b32 v63, v79, v78, s61
    v_accvgpr_write_b32 a183, v63
    s_mov_b32 s36, 0xe9000
    buffer_load_dword v78, v3, s[12:15], s36 offen offset:1024
    buffer_load_dword v79, v3, s[12:15], s36 offen offset:3072
    s_waitcnt vmcnt(54)
    v_perm_b32 v62, v81, v80, s60
    v_accvgpr_write_b32 a184, v62
    v_perm_b32 v63, v81, v80, s61
    v_accvgpr_write_b32 a188, v63
    s_mov_b32 s36, 0xf0000
    buffer_load_dword v80, v3, s[12:15], s36 offen offset:0
    buffer_load_dword v81, v3, s[12:15], s36 offen offset:2048
    s_waitcnt vmcnt(54)
    v_perm_b32 v62, v83, v82, s60
    v_accvgpr_write_b32 a185, v62
    v_perm_b32 v63, v83, v82, s61
    v_accvgpr_write_b32 a189, v63
    s_mov_b32 s36, 0xf1000
    buffer_load_dword v82, v3, s[12:15], s36 offen offset:0
    buffer_load_dword v83, v3, s[12:15], s36 offen offset:2048
    s_waitcnt vmcnt(54)
    v_perm_b32 v62, v85, v84, s60
    v_accvgpr_write_b32 a186, v62
    v_perm_b32 v63, v85, v84, s61
    v_accvgpr_write_b32 a190, v63
    s_mov_b32 s36, 0xf0000
    buffer_load_dword v84, v3, s[12:15], s36 offen offset:1024
    buffer_load_dword v85, v3, s[12:15], s36 offen offset:3072
    s_waitcnt vmcnt(54)
    v_perm_b32 v62, v87, v86, s60
    v_accvgpr_write_b32 a187, v62
    v_perm_b32 v63, v87, v86, s61
    v_accvgpr_write_b32 a191, v63
    s_mov_b32 s36, 0xf1000
    buffer_load_dword v86, v3, s[12:15], s36 offen offset:1024
    buffer_load_dword v87, v3, s[12:15], s36 offen offset:3072
    s_waitcnt vmcnt(54)
    v_perm_b32 v62, v89, v88, s60
    v_accvgpr_write_b32 a192, v62
    v_perm_b32 v63, v89, v88, s61
    v_accvgpr_write_b32 a196, v63
    s_mov_b32 s36, 0xf8000
    buffer_load_dword v88, v3, s[12:15], s36 offen offset:0
    buffer_load_dword v89, v3, s[12:15], s36 offen offset:2048
    s_waitcnt vmcnt(54)
    v_perm_b32 v62, v91, v90, s60
    v_accvgpr_write_b32 a193, v62
    v_perm_b32 v63, v91, v90, s61
    v_accvgpr_write_b32 a197, v63
    s_mov_b32 s36, 0xf9000
    buffer_load_dword v90, v3, s[12:15], s36 offen offset:0
    buffer_load_dword v91, v3, s[12:15], s36 offen offset:2048
    s_waitcnt vmcnt(54)
    v_perm_b32 v62, v93, v92, s60
    v_accvgpr_write_b32 a194, v62
    v_perm_b32 v63, v93, v92, s61
    v_accvgpr_write_b32 a198, v63
    s_mov_b32 s36, 0xf8000
    buffer_load_dword v92, v3, s[12:15], s36 offen offset:1024
    buffer_load_dword v93, v3, s[12:15], s36 offen offset:3072
    s_waitcnt vmcnt(54)
    v_perm_b32 v62, v95, v94, s60
    v_accvgpr_write_b32 a195, v62
    v_perm_b32 v63, v95, v94, s61
    v_accvgpr_write_b32 a199, v63
    s_mov_b32 s36, 0xf9000
    buffer_load_dword v94, v3, s[12:15], s36 offen offset:1024
    buffer_load_dword v95, v3, s[12:15], s36 offen offset:3072
    s_waitcnt vmcnt(54)
    v_perm_b32 v62, v97, v96, s60
    v_accvgpr_write_b32 a200, v62
    v_perm_b32 v63, v97, v96, s61
    v_accvgpr_write_b32 a204, v63
    s_waitcnt vmcnt(52)
    v_perm_b32 v62, v99, v98, s60
    v_accvgpr_write_b32 a201, v62
    v_perm_b32 v63, v99, v98, s61
    v_accvgpr_write_b32 a205, v63
    s_waitcnt vmcnt(50)
    v_perm_b32 v62, v101, v100, s60
    v_accvgpr_write_b32 a202, v62
    v_perm_b32 v63, v101, v100, s61
    v_accvgpr_write_b32 a206, v63
    s_waitcnt vmcnt(48)
    v_perm_b32 v62, v103, v102, s60
    v_accvgpr_write_b32 a203, v62
    v_perm_b32 v63, v103, v102, s61
    v_accvgpr_write_b32 a207, v63
    s_waitcnt vmcnt(46)
    v_perm_b32 v62, v105, v104, s60
    v_accvgpr_write_b32 a208, v62
    v_perm_b32 v63, v105, v104, s61
    v_accvgpr_write_b32 a212, v63
    s_waitcnt vmcnt(44)
    v_perm_b32 v62, v107, v106, s60
    v_accvgpr_write_b32 a209, v62
    v_perm_b32 v63, v107, v106, s61
    v_accvgpr_write_b32 a213, v63
    s_waitcnt vmcnt(42)
    v_perm_b32 v62, v109, v108, s60
    v_accvgpr_write_b32 a210, v62
    v_perm_b32 v63, v109, v108, s61
    v_accvgpr_write_b32 a214, v63
    s_waitcnt vmcnt(40)
    v_perm_b32 v62, v111, v110, s60
    v_accvgpr_write_b32 a211, v62
    v_perm_b32 v63, v111, v110, s61
    v_accvgpr_write_b32 a215, v63
    s_waitcnt vmcnt(38)
    v_perm_b32 v62, v113, v112, s60
    v_accvgpr_write_b32 a216, v62
    v_perm_b32 v63, v113, v112, s61
    v_accvgpr_write_b32 a220, v63
    s_waitcnt vmcnt(36)
    v_perm_b32 v62, v115, v114, s60
    v_accvgpr_write_b32 a217, v62
    v_perm_b32 v63, v115, v114, s61
    v_accvgpr_write_b32 a221, v63
    s_waitcnt vmcnt(34)
    v_perm_b32 v62, v117, v116, s60
    v_accvgpr_write_b32 a218, v62
    v_perm_b32 v63, v117, v116, s61
    v_accvgpr_write_b32 a222, v63
    s_waitcnt vmcnt(32)
    v_perm_b32 v62, v119, v118, s60
    v_accvgpr_write_b32 a219, v62
    v_perm_b32 v63, v119, v118, s61
    v_accvgpr_write_b32 a223, v63
    s_waitcnt vmcnt(30)
    v_perm_b32 v62, v65, v64, s60
    v_accvgpr_write_b32 a224, v62
    v_perm_b32 v63, v65, v64, s61
    v_accvgpr_write_b32 a228, v63
    s_waitcnt vmcnt(28)
    v_perm_b32 v62, v67, v66, s60
    v_accvgpr_write_b32 a225, v62
    v_perm_b32 v63, v67, v66, s61
    v_accvgpr_write_b32 a229, v63
    s_waitcnt vmcnt(26)
    v_perm_b32 v62, v69, v68, s60
    v_accvgpr_write_b32 a226, v62
    v_perm_b32 v63, v69, v68, s61
    v_accvgpr_write_b32 a230, v63
    s_waitcnt vmcnt(24)
    v_perm_b32 v62, v71, v70, s60
    v_accvgpr_write_b32 a227, v62
    v_perm_b32 v63, v71, v70, s61
    v_accvgpr_write_b32 a231, v63
    s_waitcnt vmcnt(22)
    v_perm_b32 v62, v73, v72, s60
    v_accvgpr_write_b32 a232, v62
    v_perm_b32 v63, v73, v72, s61
    v_accvgpr_write_b32 a236, v63
    s_waitcnt vmcnt(20)
    v_perm_b32 v62, v75, v74, s60
    v_accvgpr_write_b32 a233, v62
    v_perm_b32 v63, v75, v74, s61
    v_accvgpr_write_b32 a237, v63
    s_waitcnt vmcnt(18)
    v_perm_b32 v62, v77, v76, s60
    v_accvgpr_write_b32 a234, v62
    v_perm_b32 v63, v77, v76, s61
    v_accvgpr_write_b32 a238, v63
    s_waitcnt vmcnt(16)
    v_perm_b32 v62, v79, v78, s60
    v_accvgpr_write_b32 a235, v62
    v_perm_b32 v63, v79, v78, s61
    v_accvgpr_write_b32 a239, v63
    s_waitcnt vmcnt(14)
    v_perm_b32 v62, v81, v80, s60
    v_accvgpr_write_b32 a240, v62
    v_perm_b32 v63, v81, v80, s61
    v_accvgpr_write_b32 a244, v63
    s_waitcnt vmcnt(12)
    v_perm_b32 v62, v83, v82, s60
    v_accvgpr_write_b32 a241, v62
    v_perm_b32 v63, v83, v82, s61
    v_accvgpr_write_b32 a245, v63
    s_waitcnt vmcnt(10)
    v_perm_b32 v62, v85, v84, s60
    v_accvgpr_write_b32 a242, v62
    v_perm_b32 v63, v85, v84, s61
    v_accvgpr_write_b32 a246, v63
    s_waitcnt vmcnt(8)
    v_perm_b32 v62, v87, v86, s60
    v_accvgpr_write_b32 a243, v62
    v_perm_b32 v63, v87, v86, s61
    v_accvgpr_write_b32 a247, v63
    s_waitcnt vmcnt(6)
    v_perm_b32 v62, v89, v88, s60
    v_accvgpr_write_b32 a248, v62
    v_perm_b32 v63, v89, v88, s61
    v_accvgpr_write_b32 a252, v63
    s_waitcnt vmcnt(4)
    v_perm_b32 v62, v91, v90, s60
    v_accvgpr_write_b32 a249, v62
    v_perm_b32 v63, v91, v90, s61
    v_accvgpr_write_b32 a253, v63
    s_waitcnt vmcnt(2)
    v_perm_b32 v62, v93, v92, s60
    v_accvgpr_write_b32 a250, v62
    v_perm_b32 v63, v93, v92, s61
    v_accvgpr_write_b32 a254, v63
    s_waitcnt vmcnt(0)
    v_perm_b32 v62, v95, v94, s60
    v_accvgpr_write_b32 a251, v62
    v_perm_b32 v63, v95, v94, s61
    v_accvgpr_write_b32 a255, v63
    s_cmp_lg_u32 s28, 0
    s_cbranch_scc1 L_wgw_54
    v_mov_b32 v251, 144
L_pd_55:
    buffer_load_dword v250, v251, s[8:11], 0 offen sc1
    s_waitcnt vmcnt(0)
    v_readfirstlane_b32 s30, v250
    s_and_b32 s57, s30, 0xffff
    s_cmp_ge_u32 s57, 128
    s_cbranch_scc1 L_pdd_56
    s_sleep 4
    s_add_u32 s100, s100, 1
    s_bitcmp1_b32 s100, 15
    s_cbranch_scc1 L_exit
    s_branch L_pd_55
L_pdd_56:
L_wgw_54:
    s_barrier
    v_lshlrev_b32 v4, 4, v255
    v_lshlrev_b32 v5, 2, v255
    v_lshlrev_b32 v6, 10, v1
    v_lshl_add_u32 v6, v2, 4, v6
    s_lshl_b32 s36, s40, 6
    v_add_u32 v6, s36, v6
    s_lshl_b32 s36, s28, 11
    v_add_u32 v7, s36, v4
    s_mov_b32 s42, 0
L_op_loop:
    s_cmp_lt_u32 s41, 32
    s_cselect_b32 s36, 3, 7
    s_and_b32 s36, s41, s36
    s_lshl_b32 s36, s36, 7
    s_add_u32 s44, s36, 0x8b2000
    s_lshr_b32 s43, s41, 1
    s_max_u32 s48, s43, 3
    s_sub_u32 s48, s48, 3
    s_lshl_b32 s45, s41, 14
    s_cmp_lg_u32 s28, 0
    s_cbranch_scc1 L_opx_57
    s_add_u32 s36, s45, 0x600000
    buffer_load_dwordx4 v[8:11], v6, s[16:19], s45 offen
    buffer_load_dwordx4 v[12:15], v6, s[4:7], s36 offen sc1
    s_cmp_ge_u32 s41, 124
    s_cbranch_scc1 L_op_last
L_op_poll:
    s_mov_b32 exec_hi, 0
    buffer_load_dword v16, v5, s[4:7], s44 offen sc1
    s_waitcnt vmcnt(0)
    v_cmp_gt_u32 s[46:47], s48, v16
    v_cmp_ge_u32 vcc, s43, v16
    s_mov_b64 exec, -1
    s_cbranch_vccz L_opx_57
    s_cmp_eq_u64 s[46:47], 0
    s_cbranch_scc1 L_op_near
    s_sleep 48
L_op_near:
    s_sleep 3
    s_add_u32 s100, s100, 1
    s_bitcmp1_b32 s100, 15
    s_cbranch_scc1 L_exit
    s_branch L_op_poll
L_opx_57:
    s_barrier
    s_mov_b32 s100, 0
L_op_load:
    s_lshl_b32 s36, s41, 17
    s_lshl_b32 s37, s28, 15
    s_add_u32 s36, s36, s37
    s_add_u32 s36, s36, 0x5000000
    buffer_load_dwordx4 v[64:67], v4, s[4:7], s36 offen offset:0 sc1
    buffer_load_dwordx4 v[68:71], v4, s[4:7], s36 offen offset:1024 sc1
    buffer_load_dwordx4 v[72:75], v4, s[4:7], s36 offen offset:2048 sc1
    buffer_load_dwordx4 v[76:79], v4, s[4:7], s36 offen offset:3072 sc1
    s_add_u32 s36, s36, 4096
    buffer_load_dwordx4 v[80:83], v4, s[4:7], s36 offen offset:0 sc1
    buffer_load_dwordx4 v[84:87], v4, s[4:7], s36 offen offset:1024 sc1
    buffer_load_dwordx4 v[88:91], v4, s[4:7], s36 offen offset:2048 sc1
    buffer_load_dwordx4 v[92:95], v4, s[4:7], s36 offen offset:3072 sc1
    s_add_u32 s36, s36, 4096
    buffer_load_dwordx4 v[96:99], v4, s[4:7], s36 offen offset:0 sc1
    buffer_load_dwordx4 v[100:103], v4, s[4:7], s36 offen offset:1024 sc1
    buffer_load_dwordx4 v[104:107], v4, s[4:7], s36 offen offset:2048 sc1
    buffer_load_dwordx4 v[108:111], v4, s[4:7], s36 offen offset:3072 sc1
    s_add_u32 s36, s36, 4096
    buffer_load_dwordx4 v[112:115], v4, s[4:7], s36 offen offset:0 sc1
    buffer_load_dwordx4 v[116:119], v4, s[4:7], s36 offen offset:1024 sc1
    buffer_load_dwordx4 v[120:123], v4, s[4:7], s36 offen offset:2048 sc1
    buffer_load_dwordx4 v[124:127], v4, s[4:7], s36 offen offset:3072 sc1
    s_add_u32 s36, s36, 4096
    buffer_load_dwordx4 v[128:131], v4, s[4:7], s36 offen offset:0 sc1
    buffer_load_dwordx4 v[132:135], v4, s[4:7], s36 offen offset:1024 sc1
    buffer_load_dwordx4 v[136:139], v4, s[4:7], s36 offen offset:2048 sc1
    buffer_load_dwordx4 v[140:143], v4, s[4:7], s36 offen offset:3072 sc1
    s_add_u32 s36, s36, 4096
    buffer_load_dwordx4 v[144:147], v4, s[4:7], s36 offen offset:0 sc1
    buffer_load_dwordx4 v[148:151], v4, s[4:7], s36 offen offset:1024 sc1
    buffer_load_dwordx4 v[152:155], v4, s[4:7], s36 offen offset:2048 sc1
    buffer_load_dwordx4 v[156:159], v4, s[4:7], s36 offen offset:3072 sc1
    s_add_u32 s36, s36, 4096
    buffer_load_dwordx4 v[160:163], v4, s[4:7], s36 offen offset:0 sc1
    buffer_load_dwordx4 v[164:167], v4, s[4:7], s36 offen offset:1024 sc1
    buffer_load_dwordx4 v[168:171], v4, s[4:7], s36 offen offset:2048 sc1
    buffer_load_dwordx4 v[172:175], v4, s[4:7], s36 offen offset:3072 sc1
    s_add_u32 s36, s36, 4096
    buffer_load_dwordx4 v[176:179], v4, s[4:7], s36 offen offset:0 sc1
    buffer_load_dwordx4 v[180:183], v4, s[4:7], s36 offen offset:1024 sc1
    buffer_load_dwordx4 v[184:187], v4, s[4:7], s36 offen offset:2048 sc1
    buffer_load_dwordx4 v[188:191], v4, s[4:7], s36 offen offset:3072 sc1
    s_waitcnt vmcnt(31)
    v_mfma_f32_16x16x32_bf16 v[24:27], a[0:3], v[64:67], 0
    v_mfma_f32_16x16x32_bf16 v[28:31], a[4:7], v[64:67], 0
    v_max_u32 v19, v64, v64
    s_waitcnt vmcnt(30)
    v_mfma_f32_16x16x32_bf16 v[24:27], a[8:11], v[68:71], v[24:27]
    v_mfma_f32_16x16x32_bf16 v[28:31], a[12:15], v[68:71], v[28:31]
    v_max_u32 v19, v68, v19
    s_waitcnt vmcnt(29)
    v_mfma_f32_16x16x32_bf16 v[24:27], a[16:19], v[72:75], v[24:27]
    v_mfma_f32_16x16x32_bf16 v[28:31], a[20:23], v[72:75], v[28:31]
    v_max_u32 v19, v72, v19
    s_waitcnt vmcnt(28)
    v_mfma_f32_16x16x32_bf16 v[24:27], a[24:27], v[76:79], v[24:27]
    v_mfma_f32_16x16x32_bf16 v[28:31], a[28:31], v[76:79], v[28:31]
    v_max_u32 v19, v76, v19
    s_waitcnt vmcnt(27)
    v_mfma_f32_16x16x32_bf16 v[24:27], a[32:35], v[80:83], v[24:27]
    v_mfma_f32_16x16x32_bf16 v[28:31], a[36:39], v[80:83], v[28:31]
    v_max_u32 v19, v80, v19
    s_waitcnt vmcnt(26)
    v_mfma_f32_16x16x32_bf16 v[24:27], a[40:43], v[84:87], v[24:27]
    v_mfma_f32_16x16x32_bf16 v[28:31], a[44:47], v[84:87], v[28:31]
    v_max_u32 v19, v84, v19
    s_waitcnt vmcnt(25)
    v_mfma_f32_16x16x32_bf16 v[24:27], a[48:51], v[88:91], v[24:27]
    v_mfma_f32_16x16x32_bf16 v[28:31], a[52:55], v[88:91], v[28:31]
    v_max_u32 v19, v88, v19
    s_waitcnt vmcnt(24)
    v_mfma_f32_16x16x32_bf16 v[24:27], a[56:59], v[92:95], v[24:27]
    v_mfma_f32_16x16x32_bf16 v[28:31], a[60:63], v[92:95], v[28:31]
    v_max_u32 v19, v92, v19
    s_waitcnt vmcnt(23)
    v_mfma_f32_16x16x32_bf16 v[24:27], a[64:67], v[96:99], v[24:27]
    v_mfma_f32_16x16x32_bf16 v[28:31], a[68:71], v[96:99], v[28:31]
    v_max_u32 v19, v96, v19
    s_waitcnt vmcnt(22)
    v_mfma_f32_16x16x32_bf16 v[24:27], a[72:75], v[100:103], v[24:27]
    v_mfma_f32_16x16x32_bf16 v[28:31], a[76:79], v[100:103], v[28:31]
    v_max_u32 v19, v100, v19
    s_waitcnt vmcnt(21)
    v_mfma_f32_16x16x32_bf16 v[24:27], a[80:83], v[104:107], v[24:27]
    v_mfma_f32_16x16x32_bf16 v[28:31], a[84:87], v[104:107], v[28:31]
    v_max_u32 v19, v104, v19
    s_waitcnt vmcnt(20)
    v_mfma_f32_16x16x32_bf16 v[24:27], a[88:91], v[108:111], v[24:27]
    v_mfma_f32_16x16x32_bf16 v[28:31], a[92:95], v[108:111], v[28:31]
    v_max_u32 v19, v108, v19
    s_waitcnt vmcnt(19)
    v_mfma_f32_16x16x32_bf16 v[24:27], a[96:99], v[112:115], v[24:27]
    v_mfma_f32_16x16x32_bf16 v[28:31], a[100:103], v[112:115], v[28:31]
    v_max_u32 v19, v112, v19
    s_waitcnt vmcnt(18)
    v_mfma_f32_16x16x32_bf16 v[24:27], a[104:107], v[116:119], v[24:27]
    v_mfma_f32_16x16x32_bf16 v[28:31], a[108:111], v[116:119], v[28:31]
    v_max_u32 v19, v116, v19
    s_waitcnt vmcnt(17)
    v_mfma_f32_16x16x32_bf16 v[24:27], a[112:115], v[120:123], v[24:27]
    v_mfma_f32_16x16x32_bf16 v[28:31], a[116:119], v[120:123], v[28:31]
    v_max_u32 v19, v120, v19
    s_waitcnt vmcnt(16)
    v_mfma_f32_16x16x32_bf16 v[24:27], a[120:123], v[124:127], v[24:27]
    v_mfma_f32_16x16x32_bf16 v[28:31], a[124:127], v[124:127], v[28:31]
    v_max_u32 v19, v124, v19
    s_waitcnt vmcnt(15)
    v_mfma_f32_16x16x32_bf16 v[24:27], a[128:131], v[128:131], v[24:27]
    v_mfma_f32_16x16x32_bf16 v[28:31], a[132:135], v[128:131], v[28:31]
    v_max_u32 v19, v128, v19
    s_waitcnt vmcnt(14)
    v_mfma_f32_16x16x32_bf16 v[24:27], a[136:139], v[132:135], v[24:27]
    v_mfma_f32_16x16x32_bf16 v[28:31], a[140:143], v[132:135], v[28:31]
    v_max_u32 v19, v132, v19
    s_waitcnt vmcnt(13)
    v_mfma_f32_16x16x32_bf16 v[24:27], a[144:147], v[136:139], v[24:27]
    v_mfma_f32_16x16x32_bf16 v[28:31], a[148:151], v[136:139], v[28:31]
    v_max_u32 v19, v136, v19
    s_waitcnt vmcnt(12)
    v_mfma_f32_16x16x32_bf16 v[24:27], a[152:155], v[140:143], v[24:27]
    v_mfma_f32_16x16x32_bf16 v[28:31], a[156:159], v[140:143], v[28:31]
    v_max_u32 v19, v140, v19
    s_waitcnt vmcnt(11)
    v_mfma_f32_16x16x32_bf16 v[24:27], a[160:163], v[144:147], v[24:27]
    v_mfma_f32_16x16x32_bf16 v[28:31], a[164:167], v[144:147], v[28:31]
    v_max_u32 v19, v144, v19
    s_waitcnt vmcnt(10)
    v_mfma_f32_16x16x32_bf16 v[24:27], a[168:171], v[148:151], v[24:27]
    v_mfma_f32_16x16x32_bf16 v[28:31], a[172:175], v[148:151], v[28:31]
    v_max_u32 v19, v148, v19
    s_waitcnt vmcnt(9)
    v_mfma_f32_16x16x32_bf16 v[24:27], a[176:179], v[152:155], v[24:27]
    v_mfma_f32_16x16x32_bf16 v[28:31], a[180:183], v[152:155], v[28:31]
    v_max_u32 v19, v152, v19
    s_waitcnt vmcnt(8)
    v_mfma_f32_16x16x32_bf16 v[24:27], a[184:187], v[156:159], v[24:27]
    v_mfma_f32_16x16x32_bf16 v[28:31], a[188:191], v[156:159], v[28:31]
    v_max_u32 v19, v156, v19
    s_waitcnt vmcnt(7)
    v_mfma_f32_16x16x32_bf16 v[24:27], a[192:195], v[160:163], v[24:27]
    v_mfma_f32_16x16x32_bf16 v[28:31], a[196:199], v[160:163], v[28:31]
    v_max_u32 v19, v160, v19
    s_waitcnt vmcnt(6)
    v_mfma_f32_16x16x32_bf16 v[24:27], a[200:203], v[164:167], v[24:27]
    v_mfma_f32_16x16x32_bf16 v[28:31], a[204:207], v[164:167], v[28:31]
    v_max_u32 v19, v164, v19
    s_waitcnt vmcnt(5)
    v_mfma_f32_16x16x32_bf16 v[24:27], a[208:211], v[168:171], v[24:27]
    v_mfma_f32_16x16x32_bf16 v[28:31], a[212:215], v[168:171], v[28:31]
    v_max_u32 v19, v168, v19
    s_waitcnt vmcnt(4)
    v_mfma_f32_16x16x32_bf16 v[24:27], a[216:219], v[172:175], v[24:27]
    v_mfma_f32_16x16x32_bf16 v[28:31], a[220:223], v[172:175], v[28:31]
    v_max_u32 v19, v172, v19
    s_waitcnt vmcnt(3)
    v_mfma_f32_16x16x32_bf16 v[24:27], a[224:227], v[176:179], v[24:27]
    v_mfma_f32_16x16x32_bf16 v[28:31], a[228:231], v[176:179], v[28:31]
    v_max_u32 v19, v176, v19
    s_waitcnt vmcnt(2)
    v_mfma_f32_16x16x32_bf16 v[24:27], a[232:235], v[180:183], v[24:27]
    v_mfma_f32_16x16x32_bf16 v[28:31], a[236:239], v[180:183], v[28:31]
    v_max_u32 v19, v180, v19
    s_waitcnt vmcnt(1)
    v_mfma_f32_16x16x32_bf16 v[24:27], a[240:243], v[184:187], v[24:27]
    v_mfma_f32_16x16x32_bf16 v[28:31], a[244:247], v[184:187], v[28:31]
    v_max_u32 v19, v184, v19
    s_waitcnt vmcnt(0)
    v_mfma_f32_16x16x32_bf16 v[24:27], a[248:251], v[188:191], v[24:27]
    v_mfma_f32_16x16x32_bf16 v[28:31], a[252:255], v[188:191], v[28:31]
    v_max_u32 v19, v188, v19
    s_cmp_lt_u32 s41, 124
    s_cbranch_scc1 L_op_ok
    v_cmp_eq_u32 vcc, -1, v19
    s_cbranch_vccz L_op_ok
    s_add_u32 s100, s100, 1
    s_bitcmp1_b32 s100, 15
    s_cbranch_scc1 L_exit
    s_nop 4
    s_branch L_op_load
L_op_ok:
    v_add_u32 v17, s42, v7
    s_cmp_eq_u32 s28, 0
    s_cbranch_scc1 L_opy_58
    s_nop 4
    ds_write_b128 v17, v[24:27]
    ds_write_b128 v17, v[28:31] offset:1024
    s_waitcnt lgkmcnt(0)
    s_barrier
    s_branch L_opz_59
L_opy_58:
    s_barrier
    ds_read_b128 v[32:35], v17 offset:2048
    ds_read_b128 v[36:39], v17 offset:3072
    ds_read_b128 v[40:43], v17 offset:4096
    ds_read_b128 v[44:47], v17 offset:5120
    ds_read_b128 v[48:51], v17 offset:6144
    ds_read_b128 v[52:55], v17 offset:7168
    s_waitcnt lgkmcnt(4)
    v_add_f32 v24, v24, v32
    v_add_f32 v25, v25, v33
    v_add_f32 v26, v26, v34
    v_add_f32 v27, v27, v35
    v_add_f32 v28, v28, v36
    v_add_f32 v29, v29, v37
    v_add_f32 v30, v30, v38
    v_add_f32 v31, v31, v39
    s_waitcnt lgkmcnt(2)
    v_add_f32 v24, v24, v40
    v_add_f32 v25, v25, v41
    v_add_f32 v26, v26, v42
    v_add_f32 v27, v27, v43
    v_add_f32 v28, v28, v44
    v_add_f32 v29, v29, v45
    v_add_f32 v30, v30, v46
    v_add_f32 v31, v31, v47
    s_waitcnt lgkmcnt(0)
    v_add_f32 v24, v24, v48
    v_add_f32 v25, v25, v49
    v_add_f32 v26, v26, v50
    v_add_f32 v27, v27, v51
    v_add_f32 v28, v28, v52
    v_add_f32 v29, v29, v53
    v_add_f32 v30, v30, v54
    v_add_f32 v31, v31, v55
    v_cvt_pk_bf16_f32 v24, v24, v24
    v_and_b32 v24, s62, v24
    v_lshlrev_b32 v18, 16, v8
    v_add_f32 v24, v24, v18
    v_cvt_pk_bf16_f32 v24, v24, v24
    v_and_b32 v24, s62, v24
    v_lshlrev_b32 v18, 16, v12
    v_add_f32 v24, v24, v18
    v_cvt_pk_bf16_f32 v28, v28, v28
    v_and_b32 v28, s62, v28
    v_and_b32 v18, s62, v8
    v_add_f32 v28, v28, v18
    v_cvt_pk_bf16_f32 v28, v28, v28
    v_and_b32 v28, s62, v28
    v_and_b32 v18, s62, v12
    v_add_f32 v28, v28, v18
    v_cvt_pk_bf16_f32 v20, v24, v28
    v_cvt_pk_bf16_f32 v25, v25, v25
    v_and_b32 v25, s62, v25
    v_lshlrev_b32 v18, 16, v9
    v_add_f32 v25, v25, v18
    v_cvt_pk_bf16_f32 v25, v25, v25
    v_and_b32 v25, s62, v25
    v_lshlrev_b32 v18, 16, v13
    v_add_f32 v25, v25, v18
    v_cvt_pk_bf16_f32 v29, v29, v29
    v_and_b32 v29, s62, v29
    v_and_b32 v18, s62, v9
    v_add_f32 v29, v29, v18
    v_cvt_pk_bf16_f32 v29, v29, v29
    v_and_b32 v29, s62, v29
    v_and_b32 v18, s62, v13
    v_add_f32 v29, v29, v18
    v_cvt_pk_bf16_f32 v21, v25, v29
    v_cvt_pk_bf16_f32 v26, v26, v26
    v_and_b32 v26, s62, v26
    v_lshlrev_b32 v18, 16, v10
    v_add_f32 v26, v26, v18
    v_cvt_pk_bf16_f32 v26, v26, v26
    v_and_b32 v26, s62, v26
    v_lshlrev_b32 v18, 16, v14
    v_add_f32 v26, v26, v18
    v_cvt_pk_bf16_f32 v30, v30, v30
    v_and_b32 v30, s62, v30
    v_and_b32 v18, s62, v10
    v_add_f32 v30, v30, v18
    v_cvt_pk_bf16_f32 v30, v30, v30
    v_and_b32 v30, s62, v30
    v_and_b32 v18, s62, v14
    v_add_f32 v30, v30, v18
    v_cvt_pk_bf16_f32 v22, v26, v30
    v_cvt_pk_bf16_f32 v27, v27, v27
    v_and_b32 v27, s62, v27
    v_lshlrev_b32 v18, 16, v11
    v_add_f32 v27, v27, v18
    v_cvt_pk_bf16_f32 v27, v27, v27
    v_and_b32 v27, s62, v27
    v_lshlrev_b32 v18, 16, v15
    v_add_f32 v27, v27, v18
    v_cvt_pk_bf16_f32 v31, v31, v31
    v_and_b32 v31, s62, v31
    v_and_b32 v18, s62, v11
    v_add_f32 v31, v31, v18
    v_cvt_pk_bf16_f32 v31, v31, v31
    v_and_b32 v31, s62, v31
    v_and_b32 v18, s62, v15
    v_add_f32 v31, v31, v18
    v_cvt_pk_bf16_f32 v23, v27, v31
    buffer_store_dwordx4 v[20:23], v6, s[20:23], s45 offen
L_opz_59:
    s_xor_b32 s42, s42, 8192
    s_add_u32 s41, s41, 10
    s_cmp_lt_u32 s41, 128
    s_cbranch_scc1 L_op_loop
    s_waitcnt vmcnt(0)
    s_waitcnt vmcnt(0)
    s_endpgm
L_op_last:
    v_lshlrev_b32 v18, 12, v255
    s_lshl_b32 s36, s41, 17
    s_add_u32 s36, s36, 0x5000ff0
L_op_lp:
    s_mov_b32 exec_hi, 0
    buffer_load_dword v16, v5, s[4:7], s44 offen sc1
    s_waitcnt vmcnt(0)
    v_cmp_gt_u32 vcc, s48, v16
    s_mov_b64 exec, -1
    s_cbranch_vccz L_op_ln
    s_sleep 32
    s_add_u32 s100, s100, 1
    s_bitcmp1_b32 s100, 15
    s_cbranch_scc1 L_exit
    s_branch L_op_lp
L_op_ln:
    s_mov_b32 exec_hi, 0
    buffer_load_dword v17, v18, s[4:7], s36 offen sc1
    s_waitcnt vmcnt(0)
    v_cmp_eq_u32 vcc, -1, v17
    s_mov_b64 exec, -1
    s_cbranch_vccz L_opx_57
    s_sleep 1
    s_add_u32 s100, s100, 1
    s_bitcmp1_b32 s100, 15
    s_cbranch_scc1 L_exit
    s_branch L_op_ln
L_att_wg:
    s_and_b32 s40, s31, 31
    v_lshrrev_b32 v1, 5, v0
    s_lshl_b32 s52, s28, 1
    v_add_u32 v1, s52, v1
    v_and_b32 v2, 31, v0
    v_mul_u32_u24 v3, 1040, v1
    v_lshl_add_u32 v3, v2, 5, v3
    v_add_u32 v3, 131072, v3
    v_lshlrev_b32 v16, 16, v4
    v_and_b32 v17, s62, v4
    v_lshlrev_b32 v18, 16, v5
    v_and_b32 v19, s62, v5
    v_lshlrev_b32 v20, 16, v6
    v_and_b32 v21, s62, v6
    v_lshlrev_b32 v22, 16, v7
    v_and_b32 v23, s62, v7
    v_lshlrev_b32 v24, 16, v8
    v_and_b32 v25, s62, v8
    v_lshlrev_b32 v26, 16, v9
    v_and_b32 v27, s62, v9
    v_lshlrev_b32 v28, 16, v10
    v_and_b32 v29, s62, v10
    v_lshlrev_b32 v30, 16, v11
    v_and_b32 v31, s62, v11
    v_add_f32 v12, v16, v17
    v_add_f32 v12, v12, v18
    v_add_f32 v12, v12, v19
    v_add_f32 v12, v12, v20
    v_add_f32 v12, v12, v21
    v_add_f32 v12, v12, v22
    v_add_f32 v12, v12, v23
    v_add_f32 v12, v12, v24
    v_add_f32 v12, v12, v25
    v_add_f32 v12, v12, v26
    v_add_f32 v12, v12, v27
    v_add_f32 v12, v12, v28
    v_add_f32 v12, v12, v29
    v_add_f32 v12, v12, v30
    v_add_f32 v12, v12, v31
    s_nop 1
    v_add_f32_dpp v12, v12, v12 row_ror:1 row_mask:0xf bank_mask:0xf
    s_nop 1
    v_add_f32_dpp v12, v12, v12 row_ror:2 row_mask:0xf bank_mask:0xf
    s_nop 1
    v_add_f32_dpp v12, v12, v12 row_ror:4 row_mask:0xf bank_mask:0xf
    s_nop 1
    v_add_f32_dpp v12, v12, v12 row_ror:8 row_mask:0xf bank_mask:0xf
    v_mov_b32 v13, v12
    s_nop 1
    v_permlane16_swap_b32 v12, v13
    v_add_f32 v12, v12, v13
    v_mul_f32 v12, 0x3b000000, v12
    v_sub_f32 v32, v16, v12
    v_sub_f32 v33, v17, v12
    v_sub_f32 v34, v18, v12
    v_sub_f32 v35, v19, v12
    v_sub_f32 v36, v20, v12
    v_sub_f32 v37, v21, v12
    v_sub_f32 v38, v22, v12
    v_sub_f32 v39, v23, v12
    v_sub_f32 v40, v24, v12
    v_sub_f32 v41, v25, v12
    v_sub_f32 v42, v26, v12
    v_sub_f32 v43, v27, v12
    v_sub_f32 v44, v28, v12
    v_sub_f32 v45, v29, v12
    v_sub_f32 v46, v30, v12
    v_sub_f32 v47, v31, v12
    v_mul_f32 v14, v32, v32
    v_fmac_f32 v14, v33, v33
    v_fmac_f32 v14, v34, v34
    v_fmac_f32 v14, v35, v35
    v_fmac_f32 v14, v36, v36
    v_fmac_f32 v14, v37, v37
    v_fmac_f32 v14, v38, v38
    v_fmac_f32 v14, v39, v39
    v_fmac_f32 v14, v40, v40
    v_fmac_f32 v14, v41, v41
    v_fmac_f32 v14, v42, v42
    v_fmac_f32 v14, v43, v43
    v_fmac_f32 v14, v44, v44
    v_fmac_f32 v14, v45, v45
    v_fmac_f32 v14, v46, v46
    v_fmac_f32 v14, v47, v47
    s_nop 1
    v_add_f32_dpp v14, v14, v14 row_ror:1 row_mask:0xf bank_mask:0xf
    s_nop 1
    v_add_f32_dpp v14, v14, v14 row_ror:2 row_mask:0xf bank_mask:0xf
    s_nop 1
    v_add_f32_dpp v14, v14, v14 row_ror:4 row_mask:0xf bank_mask:0xf
    s_nop 1
    v_add_f32_dpp v14, v14, v14 row_ror:8 row_mask:0xf bank_mask:0xf
    v_mov_b32 v13, v14
    s_nop 1
    v_permlane16_swap_b32 v14, v13
    v_add_f32 v14, v14, v13
    v_mul_f32 v14, 0x3b000000, v14
    v_cvt_pk_bf16_f32 v12, v12, v12
    v_and_b32 v12, s62, v12
    v_cvt_pk_bf16_f32 v14, v14, v14
    v_and_b32 v14, s62, v14
    v_add_f32 v14, 0x3727c5ac, v14
    v_cvt_pk_bf16_f32 v14, v14, v14
    v_and_b32 v14, s62, v14
    v_sqrt_f32 v14, v14
    s_nop 0
    v_cvt_pk_bf16_f32 v14, v14, v14
    v_and_b32 v14, s62, v14
    v_rcp_f32 v14, v14
    v_sub_f32 v32, v16, v12
    v_cvt_pk_bf16_f32 v32, v32, v32
    v_and_b32 v32, s62, v32
    v_mul_f32 v32, v32, v14
    v_cvt_pk_bf16_f32 v32, v32, v32
    v_and_b32 v32, s62, v32
    v_sub_f32 v33, v17, v12
    v_cvt_pk_bf16_f32 v33, v33, v33
    v_and_b32 v33, s62, v33
    v_mul_f32 v33, v33, v14
    v_cvt_pk_bf16_f32 v33, v33, v33
    v_and_b32 v33, s62, v33
    v_sub_f32 v34, v18, v12
    v_cvt_pk_bf16_f32 v34, v34, v34
    v_and_b32 v34, s62, v34
    v_mul_f32 v34, v34, v14
    v_cvt_pk_bf16_f32 v34, v34, v34
    v_and_b32 v34, s62, v34
    v_sub_f32 v35, v19, v12
    v_cvt_pk_bf16_f32 v35, v35, v35
    v_and_b32 v35, s62, v35
    v_mul_f32 v35, v35, v14
    v_cvt_pk_bf16_f32 v35, v35, v35
    v_and_b32 v35, s62, v35
    v_sub_f32 v36, v20, v12
    v_cvt_pk_bf16_f32 v36, v36, v36
    v_and_b32 v36, s62, v36
    v_mul_f32 v36, v36, v14
    v_cvt_pk_bf16_f32 v36, v36, v36
    v_and_b32 v36, s62, v36
    v_sub_f32 v37, v21, v12
    v_cvt_pk_bf16_f32 v37, v37, v37
    v_and_b32 v37, s62, v37
    v_mul_f32 v37, v37, v14
    v_cvt_pk_bf16_f32 v37, v37, v37
    v_and_b32 v37, s62, v37
    v_sub_f32 v38, v22, v12
    v_cvt_pk_bf16_f32 v38, v38, v38
    v_and_b32 v38, s62, v38
    v_mul_f32 v38, v38, v14
    v_cvt_pk_bf16_f32 v38, v38, v38
    v_and_b32 v38, s62, v38
    v_sub_f32 v39, v23, v12
    v_cvt_pk_bf16_f32 v39, v39, v39
    v_and_b32 v39, s62, v39
    v_mul_f32 v39, v39, v14
    v_cvt_pk_bf16_f32 v39, v39, v39
    v_and_b32 v39, s62, v39
    v_sub_f32 v40, v24, v12
    v_cvt_pk_bf16_f32 v40, v40, v40
    v_and_b32 v40, s62, v40
    v_mul_f32 v40, v40, v14
    v_cvt_pk_bf16_f32 v40, v40, v40
    v_and_b32 v40, s62, v40
    v_sub_f32 v41, v25, v12
    v_cvt_pk_bf16_f32 v41, v41, v41
    v_and_b32 v41, s62, v41
    v_mul_f32 v41, v41, v14
    v_cvt_pk_bf16_f32 v41, v41, v41
    v_and_b32 v41, s62, v41
    v_sub_f32 v42, v26, v12
    v_cvt_pk_bf16_f32 v42, v42, v42
    v_and_b32 v42, s62, v42
    v_mul_f32 v42, v42, v14
    v_cvt_pk_bf16_f32 v42, v42, v42
    v_and_b32 v42, s62, v42
    v_sub_f32 v43, v27, v12
    v_cvt_pk_bf16_f32 v43, v43, v43
    v_and_b32 v43, s62, v43
    v_mul_f32 v43, v43, v14
    v_cvt_pk_bf16_f32 v43, v43, v43
    v_and_b32 v43, s62, v43
    v_sub_f32 v44, v28, v12
    v_cvt_pk_bf16_f32 v44, v44, v44
    v_and_b32 v44, s62, v44
    v_mul_f32 v44, v44, v14
    v_cvt_pk_bf16_f32 v44, v44, v44
    v_and_b32 v44, s62, v44
    v_sub_f32 v45, v29, v12
    v_cvt_pk_bf16_f32 v45, v45, v45
    v_and_b32 v45, s62, v45
    v_mul_f32 v45, v45, v14
    v_cvt_pk_bf16_f32 v45, v45, v45
    v_and_b32 v45, s62, v45
    v_sub_f32 v46, v30, v12
    v_cvt_pk_bf16_f32 v46, v46, v46
    v_and_b32 v46, s62, v46
    v_mul_f32 v46, v46, v14
    v_cvt_pk_bf16_f32 v46, v46, v46
    v_and_b32 v46, s62, v46
    v_sub_f32 v47, v31, v12
    v_cvt_pk_bf16_f32 v47, v47, v47
    v_and_b32 v47, s62, v47
    v_mul_f32 v47, v47, v14
    v_cvt_pk_bf16_f32 v47, v47, v47
    v_and_b32 v47, s62, v47
    v_perm_b32 v4, v33, v32, s61
    v_perm_b32 v5, v35, v34, s61
    v_perm_b32 v6, v37, v36, s61
    v_perm_b32 v7, v39, v38, s61
    v_perm_b32 v8, v41, v40, s61
    v_perm_b32 v9, v43, v42, s61
    v_perm_b32 v10, v45, v44, s61
    v_perm_b32 v11, v47, v46, s61
    ds_write_b128 v3, v[4:7]
    ds_write_b128 v3, v[8:11] offset:16
    v_add_f32 v12, v32, v33
    v_add_f32 v12, v12, v34
    v_add_f32 v12, v12, v35
    v_add_f32 v12, v12, v36
    v_add_f32 v12, v12, v37
    v_add_f32 v12, v12, v38
    v_add_f32 v12, v12, v39
    v_add_f32 v12, v12, v40
    v_add_f32 v12, v12, v41
    v_add_f32 v12, v12, v42
    v_add_f32 v12, v12, v43
    v_add_f32 v12, v12, v44
    v_add_f32 v12, v12, v45
    v_add_f32 v12, v12, v46
    v_add_f32 v12, v12, v47
    s_nop 1
    v_add_f32_dpp v12, v12, v12 row_ror:1 row_mask:0xf bank_mask:0xf
    s_nop 1
    v_add_f32_dpp v12, v12, v12 row_ror:2 row_mask:0xf bank_mask:0xf
    s_nop 1
    v_add_f32_dpp v12, v12, v12 row_ror:4 row_mask:0xf bank_mask:0xf
    s_nop 1
    v_add_f32_dpp v12, v12, v12 row_ror:8 row_mask:0xf bank_mask:0xf
    v_mov_b32 v13, v12
    s_nop 1
    v_permlane16_swap_b32 v12, v13
    v_add_f32 v12, v12, v13
    v_mul_f32 v12, 0x3b000000, v12
    v_sub_f32 v16, v32, v12
    v_sub_f32 v17, v33, v12
    v_sub_f32 v18, v34, v12
    v_sub_f32 v19, v35, v12
    v_sub_f32 v20, v36, v12
    v_sub_f32 v21, v37, v12
    v_sub_f32 v22, v38, v12
    v_sub_f32 v23, v39, v12
    v_sub_f32 v24, v40, v12
    v_sub_f32 v25, v41, v12
    v_sub_f32 v26, v42, v12
    v_sub_f32 v27, v43, v12
    v_sub_f32 v28, v44, v12
    v_sub_f32 v29, v45, v12
    v_sub_f32 v30, v46, v12
    v_sub_f32 v31, v47, v12
    v_mul_f32 v14, v16, v16
    v_fmac_f32 v14, v17, v17
    v_fmac_f32 v14, v18, v18
    v_fmac_f32 v14, v19, v19
    v_fmac_f32 v14, v20, v20
    v_fmac_f32 v14, v21, v21
    v_fmac_f32 v14, v22, v22
    v_fmac_f32 v14, v23, v23
    v_fmac_f32 v14, v24, v24
    v_fmac_f32 v14, v25, v25
    v_fmac_f32 v14, v26, v26
    v_fmac_f32 v14, v27, v27
    v_fmac_f32 v14, v28, v28
    v_fmac_f32 v14, v29, v29
    v_fmac_f32 v14, v30, v30
    v_fmac_f32 v14, v31, v31
    s_nop 1
    v_add_f32_dpp v14, v14, v14 row_ror:1 row_mask:0xf bank_mask:0xf
    s_nop 1
    v_add_f32_dpp v14, v14, v14 row_ror:2 row_mask:0xf bank_mask:0xf
    s_nop 1
    v_add_f32_dpp v14, v14, v14 row_ror:4 row_mask:0xf bank_mask:0xf
    s_nop 1
    v_add_f32_dpp v14, v14, v14 row_ror:8 row_mask:0xf bank_mask:0xf
    v_mov_b32 v13, v14
    s_nop 1
    v_permlane16_swap_b32 v14, v13
    v_add_f32 v14, v14, v13
    v_mul_f32 v14, 0x3b000000, v14
    v_cvt_pk_bf16_f32 v12, v12, v12
    v_and_b32 v12, s62, v12
    v_cvt_pk_bf16_f32 v14, v14, v14
    v_and_b32 v14, s62, v14
    v_add_f32 v14, 0x3727c5ac, v14
    v_cvt_pk_bf16_f32 v14, v14, v14
    v_and_b32 v14, s62, v14
    v_sqrt_f32 v14, v14
    s_nop 0
    v_cvt_pk_bf16_f32 v14, v14, v14
    v_and_b32 v14, s62, v14
    v_rcp_f32 v14, v14
    v_sub_f32 v16, v32, v12
    v_cvt_pk_bf16_f32 v16, v16, v16
    v_and_b32 v16, s62, v16
    v_mul_f32 v16, v16, v14
    v_cvt_pk_bf16_f32 v16, v16, v16
    v_and_b32 v16, s62, v16
    v_sub_f32 v17, v33, v12
    v_cvt_pk_bf16_f32 v17, v17, v17
    v_and_b32 v17, s62, v17
    v_mul_f32 v17, v17, v14
    v_cvt_pk_bf16_f32 v17, v17, v17
    v_and_b32 v17, s62, v17
    v_sub_f32 v18, v34, v12
    v_cvt_pk_bf16_f32 v18, v18, v18
    v_and_b32 v18, s62, v18
    v_mul_f32 v18, v18, v14
    v_cvt_pk_bf16_f32 v18, v18, v18
    v_and_b32 v18, s62, v18
    v_sub_f32 v19, v35, v12
    v_cvt_pk_bf16_f32 v19, v19, v19
    v_and_b32 v19, s62, v19
    v_mul_f32 v19, v19, v14
    v_cvt_pk_bf16_f32 v19, v19, v19
    v_and_b32 v19, s62, v19
    v_sub_f32 v20, v36, v12
    v_cvt_pk_bf16_f32 v20, v20, v20
    v_and_b32 v20, s62, v20
    v_mul_f32 v20, v20, v14
    v_cvt_pk_bf16_f32 v20, v20, v20
    v_and_b32 v20, s62, v20
    v_sub_f32 v21, v37, v12
    v_cvt_pk_bf16_f32 v21, v21, v21
    v_and_b32 v21, s62, v21
    v_mul_f32 v21, v21, v14
    v_cvt_pk_bf16_f32 v21, v21, v21
    v_and_b32 v21, s62, v21
    v_sub_f32 v22, v38, v12
    v_cvt_pk_bf16_f32 v22, v22, v22
    v_and_b32 v22, s62, v22
    v_mul_f32 v22, v22, v14
    v_cvt_pk_bf16_f32 v22, v22, v22
    v_and_b32 v22, s62, v22
    v_sub_f32 v23, v39, v12
    v_cvt_pk_bf16_f32 v23, v23, v23
    v_and_b32 v23, s62, v23
    v_mul_f32 v23, v23, v14
    v_cvt_pk_bf16_f32 v23, v23, v23
    v_and_b32 v23, s62, v23
    v_sub_f32 v24, v40, v12
    v_cvt_pk_bf16_f32 v24, v24, v24
    v_and_b32 v24, s62, v24
    v_mul_f32 v24, v24, v14
    v_cvt_pk_bf16_f32 v24, v24, v24
    v_and_b32 v24, s62, v24
    v_sub_f32 v25, v41, v12
    v_cvt_pk_bf16_f32 v25, v25, v25
    v_and_b32 v25, s62, v25
    v_mul_f32 v25, v25, v14
    v_cvt_pk_bf16_f32 v25, v25, v25
    v_and_b32 v25, s62, v25
    v_sub_f32 v26, v42, v12
    v_cvt_pk_bf16_f32 v26, v26, v26
    v_and_b32 v26, s62, v26
    v_mul_f32 v26, v26, v14
    v_cvt_pk_bf16_f32 v26, v26, v26
    v_and_b32 v26, s62, v26
    v_sub_f32 v27, v43, v12
    v_cvt_pk_bf16_f32 v27, v27, v27
    v_and_b32 v27, s62, v27
    v_mul_f32 v27, v27, v14
    v_cvt_pk_bf16_f32 v27, v27, v27
    v_and_b32 v27, s62, v27
    v_sub_f32 v28, v44, v12
    v_cvt_pk_bf16_f32 v28, v28, v28
    v_and_b32 v28, s62, v28
    v_mul_f32 v28, v28, v14
    v_cvt_pk_bf16_f32 v28, v28, v28
    v_and_b32 v28, s62, v28
    v_sub_f32 v29, v45, v12
    v_cvt_pk_bf16_f32 v29, v29, v29
    v_and_b32 v29, s62, v29
    v_mul_f32 v29, v29, v14
    v_cvt_pk_bf16_f32 v29, v29, v29
    v_and_b32 v29, s62, v29
    v_sub_f32 v30, v46, v12
    v_cvt_pk_bf16_f32 v30, v30, v30
    v_and_b32 v30, s62, v30
    v_mul_f32 v30, v30, v14
    v_cvt_pk_bf16_f32 v30, v30, v30
    v_and_b32 v30, s62, v30
    v_sub_f32 v31, v47, v12
    v_cvt_pk_bf16_f32 v31, v31, v31
    v_and_b32 v31, s62, v31
    v_mul_f32 v31, v31, v14
    v_cvt_pk_bf16_f32 v31, v31, v31
    v_and_b32 v31, s62, v31
    v_perm_b32 v48, v17, v16, s61
    v_perm_b32 v49, v19, v18, s61
    v_perm_b32 v50, v21, v20, s61
    v_perm_b32 v51, v23, v22, s61
    v_perm_b32 v52, v25, v24, s61
    v_perm_b32 v53, v27, v26, s61
    v_perm_b32 v54, v29, v28, s61
    v_perm_b32 v55, v31, v30, s61
    ds_write_b128 v3, v[48:51] offset:8320
    ds_write_b128 v3, v[52:55] offset:8336
    v_and_b32 v1, 7, v0
    v_lshrrev_b32 v2, 3, v0
    s_lshl_b32 s52, s28, 4
    v_add_u32 v2, s52, v2
    v_mul_u32_u24 v4, 1040, v1
    v_lshl_add_u32 v4, v2, 4, v4
    v_add_u32 v4, 131072, v4
    v_lshlrev_b32 v5, 8, v2
    v_lshl_add_u32 v5, v1, 4, v5
    v_bfe_u32 v1, v0, 2, 2
    v_mul_u32_u24 v6, 1040, v1
    v_and_b32 v1, 3, v0
    v_lshl_add_u32 v6, v1, 3, v6
    v_lshrrev_b32 v1, 4, v0
    v_lshl_add_u32 v6, v1, 5, v6
    s_lshl_b32 s52, s28, 8
    s_add_u32 s52, s52, 131072
    v_add_u32 v6, s52, v6
    v_lshlrev_b32 v7, 4, v0
    s_lshr_b32 s52, s2, 1
    s_lshl_b32 s52, s52, 14
    s_and_b32 s53, s2, 1
    s_lshl_b32 s53, s53, 7
    s_add_u32 s52, s52, s53
    s_add_u32 s52, s52, 0x0
    s_lshl_b32 s53, s2, 13
    s_lshl_b32 s54, s28, 11
    s_add_u32 s53, s53, s54
    s_add_u32 s53, s53, 0x200000
    s_waitcnt lgkmcnt(0)
    s_barrier
    ds_read_b128 v[8:11], v4
    ds_read_b128 v[12:15], v4 offset:128
    ds_read_b64_tr_b16 v[16:17], v6 offset:8320
    ds_read_b64_tr_b16 v[18:19], v6 offset:12480
    ds_read_b64_tr_b16 v[20:21], v6 offset:8448
    ds_read_b64_tr_b16 v[22:23], v6 offset:12608
    s_waitcnt lgkmcnt(4)
    buffer_store_dwordx4 v[8:11], v5, s[4:7], s52 offen sc1
    buffer_store_dwordx4 v[12:15], v5, s[4:7], s52 offen offset:2048 sc1
    s_waitcnt lgkmcnt(0)
    buffer_store_dwordx4 v[16:19], v7, s[4:7], s53 offen sc1
    buffer_store_dwordx4 v[20:23], v7, s[4:7], s53 offen offset:1024 sc1
    v_mov_b32 v12, 0
    v_mov_b32 v13, 0
    v_mov_b32 v14, 0
    v_mov_b32 v15, 0
    v_mov_b32 v20, -1
    v_mov_b32 v21, -1
    v_mov_b32 v22, -1
    v_mov_b32 v23, -1
    v_lshlrev_b32 v16, 4, v255
    v_lshlrev_b32 v17, 2, v255
    s_lshl_b32 s52, s40, 13
    s_lshl_b32 s53, s28, 11
    s_add_u32 s52, s52, s53
    s_add_u32 s52, s52, 0x900000
    buffer_store_dwordx4 v[12:15], v16, s[4:7], s52 offen sc1
    buffer_store_dwordx4 v[12:15], v16, s[4:7], s52 offen offset:1024 sc1
    s_add_u32 s52, s52, 0x40000
    buffer_store_dwordx4 v[12:15], v16, s[4:7], s52 offen sc1
    buffer_store_dwordx4 v[12:15], v16, s[4:7], s52 offen offset:1024 sc1
    s_add_u32 s52, s52, 0x40000
    buffer_store_dwordx4 v[12:15], v16, s[4:7], s52 offen sc1
    buffer_store_dwordx4 v[12:15], v16, s[4:7], s52 offen offset:1024 sc1
    s_add_u32 s52, s52, 0x40000
    buffer_store_dwordx4 v[12:15], v16, s[4:7], s52 offen sc1
    buffer_store_dwordx4 v[12:15], v16, s[4:7], s52 offen offset:1024 sc1
    s_add_u32 s52, s52, 0x40000
    s_lshl_b32 s52, s40, 10
    s_lshl_b32 s53, s28, 8
    s_add_u32 s52, s52, s53
    s_add_u32 s52, s52, 0xa00000
    buffer_store_dword v20, v17, s[4:7], s52 offen sc1
    s_lshl_b32 s52, s40, 12
    s_lshl_b32 s53, s28, 10
    s_add_u32 s52, s52, s53
    s_add_u32 s53, s52, 0x17c0000
    buffer_store_dwordx4 v[20:23], v16, s[4:7], s53 offen sc1
    s_add_u32 s53, s52, 0x17e0000
    buffer_store_dwordx4 v[20:23], v16, s[4:7], s53 offen sc1
    s_add_u32 s53, s52, 0x5f80000
    buffer_store_dwordx4 v[20:23], v16, s[4:7], s53 offen sc1
    s_add_u32 s53, s52, 0x5fa0000
    buffer_store_dwordx4 v[20:23], v16, s[4:7], s53 offen sc1
    s_add_u32 s53, s52, 0x5fc0000
    buffer_store_dwordx4 v[20:23], v16, s[4:7], s53 offen sc1
    s_add_u32 s53, s52, 0x5fe0000
    buffer_store_dwordx4 v[20:23], v16, s[4:7], s53 offen sc1
    s_lshl_b32 s52, s40, 7
    s_lshl_b32 s53, s28, 5
    s_add_u32 s52, s52, s53
    s_add_u32 s52, s52, 0x8b0000
    s_lshl_b32 s53, s28, 7
    s_lshl_b32 s54, s40, 2
    s_add_u32 s53, s53, s54
    s_add_u32 s53, s53, 0x8b2000
    s_mov_b64 exec, 0xff
    buffer_store_dword v12, v17, s[4:7], s52 offen sc1
    s_mov_b64 exec, 1
    buffer_store_dword v12, v17, s[4:7], s53 offen sc1
    buffer_store_dword v12, v17, s[4:7], s53 offen offset:512 sc1
    s_mov_b64 exec, -1
    s_mov_b32 s12, s72
    s_mov_b32 s13, s73
    s_mov_b32 s14, 0x400000
    s_mov_b32 s15, 0x20000
    s_and_b32 s40, s31, 31
    s_and_b32 s42, s40, 3
    s_lshr_b32 s41, s40, 2
    s_lshl_b32 s43, s41, 10
    s_add_u32 s43, s43, 256
    s_lshl_b32 s44, s41, 12
    v_lshrrev_b32 v1, 5, v255
    v_lshlrev_b32 v1, 2, v1
    v_bfe_u32 v2, v255, 4, 1
    v_lshl_add_u32 v1, v2, 1, v1
    v_bfe_u32 v2, v255, 3, 1
    v_add_u32 v1, v2, v1
    v_bfe_u32 v2, v255, 2, 1
    v_lshl_add_u32 v1, v2, 4, v1
    v_lshlrev_b32 v1, 13, v1
    v_and_b32 v2, 3, v255
    v_lshl_add_u32 v1, v2, 4, v1
    s_lshl_b32 s37, s42, 6
    s_add_u32 s36, s43, s37
    s_lshl_b32 s38, s28, 20
    s_add_u32 s36, s36, s38
    v_add_u32 v1, s36, v1
    s_lshl_b32 s37, s42, 10
    s_add_u32 s36, s44, s37
    s_add_u32 s36, s36, s38
    s_add_u32 s36, s36, 0x7000000
    v_lshlrev_b32 v2, 4, v255
    v_add_u32 v2, s36, v2
    s_mov_b32 s36, 0x0
    buffer_load_dwordx4 v[24:27], v1, s[12:15], s36 offen
    s_mov_b32 s36, 0x10000
    buffer_load_dwordx4 v[28:31], v1, s[12:15], s36 offen
    s_mov_b32 s36, 0x40000
    buffer_load_dwordx4 v[32:35], v1, s[12:15], s36 offen
    s_mov_b32 s36, 0x50000
    buffer_load_dwordx4 v[36:39], v1, s[12:15], s36 offen
    s_mov_b32 s36, 0x80000
    buffer_load_dwordx4 v[40:43], v1, s[12:15], s36 offen
    s_mov_b32 s36, 0x90000
    buffer_load_dwordx4 v[44:47], v1, s[12:15], s36 offen
    s_mov_b32 s36, 0xc0000
    buffer_load_dwordx4 v[48:51], v1, s[12:15], s36 offen
    s_mov_b32 s36, 0xd0000
    buffer_load_dwordx4 v[52:55], v1, s[12:15], s36 offen
    s_waitcnt vmcnt(8)
    s_barrier
    s_cmp_lg_u32 s28, 0
    s_cbranch_scc1 L_arr_60
    v_mov_b32 v250, 1
    v_mov_b32 v251, 8
    s_mov_b64 exec, 1
    buffer_atomic_add v250, v251, s[8:11], 0 offen sc0
    s_mov_b64 exec, -1
L_arr_60:
    s_mov_b32 s36, 0x0
    s_waitcnt vmcnt(7)
    buffer_store_dwordx4 v[24:27], v2, s[4:7], s36 offen sc1
    s_mov_b32 s36, 0x10000
    s_waitcnt vmcnt(7)
    buffer_store_dwordx4 v[28:31], v2, s[4:7], s36 offen sc1
    s_mov_b32 s36, 0x40000
    s_waitcnt vmcnt(7)
    buffer_store_dwordx4 v[32:35], v2, s[4:7], s36 offen sc1
    s_mov_b32 s36, 0x50000
    s_waitcnt vmcnt(7)
    buffer_store_dwordx4 v[36:39], v2, s[4:7], s36 offen sc1
    s_mov_b32 s36, 0x80000
    s_waitcnt vmcnt(7)
    buffer_store_dwordx4 v[40:43], v2, s[4:7], s36 offen sc1
    s_mov_b32 s36, 0x90000
    s_waitcnt vmcnt(7)
    buffer_store_dwordx4 v[44:47], v2, s[4:7], s36 offen sc1
    s_mov_b32 s36, 0xc0000
    s_waitcnt vmcnt(7)
    buffer_store_dwordx4 v[48:51], v2, s[4:7], s36 offen sc1
    s_mov_b32 s36, 0xd0000
    s_waitcnt vmcnt(7)
    buffer_store_dwordx4 v[52:55], v2, s[4:7], s36 offen sc1
    s_waitcnt vmcnt(0)
    s_barrier
    s_cmp_lg_u32 s28, 0
    s_cbranch_scc1 L_vc_61
    v_mov_b32 v1, 1
    s_add_u32 s36, s40, 64
    v_mov_b32 v2, s36
    s_mov_b64 exec, 1
    buffer_store_byte v1, v2, s[8:11], 0 offen sc1
    s_mov_b64 exec, -1
L_vc_61:
    s_cmp_lg_u32 s28, 0
    s_cbranch_scc1 L_arr_62
    s_waitcnt vmcnt(0)
    v_readfirstlane_b32 s30, v250
    s_add_u32 s30, s30, 1
    s_and_b32 s57, s30, 0xffff
    s_cmp_lg_u32 s57, 224
    s_cbranch_scc1 L_ae_63
    v_mov_b32 v251, 4
L_pd_64:
    buffer_load_dword v250, v251, s[8:11], 0 offen sc1
    s_waitcnt vmcnt(0)
    v_readfirstlane_b32 s30, v250
    s_and_b32 s57, s30, 0xffff
    s_cmp_ge_u32 s57, 32
    s_cbranch_scc1 L_pdd_65
    s_sleep 4
    s_add_u32 s100, s100, 1
    s_bitcmp1_b32 s100, 15
    s_cbranch_scc1 L_exit
    s_branch L_pd_64
L_pdd_65:
    v_mov_b32 v250, s30
    v_mov_b32 v251, 132
    s_mov_b64 exec, 1
    buffer_store_dword v250, v251, s[8:11], 0 offen sc1
    s_mov_b64 exec, -1
L_ae_63:
L_arr_62:
    s_cmp_ge_u32 s31, 196
    s_cbranch_scc1 L_vc_done
    s_mov_b32 s12, s72
    s_mov_b32 s13, s73
    s_mov_b32 s14, 0x400000
    s_mov_b32 s15, 0x20000
    s_and_b32 s40, s31, 31
    s_and_b32 s42, s40, 3
    s_mov_b32 s43, 7936
    s_mov_b32 s44, 32768
    s_add_u32 s40, s40, 32
    v_lshrrev_b32 v1, 5, v255
    v_lshlrev_b32 v1, 2, v1
    v_bfe_u32 v2, v255, 4, 1
    v_lshl_add_u32 v1, v2, 1, v1
    v_bfe_u32 v2, v255, 3, 1
    v_add_u32 v1, v2, v1
    v_bfe_u32 v2, v255, 2, 1
    v_lshl_add_u32 v1, v2, 4, v1
    v_lshlrev_b32 v1, 13, v1
    v_and_b32 v2, 3, v255
    v_lshl_add_u32 v1, v2, 4, v1
    s_lshl_b32 s37, s42, 6
    s_add_u32 s36, s43, s37
    s_lshl_b32 s38, s28, 20
    s_add_u32 s36, s36, s38
    v_add_u32 v1, s36, v1
    s_lshl_b32 s37, s42, 10
    s_add_u32 s36, s44, s37
    s_add_u32 s36, s36, s38
    s_add_u32 s36, s36, 0x7000000
    v_lshlrev_b32 v2, 4, v255
    v_add_u32 v2, s36, v2
    s_mov_b32 s36, 0x0
    buffer_load_dwordx4 v[24:27], v1, s[12:15], s36 offen
    s_mov_b32 s36, 0x10000
    buffer_load_dwordx4 v[28:31], v1, s[12:15], s36 offen
    s_mov_b32 s36, 0x40000
    buffer_load_dwordx4 v[32:35], v1, s[12:15], s36 offen
    s_mov_b32 s36, 0x50000
    buffer_load_dwordx4 v[36:39], v1, s[12:15], s36 offen
    s_mov_b32 s36, 0x80000
    buffer_load_dwordx4 v[40:43], v1, s[12:15], s36 offen
    s_mov_b32 s36, 0x90000
    buffer_load_dwordx4 v[44:47], v1, s[12:15], s36 offen
    s_mov_b32 s36, 0xc0000
    buffer_load_dwordx4 v[48:51], v1, s[12:15], s36 offen
    s_mov_b32 s36, 0xd0000
    buffer_load_dwordx4 v[52:55], v1, s[12:15], s36 offen
    s_mov_b32 s36, 0x0
    s_waitcnt vmcnt(7)
    buffer_store_dwordx4 v[24:27], v2, s[4:7], s36 offen sc1
    s_mov_b32 s36, 0x10000
    s_waitcnt vmcnt(7)
    buffer_store_dwordx4 v[28:31], v2, s[4:7], s36 offen sc1
    s_mov_b32 s36, 0x40000
    s_waitcnt vmcnt(7)
    buffer_store_dwordx4 v[32:35], v2, s[4:7], s36 offen sc1
    s_mov_b32 s36, 0x50000
    s_waitcnt vmcnt(7)
    buffer_store_dwordx4 v[36:39], v2, s[4:7], s36 offen sc1
    s_mov_b32 s36, 0x80000
    s_waitcnt vmcnt(7)
    buffer_store_dwordx4 v[40:43], v2, s[4:7], s36 offen sc1
    s_mov_b32 s36, 0x90000
    s_waitcnt vmcnt(7)
    buffer_store_dwordx4 v[44:47], v2, s[4:7], s36 offen sc1
    s_mov_b32 s36, 0xc0000
    s_waitcnt vmcnt(7)
    buffer_store_dwordx4 v[48:51], v2, s[4:7], s36 offen sc1
    s_mov_b32 s36, 0xd0000
    s_waitcnt vmcnt(7)
    buffer_store_dwordx4 v[52:55], v2, s[4:7], s36 offen sc1
    s_waitcnt vmcnt(0)
    s_barrier
    s_cmp_lg_u32 s28, 0
    s_cbranch_scc1 L_vc_66
    v_mov_b32 v1, 1
    s_add_u32 s36, s40, 64
    v_mov_b32 v2, s36
    s_mov_b64 exec, 1
    buffer_store_byte v1, v2, s[8:11], 0 offen sc1
    s_mov_b64 exec, -1
L_vc_66:
L_vc_done:
    s_cmp_lg_u32 s28, 0
    s_cbranch_scc1 L_wgw_67
    v_mov_b32 v251, 132
L_pd_68:
    buffer_load_dword v250, v251, s[8:11], 0 offen sc1
    s_waitcnt vmcnt(0)
    v_readfirstlane_b32 s30, v250
    s_and_b32 s57, s30, 0xffff
    s_cmp_ge_u32 s57, 32
    s_cbranch_scc1 L_pdd_69
    s_sleep 4
    s_add_u32 s100, s100, 1
    s_bitcmp1_b32 s100, 15
    s_cbranch_scc1 L_exit
    s_branch L_pd_68
L_pdd_69:
L_wgw_67:
    s_barrier
L_att:
    s_and_b32 s40, s31, 31
    s_lshr_b32 s41, s28, 1
    s_cmp_lt_u32 s31, 192
    s_cselect_b32 s36, 18, 0
    s_cselect_b32 s38, 512, 0
    s_add_u32 s41, s41, s36
    s_mov_b32 s35, 0
    s_lshl_b32 s36, s40, 7
    s_add_u32 s42, s36, 0x8b0000
    s_mov_b32 s43, 0
    s_mov_b32 s44, 0
    s_mov_b32 s46, 0x3e0293ee
    s_mov_b32 s47, s46
    s_mov_b32 s48, 0
    s_mov_b32 s49, -1
    s_lshl_b32 s36, s28, 7
    s_lshl_b32 s37, s40, 2
    s_add_u32 s36, s36, s37
    s_add_u32 s36, s36, s38
    s_add_u32 s58, s36, 0x8b2000
    v_and_b32 v1, 15, v255
    v_lshrrev_b32 v2, 4, v255
    v_lshlrev_b32 v3, 4, v255
    v_lshrrev_b32 v6, 1, v2
    v_lshlrev_b32 v6, 8, v6
    v_lshl_add_u32 v6, v1, 4, v6
    v_and_b32 v7, 1, v2
    v_lshl_add_u32 v6, v7, 3, v6
    s_lshl_b32 s36, s28, 11
    v_add_u32 v4, s36, v6
    v_lshrrev_b32 v6, 2, v1
    v_lshl_add_u32 v6, v2, 2, v6
    v_lshlrev_b32 v6, 4, v6
    v_and_b32 v7, 1, v1
    v_lshl_add_u32 v6, v7, 3, v6
    v_add_u32 v5, s36, v6
    v_lshlrev_b32 v6, 2, v2
    v_mov_b32 v8, 0
    v_mov_b32 v9, 0xd028965f
    v_mov_b32 v56, 0x3f803f80
    v_mov_b32 v57, 0x3f803f80
    v_mov_b32 v58, 0x3f803f80
    v_mov_b32 v59, 0x3f803f80
    v_mov_b32 v61, 0
    v_mov_b32 v62, 0
    v_add_u32 v7, 0, v6
    v_cmp_le_u32 s[50:51], v7, v1
    v_add_u32 v7, 1, v6
    v_cmp_le_u32 s[52:53], v7, v1
    v_add_u32 v7, 2, v6
    v_cmp_le_u32 s[54:55], v7, v1
    v_add_u32 v7, 3, v6
    v_cmp_le_u32 s[56:57], v7, v1
    s_bitcmp1_b32 s28, 0
    s_cbranch_scc1 L_at_1_pre
L_at_0_pre:
    s_cmp_gt_u32 s43, s41
    s_cbranch_scc1 L_ath_71
L_atp_70:
    buffer_load_dwordx4 v[10:13], v8, s[4:7], s42 offen sc1
    buffer_load_dwordx2 v[14:15], v8, s[4:7], s42 offen offset:16 sc1
    s_waitcnt vmcnt(0)
    v_min3_u32 v10, v10, v12, v14
    v_min3_u32 v11, v11, v13, v15
    v_lshlrev_b32 v10, 1, v10
    v_lshl_or_b32 v11, v11, 1, 1
    v_min_u32 v10, v10, v11
    s_nop 0
    v_readfirstlane_b32 s43, v10
    s_cmp_gt_u32 s43, s41
    s_cbranch_scc1 L_ath_71
    s_sleep 8
    s_add_u32 s100, s100, 1
    s_bitcmp1_b32 s100, 15
    s_cbranch_scc1 L_exit
    s_branch L_atp_70
L_ath_71:
    s_lshl_b32 s36, s41, 5
    s_add_u32 s36, s36, s40
    s_lshl_b32 s36, s36, 13
    s_add_u32 s37, s36, 0x4000000
    buffer_load_dwordx4 a[0:3], v3, s[4:7], s37 offen offset:0 sc1
    buffer_load_dwordx4 a[4:7], v3, s[4:7], s37 offen offset:1024 sc1
    buffer_load_dwordx4 a[8:11], v3, s[4:7], s37 offen offset:2048 sc1
    buffer_load_dwordx4 a[12:15], v3, s[4:7], s37 offen offset:3072 sc1
    s_add_u32 s37, s36, 0x2000000
    s_add_u32 s38, s37, 4096
    buffer_load_dwordx4 a[16:19], v3, s[4:7], s37 offen offset:0 sc1
    buffer_load_dwordx4 a[20:23], v3, s[4:7], s37 offen offset:1024 sc1
    buffer_load_dwordx4 a[24:27], v3, s[4:7], s37 offen offset:2048 sc1
    buffer_load_dwordx4 a[28:31], v3, s[4:7], s37 offen offset:3072 sc1
    s_add_u32 s37, s36, 0x3000000
    s_add_u32 s38, s37, 4096
    buffer_load_dwordx4 a[48:51], v3, s[4:7], s37 offen offset:0 sc1
    buffer_load_dwordx4 a[52:55], v3, s[4:7], s37 offen offset:1024 sc1
    buffer_load_dwordx4 a[56:59], v3, s[4:7], s37 offen offset:2048 sc1
    buffer_load_dwordx4 a[60:63], v3, s[4:7], s37 offen offset:3072 sc1
    buffer_load_dwordx4 a[64:67], v3, s[4:7], s38 offen offset:0 sc1
    buffer_load_dwordx4 a[68:71], v3, s[4:7], s38 offen offset:1024 sc1
    buffer_load_dwordx4 a[72:75], v3, s[4:7], s38 offen offset:2048 sc1
    buffer_load_dwordx4 a[76:79], v3, s[4:7], s38 offen offset:3072 sc1
    s_waitcnt vmcnt(0)
L_at_0:
    v_mfma_f32_16x16x32_bf16 v[16:19], a[16:19], a[0:3], 0
    v_mfma_f32_16x16x32_bf16 v[16:19], a[20:23], a[4:7], v[16:19]
    v_mfma_f32_16x16x32_bf16 v[16:19], a[24:27], a[8:11], v[16:19]
    v_mfma_f32_16x16x32_bf16 v[16:19], a[28:31], a[12:15], v[16:19]
    s_cmp_lt_u32 s41, 16
    s_cselect_b32 s39, 2, 4
    s_add_u32 s39, s39, s41
    s_cmp_gt_u32 s39, 63
    s_cbranch_scc1 L_atq_72
    s_cmp_gt_u32 s43, s39
    s_cbranch_scc1 L_ath_75
L_atp_74:
    buffer_load_dwordx4 v[10:13], v8, s[4:7], s42 offen sc1
    buffer_load_dwordx2 v[14:15], v8, s[4:7], s42 offen offset:16 sc1
    s_waitcnt vmcnt(0)
    v_min3_u32 v10, v10, v12, v14
    v_min3_u32 v11, v11, v13, v15
    v_lshlrev_b32 v10, 1, v10
    v_lshl_or_b32 v11, v11, 1, 1
    v_min_u32 v10, v10, v11
    s_nop 0
    v_readfirstlane_b32 s43, v10
    s_cmp_gt_u32 s43, s39
    s_cbranch_scc1 L_ath_75
    s_sleep 8
    s_add_u32 s100, s100, 1
    s_bitcmp1_b32 s100, 15
    s_cbranch_scc1 L_exit
    s_branch L_atp_74
L_ath_75:
    s_lshl_b32 s36, s39, 5
    s_add_u32 s36, s36, s40
    s_lshl_b32 s36, s36, 13
    s_add_u32 s37, s36, 0x4000000
    buffer_load_dwordx4 a[128:131], v3, s[4:7], s37 offen offset:0 sc1
    buffer_load_dwordx4 a[132:135], v3, s[4:7], s37 offen offset:1024 sc1
    buffer_load_dwordx4 a[136:139], v3, s[4:7], s37 offen offset:2048 sc1
    buffer_load_dwordx4 a[140:143], v3, s[4:7], s37 offen offset:3072 sc1
    s_add_u32 s37, s36, 0x2000000
    s_add_u32 s38, s37, 4096
    buffer_load_dwordx4 a[144:147], v3, s[4:7], s37 offen offset:0 sc1
    buffer_load_dwordx4 a[148:151], v3, s[4:7], s37 offen offset:1024 sc1
    buffer_load_dwordx4 a[152:155], v3, s[4:7], s37 offen offset:2048 sc1
    buffer_load_dwordx4 a[156:159], v3, s[4:7], s37 offen offset:3072 sc1
    s_add_u32 s37, s36, 0x3000000
    s_add_u32 s38, s37, 4096
    buffer_load_dwordx4 a[176:179], v3, s[4:7], s37 offen offset:0 sc1
    buffer_load_dwordx4 a[180:183], v3, s[4:7], s37 offen offset:1024 sc1
    buffer_load_dwordx4 a[184:187], v3, s[4:7], s37 offen offset:2048 sc1
    buffer_load_dwordx4 a[188:191], v3, s[4:7], s37 offen offset:3072 sc1
    buffer_load_dwordx4 a[192:195], v3, s[4:7], s38 offen offset:0 sc1
    buffer_load_dwordx4 a[196:199], v3, s[4:7], s38 offen offset:1024 sc1
    buffer_load_dwordx4 a[200:203], v3, s[4:7], s38 offen offset:2048 sc1
    buffer_load_dwordx4 a[204:207], v3, s[4:7], s38 offen offset:3072 sc1
    s_waitcnt vmcnt(16)
    s_branch L_atr_73
L_atq_72:
    s_waitcnt vmcnt(0)
L_atr_73:
    v_mov_b32 v10, s35
    s_mov_b64 exec, 1
    buffer_store_dword v10, v8, s[4:7], s58 offen sc1
    s_mov_b64 exec, -1
    s_min_u32 s59, s41, 61
    s_cmp_gt_u32 s44, s59
    s_cbranch_scc1 L_atn_77
L_atm_76:
    buffer_load_dword v10, v8, s[4:7], s42 offen offset:32 sc1
    s_waitcnt vmcnt(0)
    v_readfirstlane_b32 s44, v10
    s_cmp_gt_u32 s44, s59
    s_cbranch_scc1 L_atn_77
    s_cmp_eq_u32 s44, s59
    s_cbranch_scc1 L_atm_76_n
    s_sleep 16
L_atm_76_n:
    s_sleep 2
    s_add_u32 s100, s100, 1
    s_bitcmp1_b32 s100, 15
    s_cbranch_scc1 L_exit
    s_branch L_atm_76
L_atn_77:
    s_mov_b32 s100, 0
    s_lshl_b32 s36, s41, 5
    s_add_u32 s36, s36, s40
    s_lshl_b32 s36, s36, 12
    s_add_u32 s36, s36, 0x1000000
    buffer_load_dwordx4 v[64:67], v3, s[4:7], s36 offen offset:0 sc1
    buffer_load_dwordx4 v[68:71], v3, s[4:7], s36 offen offset:1024 sc1
    buffer_load_dwordx4 v[72:75], v3, s[4:7], s36 offen offset:2048 sc1
    buffer_load_dwordx4 v[76:79], v3, s[4:7], s36 offen offset:3072 sc1
    v_cndmask_b32 v16, v9, v16, s[50:51]
    v_cndmask_b32 v17, v9, v17, s[52:53]
    v_cndmask_b32 v18, v9, v18, s[54:55]
    v_cndmask_b32 v19, v9, v19, s[56:57]
    v_max_f32 v36, v16, v17
    v_max3_f32 v36, v36, v18, v19
    v_mov_b32 v37, v36
    s_nop 1
    v_permlane32_swap_b32 v36, v37
    v_max_f32 v36, v36, v37
    s_lshl_b32 s45, s41, 6
    s_add_u32 s45, s45, s40
    s_lshl_b32 s45, s45, 12
    s_add_u32 s45, s45, 0x5000000
    s_waitcnt vmcnt(3)
    ds_write_b64 v4, v[64:65] offset:0
    s_waitcnt vmcnt(2)
    ds_write_b64 v4, v[68:69] offset:512
    s_waitcnt vmcnt(1)
    ds_write_b64 v4, v[72:73] offset:1024
    s_waitcnt vmcnt(0)
    ds_write_b64 v4, v[76:77] offset:1536
    s_waitcnt lgkmcnt(0)
    ds_read_b64_tr_b16 v[80:81], v5 offset:0
    ds_read_b64_tr_b16 v[82:83], v5 offset:256
    ds_read_b64_tr_b16 v[84:85], v5 offset:512
    ds_read_b64_tr_b16 v[86:87], v5 offset:768
    ds_read_b64_tr_b16 v[88:89], v5 offset:1024
    ds_read_b64_tr_b16 v[90:91], v5 offset:1280
    ds_read_b64_tr_b16 v[92:93], v5 offset:1536
    ds_read_b64_tr_b16 v[94:95], v5 offset:1792
    s_waitcnt lgkmcnt(6)
    v_mfma_f32_16x16x32_bf16 v[28:31], v[80:83], a[0:3], 0
    s_waitcnt lgkmcnt(4)
    v_mfma_f32_16x16x32_bf16 v[28:31], v[84:87], a[4:7], v[28:31]
    s_waitcnt lgkmcnt(2)
    v_mfma_f32_16x16x32_bf16 v[28:31], v[88:91], a[8:11], v[28:31]
    s_waitcnt lgkmcnt(0)
    v_mfma_f32_16x16x32_bf16 v[28:31], v[92:95], a[12:15], v[28:31]
    s_nop 7
    v_max3_f32 v36, v36, v28, v29
    v_max3_f32 v36, v36, v30, v31
    v_mov_b32 v37, v36
    v_cndmask_b32 v28, v28, v30, s[48:49]
    v_cndmask_b32 v29, v29, v31, s[48:49]
    v_permlane16_swap_b32 v36, v37
    v_max_f32 v36, v36, v37
    v_mul_f32 v36, s46, v36
    v_pk_fma_f32 v[16:17], v[16:17], s[46:47], v[36:37] op_sel_hi:[1,1,0] neg_lo:[0,0,1] neg_hi:[0,0,1]
    v_pk_fma_f32 v[18:19], v[18:19], s[46:47], v[36:37] op_sel_hi:[1,1,0] neg_lo:[0,0,1] neg_hi:[0,0,1]
    v_pk_fma_f32 v[28:29], v[28:29], s[46:47], v[36:37] op_sel_hi:[1,1,0] neg_lo:[0,0,1] neg_hi:[0,0,1]
    v_exp_f32 v16, v16
    v_exp_f32 v17, v17
    v_exp_f32 v18, v18
    v_exp_f32 v19, v19
    v_exp_f32 v28, v28
    v_exp_f32 v29, v29
    v_cvt_pk_bf16_f32 v40, v16, v17
    v_cvt_pk_bf16_f32 v41, v18, v19
    v_mov_b32 v42, 0
    v_mov_b32 v43, 0
    v_cvt_pk_bf16_f32 v60, v28, v29
    v_cvt_pk_bf16_f32 v63, v28, v29
    v_mfma_f32_16x16x32_bf16 v[44:47], v[56:59], v[40:43], 0
    v_mfma_f32_16x16x32_bf16 v[96:99], a[48:51], v[40:43], 0
    v_mfma_f32_16x16x32_bf16 v[100:103], a[52:55], v[40:43], 0
    v_mfma_f32_16x16x32_bf16 v[104:107], a[56:59], v[40:43], 0
    v_mfma_f32_16x16x32_bf16 v[108:111], a[60:63], v[40:43], 0
    v_mfma_f32_16x16x32_bf16 v[112:115], a[64:67], v[40:43], 0
    v_mfma_f32_16x16x32_bf16 v[116:119], a[68:71], v[40:43], 0
    v_mfma_f32_16x16x32_bf16 v[120:123], a[72:75], v[40:43], 0
    v_mfma_f32_16x16x32_bf16 v[124:127], a[76:79], v[40:43], 0
    v_mfma_f32_16x16x16_bf16 v[44:47], v[56:57], v[60:61], v[44:47]
    v_mfma_f32_16x16x16_bf16 v[96:99], v[66:67], v[60:61], v[96:99]
    v_mfma_f32_16x16x16_bf16 v[100:103], v[66:67], v[62:63], v[100:103]
    v_mfma_f32_16x16x16_bf16 v[104:107], v[70:71], v[60:61], v[104:107]
    v_mfma_f32_16x16x16_bf16 v[108:111], v[70:71], v[62:63], v[108:111]
    v_mfma_f32_16x16x16_bf16 v[112:115], v[74:75], v[60:61], v[112:115]
    v_mfma_f32_16x16x16_bf16 v[116:119], v[74:75], v[62:63], v[116:119]
    v_mfma_f32_16x16x16_bf16 v[120:123], v[78:79], v[60:61], v[120:123]
    v_mfma_f32_16x16x16_bf16 v[124:127], v[78:79], v[62:63], v[124:127]
    v_rcp_f32 v44, v44
    s_nop 0
    v_pk_mul_f32 v[96:97], v[96:97], v[44:45] op_sel_hi:[1,0]
    v_pk_mul_f32 v[98:99], v[98:99], v[44:45] op_sel_hi:[1,0]
    v_pk_mul_f32 v[100:101], v[100:101], v[44:45] op_sel_hi:[1,0]
    v_pk_mul_f32 v[102:103], v[102:103], v[44:45] op_sel_hi:[1,0]
    v_cvt_pk_bf16_f32 v128, v96, v97
    v_cvt_pk_bf16_f32 v129, v98, v99
    v_cvt_pk_bf16_f32 v130, v100, v101
    v_cvt_pk_bf16_f32 v131, v102, v103
    v_min_u32 v128, -2, v128
    buffer_store_dwordx4 v[128:131], v3, s[4:7], s45 offen offset:0 sc1
    v_pk_mul_f32 v[104:105], v[104:105], v[44:45] op_sel_hi:[1,0]
    v_pk_mul_f32 v[106:107], v[106:107], v[44:45] op_sel_hi:[1,0]
    v_pk_mul_f32 v[108:109], v[108:109], v[44:45] op_sel_hi:[1,0]
    v_pk_mul_f32 v[110:111], v[110:111], v[44:45] op_sel_hi:[1,0]
    v_cvt_pk_bf16_f32 v132, v104, v105
    v_cvt_pk_bf16_f32 v133, v106, v107
    v_cvt_pk_bf16_f32 v134, v108, v109
    v_cvt_pk_bf16_f32 v135, v110, v111
    v_min_u32 v132, -2, v132
    buffer_store_dwordx4 v[132:135], v3, s[4:7], s45 offen offset:1024 sc1
    v_pk_mul_f32 v[112:113], v[112:113], v[44:45] op_sel_hi:[1,0]
    v_pk_mul_f32 v[114:115], v[114:115], v[44:45] op_sel_hi:[1,0]
    v_pk_mul_f32 v[116:117], v[116:117], v[44:45] op_sel_hi:[1,0]
    v_pk_mul_f32 v[118:119], v[118:119], v[44:45] op_sel_hi:[1,0]
    v_cvt_pk_bf16_f32 v136, v112, v113
    v_cvt_pk_bf16_f32 v137, v114, v115
    v_cvt_pk_bf16_f32 v138, v116, v117
    v_cvt_pk_bf16_f32 v139, v118, v119
    v_min_u32 v136, -2, v136
    buffer_store_dwordx4 v[136:139], v3, s[4:7], s45 offen offset:2048 sc1
    v_pk_mul_f32 v[120:121], v[120:121], v[44:45] op_sel_hi:[1,0]
    v_pk_mul_f32 v[122:123], v[122:123], v[44:45] op_sel_hi:[1,0]
    v_pk_mul_f32 v[124:125], v[124:125], v[44:45] op_sel_hi:[1,0]
    v_pk_mul_f32 v[126:127], v[126:127], v[44:45] op_sel_hi:[1,0]
    v_cvt_pk_bf16_f32 v140, v120, v121
    v_cvt_pk_bf16_f32 v141, v122, v123
    v_cvt_pk_bf16_f32 v142, v124, v125
    v_cvt_pk_bf16_f32 v143, v126, v127
    v_min_u32 v140, -2, v140
    buffer_store_dwordx4 v[140:143], v3, s[4:7], s45 offen offset:3072 sc1
    s_add_u32 s35, s41, 1
    s_mov_b32 s41, s39
    v_mfma_f32_16x16x32_bf16 v[16:19], a[144:147], a[128:131], 0
    v_mfma_f32_16x16x32_bf16 v[16:19], a[148:151], a[132:135], v[16:19]
    v_mfma_f32_16x16x32_bf16 v[16:19], a[152:155], a[136:139], v[16:19]
    v_mfma_f32_16x16x32_bf16 v[16:19], a[156:159], a[140:143], v[16:19]
    s_cmp_lt_u32 s41, 16
    s_cselect_b32 s39, 2, 4
    s_add_u32 s39, s39, s41
    s_cmp_gt_u32 s39, 63
    s_cbranch_scc1 L_atq_78
    s_cmp_gt_u32 s43, s39
    s_cbranch_scc1 L_ath_81
L_atp_80:
    buffer_load_dwordx4 v[10:13], v8, s[4:7], s42 offen sc1
    buffer_load_dwordx2 v[14:15], v8, s[4:7], s42 offen offset:16 sc1
    s_waitcnt vmcnt(0)
    v_min3_u32 v10, v10, v12, v14
    v_min3_u32 v11, v11, v13, v15
    v_lshlrev_b32 v10, 1, v10
    v_lshl_or_b32 v11, v11, 1, 1
    v_min_u32 v10, v10, v11
    s_nop 0
    v_readfirstlane_b32 s43, v10
    s_cmp_gt_u32 s43, s39
    s_cbranch_scc1 L_ath_81
    s_sleep 8
    s_add_u32 s100, s100, 1
    s_bitcmp1_b32 s100, 15
    s_cbranch_scc1 L_exit
    s_branch L_atp_80
L_ath_81:
    s_lshl_b32 s36, s39, 5
    s_add_u32 s36, s36, s40
    s_lshl_b32 s36, s36, 13
    s_add_u32 s37, s36, 0x4000000
    buffer_load_dwordx4 a[0:3], v3, s[4:7], s37 offen offset:0 sc1
    buffer_load_dwordx4 a[4:7], v3, s[4:7], s37 offen offset:1024 sc1
    buffer_load_dwordx4 a[8:11], v3, s[4:7], s37 offen offset:2048 sc1
    buffer_load_dwordx4 a[12:15], v3, s[4:7], s37 offen offset:3072 sc1
    s_add_u32 s37, s36, 0x2000000
    s_add_u32 s38, s37, 4096
    buffer_load_dwordx4 a[16:19], v3, s[4:7], s37 offen offset:0 sc1
    buffer_load_dwordx4 a[20:23], v3, s[4:7], s37 offen offset:1024 sc1
    buffer_load_dwordx4 a[24:27], v3, s[4:7], s37 offen offset:2048 sc1
    buffer_load_dwordx4 a[28:31], v3, s[4:7], s37 offen offset:3072 sc1
    s_add_u32 s37, s36, 0x3000000
    s_add_u32 s38, s37, 4096
    buffer_load_dwordx4 a[48:51], v3, s[4:7], s37 offen offset:0 sc1
    buffer_load_dwordx4 a[52:55], v3, s[4:7], s37 offen offset:1024 sc1
    buffer_load_dwordx4 a[56:59], v3, s[4:7], s37 offen offset:2048 sc1
    buffer_load_dwordx4 a[60:63], v3, s[4:7], s37 offen offset:3072 sc1
    buffer_load_dwordx4 a[64:67], v3, s[4:7], s38 offen offset:0 sc1
    buffer_load_dwordx4 a[68:71], v3, s[4:7], s38 offen offset:1024 sc1
    buffer_load_dwordx4 a[72:75], v3, s[4:7], s38 offen offset:2048 sc1
    buffer_load_dwordx4 a[76:79], v3, s[4:7], s38 offen offset:3072 sc1
    s_waitcnt vmcnt(16)
    s_branch L_atr_79
L_atq_78:
    s_waitcnt vmcnt(0)
L_atr_79:
    v_mov_b32 v10, s35
    s_mov_b64 exec, 1
    buffer_store_dword v10, v8, s[4:7], s58 offen sc1
    s_mov_b64 exec, -1
    s_min_u32 s59, s41, 61
    s_cmp_gt_u32 s44, s59
    s_cbranch_scc1 L_atn_83
L_atm_82:
    buffer_load_dword v10, v8, s[4:7], s42 offen offset:32 sc1
    s_waitcnt vmcnt(0)
    v_readfirstlane_b32 s44, v10
    s_cmp_gt_u32 s44, s59
    s_cbranch_scc1 L_atn_83
    s_cmp_eq_u32 s44, s59
    s_cbranch_scc1 L_atm_82_n
    s_sleep 16
L_atm_82_n:
    s_sleep 2
    s_add_u32 s100, s100, 1
    s_bitcmp1_b32 s100, 15
    s_cbranch_scc1 L_exit
    s_branch L_atm_82
L_atn_83:
    s_cmp_lg_u32 s41, 63
    s_cbranch_scc1 L_ats_84
    s_sleep 48
L_ats_84:
    s_mov_b32 s100, 0
    s_lshl_b32 s36, s41, 5
    s_add_u32 s36, s36, s40
    s_lshl_b32 s36, s36, 12
    s_add_u32 s36, s36, 0x1000000
    buffer_load_dwordx4 v[64:67], v3, s[4:7], s36 offen offset:0 sc1
    buffer_load_dwordx4 v[68:71], v3, s[4:7], s36 offen offset:1024 sc1
    buffer_load_dwordx4 v[72:75], v3, s[4:7], s36 offen offset:2048 sc1
    buffer_load_dwordx4 v[76:79], v3, s[4:7], s36 offen offset:3072 sc1
    v_cndmask_b32 v16, v9, v16, s[50:51]
    v_cndmask_b32 v17, v9, v17, s[52:53]
    v_cndmask_b32 v18, v9, v18, s[54:55]
    v_cndmask_b32 v19, v9, v19, s[56:57]
    v_max_f32 v36, v16, v17
    v_max3_f32 v36, v36, v18, v19
    v_mov_b32 v37, v36
    s_nop 1
    v_permlane32_swap_b32 v36, v37
    v_max_f32 v36, v36, v37
    s_lshl_b32 s45, s41, 6
    s_add_u32 s45, s45, s40
    s_lshl_b32 s45, s45, 12
    s_add_u32 s45, s45, 0x5000000
    s_cmp_lt_u32 s41, 62
    s_cbranch_scc1 L_atd_86
L_atk_85:
    s_waitcnt vmcnt(0)
    v_max3_u32 v10, v64, v68, v72
    v_max_u32 v10, v10, v76
    v_cmp_eq_u32 vcc, -1, v10
    s_cbranch_vccz L_atd_86
    s_sleep 1
    s_add_u32 s100, s100, 1
    s_bitcmp1_b32 s100, 15
    s_cbranch_scc1 L_exit
    buffer_load_dwordx4 v[64:67], v3, s[4:7], s36 offen offset:0 sc1
    buffer_load_dwordx4 v[68:71], v3, s[4:7], s36 offen offset:1024 sc1
    buffer_load_dwordx4 v[72:75], v3, s[4:7], s36 offen offset:2048 sc1
    buffer_load_dwordx4 v[76:79], v3, s[4:7], s36 offen offset:3072 sc1
    s_branch L_atk_85
L_atd_86:
    s_waitcnt vmcnt(3)
    ds_write_b64 v4, v[64:65] offset:0
    s_waitcnt vmcnt(2)
    ds_write_b64 v4, v[68:69] offset:512
    s_waitcnt vmcnt(1)
    ds_write_b64 v4, v[72:73] offset:1024
    s_waitcnt vmcnt(0)
    ds_write_b64 v4, v[76:77] offset:1536
    s_waitcnt lgkmcnt(0)
    ds_read_b64_tr_b16 v[80:81], v5 offset:0
    ds_read_b64_tr_b16 v[82:83], v5 offset:256
    ds_read_b64_tr_b16 v[84:85], v5 offset:512
    ds_read_b64_tr_b16 v[86:87], v5 offset:768
    ds_read_b64_tr_b16 v[88:89], v5 offset:1024
    ds_read_b64_tr_b16 v[90:91], v5 offset:1280
    ds_read_b64_tr_b16 v[92:93], v5 offset:1536
    ds_read_b64_tr_b16 v[94:95], v5 offset:1792
    s_waitcnt lgkmcnt(6)
    v_mfma_f32_16x16x32_bf16 v[28:31], v[80:83], a[128:131], 0
    s_waitcnt lgkmcnt(4)
    v_mfma_f32_16x16x32_bf16 v[28:31], v[84:87], a[132:135], v[28:31]
    s_waitcnt lgkmcnt(2)
    v_mfma_f32_16x16x32_bf16 v[28:31], v[88:91], a[136:139], v[28:31]
    s_waitcnt lgkmcnt(0)
    v_mfma_f32_16x16x32_bf16 v[28:31], v[92:95], a[140:143], v[28:31]
    s_nop 7
    v_max3_f32 v36, v36, v28, v29
    v_max3_f32 v36, v36, v30, v31
    v_mov_b32 v37, v36
    v_cndmask_b32 v28, v28, v30, s[48:49]
    v_cndmask_b32 v29, v29, v31, s[48:49]
    v_permlane16_swap_b32 v36, v37
    v_max_f32 v36, v36, v37
    v_mul_f32 v36, s46, v36
    v_pk_fma_f32 v[16:17], v[16:17], s[46:47], v[36:37] op_sel_hi:[1,1,0] neg_lo:[0,0,1] neg_hi:[0,0,1]
    v_pk_fma_f32 v[18:19], v[18:19], s[46:47], v[36:37] op_sel_hi:[1,1,0] neg_lo:[0,0,1] neg_hi:[0,0,1]
    v_pk_fma_f32 v[28:29], v[28:29], s[46:47], v[36:37] op_sel_hi:[1,1,0] neg_lo:[0,0,1] neg_hi:[0,0,1]
    v_exp_f32 v16, v16
    v_exp_f32 v17, v17
    v_exp_f32 v18, v18
    v_exp_f32 v19, v19
    v_exp_f32 v28, v28
    v_exp_f32 v29, v29
    v_cvt_pk_bf16_f32 v40, v16, v17
    v_cvt_pk_bf16_f32 v41, v18, v19
    v_mov_b32 v42, 0
    v_mov_b32 v43, 0
    v_cvt_pk_bf16_f32 v60, v28, v29
    v_cvt_pk_bf16_f32 v63, v28, v29
    v_mfma_f32_16x16x32_bf16 v[44:47], v[56:59], v[40:43], 0
    v_mfma_f32_16x16x32_bf16 v[96:99], a[176:179], v[40:43], 0
    v_mfma_f32_16x16x32_bf16 v[100:103], a[180:183], v[40:43], 0
    v_mfma_f32_16x16x32_bf16 v[104:107], a[184:187], v[40:43], 0
    v_mfma_f32_16x16x32_bf16 v[108:111], a[188:191], v[40:43], 0
    v_mfma_f32_16x16x32_bf16 v[112:115], a[192:195], v[40:43], 0
    v_mfma_f32_16x16x32_bf16 v[116:119], a[196:199], v[40:43], 0
    v_mfma_f32_16x16x32_bf16 v[120:123], a[200:203], v[40:43], 0
    v_mfma_f32_16x16x32_bf16 v[124:127], a[204:207], v[40:43], 0
    v_mfma_f32_16x16x16_bf16 v[44:47], v[56:57], v[60:61], v[44:47]
    v_mfma_f32_16x16x16_bf16 v[96:99], v[66:67], v[60:61], v[96:99]
    v_mfma_f32_16x16x16_bf16 v[100:103], v[66:67], v[62:63], v[100:103]
    v_mfma_f32_16x16x16_bf16 v[104:107], v[70:71], v[60:61], v[104:107]
    v_mfma_f32_16x16x16_bf16 v[108:111], v[70:71], v[62:63], v[108:111]
    v_mfma_f32_16x16x16_bf16 v[112:115], v[74:75], v[60:61], v[112:115]
    v_mfma_f32_16x16x16_bf16 v[116:119], v[74:75], v[62:63], v[116:119]
    v_mfma_f32_16x16x16_bf16 v[120:123], v[78:79], v[60:61], v[120:123]
    v_mfma_f32_16x16x16_bf16 v[124:127], v[78:79], v[62:63], v[124:127]
    v_rcp_f32 v44, v44
    s_nop 0
    v_pk_mul_f32 v[96:97], v[96:97], v[44:45] op_sel_hi:[1,0]
    v_pk_mul_f32 v[98:99], v[98:99], v[44:45] op_sel_hi:[1,0]
    v_pk_mul_f32 v[100:101], v[100:101], v[44:45] op_sel_hi:[1,0]
    v_pk_mul_f32 v[102:103], v[102:103], v[44:45] op_sel_hi:[1,0]
    v_cvt_pk_bf16_f32 v128, v96, v97
    v_cvt_pk_bf16_f32 v129, v98, v99
    v_cvt_pk_bf16_f32 v130, v100, v101
    v_cvt_pk_bf16_f32 v131, v102, v103
    v_min_u32 v128, -2, v128
    buffer_store_dwordx4 v[128:131], v3, s[4:7], s45 offen offset:0 sc1
    v_pk_mul_f32 v[104:105], v[104:105], v[44:45] op_sel_hi:[1,0]
    v_pk_mul_f32 v[106:107], v[106:107], v[44:45] op_sel_hi:[1,0]
    v_pk_mul_f32 v[108:109], v[108:109], v[44:45] op_sel_hi:[1,0]
    v_pk_mul_f32 v[110:111], v[110:111], v[44:45] op_sel_hi:[1,0]
    v_cvt_pk_bf16_f32 v132, v104, v105
    v_cvt_pk_bf16_f32 v133, v106, v107
    v_cvt_pk_bf16_f32 v134, v108, v109
    v_cvt_pk_bf16_f32 v135, v110, v111
    v_min_u32 v132, -2, v132
    buffer_store_dwordx4 v[132:135], v3, s[4:7], s45 offen offset:1024 sc1
    v_pk_mul_f32 v[112:113], v[112:113], v[44:45] op_sel_hi:[1,0]
    v_pk_mul_f32 v[114:115], v[114:115], v[44:45] op_sel_hi:[1,0]
    v_pk_mul_f32 v[116:117], v[116:117], v[44:45] op_sel_hi:[1,0]
    v_pk_mul_f32 v[118:119], v[118:119], v[44:45] op_sel_hi:[1,0]
    v_cvt_pk_bf16_f32 v136, v112, v113
    v_cvt_pk_bf16_f32 v137, v114, v115
    v_cvt_pk_bf16_f32 v138, v116, v117
    v_cvt_pk_bf16_f32 v139, v118, v119
    v_min_u32 v136, -2, v136
    buffer_store_dwordx4 v[136:139], v3, s[4:7], s45 offen offset:2048 sc1
    v_pk_mul_f32 v[120:121], v[120:121], v[44:45] op_sel_hi:[1,0]
    v_pk_mul_f32 v[122:123], v[122:123], v[44:45] op_sel_hi:[1,0]
    v_pk_mul_f32 v[124:125], v[124:125], v[44:45] op_sel_hi:[1,0]
    v_pk_mul_f32 v[126:127], v[126:127], v[44:45] op_sel_hi:[1,0]
    v_cvt_pk_bf16_f32 v140, v120, v121
    v_cvt_pk_bf16_f32 v141, v122, v123
    v_cvt_pk_bf16_f32 v142, v124, v125
    v_cvt_pk_bf16_f32 v143, v126, v127
    v_min_u32 v140, -2, v140
    buffer_store_dwordx4 v[140:143], v3, s[4:7], s45 offen offset:3072 sc1
    s_add_u32 s35, s41, 1
    s_mov_b32 s41, s39
    s_cmp_lt_u32 s41, 64
    s_cbranch_scc1 L_at_0
    s_waitcnt vmcnt(0)
    v_mov_b32 v10, s35
    s_mov_b64 exec, 1
    buffer_store_dword v10, v8, s[4:7], s58 offen sc1
    s_mov_b64 exec, -1
    s_waitcnt vmcnt(0)
    s_endpgm
L_at_1_pre:
    s_cmp_gt_u32 s43, s41
    s_cbranch_scc1 L_ath_88
L_atp_87:
    buffer_load_dwordx4 v[10:13], v8, s[4:7], s42 offen sc1
    buffer_load_dwordx2 v[14:15], v8, s[4:7], s42 offen offset:16 sc1
    s_waitcnt vmcnt(0)
    v_min3_u32 v10, v10, v12, v14
    v_min3_u32 v11, v11, v13, v15
    v_lshlrev_b32 v10, 1, v10
    v_lshl_or_b32 v11, v11, 1, 1
    v_min_u32 v10, v10, v11
    s_nop 0
    v_readfirstlane_b32 s43, v10
    s_cmp_gt_u32 s43, s41
    s_cbranch_scc1 L_ath_88
    s_sleep 8
    s_add_u32 s100, s100, 1
    s_bitcmp1_b32 s100, 15
    s_cbranch_scc1 L_exit
    s_branch L_atp_87
L_ath_88:
    s_lshl_b32 s36, s41, 5
    s_add_u32 s36, s36, s40
    s_lshl_b32 s36, s36, 13
    s_add_u32 s37, s36, 0x4001000
    buffer_load_dwordx4 a[0:3], v3, s[4:7], s37 offen offset:0 sc1
    buffer_load_dwordx4 a[4:7], v3, s[4:7], s37 offen offset:1024 sc1
    buffer_load_dwordx4 a[8:11], v3, s[4:7], s37 offen offset:2048 sc1
    buffer_load_dwordx4 a[12:15], v3, s[4:7], s37 offen offset:3072 sc1
    s_add_u32 s37, s36, 0x2000000
    s_add_u32 s38, s37, 4096
    buffer_load_dwordx4 a[16:19], v3, s[4:7], s37 offen offset:0 sc1
    buffer_load_dwordx4 a[20:23], v3, s[4:7], s37 offen offset:1024 sc1
    buffer_load_dwordx4 a[24:27], v3, s[4:7], s37 offen offset:2048 sc1
    buffer_load_dwordx4 a[28:31], v3, s[4:7], s37 offen offset:3072 sc1
    buffer_load_dwordx4 a[32:35], v3, s[4:7], s38 offen offset:0 sc1
    buffer_load_dwordx4 a[36:39], v3, s[4:7], s38 offen offset:1024 sc1
    buffer_load_dwordx4 a[40:43], v3, s[4:7], s38 offen offset:2048 sc1
    buffer_load_dwordx4 a[44:47], v3, s[4:7], s38 offen offset:3072 sc1
    s_add_u32 s37, s36, 0x3000000
    s_add_u32 s38, s37, 4096
    buffer_load_dwordx4 a[48:51], v3, s[4:7], s37 offen offset:0 sc1
    buffer_load_dwordx4 a[52:55], v3, s[4:7], s37 offen offset:1024 sc1
    buffer_load_dwordx4 a[56:59], v3, s[4:7], s37 offen offset:2048 sc1
    buffer_load_dwordx4 a[60:63], v3, s[4:7], s37 offen offset:3072 sc1
    buffer_load_dwordx4 a[64:67], v3, s[4:7], s38 offen offset:0 sc1
    buffer_load_dwordx4 a[68:71], v3, s[4:7], s38 offen offset:1024 sc1
    buffer_load_dwordx4 a[72:75], v3, s[4:7], s38 offen offset:2048 sc1
    buffer_load_dwordx4 a[76:79], v3, s[4:7], s38 offen offset:3072 sc1
    s_waitcnt vmcnt(0)
L_at_1:
    v_mfma_f32_16x16x32_bf16 v[16:19], a[16:19], a[0:3], 0
    v_mfma_f32_16x16x32_bf16 v[20:23], a[32:35], a[0:3], 0
    v_mfma_f32_16x16x32_bf16 v[16:19], a[20:23], a[4:7], v[16:19]
    v_mfma_f32_16x16x32_bf16 v[20:23], a[36:39], a[4:7], v[20:23]
    v_mfma_f32_16x16x32_bf16 v[16:19], a[24:27], a[8:11], v[16:19]
    v_mfma_f32_16x16x32_bf16 v[20:23], a[40:43], a[8:11], v[20:23]
    v_mfma_f32_16x16x32_bf16 v[16:19], a[28:31], a[12:15], v[16:19]
    v_mfma_f32_16x16x32_bf16 v[20:23], a[44:47], a[12:15], v[20:23]
    s_cmp_lt_u32 s41, 16
    s_cselect_b32 s39, 2, 4
    s_add_u32 s39, s39, s41
    s_cmp_gt_u32 s39, 63
    s_cbranch_scc1 L_atq_89
    s_cmp_gt_u32 s43, s39
    s_cbranch_scc1 L_ath_92
L_atp_91:
    buffer_load_dwordx4 v[10:13], v8, s[4:7], s42 offen sc1
    buffer_load_dwordx2 v[14:15], v8, s[4:7], s42 offen offset:16 sc1
    s_waitcnt vmcnt(0)
    v_min3_u32 v10, v10, v12, v14
    v_min3_u32 v11, v11, v13, v15
    v_lshlrev_b32 v10, 1, v10
    v_lshl_or_b32 v11, v11, 1, 1
    v_min_u32 v10, v10, v11
    s_nop 0
    v_readfirstlane_b32 s43, v10
    s_cmp_gt_u32 s43, s39
    s_cbranch_scc1 L_ath_92
    s_sleep 8
    s_add_u32 s100, s100, 1
    s_bitcmp1_b32 s100, 15
    s_cbranch_scc1 L_exit
    s_branch L_atp_91
L_ath_92:
    s_lshl_b32 s36, s39, 5
    s_add_u32 s36, s36, s40
    s_lshl_b32 s36, s36, 13
    s_add_u32 s37, s36, 0x4001000
    buffer_load_dwordx4 a[128:131], v3, s[4:7], s37 offen offset:0 sc1
    buffer_load_dwordx4 a[132:135], v3, s[4:7], s37 offen offset:1024 sc1
    buffer_load_dwordx4 a[136:139], v3, s[4:7], s37 offen offset:2048 sc1
    buffer_load_dwordx4 a[140:143], v3, s[4:7], s37 offen offset:3072 sc1
    s_add_u32 s37, s36, 0x2000000
    s_add_u32 s38, s37, 4096
    buffer_load_dwordx4 a[144:147], v3, s[4:7], s37 offen offset:0 sc1
    buffer_load_dwordx4 a[148:151], v3, s[4:7], s37 offen offset:1024 sc1
    buffer_load_dwordx4 a[152:155], v3, s[4:7], s37 offen offset:2048 sc1
    buffer_load_dwordx4 a[156:159], v3, s[4:7], s37 offen offset:3072 sc1
    buffer_load_dwordx4 a[160:163], v3, s[4:7], s38 offen offset:0 sc1
    buffer_load_dwordx4 a[164:167], v3, s[4:7], s38 offen offset:1024 sc1
    buffer_load_dwordx4 a[168:171], v3, s[4:7], s38 offen offset:2048 sc1
    buffer_load_dwordx4 a[172:175], v3, s[4:7], s38 offen offset:3072 sc1
    s_add_u32 s37, s36, 0x3000000
    s_add_u32 s38, s37, 4096
    buffer_load_dwordx4 a[176:179], v3, s[4:7], s37 offen offset:0 sc1
    buffer_load_dwordx4 a[180:183], v3, s[4:7], s37 offen offset:1024 sc1
    buffer_load_dwordx4 a[184:187], v3, s[4:7], s37 offen offset:2048 sc1
    buffer_load_dwordx4 a[188:191], v3, s[4:7], s37 offen offset:3072 sc1
    buffer_load_dwordx4 a[192:195], v3, s[4:7], s38 offen offset:0 sc1
    buffer_load_dwordx4 a[196:199], v3, s[4:7], s38 offen offset:1024 sc1
    buffer_load_dwordx4 a[200:203], v3, s[4:7], s38 offen offset:2048 sc1
    buffer_load_dwordx4 a[204:207], v3, s[4:7], s38 offen offset:3072 sc1
    s_waitcnt vmcnt(20)
    s_branch L_atr_90
L_atq_89:
    s_waitcnt vmcnt(0)
L_atr_90:
    v_mov_b32 v10, s35
    s_mov_b64 exec, 1
    buffer_store_dword v10, v8, s[4:7], s58 offen sc1
    s_mov_b64 exec, -1
    s_min_u32 s59, s41, 61
    s_cmp_gt_u32 s44, s59
    s_cbranch_scc1 L_atn_94
L_atm_93:
    buffer_load_dword v10, v8, s[4:7], s42 offen offset:32 sc1
    s_waitcnt vmcnt(0)
    v_readfirstlane_b32 s44, v10
    s_cmp_gt_u32 s44, s59
    s_cbranch_scc1 L_atn_94
    s_cmp_eq_u32 s44, s59
    s_cbranch_scc1 L_atm_93_n
    s_sleep 16
L_atm_93_n:
    s_sleep 2
    s_add_u32 s100, s100, 1
    s_bitcmp1_b32 s100, 15
    s_cbranch_scc1 L_exit
    s_branch L_atm_93
L_atn_94:
    s_mov_b32 s100, 0
    s_lshl_b32 s36, s41, 5
    s_add_u32 s36, s36, s40
    s_lshl_b32 s36, s36, 12
    s_add_u32 s36, s36, 0x1000000
    buffer_load_dwordx4 v[64:67], v3, s[4:7], s36 offen offset:0 sc1
    buffer_load_dwordx4 v[68:71], v3, s[4:7], s36 offen offset:1024 sc1
    buffer_load_dwordx4 v[72:75], v3, s[4:7], s36 offen offset:2048 sc1
    buffer_load_dwordx4 v[76:79], v3, s[4:7], s36 offen offset:3072 sc1
    v_cndmask_b32 v20, v9, v20, s[50:51]
    v_cndmask_b32 v21, v9, v21, s[52:53]
    v_cndmask_b32 v22, v9, v22, s[54:55]
    v_cndmask_b32 v23, v9, v23, s[56:57]
    v_max_f32 v36, v16, v17
    v_max3_f32 v36, v36, v18, v19
    v_max3_f32 v36, v36, v20, v21
    v_max3_f32 v36, v36, v22, v23
    v_mov_b32 v37, v36
    s_nop 1
    v_permlane32_swap_b32 v36, v37
    v_max_f32 v36, v36, v37
    s_lshl_b32 s45, s41, 6
    s_add_u32 s45, s45, s40
    s_lshl_b32 s45, s45, 12
    s_add_u32 s45, s45, 0x5020000
    s_waitcnt vmcnt(3)
    ds_write_b64 v4, v[64:65] offset:0
    s_waitcnt vmcnt(2)
    ds_write_b64 v4, v[68:69] offset:512
    s_waitcnt vmcnt(1)
    ds_write_b64 v4, v[72:73] offset:1024
    s_waitcnt vmcnt(0)
    ds_write_b64 v4, v[76:77] offset:1536
    s_waitcnt lgkmcnt(0)
    ds_read_b64_tr_b16 v[80:81], v5 offset:0
    ds_read_b64_tr_b16 v[82:83], v5 offset:256
    ds_read_b64_tr_b16 v[84:85], v5 offset:512
    ds_read_b64_tr_b16 v[86:87], v5 offset:768
    ds_read_b64_tr_b16 v[88:89], v5 offset:1024
    ds_read_b64_tr_b16 v[90:91], v5 offset:1280
    ds_read_b64_tr_b16 v[92:93], v5 offset:1536
    ds_read_b64_tr_b16 v[94:95], v5 offset:1792
    s_waitcnt lgkmcnt(6)
    v_mfma_f32_16x16x32_bf16 v[28:31], v[80:83], a[0:3], 0
    s_waitcnt lgkmcnt(4)
    v_mfma_f32_16x16x32_bf16 v[28:31], v[84:87], a[4:7], v[28:31]
    s_waitcnt lgkmcnt(2)
    v_mfma_f32_16x16x32_bf16 v[28:31], v[88:91], a[8:11], v[28:31]
    s_waitcnt lgkmcnt(0)
    v_mfma_f32_16x16x32_bf16 v[28:31], v[92:95], a[12:15], v[28:31]
    s_nop 7
    v_max3_f32 v36, v36, v28, v29
    v_max3_f32 v36, v36, v30, v31
    v_mov_b32 v37, v36
    v_cndmask_b32 v28, v28, v30, s[48:49]
    v_cndmask_b32 v29, v29, v31, s[48:49]
    v_permlane16_swap_b32 v36, v37
    v_max_f32 v36, v36, v37
    v_mul_f32 v36, s46, v36
    v_pk_fma_f32 v[16:17], v[16:17], s[46:47], v[36:37] op_sel_hi:[1,1,0] neg_lo:[0,0,1] neg_hi:[0,0,1]
    v_pk_fma_f32 v[18:19], v[18:19], s[46:47], v[36:37] op_sel_hi:[1,1,0] neg_lo:[0,0,1] neg_hi:[0,0,1]
    v_pk_fma_f32 v[20:21], v[20:21], s[46:47], v[36:37] op_sel_hi:[1,1,0] neg_lo:[0,0,1] neg_hi:[0,0,1]
    v_pk_fma_f32 v[22:23], v[22:23], s[46:47], v[36:37] op_sel_hi:[1,1,0] neg_lo:[0,0,1] neg_hi:[0,0,1]
    v_pk_fma_f32 v[28:29], v[28:29], s[46:47], v[36:37] op_sel_hi:[1,1,0] neg_lo:[0,0,1] neg_hi:[0,0,1]
    v_exp_f32 v16, v16
    v_exp_f32 v17, v17
    v_exp_f32 v18, v18
    v_exp_f32 v19, v19
    v_exp_f32 v20, v20
    v_exp_f32 v21, v21
    v_exp_f32 v22, v22
    v_exp_f32 v23, v23
    v_exp_f32 v28, v28
    v_exp_f32 v29, v29
    v_cvt_pk_bf16_f32 v40, v16, v17
    v_cvt_pk_bf16_f32 v41, v18, v19
    v_cvt_pk_bf16_f32 v42, v20, v21
    v_cvt_pk_bf16_f32 v43, v22, v23
    v_cvt_pk_bf16_f32 v60, v28, v29
    v_cvt_pk_bf16_f32 v63, v28, v29
    v_mfma_f32_16x16x32_bf16 v[44:47], v[56:59], v[40:43], 0
    v_mfma_f32_16x16x32_bf16 v[96:99], a[48:51], v[40:43], 0
    v_mfma_f32_16x16x32_bf16 v[100:103], a[52:55], v[40:43], 0
    v_mfma_f32_16x16x32_bf16 v[104:107], a[56:59], v[40:43], 0
    v_mfma_f32_16x16x32_bf16 v[108:111], a[60:63], v[40:43], 0
    v_mfma_f32_16x16x32_bf16 v[112:115], a[64:67], v[40:43], 0
    v_mfma_f32_16x16x32_bf16 v[116:119], a[68:71], v[40:43], 0
    v_mfma_f32_16x16x32_bf16 v[120:123], a[72:75], v[40:43], 0
    v_mfma_f32_16x16x32_bf16 v[124:127], a[76:79], v[40:43], 0
    v_mfma_f32_16x16x16_bf16 v[44:47], v[56:57], v[60:61], v[44:47]
    v_mfma_f32_16x16x16_bf16 v[96:99], v[66:67], v[60:61], v[96:99]
    v_mfma_f32_16x16x16_bf16 v[100:103], v[66:67], v[62:63], v[100:103]
    v_mfma_f32_16x16x16_bf16 v[104:107], v[70:71], v[60:61], v[104:107]
    v_mfma_f32_16x16x16_bf16 v[108:111], v[70:71], v[62:63], v[108:111]
    v_mfma_f32_16x16x16_bf16 v[112:115], v[74:75], v[60:61], v[112:115]
    v_mfma_f32_16x16x16_bf16 v[116:119], v[74:75], v[62:63], v[116:119]
    v_mfma_f32_16x16x16_bf16 v[120:123], v[78:79], v[60:61], v[120:123]
    v_mfma_f32_16x16x16_bf16 v[124:127], v[78:79], v[62:63], v[124:127]
    v_rcp_f32 v44, v44
    s_nop 0
    v_pk_mul_f32 v[96:97], v[96:97], v[44:45] op_sel_hi:[1,0]
    v_pk_mul_f32 v[98:99], v[98:99], v[44:45] op_sel_hi:[1,0]
    v_pk_mul_f32 v[100:101], v[100:101], v[44:45] op_sel_hi:[1,0]
    v_pk_mul_f32 v[102:103], v[102:103], v[44:45] op_sel_hi:[1,0]
    v_cvt_pk_bf16_f32 v128, v96, v97
    v_cvt_pk_bf16_f32 v129, v98, v99
    v_cvt_pk_bf16_f32 v130, v100, v101
    v_cvt_pk_bf16_f32 v131, v102, v103
    v_min_u32 v128, -2, v128
    buffer_store_dwordx4 v[128:131], v3, s[4:7], s45 offen offset:0 sc1
    v_pk_mul_f32 v[104:105], v[104:105], v[44:45] op_sel_hi:[1,0]
    v_pk_mul_f32 v[106:107], v[106:107], v[44:45] op_sel_hi:[1,0]
    v_pk_mul_f32 v[108:109], v[108:109], v[44:45] op_sel_hi:[1,0]
    v_pk_mul_f32 v[110:111], v[110:111], v[44:45] op_sel_hi:[1,0]
    v_cvt_pk_bf16_f32 v132, v104, v105
    v_cvt_pk_bf16_f32 v133, v106, v107
    v_cvt_pk_bf16_f32 v134, v108, v109
    v_cvt_pk_bf16_f32 v135, v110, v111
    v_min_u32 v132, -2, v132
    buffer_store_dwordx4 v[132:135], v3, s[4:7], s45 offen offset:1024 sc1
    v_pk_mul_f32 v[112:113], v[112:113], v[44:45] op_sel_hi:[1,0]
    v_pk_mul_f32 v[114:115], v[114:115], v[44:45] op_sel_hi:[1,0]
    v_pk_mul_f32 v[116:117], v[116:117], v[44:45] op_sel_hi:[1,0]
    v_pk_mul_f32 v[118:119], v[118:119], v[44:45] op_sel_hi:[1,0]
    v_cvt_pk_bf16_f32 v136, v112, v113
    v_cvt_pk_bf16_f32 v137, v114, v115
    v_cvt_pk_bf16_f32 v138, v116, v117
    v_cvt_pk_bf16_f32 v139, v118, v119
    v_min_u32 v136, -2, v136
    buffer_store_dwordx4 v[136:139], v3, s[4:7], s45 offen offset:2048 sc1
    v_pk_mul_f32 v[120:121], v[120:121], v[44:45] op_sel_hi:[1,0]
    v_pk_mul_f32 v[122:123], v[122:123], v[44:45] op_sel_hi:[1,0]
    v_pk_mul_f32 v[124:125], v[124:125], v[44:45] op_sel_hi:[1,0]
    v_pk_mul_f32 v[126:127], v[126:127], v[44:45] op_sel_hi:[1,0]
    v_cvt_pk_bf16_f32 v140, v120, v121
    v_cvt_pk_bf16_f32 v141, v122, v123
    v_cvt_pk_bf16_f32 v142, v124, v125
    v_cvt_pk_bf16_f32 v143, v126, v127
    v_min_u32 v140, -2, v140
    buffer_store_dwordx4 v[140:143], v3, s[4:7], s45 offen offset:3072 sc1
    s_add_u32 s35, s41, 1
    s_mov_b32 s41, s39
    v_mfma_f32_16x16x32_bf16 v[16:19], a[144:147], a[128:131], 0
    v_mfma_f32_16x16x32_bf16 v[20:23], a[160:163], a[128:131], 0
    v_mfma_f32_16x16x32_bf16 v[16:19], a[148:151], a[132:135], v[16:19]
    v_mfma_f32_16x16x32_bf16 v[20:23], a[164:167], a[132:135], v[20:23]
    v_mfma_f32_16x16x32_bf16 v[16:19], a[152:155], a[136:139], v[16:19]
    v_mfma_f32_16x16x32_bf16 v[20:23], a[168:171], a[136:139], v[20:23]
    v_mfma_f32_16x16x32_bf16 v[16:19], a[156:159], a[140:143], v[16:19]
    v_mfma_f32_16x16x32_bf16 v[20:23], a[172:175], a[140:143], v[20:23]
    s_cmp_lt_u32 s41, 16
    s_cselect_b32 s39, 2, 4
    s_add_u32 s39, s39, s41
    s_cmp_gt_u32 s39, 63
    s_cbranch_scc1 L_atq_95
    s_cmp_gt_u32 s43, s39
    s_cbranch_scc1 L_ath_98
L_atp_97:
    buffer_load_dwordx4 v[10:13], v8, s[4:7], s42 offen sc1
    buffer_load_dwordx2 v[14:15], v8, s[4:7], s42 offen offset:16 sc1
    s_waitcnt vmcnt(0)
    v_min3_u32 v10, v10, v12, v14
    v_min3_u32 v11, v11, v13, v15
    v_lshlrev_b32 v10, 1, v10
    v_lshl_or_b32 v11, v11, 1, 1
    v_min_u32 v10, v10, v11
    s_nop 0
    v_readfirstlane_b32 s43, v10
    s_cmp_gt_u32 s43, s39
    s_cbranch_scc1 L_ath_98
    s_sleep 8
    s_add_u32 s100, s100, 1
    s_bitcmp1_b32 s100, 15
    s_cbranch_scc1 L_exit
    s_branch L_atp_97
L_ath_98:
    s_lshl_b32 s36, s39, 5
    s_add_u32 s36, s36, s40
    s_lshl_b32 s36, s36, 13
    s_add_u32 s37, s36, 0x4001000
    buffer_load_dwordx4 a[0:3], v3, s[4:7], s37 offen offset:0 sc1
    buffer_load_dwordx4 a[4:7], v3, s[4:7], s37 offen offset:1024 sc1
    buffer_load_dwordx4 a[8:11], v3, s[4:7], s37 offen offset:2048 sc1
    buffer_load_dwordx4 a[12:15], v3, s[4:7], s37 offen offset:3072 sc1
    s_add_u32 s37, s36, 0x2000000
    s_add_u32 s38, s37, 4096
    buffer_load_dwordx4 a[16:19], v3, s[4:7], s37 offen offset:0 sc1
    buffer_load_dwordx4 a[20:23], v3, s[4:7], s37 offen offset:1024 sc1
    buffer_load_dwordx4 a[24:27], v3, s[4:7], s37 offen offset:2048 sc1
    buffer_load_dwordx4 a[28:31], v3, s[4:7], s37 offen offset:3072 sc1
    buffer_load_dwordx4 a[32:35], v3, s[4:7], s38 offen offset:0 sc1
    buffer_load_dwordx4 a[36:39], v3, s[4:7], s38 offen offset:1024 sc1
    buffer_load_dwordx4 a[40:43], v3, s[4:7], s38 offen offset:2048 sc1
    buffer_load_dwordx4 a[44:47], v3, s[4:7], s38 offen offset:3072 sc1
    s_add_u32 s37, s36, 0x3000000
    s_add_u32 s38, s37, 4096
    buffer_load_dwordx4 a[48:51], v3, s[4:7], s37 offen offset:0 sc1
    buffer_load_dwordx4 a[52:55], v3, s[4:7], s37 offen offset:1024 sc1
    buffer_load_dwordx4 a[56:59], v3, s[4:7], s37 offen offset:2048 sc1
    buffer_load_dwordx4 a[60:63], v3, s[4:7], s37 offen offset:3072 sc1
    buffer_load_dwordx4 a[64:67], v3, s[4:7], s38 offen offset:0 sc1
    buffer_load_dwordx4 a[68:71], v3, s[4:7], s38 offen offset:1024 sc1
    buffer_load_dwordx4 a[72:75], v3, s[4:7], s38 offen offset:2048 sc1
    buffer_load_dwordx4 a[76:79], v3, s[4:7], s38 offen offset:3072 sc1
    s_waitcnt vmcnt(20)
    s_branch L_atr_96
L_atq_95:
    s_waitcnt vmcnt(0)
L_atr_96:
    v_mov_b32 v10, s35
    s_mov_b64 exec, 1
    buffer_store_dword v10, v8, s[4:7], s58 offen sc1
    s_mov_b64 exec, -1
    s_min_u32 s59, s41, 61
    s_cmp_gt_u32 s44, s59
    s_cbranch_scc1 L_atn_100
L_atm_99:
    buffer_load_dword v10, v8, s[4:7], s42 offen offset:32 sc1
    s_waitcnt vmcnt(0)
    v_readfirstlane_b32 s44, v10
    s_cmp_gt_u32 s44, s59
    s_cbranch_scc1 L_atn_100
    s_cmp_eq_u32 s44, s59
    s_cbranch_scc1 L_atm_99_n
    s_sleep 16
L_atm_99_n:
    s_sleep 2
    s_add_u32 s100, s100, 1
    s_bitcmp1_b32 s100, 15
    s_cbranch_scc1 L_exit
    s_branch L_atm_99
L_atn_100:
    s_cmp_lg_u32 s41, 63
    s_cbranch_scc1 L_ats_101
    s_sleep 48
L_ats_101:
    s_mov_b32 s100, 0
    s_lshl_b32 s36, s41, 5
    s_add_u32 s36, s36, s40
    s_lshl_b32 s36, s36, 12
    s_add_u32 s36, s36, 0x1000000
    buffer_load_dwordx4 v[64:67], v3, s[4:7], s36 offen offset:0 sc1
    buffer_load_dwordx4 v[68:71], v3, s[4:7], s36 offen offset:1024 sc1
    buffer_load_dwordx4 v[72:75], v3, s[4:7], s36 offen offset:2048 sc1
    buffer_load_dwordx4 v[76:79], v3, s[4:7], s36 offen offset:3072 sc1
    v_cndmask_b32 v20, v9, v20, s[50:51]
    v_cndmask_b32 v21, v9, v21, s[52:53]
    v_cndmask_b32 v22, v9, v22, s[54:55]
    v_cndmask_b32 v23, v9, v23, s[56:57]
    v_max_f32 v36, v16, v17
    v_max3_f32 v36, v36, v18, v19
    v_max3_f32 v36, v36, v20, v21
    v_max3_f32 v36, v36, v22, v23
    v_mov_b32 v37, v36
    s_nop 1
    v_permlane32_swap_b32 v36, v37
    v_max_f32 v36, v36, v37
    s_lshl_b32 s45, s41, 6
    s_add_u32 s45, s45, s40
    s_lshl_b32 s45, s45, 12
    s_add_u32 s45, s45, 0x5020000
    s_cmp_lt_u32 s41, 62
    s_cbranch_scc1 L_atd_103
L_atk_102:
    s_waitcnt vmcnt(0)
    v_max3_u32 v10, v64, v68, v72
    v_max_u32 v10, v10, v76
    v_cmp_eq_u32 vcc, -1, v10
    s_cbranch_vccz L_atd_103
    s_sleep 1
    s_add_u32 s100, s100, 1
    s_bitcmp1_b32 s100, 15
    s_cbranch_scc1 L_exit
    buffer_load_dwordx4 v[64:67], v3, s[4:7], s36 offen offset:0 sc1
    buffer_load_dwordx4 v[68:71], v3, s[4:7], s36 offen offset:1024 sc1
    buffer_load_dwordx4 v[72:75], v3, s[4:7], s36 offen offset:2048 sc1
    buffer_load_dwordx4 v[76:79], v3, s[4:7], s36 offen offset:3072 sc1
    s_branch L_atk_102
L_atd_103:
    s_waitcnt vmcnt(3)
    ds_write_b64 v4, v[64:65] offset:0
    s_waitcnt vmcnt(2)
    ds_write_b64 v4, v[68:69] offset:512
    s_waitcnt vmcnt(1)
    ds_write_b64 v4, v[72:73] offset:1024
    s_waitcnt vmcnt(0)
    ds_write_b64 v4, v[76:77] offset:1536
    s_waitcnt lgkmcnt(0)
    ds_read_b64_tr_b16 v[80:81], v5 offset:0
    ds_read_b64_tr_b16 v[82:83], v5 offset:256
    ds_read_b64_tr_b16 v[84:85], v5 offset:512
    ds_read_b64_tr_b16 v[86:87], v5 offset:768
    ds_read_b64_tr_b16 v[88:89], v5 offset:1024
    ds_read_b64_tr_b16 v[90:91], v5 offset:1280
    ds_read_b64_tr_b16 v[92:93], v5 offset:1536
    ds_read_b64_tr_b16 v[94:95], v5 offset:1792
    s_waitcnt lgkmcnt(6)
    v_mfma_f32_16x16x32_bf16 v[28:31], v[80:83], a[128:131], 0
    s_waitcnt lgkmcnt(4)
    v_mfma_f32_16x16x32_bf16 v[28:31], v[84:87], a[132:135], v[28:31]
    s_waitcnt lgkmcnt(2)
    v_mfma_f32_16x16x32_bf16 v[28:31], v[88:91], a[136:139], v[28:31]
    s_waitcnt lgkmcnt(0)
    v_mfma_f32_16x16x32_bf16 v[28:31], v[92:95], a[140:143], v[28:31]
    s_nop 7
    v_max3_f32 v36, v36, v28, v29
    v_max3_f32 v36, v36, v30, v31
    v_mov_b32 v37, v36
    v_cndmask_b32 v28, v28, v30, s[48:49]
    v_cndmask_b32 v29, v29, v31, s[48:49]
    v_permlane16_swap_b32 v36, v37
    v_max_f32 v36, v36, v37
    v_mul_f32 v36, s46, v36
    v_pk_fma_f32 v[16:17], v[16:17], s[46:47], v[36:37] op_sel_hi:[1,1,0] neg_lo:[0,0,1] neg_hi:[0,0,1]
    v_pk_fma_f32 v[18:19], v[18:19], s[46:47], v[36:37] op_sel_hi:[1,1,0] neg_lo:[0,0,1] neg_hi:[0,0,1]
    v_pk_fma_f32 v[20:21], v[20:21], s[46:47], v[36:37] op_sel_hi:[1,1,0] neg_lo:[0,0,1] neg_hi:[0,0,1]
    v_pk_fma_f32 v[22:23], v[22:23], s[46:47], v[36:37] op_sel_hi:[1,1,0] neg_lo:[0,0,1] neg_hi:[0,0,1]
    v_pk_fma_f32 v[28:29], v[28:29], s[46:47], v[36:37] op_sel_hi:[1,1,0] neg_lo:[0,0,1] neg_hi:[0,0,1]
    v_exp_f32 v16, v16
    v_exp_f32 v17, v17
    v_exp_f32 v18, v18
    v_exp_f32 v19, v19
    v_exp_f32 v20, v20
    v_exp_f32 v21, v21
    v_exp_f32 v22, v22
    v_exp_f32 v23, v23
    v_exp_f32 v28, v28
    v_exp_f32 v29, v29
    v_cvt_pk_bf16_f32 v40, v16, v17
    v_cvt_pk_bf16_f32 v41, v18, v19
    v_cvt_pk_bf16_f32 v42, v20, v21
    v_cvt_pk_bf16_f32 v43, v22, v23
    v_cvt_pk_bf16_f32 v60, v28, v29
    v_cvt_pk_bf16_f32 v63, v28, v29
    v_mfma_f32_16x16x32_bf16 v[44:47], v[56:59], v[40:43], 0
    v_mfma_f32_16x16x32_bf16 v[96:99], a[176:179], v[40:43], 0
    v_mfma_f32_16x16x32_bf16 v[100:103], a[180:183], v[40:43], 0
    v_mfma_f32_16x16x32_bf16 v[104:107], a[184:187], v[40:43], 0
    v_mfma_f32_16x16x32_bf16 v[108:111], a[188:191], v[40:43], 0
    v_mfma_f32_16x16x32_bf16 v[112:115], a[192:195], v[40:43], 0
    v_mfma_f32_16x16x32_bf16 v[116:119], a[196:199], v[40:43], 0
    v_mfma_f32_16x16x32_bf16 v[120:123], a[200:203], v[40:43], 0
    v_mfma_f32_16x16x32_bf16 v[124:127], a[204:207], v[40:43], 0
    v_mfma_f32_16x16x16_bf16 v[44:47], v[56:57], v[60:61], v[44:47]
    v_mfma_f32_16x16x16_bf16 v[96:99], v[66:67], v[60:61], v[96:99]
    v_mfma_f32_16x16x16_bf16 v[100:103], v[66:67], v[62:63], v[100:103]
    v_mfma_f32_16x16x16_bf16 v[104:107], v[70:71], v[60:61], v[104:107]
    v_mfma_f32_16x16x16_bf16 v[108:111], v[70:71], v[62:63], v[108:111]
    v_mfma_f32_16x16x16_bf16 v[112:115], v[74:75], v[60:61], v[112:115]
    v_mfma_f32_16x16x16_bf16 v[116:119], v[74:75], v[62:63], v[116:119]
    v_mfma_f32_16x16x16_bf16 v[120:123], v[78:79], v[60:61], v[120:123]
    v_mfma_f32_16x16x16_bf16 v[124:127], v[78:79], v[62:63], v[124:127]
    v_rcp_f32 v44, v44
    s_nop 0
    v_pk_mul_f32 v[96:97], v[96:97], v[44:45] op_sel_hi:[1,0]
    v_pk_mul_f32 v[98:99], v[98:99], v[44:45] op_sel_hi:[1,0]
    v_pk_mul_f32 v[100:101], v[100:101], v[44:45] op_sel_hi:[1,0]
    v_pk_mul_f32 v[102:103], v[102:103], v[44:45] op_sel_hi:[1,0]
    v_cvt_pk_bf16_f32 v128, v96, v97
    v_cvt_pk_bf16_f32 v129, v98, v99
    v_cvt_pk_bf16_f32 v130, v100, v101
    v_cvt_pk_bf16_f32 v131, v102, v103
    v_min_u32 v128, -2, v128
    buffer_store_dwordx4 v[128:131], v3, s[4:7], s45 offen offset:0 sc1
    v_pk_mul_f32 v[104:105], v[104:105], v[44:45] op_sel_hi:[1,0]
    v_pk_mul_f32 v[106:107], v[106:107], v[44:45] op_sel_hi:[1,0]
    v_pk_mul_f32 v[108:109], v[108:109], v[44:45] op_sel_hi:[1,0]
    v_pk_mul_f32 v[110:111], v[110:111], v[44:45] op_sel_hi:[1,0]
    v_cvt_pk_bf16_f32 v132, v104, v105
    v_cvt_pk_bf16_f32 v133, v106, v107
    v_cvt_pk_bf16_f32 v134, v108, v109
    v_cvt_pk_bf16_f32 v135, v110, v111
    v_min_u32 v132, -2, v132
    buffer_store_dwordx4 v[132:135], v3, s[4:7], s45 offen offset:1024 sc1
    v_pk_mul_f32 v[112:113], v[112:113], v[44:45] op_sel_hi:[1,0]
    v_pk_mul_f32 v[114:115], v[114:115], v[44:45] op_sel_hi:[1,0]
    v_pk_mul_f32 v[116:117], v[116:117], v[44:45] op_sel_hi:[1,0]
    v_pk_mul_f32 v[118:119], v[118:119], v[44:45] op_sel_hi:[1,0]
    v_cvt_pk_bf16_f32 v136, v112, v113
    v_cvt_pk_bf16_f32 v137, v114, v115
    v_cvt_pk_bf16_f32 v138, v116, v117
    v_cvt_pk_bf16_f32 v139, v118, v119
    v_min_u32 v136, -2, v136
    buffer_store_dwordx4 v[136:139], v3, s[4:7], s45 offen offset:2048 sc1
    v_pk_mul_f32 v[120:121], v[120:121], v[44:45] op_sel_hi:[1,0]
    v_pk_mul_f32 v[122:123], v[122:123], v[44:45] op_sel_hi:[1,0]
    v_pk_mul_f32 v[124:125], v[124:125], v[44:45] op_sel_hi:[1,0]
    v_pk_mul_f32 v[126:127], v[126:127], v[44:45] op_sel_hi:[1,0]
    v_cvt_pk_bf16_f32 v140, v120, v121
    v_cvt_pk_bf16_f32 v141, v122, v123
    v_cvt_pk_bf16_f32 v142, v124, v125
    v_cvt_pk_bf16_f32 v143, v126, v127
    v_min_u32 v140, -2, v140
    buffer_store_dwordx4 v[140:143], v3, s[4:7], s45 offen offset:3072 sc1
    s_add_u32 s35, s41, 1
    s_mov_b32 s41, s39
    s_cmp_lt_u32 s41, 64
    s_cbranch_scc1 L_at_1
    s_waitcnt vmcnt(0)
    v_mov_b32 v10, s35
    s_mov_b64 exec, 1
    buffer_store_dword v10, v8, s[4:7], s58 offen sc1
    s_mov_b64 exec, -1
    s_waitcnt vmcnt(0)
    s_endpgm
.section .rodata,"a"
.p2align 6
.amdhsa_kernel parallel_sum__memory_aug_recurrent_mem_tr__mixer_token_mlp__prompt_kernel
  .amdhsa_next_free_vgpr 512
  .amdhsa_next_free_sgpr 102
  .amdhsa_accum_offset 256
  .amdhsa_group_segment_fixed_size 0
  .amdhsa_kernarg_size 120
  .amdhsa_user_sgpr_count 2
  .amdhsa_user_sgpr_kernarg_segment_ptr 1
  .amdhsa_system_sgpr_workgroup_id_x 1
  .amdhsa_float_denorm_mode_32 3
.end_amdhsa_kernel
```
